```python
import torch

def _softmax(x, axis=-1):
    return torch.softmax(x, dim=axis)
def _gelu(x):
    return torch.nn.functional.gelu(x, approximate="tanh")
def _silu(x):
    return torch.nn.functional.silu(x)
def _sigmoid(x):
    return torch.sigmoid(x)
def _layernorm(x, axis=-1, eps=1e-5):
    m = x.mean(dim=axis, keepdim=True)
    v = x.var(dim=axis, keepdim=True, unbiased=False)
    return (x - m) / torch.sqrt(v + eps)
def _scatter_add(tgt, idx, src, axis=0):
    return tgt.clone().index_add_(axis, idx, src)
def _segment_sum(src, seg, n):
    out = torch.zeros((n,) + src.shape[1:], dtype=src.dtype)
    return out.index_add_(0, seg, src)
def _pad(x, pw):
    flat = tuple(v for pair in reversed(pw) for v in pair)
    return torch.nn.functional.pad(x, flat)

kernel_name = 'concat_heads__mha_block_cached__gqa_block_cached__near_ridge'

def setup_inputs():

    _w = (lambda a: (lambda t: t.to(torch.bfloat16) if t.is_floating_point() else t)(torch.as_tensor(a)))
    def _A_setup():
        B, Sq, D = 8, 144, 512
        H, Sk, Dh = 32, 1024, 128
        return {
            "x": _w((lambda *s: torch.randn(*s, dtype=torch.bfloat16) * 0.8)(B, Sq, D)),
            "k_cache": _w((lambda *s: torch.randn(*s, dtype=torch.bfloat16) * 0.8)(B, H, Sk, Dh)),
            "v_cache": _w((lambda *s: torch.randn(*s, dtype=torch.bfloat16) * 0.05)(B, H, Sk, Dh)),
            "wq": _w((lambda *s: torch.randn(*s, dtype=torch.bfloat16) * 0.8)(D, H * Dh) * (D ** -0.5)),
            "wo": _w((lambda *s: torch.randn(*s, dtype=torch.bfloat16) * 0.05)(H * Dh, D) * ((H * Dh) ** -0.5)),
        }
    _A_in = _A_setup()

    def _B_setup():
        B, Sq, D = 8, 144, 512
        Hq, Hkv, Sk, Dh = 32, 32, 1024, 128
        assert Hq % Hkv == 0, (Hq, Hkv)
        return {
            "x": _w((lambda *s: torch.randn(*s, dtype=torch.bfloat16) * 0.8)(B, Sq, D)),
            "k_cache": _w((lambda *s: torch.randn(*s, dtype=torch.bfloat16) * 0.8)(B, Hkv, Sk, Dh)),
            "v_cache": _w((lambda *s: torch.randn(*s, dtype=torch.bfloat16) * 0.05)(B, Hkv, Sk, Dh)),
            "wq": _w((lambda *s: torch.randn(*s, dtype=torch.bfloat16) * 0.8)(D, Hq * Dh) * (D ** -0.5)),
            "wo": _w((lambda *s: torch.randn(*s, dtype=torch.bfloat16) * 0.05)(Hq * Dh, D) * ((Hq * Dh) ** -0.5)),
        }
    _B_in = _B_setup()

    return {
        "A_x": _A_in["x"],
        "A_k_cache": _A_in["k_cache"],
        "A_v_cache": _A_in["v_cache"],
        "A_wq": _A_in["wq"],
        "A_wo": _A_in["wo"],
        "B_x": _B_in["x"],
        "B_k_cache": _B_in["k_cache"],
        "B_v_cache": _B_in["v_cache"],
        "B_wq": _B_in["wq"],
        "B_wo": _B_in["wo"],
    }

def reference(A_x, A_k_cache, A_v_cache, A_wq, A_wo, B_x, B_k_cache, B_v_cache, B_wq, B_wo):
    def _A_ref(x, k_cache, v_cache, wq, wo):
        B, Sq, D = x.shape
        H, Dh = 32, 128
        q = (lambda x, *d: x.permute(*d))((x @ wq).reshape(B, Sq, H, Dh), 0, 2, 1, 3)
        scores = torch.einsum("bhqd,bhkd->bhqk", q, k_cache) * (Dh ** -0.5)
        p = _softmax(scores, axis=-1)
        o = torch.einsum("bhqk,bhkd->bhqd", p, v_cache)
        return (lambda x, *d: x.permute(*d))(o, 0, 2, 1, 3).reshape(B, Sq, H * Dh) @ wo

    def _B_ref(x, k_cache, v_cache, wq, wo):
        B, Sq, D = x.shape
        Hq, Dh = 32, 128
        Hkv = k_cache.shape[1]
        rep = Hq // Hkv
        q = (lambda x, *d: x.permute(*d))((x @ wq).reshape(B, Sq, Hq, Dh), 0, 2, 1, 3)
        k = (lambda x, n, axis: torch.repeat_interleave(x, n, dim=axis))(k_cache, rep, axis=1)
        v = (lambda x, n, axis: torch.repeat_interleave(x, n, dim=axis))(v_cache, rep, axis=1)
        scores = torch.einsum("bhqd,bhkd->bhqk", q, k) * (Dh ** -0.5)
        p = _softmax(scores, axis=-1)
        o = torch.einsum("bhqk,bhkd->bhqd", p, v)
        return (lambda x, *d: x.permute(*d))(o, 0, 2, 1, 3).reshape(B, Sq, Hq * Dh) @ wo

    a = _A_ref(A_x, A_k_cache, A_v_cache, A_wq, A_wo)
    b = _B_ref(B_x, B_k_cache, B_v_cache, B_wq, B_wo)
    return torch.concatenate([a, b], axis=-1)
```

```asm
; @launch grid=(256,1,1) block=(256,1,1) lds=163840
.amdgcn_target "amdgcn-amd-amdhsa--gfx950"
.text
.globl concat_heads__mha_block_cached__gqa_block_cached__near_ridge_kernel
.p2align 8
.type concat_heads__mha_block_cached__gqa_block_cached__near_ridge_kernel,@function
concat_heads__mha_block_cached__gqa_block_cached__near_ridge_kernel:
    s_cmp_ge_u32 s2, 256
    s_cbranch_scc1 L_done
    s_load_dwordx16 s[76:91], s[0:1], 0
    s_load_dwordx8 s[92:99], s[0:1], 64
    s_load_dwordx2 s[100:101], s[0:1], 96
    s_memrealtime s[72:73]
    v_lshrrev_b32 v3, 6, v0
    v_and_b32 v1, 63, v0
    v_readfirstlane_b32 s36, v3
    s_and_b32 s37, s2, 7
    s_lshr_b32 s38, s2, 3
    s_lshr_b32 s42, s38, 2
    s_and_b32 s43, s38, 3
    s_and_b32 s44, s37, 3
    s_lshr_b32 s45, s37, 2
    v_lshlrev_b32 v2, 4, v1
    v_lshrrev_b32 v4, 4, v1
    v_lshrrev_b32 v3, 3, v1
    s_lshl_b32 s39, s43, 1
    s_add_u32 s39, s39, s42
    s_and_b32 s39, s39, 4
    s_lshl_b32 s50, s39, 7
    s_lshl_b32 s51, s39, 19
    s_mul_i32 s39, s36, 9
    s_lshr_b32 s39, s39, 1
    s_lshl_b32 s61, s39, 10
    s_add_u32 s52, s61, 65536
    s_mul_i32 s40, s42, 147456
    s_lshl_b32 s41, s39, 13
    s_add_u32 s40, s40, s41
    s_and_b32 s39, s39, 1
    s_lshl_b32 s39, s39, 6
    v_and_b32 v5, 7, v1
    v_xor_b32 v5, v5, v4
    v_lshlrev_b32 v5, 4, v5
    v_lshl_add_u32 v5, v3, 10, v5
    v_xor_b32 v5, s39, v5
    v_add_u32 v56, s40, v5
    v_xor_b32 v5, 64, v56
    v_add_u32 v57, 7168, v5
    v_add_u32 v58, 14336, v56
    v_add_u32 v59, 24576, v5
    v_add_u32 v60, 31744, v56
    s_lshl_b32 s40, s44, 11
    s_lshl_b32 s41, s43, 9
    s_add_u32 s40, s40, s41
    s_lshl_b32 s41, s36, 7
    s_add_u32 s40, s40, s41
    v_and_b32 v5, 1, v4
    v_lshlrev_b32 v5, 2, v5
    v_and_b32 v61, 7, v1
    v_xor_b32 v5, v61, v5
    v_lshlrev_b32 v5, 4, v5
    v_lshl_add_u32 v5, v3, 13, v5
    v_add_u32 v61, s40, v5
    v_add_u32 v62, 64512, v61
    v_add_u32 v63, 129024, v61
    v_add_u32 v64, 193536, v61
    s_lshl_b32 s66, s36, 12
    s_add_u32 s53, s66, 102400
    s_waitcnt lgkmcnt(0)
    s_cmp_lg_u32 s45, 0
    s_cselect_b32 s4, s86, s76
    s_cselect_b32 s5, s87, s77
    s_mov_b32 s6, 0x120000
    s_mov_b32 s7, 0x20000
    s_cselect_b32 s8, s92, s82
    s_cselect_b32 s9, s93, s83
    s_mov_b32 s10, 0x400000
    s_mov_b32 s11, 0x20000
    s_cselect_b32 s12, s88, s78
    s_cselect_b32 s13, s89, s79
    s_mov_b32 s14, 0x4000000
    s_mov_b32 s15, 0x20000
    s_cselect_b32 s16, s90, s80
    s_cselect_b32 s17, s91, s81
    s_mov_b32 s18, 0x4000000
    s_mov_b32 s19, 0x20000
    s_cselect_b32 s24, s94, s84
    s_cselect_b32 s25, s95, s85
    s_mov_b32 s26, 0x400000
    s_mov_b32 s27, 0x20000
    s_mov_b32 s32, s98
    s_mov_b32 s33, s99
    s_mov_b32 s34, 0x100
    s_mov_b32 s35, 0x20000
    s_cmp_lg_u32 s36, 3
    s_cbranch_scc1 1f
    s_or_b32 s72, s72, 1
    s_lshl_b32 s39, s45, 3
    s_add_u32 s39, s39, s42
    s_lshl_b32 s39, s39, 4
    v_mov_b32 v108, s72
    v_mov_b32 v109, 0
    v_mov_b32 v110, 0
    s_mov_b64 exec, 1
    buffer_atomic_cmpswap v[108:109], v110, s[32:35], s39 offen sc0 sc1
    s_mov_b64 exec, -1
1:
    s_add_u32 m0, s53, 0
    s_nop 0
    buffer_load_dwordx4 v61, s[8:11], s51 offen lds
    buffer_load_dwordx4 v62, s[8:11], s51 offen offset:1024 lds
    buffer_load_dwordx4 v63, s[8:11], s51 offen offset:2048 lds
    buffer_load_dwordx4 v64, s[8:11], s51 offen offset:3072 lds
    s_add_u32 s51, s51, 262144
    s_and_b32 s51, s51, 0x3fffff
    s_add_u32 m0, s52, 0
    s_nop 0
    buffer_load_dwordx4 v56, s[4:7], s50 offen lds
    buffer_load_dwordx4 v57, s[4:7], s50 offen offset:1024 lds
    buffer_load_dwordx4 v58, s[4:7], s50 offen offset:2048 lds
    s_add_u32 m0, s52, 3072
    s_nop 0
    buffer_load_dwordx4 v59, s[4:7], s50 offen lds
    buffer_load_dwordx4 v60, s[4:7], s50 offen offset:1024 lds
    s_add_u32 s50, s50, 128
    s_and_b32 s50, s50, 1023
    s_mov_b32 s20, s100
    s_mov_b32 s21, s101
    s_mov_b32 s22, 0x1b15000
    s_mov_b32 s23, 0x20000
    s_mov_b32 s28, s96
    s_mov_b32 s29, s97
    s_mov_b32 s30, 0x240000
    s_mov_b32 s31, 0x20000
    s_lshl_b32 s39, s44, 3
    s_lshl_b32 s40, s43, 1
    s_add_u32 s39, s39, s40
    s_lshl_b32 s69, s42, 5
    s_add_u32 s69, s69, s39
    s_lshl_b32 s69, s69, 18
    s_lshl_b32 s40, s45, 3
    s_add_u32 s40, s40, s42
    s_lshl_b32 s41, s40, 5
    s_add_u32 s41, s41, s39
    s_mul_i32 s58, s41, 36864
    s_add_u32 s58, s58, s66
    s_and_b32 s3, s3, 0
    s_lshl_b32 s41, s3, 18
    s_add_u32 s69, s69, s41
    s_mul_i32 s41, s3, 36864
    s_add_u32 s78, s58, 36864
    s_sub_u32 s78, s78, s41
    s_add_u32 s58, s58, s41
    s_lshl_b32 s3, s3, 1
    s_lshl_b32 s41, s40, 2
    s_add_u32 s63, s41, s44
    s_add_u32 s64, s41, s43
    s_mul_i32 s59, s63, 294912
    s_mul_i32 s62, s64, 147456
    s_add_u32 s62, s62, 18874368
    s_lshl_b32 s84, s63, 8
    s_add_u32 s84, s84, 28311552
    s_lshl_b32 s85, s64, 10
    s_add_u32 s85, s85, 28327936
    s_mul_i32 s39, s36, 9216
    s_add_u32 s62, s62, s39
    s_lshl_b32 s39, s36, 8
    s_add_u32 s85, s85, s39
    s_lshl_b32 s86, s40, 8
    s_add_u32 s86, s86, 28393472
    s_lshl_b32 s88, s44, 2
    s_add_u32 s88, s88, s43
    s_lshl_b32 s88, s88, 3
    s_mov_b32 s87, 0
    s_lshl_b32 s60, s44, 20
    s_lshl_b32 s39, s43, 8
    s_add_u32 s60, s60, s39
    s_lshl_b32 s39, s36, 14
    s_add_u32 s79, s60, s39
    s_add_u32 s80, s59, s61
    s_getpc_b64 s[82:83]
L_pc:
    s_mul_i32 s57, s2, 0x9e3779b1
    s_mov_b32 s89, 8192
    s_lshr_b32 s57, s57, 27
    s_lshl_b32 s57, s57, 13
    s_mov_b32 s55, 0
    s_mov_b32 s68, 0
    s_mov_b32 s56, 0x3e0293ee
    v_and_b32 v3, 15, v1
    v_lshrrev_b32 v4, 4, v1
    v_xor_b32 v5, v3, v4
    v_lshlrev_b32 v5, 4, v5
    v_lshl_add_u32 v18, v4, 8, v5
    v_xor_b32 v19, 64, v18
    v_xor_b32 v20, 128, v18
    v_xor_b32 v21, 192, v18
    v_lshlrev_b32 v5, 1, v4
    v_xor_b32 v5, v3, v5
    v_lshlrev_b32 v5, 4, v5
    v_lshl_add_u32 v22, v4, 8, v5
    v_xor_b32 v23, 128, v22
    v_lshlrev_b32 v5, 2, v4
    v_xor_b32 v5, v3, v5
    v_lshlrev_b32 v5, 4, v5
    v_lshl_add_u32 v24, v4, 10, v5
    v_add_u32 v25, 3072, v24
    v_add_u32 v26, 6144, v24
    v_add_u32 v27, 9216, v24
    v_and_b32 v3, 15, v1
    v_lshrrev_b32 v4, 4, v1
    v_xor_b32 v5, v3, v4
    v_lshlrev_b32 v5, 4, v5
    v_lshl_add_u32 v6, v3, 8, v5
    v_xor_b32 v7, 64, v6
    v_xor_b32 v8, 128, v6
    v_xor_b32 v9, 192, v6
    v_lshlrev_b32 v96, 4, v4
    v_lshrrev_b32 v3, 2, v1
    v_and_b32 v5, 7, v3
    v_lshlrev_b32 v5, 5, v5
    v_lshl_add_u32 v5, v3, 8, v5
    v_and_b32 v3, 3, v1
    v_lshl_add_u32 v5, v3, 3, v5
    v_add_u32 v10, 8192, v5
    v_xor_b32 v11, 32, v10
    v_xor_b32 v12, 64, v10
    v_xor_b32 v13, 96, v10
    v_xor_b32 v14, 128, v10
    v_xor_b32 v15, 160, v10
    v_xor_b32 v16, 192, v10
    v_xor_b32 v17, 224, v10
    v_and_b32 v3, 15, v1
    v_lshrrev_b32 v5, 1, v3
    v_xor_b32 v5, v5, v4
    v_lshlrev_b32 v5, 4, v5
    v_lshl_add_u32 v5, v3, 7, v5
    v_add_u32 v28, 65536, v5
    v_xor_b32 v29, 64, v28
    v_lshlrev_b32 v103, 11, v3
    v_lshl_add_u32 v103, v4, 4, v103
    v_lshrrev_b32 v3, 2, v1
    v_and_b32 v3, 3, v3
    v_lshl_add_u32 v5, v4, 3, v3
    v_lshlrev_b32 v5, 7, v5
    v_lshrrev_b32 v31, 1, v3
    v_lshl_add_u32 v5, v31, 6, v5
    v_and_b32 v31, 3, v1
    v_lshl_add_u32 v5, v31, 4, v5
    v_add_u32 v30, s53, v5
    v_xor_b32 v31, 64, v30
    v_xor_b32 v3, s36, v3
    v_lshlrev_b32 v3, 6, v3
    v_and_b32 v5, 3, v1
    v_lshl_add_u32 v3, v5, 4, v3
    v_lshrrev_b32 v5, 2, v1
    v_lshl_add_u32 v100, v5, 8, v3
    v_add_u32 v99, 69632, v100
    v_add_u32 v102, 32768, v2
    v_add_u32 v101, 86016, v2
    s_lshr_b32 s40, s36, 1
    s_mul_i32 s40, s40, 36864
    s_and_b32 s41, s36, 1
    s_lshl_b32 s41, s41, 11
    s_add_u32 s41, s41, s40
    s_add_u32 s41, s41, 65536
    v_add_u32 v98, s41, v2
    s_lshl_b32 s41, s36, 13
    s_add_u32 s41, s41, 65536
    v_add_u32 v97, s41, v2
    s_lshl_b32 s41, s36, 2
    s_add_u32 s41, s41, 163776
    v_mov_b32 v104, s41
    s_and_b32 s39, s36, 1
    s_lshl_b32 s39, s39, 7
    v_xor_b32 v32, s39, v18
    v_xor_b32 v33, s39, v19
    s_lshl_b32 s49, s36, 11
    s_add_u32 s46, s69, s49
    s_mov_b32 s47, s57
    s_cmp_lg_u32 s36, 2
    s_cbranch_scc1 1f
    s_lshl_b32 s39, s38, 12
    v_lshlrev_b32 v109, 6, v1
    v_add_u32 v109, s39, v109
    v_min_u32 v109, L_end-L_pc-4, v109
    v_add_co_u32 v110, vcc, s82, v109
    v_mov_b32 v111, s83
    s_nop 0
    v_addc_co_u32 v111, vcc, 0, v111, vcc
    global_load_dword v107, v[110:111], off
1:
    s_add_u32 m0, s53, 16384
    s_nop 0
    buffer_load_dwordx4 v61, s[8:11], s51 offen lds
    buffer_load_dwordx4 v62, s[8:11], s51 offen offset:1024 lds
    buffer_load_dwordx4 v63, s[8:11], s51 offen offset:2048 lds
    buffer_load_dwordx4 v64, s[8:11], s51 offen offset:3072 lds
    s_add_u32 s51, s51, 262144
    s_and_b32 s51, s51, 0x3fffff
    s_add_u32 m0, s52, 18432
    s_nop 0
    buffer_load_dwordx4 v56, s[4:7], s50 offen lds
    buffer_load_dwordx4 v57, s[4:7], s50 offen offset:1024 lds
    buffer_load_dwordx4 v58, s[4:7], s50 offen offset:2048 lds
    s_add_u32 m0, s52, 21504
    s_nop 0
    buffer_load_dwordx4 v59, s[4:7], s50 offen lds
    buffer_load_dwordx4 v60, s[4:7], s50 offen offset:1024 lds
    s_add_u32 s50, s50, 128
    s_and_b32 s50, s50, 1023
    s_add_u32 m0, s53, 32768
    s_nop 0
    buffer_load_dwordx4 v61, s[8:11], s51 offen lds
    buffer_load_dwordx4 v62, s[8:11], s51 offen offset:1024 lds
    buffer_load_dwordx4 v63, s[8:11], s51 offen offset:2048 lds
    buffer_load_dwordx4 v64, s[8:11], s51 offen offset:3072 lds
    s_add_u32 s51, s51, 262144
    s_and_b32 s51, s51, 0x3fffff
    s_waitcnt vmcnt(13)
    s_barrier
    ds_read_b64_tr_b16 a[108:109], v30
    ds_read_b64_tr_b16 a[110:111], v30 offset:512
    ds_read_b64_tr_b16 a[112:113], v30 offset:8
    ds_read_b64_tr_b16 a[114:115], v30 offset:520
    ds_read_b64_tr_b16 a[116:117], v31
    ds_read_b64_tr_b16 a[118:119], v31 offset:512
    ds_read_b64_tr_b16 a[120:121], v31 offset:8
    ds_read_b64_tr_b16 a[122:123], v31 offset:520
    ds_read_b128 a[0:3], v28
    ds_read_b128 a[4:7], v28 offset:2048
    ds_read_b128 a[8:11], v28 offset:4096
    ds_read_b128 a[12:15], v28 offset:6144
    ds_read_b128 a[16:19], v28 offset:8192
    ds_read_b128 a[20:23], v28 offset:10240
    ds_read_b128 a[24:27], v28 offset:12288
    ds_read_b128 a[28:31], v28 offset:14336
    ds_read_b128 a[32:35], v28 offset:16384
    ds_read_b128 a[36:39], v29
    ds_read_b128 a[40:43], v29 offset:2048
    ds_read_b128 a[44:47], v29 offset:4096
    ds_read_b128 a[48:51], v29 offset:6144
    ds_read_b128 a[52:55], v29 offset:8192
    ds_read_b128 a[56:59], v29 offset:10240
    ds_read_b128 a[60:63], v29 offset:12288
    ds_read_b128 a[64:67], v29 offset:14336
    ds_read_b128 a[68:71], v29 offset:16384
    v_mov_b32 v34, s56
    v_mov_b32 v35, s56
    s_waitcnt vmcnt(9)
    s_waitcnt lgkmcnt(0)
    v_mfma_f32_16x16x32_bf16 v[112:115], a[108:111], a[0:3], 0
    ds_read_b64_tr_b16 a[124:125], v30 offset:16384
    s_add_u32 m0, s53, 0
    v_mfma_f32_16x16x32_bf16 v[116:119], a[112:115], a[0:3], 0
    ds_read_b64_tr_b16 a[126:127], v30 offset:16896
    v_mfma_f32_16x16x32_bf16 v[120:123], a[116:119], a[0:3], 0
    ds_read_b64_tr_b16 a[128:129], v30 offset:16392
    v_mfma_f32_16x16x32_bf16 v[124:127], a[120:123], a[0:3], 0
    ds_read_b64_tr_b16 a[130:131], v30 offset:16904
    v_mfma_f32_16x16x32_bf16 v[128:131], a[108:111], a[4:7], 0
    ds_read_b64_tr_b16 a[132:133], v31 offset:16384
    v_mfma_f32_16x16x32_bf16 v[132:135], a[112:115], a[4:7], 0
    ds_read_b64_tr_b16 a[134:135], v31 offset:16896
    v_mfma_f32_16x16x32_bf16 v[136:139], a[116:119], a[4:7], 0
    ds_read_b64_tr_b16 a[136:137], v31 offset:16392
    buffer_load_dwordx4 v61, s[8:11], s51 offen lds
    v_mfma_f32_16x16x32_bf16 v[140:143], a[120:123], a[4:7], 0
    ds_read_b64_tr_b16 a[138:139], v31 offset:16904
    v_mfma_f32_16x16x32_bf16 v[144:147], a[108:111], a[8:11], 0
    v_mfma_f32_16x16x32_bf16 v[148:151], a[112:115], a[8:11], 0
    v_mfma_f32_16x16x32_bf16 v[152:155], a[116:119], a[8:11], 0
    v_mfma_f32_16x16x32_bf16 v[156:159], a[120:123], a[8:11], 0
    buffer_load_dwordx4 v62, s[8:11], s51 offen offset:1024 lds
    v_mfma_f32_16x16x32_bf16 v[160:163], a[108:111], a[12:15], 0
    v_mfma_f32_16x16x32_bf16 v[164:167], a[112:115], a[12:15], 0
    v_mfma_f32_16x16x32_bf16 v[168:171], a[116:119], a[12:15], 0
    v_mfma_f32_16x16x32_bf16 v[172:175], a[120:123], a[12:15], 0
    v_mfma_f32_16x16x32_bf16 v[176:179], a[108:111], a[16:19], 0
    buffer_load_dwordx4 v63, s[8:11], s51 offen offset:2048 lds
    v_mfma_f32_16x16x32_bf16 v[180:183], a[112:115], a[16:19], 0
    v_mfma_f32_16x16x32_bf16 v[184:187], a[116:119], a[16:19], 0
    v_mfma_f32_16x16x32_bf16 v[188:191], a[120:123], a[16:19], 0
    v_mfma_f32_16x16x32_bf16 v[192:195], a[108:111], a[20:23], 0
    v_mfma_f32_16x16x32_bf16 v[196:199], a[112:115], a[20:23], 0
    buffer_load_dwordx4 v64, s[8:11], s51 offen offset:3072 lds
    v_mfma_f32_16x16x32_bf16 v[200:203], a[116:119], a[20:23], 0
    v_mfma_f32_16x16x32_bf16 v[204:207], a[120:123], a[20:23], 0
    v_mfma_f32_16x16x32_bf16 v[208:211], a[108:111], a[24:27], 0
    v_mfma_f32_16x16x32_bf16 v[212:215], a[112:115], a[24:27], 0
    v_mfma_f32_16x16x32_bf16 v[216:219], a[116:119], a[24:27], 0
    s_add_u32 s51, s51, 262144
    v_mfma_f32_16x16x32_bf16 v[220:223], a[120:123], a[24:27], 0
    v_mfma_f32_16x16x32_bf16 v[224:227], a[108:111], a[28:31], 0
    v_mfma_f32_16x16x32_bf16 v[228:231], a[112:115], a[28:31], 0
    v_mfma_f32_16x16x32_bf16 v[232:235], a[116:119], a[28:31], 0
    v_mfma_f32_16x16x32_bf16 v[236:239], a[120:123], a[28:31], 0
    s_and_b32 s51, s51, 0x3fffff
    v_mfma_f32_16x16x32_bf16 v[240:243], a[108:111], a[32:35], 0
    v_mfma_f32_16x16x32_bf16 v[244:247], a[112:115], a[32:35], 0
    v_mfma_f32_16x16x32_bf16 v[248:251], a[116:119], a[32:35], 0
    v_mfma_f32_16x16x32_bf16 v[252:255], a[120:123], a[32:35], 0
    s_waitcnt vmcnt(4)
    s_waitcnt lgkmcnt(0)
    s_barrier
    v_mfma_f32_16x16x32_bf16 v[112:115], a[124:127], a[36:39], v[112:115]
    ds_read_b64_tr_b16 a[108:109], v30 offset:32768
    s_add_u32 m0, s52, 0
    v_mfma_f32_16x16x32_bf16 v[116:119], a[128:131], a[36:39], v[116:119]
    ds_read_b64_tr_b16 a[110:111], v30 offset:33280
    v_mfma_f32_16x16x32_bf16 v[120:123], a[132:135], a[36:39], v[120:123]
    ds_read_b64_tr_b16 a[112:113], v30 offset:32776
    v_mfma_f32_16x16x32_bf16 v[124:127], a[136:139], a[36:39], v[124:127]
    ds_read_b64_tr_b16 a[114:115], v30 offset:33288
    buffer_load_dwordx4 v56, s[4:7], s50 offen lds
    v_mfma_f32_16x16x32_bf16 v[128:131], a[124:127], a[40:43], v[128:131]
    ds_read_b64_tr_b16 a[116:117], v31 offset:32768
    v_mfma_f32_16x16x32_bf16 v[132:135], a[128:131], a[40:43], v[132:135]
    ds_read_b64_tr_b16 a[118:119], v31 offset:33280
    buffer_load_dwordx4 v57, s[4:7], s50 offen offset:1024 lds
    v_mfma_f32_16x16x32_bf16 v[136:139], a[132:135], a[40:43], v[136:139]
    ds_read_b64_tr_b16 a[120:121], v31 offset:32776
    v_mfma_f32_16x16x32_bf16 v[140:143], a[136:139], a[40:43], v[140:143]
    ds_read_b64_tr_b16 a[122:123], v31 offset:33288
    buffer_load_dwordx4 v58, s[4:7], s50 offen offset:2048 lds
    v_mfma_f32_16x16x32_bf16 v[144:147], a[124:127], a[44:47], v[144:147]
    ds_read_b128 a[72:75], v28 offset:18432
    v_mfma_f32_16x16x32_bf16 v[148:151], a[128:131], a[44:47], v[148:151]
    ds_read_b128 a[76:79], v28 offset:20480
    s_add_u32 m0, s52, 3072
    v_mfma_f32_16x16x32_bf16 v[152:155], a[132:135], a[44:47], v[152:155]
    ds_read_b128 a[80:83], v28 offset:22528
    v_mfma_f32_16x16x32_bf16 v[156:159], a[136:139], a[44:47], v[156:159]
    ds_read_b128 a[84:87], v28 offset:24576
    v_mfma_f32_16x16x32_bf16 v[160:163], a[124:127], a[48:51], v[160:163]
    ds_read_b128 a[88:91], v28 offset:26624
    buffer_load_dwordx4 v59, s[4:7], s50 offen lds
    v_mfma_f32_16x16x32_bf16 v[164:167], a[128:131], a[48:51], v[164:167]
    ds_read_b128 a[92:95], v28 offset:28672
    v_mfma_f32_16x16x32_bf16 v[168:171], a[132:135], a[48:51], v[168:171]
    ds_read_b128 a[96:99], v28 offset:30720
    buffer_load_dwordx4 v60, s[4:7], s50 offen offset:1024 lds
    v_mfma_f32_16x16x32_bf16 v[172:175], a[136:139], a[48:51], v[172:175]
    ds_read_b128 a[100:103], v28 offset:32768
    v_mfma_f32_16x16x32_bf16 v[176:179], a[124:127], a[52:55], v[176:179]
    ds_read_b128 a[104:107], v28 offset:34816
    s_add_u32 s50, s50, 128
    v_mfma_f32_16x16x32_bf16 v[180:183], a[128:131], a[52:55], v[180:183]
    ds_read_b128 a[0:3], v29 offset:18432
    v_mfma_f32_16x16x32_bf16 v[184:187], a[132:135], a[52:55], v[184:187]
    ds_read_b128 a[4:7], v29 offset:20480
    s_and_b32 s50, s50, 1023
    v_mfma_f32_16x16x32_bf16 v[188:191], a[136:139], a[52:55], v[188:191]
    ds_read_b128 a[8:11], v29 offset:22528
    v_mfma_f32_16x16x32_bf16 v[192:195], a[124:127], a[56:59], v[192:195]
    ds_read_b128 a[12:15], v29 offset:24576
    v_mfma_f32_16x16x32_bf16 v[196:199], a[128:131], a[56:59], v[196:199]
    ds_read_b128 a[16:19], v29 offset:26624
    s_add_u32 m0, s53, 16384
    v_mfma_f32_16x16x32_bf16 v[200:203], a[132:135], a[56:59], v[200:203]
    ds_read_b128 a[20:23], v29 offset:28672
    v_mfma_f32_16x16x32_bf16 v[204:207], a[136:139], a[56:59], v[204:207]
    ds_read_b128 a[24:27], v29 offset:30720
    buffer_load_dwordx4 v61, s[8:11], s51 offen lds
    v_mfma_f32_16x16x32_bf16 v[208:211], a[124:127], a[60:63], v[208:211]
    ds_read_b128 a[28:31], v29 offset:32768
    v_mfma_f32_16x16x32_bf16 v[212:215], a[128:131], a[60:63], v[212:215]
    ds_read_b128 a[32:35], v29 offset:34816
    buffer_load_dwordx4 v62, s[8:11], s51 offen offset:1024 lds
    v_mfma_f32_16x16x32_bf16 v[216:219], a[132:135], a[60:63], v[216:219]
    v_mfma_f32_16x16x32_bf16 v[220:223], a[136:139], a[60:63], v[220:223]
    buffer_load_dwordx4 v63, s[8:11], s51 offen offset:2048 lds
    v_mfma_f32_16x16x32_bf16 v[224:227], a[124:127], a[64:67], v[224:227]
    v_mfma_f32_16x16x32_bf16 v[228:231], a[128:131], a[64:67], v[228:231]
    v_mfma_f32_16x16x32_bf16 v[232:235], a[132:135], a[64:67], v[232:235]
    buffer_load_dwordx4 v64, s[8:11], s51 offen offset:3072 lds
    v_mfma_f32_16x16x32_bf16 v[236:239], a[136:139], a[64:67], v[236:239]
    v_mfma_f32_16x16x32_bf16 v[240:243], a[124:127], a[68:71], v[240:243]
    s_add_u32 s51, s51, 262144
    v_mfma_f32_16x16x32_bf16 v[244:247], a[128:131], a[68:71], v[244:247]
    v_mfma_f32_16x16x32_bf16 v[248:251], a[132:135], a[68:71], v[248:251]
    s_and_b32 s51, s51, 0x3fffff
    v_mfma_f32_16x16x32_bf16 v[252:255], a[136:139], a[68:71], v[252:255]
    s_waitcnt vmcnt(9)
    s_waitcnt lgkmcnt(0)
    v_mfma_f32_16x16x32_bf16 v[112:115], a[108:111], a[72:75], v[112:115]
    ds_read_b64_tr_b16 a[124:125], v30
    s_add_u32 m0, s53, 32768
    v_mfma_f32_16x16x32_bf16 v[116:119], a[112:115], a[72:75], v[116:119]
    ds_read_b64_tr_b16 a[126:127], v30 offset:512
    v_mfma_f32_16x16x32_bf16 v[120:123], a[116:119], a[72:75], v[120:123]
    ds_read_b64_tr_b16 a[128:129], v30 offset:8
    v_mfma_f32_16x16x32_bf16 v[124:127], a[120:123], a[72:75], v[124:127]
    ds_read_b64_tr_b16 a[130:131], v30 offset:520
    v_mfma_f32_16x16x32_bf16 v[128:131], a[108:111], a[76:79], v[128:131]
    ds_read_b64_tr_b16 a[132:133], v31
    v_mfma_f32_16x16x32_bf16 v[132:135], a[112:115], a[76:79], v[132:135]
    ds_read_b64_tr_b16 a[134:135], v31 offset:512
    v_mfma_f32_16x16x32_bf16 v[136:139], a[116:119], a[76:79], v[136:139]
    ds_read_b64_tr_b16 a[136:137], v31 offset:8
    buffer_load_dwordx4 v61, s[8:11], s51 offen lds
    v_mfma_f32_16x16x32_bf16 v[140:143], a[120:123], a[76:79], v[140:143]
    ds_read_b64_tr_b16 a[138:139], v31 offset:520
    v_mfma_f32_16x16x32_bf16 v[144:147], a[108:111], a[80:83], v[144:147]
    v_mfma_f32_16x16x32_bf16 v[148:151], a[112:115], a[80:83], v[148:151]
    v_mfma_f32_16x16x32_bf16 v[152:155], a[116:119], a[80:83], v[152:155]
    v_mfma_f32_16x16x32_bf16 v[156:159], a[120:123], a[80:83], v[156:159]
    buffer_load_dwordx4 v62, s[8:11], s51 offen offset:1024 lds
    v_mfma_f32_16x16x32_bf16 v[160:163], a[108:111], a[84:87], v[160:163]
    v_mfma_f32_16x16x32_bf16 v[164:167], a[112:115], a[84:87], v[164:167]
    v_mfma_f32_16x16x32_bf16 v[168:171], a[116:119], a[84:87], v[168:171]
    v_mfma_f32_16x16x32_bf16 v[172:175], a[120:123], a[84:87], v[172:175]
    v_mfma_f32_16x16x32_bf16 v[176:179], a[108:111], a[88:91], v[176:179]
    buffer_load_dwordx4 v63, s[8:11], s51 offen offset:2048 lds
    v_mfma_f32_16x16x32_bf16 v[180:183], a[112:115], a[88:91], v[180:183]
    v_mfma_f32_16x16x32_bf16 v[184:187], a[116:119], a[88:91], v[184:187]
    v_mfma_f32_16x16x32_bf16 v[188:191], a[120:123], a[88:91], v[188:191]
    v_mfma_f32_16x16x32_bf16 v[192:195], a[108:111], a[92:95], v[192:195]
    v_mfma_f32_16x16x32_bf16 v[196:199], a[112:115], a[92:95], v[196:199]
    buffer_load_dwordx4 v64, s[8:11], s51 offen offset:3072 lds
    v_mfma_f32_16x16x32_bf16 v[200:203], a[116:119], a[92:95], v[200:203]
    v_mfma_f32_16x16x32_bf16 v[204:207], a[120:123], a[92:95], v[204:207]
    v_mfma_f32_16x16x32_bf16 v[208:211], a[108:111], a[96:99], v[208:211]
    v_mfma_f32_16x16x32_bf16 v[212:215], a[112:115], a[96:99], v[212:215]
    v_mfma_f32_16x16x32_bf16 v[216:219], a[116:119], a[96:99], v[216:219]
    s_add_u32 s51, s51, 262144
    v_mfma_f32_16x16x32_bf16 v[220:223], a[120:123], a[96:99], v[220:223]
    v_mfma_f32_16x16x32_bf16 v[224:227], a[108:111], a[100:103], v[224:227]
    v_mfma_f32_16x16x32_bf16 v[228:231], a[112:115], a[100:103], v[228:231]
    v_mfma_f32_16x16x32_bf16 v[232:235], a[116:119], a[100:103], v[232:235]
    v_mfma_f32_16x16x32_bf16 v[236:239], a[120:123], a[100:103], v[236:239]
    s_and_b32 s51, s51, 0x3fffff
    v_mfma_f32_16x16x32_bf16 v[240:243], a[108:111], a[104:107], v[240:243]
    v_mfma_f32_16x16x32_bf16 v[244:247], a[112:115], a[104:107], v[244:247]
    v_mfma_f32_16x16x32_bf16 v[248:251], a[116:119], a[104:107], v[248:251]
    v_mfma_f32_16x16x32_bf16 v[252:255], a[120:123], a[104:107], v[252:255]
    s_waitcnt vmcnt(4)
    s_waitcnt lgkmcnt(0)
    s_barrier
    v_mfma_f32_16x16x32_bf16 v[112:115], a[124:127], a[0:3], v[112:115]
    ds_read_b64_tr_b16 a[108:109], v30 offset:16384
    s_add_u32 m0, s52, 18432
    v_mfma_f32_16x16x32_bf16 v[116:119], a[128:131], a[0:3], v[116:119]
    ds_read_b64_tr_b16 a[110:111], v30 offset:16896
    v_mfma_f32_16x16x32_bf16 v[120:123], a[132:135], a[0:3], v[120:123]
    ds_read_b64_tr_b16 a[112:113], v30 offset:16392
    v_mfma_f32_16x16x32_bf16 v[124:127], a[136:139], a[0:3], v[124:127]
    ds_read_b64_tr_b16 a[114:115], v30 offset:16904
    buffer_load_dwordx4 v56, s[4:7], s50 offen lds
    v_mfma_f32_16x16x32_bf16 v[128:131], a[124:127], a[4:7], v[128:131]
    ds_read_b64_tr_b16 a[116:117], v31 offset:16384
    v_mfma_f32_16x16x32_bf16 v[132:135], a[128:131], a[4:7], v[132:135]
    ds_read_b64_tr_b16 a[118:119], v31 offset:16896
    buffer_load_dwordx4 v57, s[4:7], s50 offen offset:1024 lds
    v_mfma_f32_16x16x32_bf16 v[136:139], a[132:135], a[4:7], v[136:139]
    ds_read_b64_tr_b16 a[120:121], v31 offset:16392
    v_mfma_f32_16x16x32_bf16 v[140:143], a[136:139], a[4:7], v[140:143]
    ds_read_b64_tr_b16 a[122:123], v31 offset:16904
    buffer_load_dwordx4 v58, s[4:7], s50 offen offset:2048 lds
    v_mfma_f32_16x16x32_bf16 v[144:147], a[124:127], a[8:11], v[144:147]
    ds_read_b128 a[36:39], v28
    v_mfma_f32_16x16x32_bf16 v[148:151], a[128:131], a[8:11], v[148:151]
    ds_read_b128 a[40:43], v28 offset:2048
    s_add_u32 m0, s52, 21504
    v_mfma_f32_16x16x32_bf16 v[152:155], a[132:135], a[8:11], v[152:155]
    ds_read_b128 a[44:47], v28 offset:4096
    v_mfma_f32_16x16x32_bf16 v[156:159], a[136:139], a[8:11], v[156:159]
    ds_read_b128 a[48:51], v28 offset:6144
    v_mfma_f32_16x16x32_bf16 v[160:163], a[124:127], a[12:15], v[160:163]
    ds_read_b128 a[52:55], v28 offset:8192
    buffer_load_dwordx4 v59, s[4:7], s50 offen lds
    v_mfma_f32_16x16x32_bf16 v[164:167], a[128:131], a[12:15], v[164:167]
    ds_read_b128 a[56:59], v28 offset:10240
    v_mfma_f32_16x16x32_bf16 v[168:171], a[132:135], a[12:15], v[168:171]
    ds_read_b128 a[60:63], v28 offset:12288
    buffer_load_dwordx4 v60, s[4:7], s50 offen offset:1024 lds
    v_mfma_f32_16x16x32_bf16 v[172:175], a[136:139], a[12:15], v[172:175]
    ds_read_b128 a[64:67], v28 offset:14336
    v_mfma_f32_16x16x32_bf16 v[176:179], a[124:127], a[16:19], v[176:179]
    ds_read_b128 a[68:71], v28 offset:16384
    s_add_u32 s50, s50, 128
    v_mfma_f32_16x16x32_bf16 v[180:183], a[128:131], a[16:19], v[180:183]
    ds_read_b128 a[72:75], v29
    v_mfma_f32_16x16x32_bf16 v[184:187], a[132:135], a[16:19], v[184:187]
    ds_read_b128 a[76:79], v29 offset:2048
    s_and_b32 s50, s50, 1023
    v_mfma_f32_16x16x32_bf16 v[188:191], a[136:139], a[16:19], v[188:191]
    ds_read_b128 a[80:83], v29 offset:4096
    v_mfma_f32_16x16x32_bf16 v[192:195], a[124:127], a[20:23], v[192:195]
    ds_read_b128 a[84:87], v29 offset:6144
    v_mfma_f32_16x16x32_bf16 v[196:199], a[128:131], a[20:23], v[196:199]
    ds_read_b128 a[88:91], v29 offset:8192
    s_add_u32 m0, s53, 0
    v_mfma_f32_16x16x32_bf16 v[200:203], a[132:135], a[20:23], v[200:203]
    ds_read_b128 a[92:95], v29 offset:10240
    v_mfma_f32_16x16x32_bf16 v[204:207], a[136:139], a[20:23], v[204:207]
    ds_read_b128 a[96:99], v29 offset:12288
    buffer_load_dwordx4 v61, s[8:11], s51 offen lds
    v_mfma_f32_16x16x32_bf16 v[208:211], a[124:127], a[24:27], v[208:211]
    ds_read_b128 a[100:103], v29 offset:14336
    v_mfma_f32_16x16x32_bf16 v[212:215], a[128:131], a[24:27], v[212:215]
    ds_read_b128 a[104:107], v29 offset:16384
    buffer_load_dwordx4 v62, s[8:11], s51 offen offset:1024 lds
    v_mfma_f32_16x16x32_bf16 v[216:219], a[132:135], a[24:27], v[216:219]
    v_mfma_f32_16x16x32_bf16 v[220:223], a[136:139], a[24:27], v[220:223]
    buffer_load_dwordx4 v63, s[8:11], s51 offen offset:2048 lds
    v_mfma_f32_16x16x32_bf16 v[224:227], a[124:127], a[28:31], v[224:227]
    v_mfma_f32_16x16x32_bf16 v[228:231], a[128:131], a[28:31], v[228:231]
    v_mfma_f32_16x16x32_bf16 v[232:235], a[132:135], a[28:31], v[232:235]
    buffer_load_dwordx4 v64, s[8:11], s51 offen offset:3072 lds
    v_mfma_f32_16x16x32_bf16 v[236:239], a[136:139], a[28:31], v[236:239]
    v_mfma_f32_16x16x32_bf16 v[240:243], a[124:127], a[32:35], v[240:243]
    s_add_u32 s51, s51, 262144
    v_mfma_f32_16x16x32_bf16 v[244:247], a[128:131], a[32:35], v[244:247]
    v_mfma_f32_16x16x32_bf16 v[248:251], a[132:135], a[32:35], v[248:251]
    s_and_b32 s51, s51, 0x3fffff
    v_mfma_f32_16x16x32_bf16 v[252:255], a[136:139], a[32:35], v[252:255]
    s_waitcnt vmcnt(9)
    s_waitcnt lgkmcnt(0)
    v_mfma_f32_16x16x32_bf16 v[112:115], a[108:111], a[36:39], v[112:115]
    ds_read_b64_tr_b16 a[124:125], v30 offset:32768
    s_add_u32 m0, s53, 16384
    v_mfma_f32_16x16x32_bf16 v[116:119], a[112:115], a[36:39], v[116:119]
    ds_read_b64_tr_b16 a[126:127], v30 offset:33280
    v_mfma_f32_16x16x32_bf16 v[120:123], a[116:119], a[36:39], v[120:123]
    ds_read_b64_tr_b16 a[128:129], v30 offset:32776
    v_mfma_f32_16x16x32_bf16 v[124:127], a[120:123], a[36:39], v[124:127]
    ds_read_b64_tr_b16 a[130:131], v30 offset:33288
    v_mfma_f32_16x16x32_bf16 v[128:131], a[108:111], a[40:43], v[128:131]
    ds_read_b64_tr_b16 a[132:133], v31 offset:32768
    v_mfma_f32_16x16x32_bf16 v[132:135], a[112:115], a[40:43], v[132:135]
    ds_read_b64_tr_b16 a[134:135], v31 offset:33280
    v_mfma_f32_16x16x32_bf16 v[136:139], a[116:119], a[40:43], v[136:139]
    ds_read_b64_tr_b16 a[136:137], v31 offset:32776
    buffer_load_dwordx4 v61, s[8:11], s51 offen lds
    v_mfma_f32_16x16x32_bf16 v[140:143], a[120:123], a[40:43], v[140:143]
    ds_read_b64_tr_b16 a[138:139], v31 offset:33288
    v_mfma_f32_16x16x32_bf16 v[144:147], a[108:111], a[44:47], v[144:147]
    v_mfma_f32_16x16x32_bf16 v[148:151], a[112:115], a[44:47], v[148:151]
    v_mfma_f32_16x16x32_bf16 v[152:155], a[116:119], a[44:47], v[152:155]
    v_mfma_f32_16x16x32_bf16 v[156:159], a[120:123], a[44:47], v[156:159]
    buffer_load_dwordx4 v62, s[8:11], s51 offen offset:1024 lds
    v_mfma_f32_16x16x32_bf16 v[160:163], a[108:111], a[48:51], v[160:163]
    v_mfma_f32_16x16x32_bf16 v[164:167], a[112:115], a[48:51], v[164:167]
    v_mfma_f32_16x16x32_bf16 v[168:171], a[116:119], a[48:51], v[168:171]
    v_mfma_f32_16x16x32_bf16 v[172:175], a[120:123], a[48:51], v[172:175]
    v_mfma_f32_16x16x32_bf16 v[176:179], a[108:111], a[52:55], v[176:179]
    buffer_load_dwordx4 v63, s[8:11], s51 offen offset:2048 lds
    v_mfma_f32_16x16x32_bf16 v[180:183], a[112:115], a[52:55], v[180:183]
    v_mfma_f32_16x16x32_bf16 v[184:187], a[116:119], a[52:55], v[184:187]
    v_mfma_f32_16x16x32_bf16 v[188:191], a[120:123], a[52:55], v[188:191]
    v_mfma_f32_16x16x32_bf16 v[192:195], a[108:111], a[56:59], v[192:195]
    v_mfma_f32_16x16x32_bf16 v[196:199], a[112:115], a[56:59], v[196:199]
    buffer_load_dwordx4 v64, s[8:11], s51 offen offset:3072 lds
    v_mfma_f32_16x16x32_bf16 v[200:203], a[116:119], a[56:59], v[200:203]
    v_mfma_f32_16x16x32_bf16 v[204:207], a[120:123], a[56:59], v[204:207]
    v_mfma_f32_16x16x32_bf16 v[208:211], a[108:111], a[60:63], v[208:211]
    v_mfma_f32_16x16x32_bf16 v[212:215], a[112:115], a[60:63], v[212:215]
    v_mfma_f32_16x16x32_bf16 v[216:219], a[116:119], a[60:63], v[216:219]
    s_add_u32 s51, s51, 262144
    v_mfma_f32_16x16x32_bf16 v[220:223], a[120:123], a[60:63], v[220:223]
    v_mfma_f32_16x16x32_bf16 v[224:227], a[108:111], a[64:67], v[224:227]
    v_mfma_f32_16x16x32_bf16 v[228:231], a[112:115], a[64:67], v[228:231]
    v_mfma_f32_16x16x32_bf16 v[232:235], a[116:119], a[64:67], v[232:235]
    v_mfma_f32_16x16x32_bf16 v[236:239], a[120:123], a[64:67], v[236:239]
    s_and_b32 s51, s51, 0x3fffff
    v_mfma_f32_16x16x32_bf16 v[240:243], a[108:111], a[68:71], v[240:243]
    v_mfma_f32_16x16x32_bf16 v[244:247], a[112:115], a[68:71], v[244:247]
    v_mfma_f32_16x16x32_bf16 v[248:251], a[116:119], a[68:71], v[248:251]
    v_mfma_f32_16x16x32_bf16 v[252:255], a[120:123], a[68:71], v[252:255]
    s_waitcnt vmcnt(4)
    s_waitcnt lgkmcnt(0)
    s_barrier
    v_mfma_f32_16x16x32_bf16 v[112:115], a[124:127], a[72:75], v[112:115]
    ds_read_b64_tr_b16 a[108:109], v30
    s_add_u32 m0, s52, 0
    v_mfma_f32_16x16x32_bf16 v[116:119], a[128:131], a[72:75], v[116:119]
    ds_read_b64_tr_b16 a[110:111], v30 offset:512
    v_mfma_f32_16x16x32_bf16 v[120:123], a[132:135], a[72:75], v[120:123]
    ds_read_b64_tr_b16 a[112:113], v30 offset:8
    v_mfma_f32_16x16x32_bf16 v[124:127], a[136:139], a[72:75], v[124:127]
    ds_read_b64_tr_b16 a[114:115], v30 offset:520
    buffer_load_dwordx4 v56, s[4:7], s50 offen lds
    v_mfma_f32_16x16x32_bf16 v[128:131], a[124:127], a[76:79], v[128:131]
    ds_read_b64_tr_b16 a[116:117], v31
    v_mfma_f32_16x16x32_bf16 v[132:135], a[128:131], a[76:79], v[132:135]
    ds_read_b64_tr_b16 a[118:119], v31 offset:512
    buffer_load_dwordx4 v57, s[4:7], s50 offen offset:1024 lds
    v_mfma_f32_16x16x32_bf16 v[136:139], a[132:135], a[76:79], v[136:139]
    ds_read_b64_tr_b16 a[120:121], v31 offset:8
    v_mfma_f32_16x16x32_bf16 v[140:143], a[136:139], a[76:79], v[140:143]
    ds_read_b64_tr_b16 a[122:123], v31 offset:520
    buffer_load_dwordx4 v58, s[4:7], s50 offen offset:2048 lds
    v_mfma_f32_16x16x32_bf16 v[144:147], a[124:127], a[80:83], v[144:147]
    ds_read_b128 a[0:3], v28 offset:18432
    v_mfma_f32_16x16x32_bf16 v[148:151], a[128:131], a[80:83], v[148:151]
    ds_read_b128 a[4:7], v28 offset:20480
    s_add_u32 m0, s52, 3072
    v_mfma_f32_16x16x32_bf16 v[152:155], a[132:135], a[80:83], v[152:155]
    ds_read_b128 a[8:11], v28 offset:22528
    v_mfma_f32_16x16x32_bf16 v[156:159], a[136:139], a[80:83], v[156:159]
    ds_read_b128 a[12:15], v28 offset:24576
    v_mfma_f32_16x16x32_bf16 v[160:163], a[124:127], a[84:87], v[160:163]
    ds_read_b128 a[16:19], v28 offset:26624
    buffer_load_dwordx4 v59, s[4:7], s50 offen lds
    v_mfma_f32_16x16x32_bf16 v[164:167], a[128:131], a[84:87], v[164:167]
    ds_read_b128 a[20:23], v28 offset:28672
    v_mfma_f32_16x16x32_bf16 v[168:171], a[132:135], a[84:87], v[168:171]
    ds_read_b128 a[24:27], v28 offset:30720
    buffer_load_dwordx4 v60, s[4:7], s50 offen offset:1024 lds
    v_mfma_f32_16x16x32_bf16 v[172:175], a[136:139], a[84:87], v[172:175]
    ds_read_b128 a[28:31], v28 offset:32768
    v_mfma_f32_16x16x32_bf16 v[176:179], a[124:127], a[88:91], v[176:179]
    ds_read_b128 a[32:35], v28 offset:34816
    s_add_u32 s50, s50, 128
    v_mfma_f32_16x16x32_bf16 v[180:183], a[128:131], a[88:91], v[180:183]
    ds_read_b128 a[36:39], v29 offset:18432
    v_mfma_f32_16x16x32_bf16 v[184:187], a[132:135], a[88:91], v[184:187]
    ds_read_b128 a[40:43], v29 offset:20480
    s_and_b32 s50, s50, 1023
    v_mfma_f32_16x16x32_bf16 v[188:191], a[136:139], a[88:91], v[188:191]
    ds_read_b128 a[44:47], v29 offset:22528
    v_mfma_f32_16x16x32_bf16 v[192:195], a[124:127], a[92:95], v[192:195]
    ds_read_b128 a[48:51], v29 offset:24576
    v_mfma_f32_16x16x32_bf16 v[196:199], a[128:131], a[92:95], v[196:199]
    ds_read_b128 a[52:55], v29 offset:26624
    s_add_u32 m0, s53, 32768
    v_mfma_f32_16x16x32_bf16 v[200:203], a[132:135], a[92:95], v[200:203]
    ds_read_b128 a[56:59], v29 offset:28672
    v_mfma_f32_16x16x32_bf16 v[204:207], a[136:139], a[92:95], v[204:207]
    ds_read_b128 a[60:63], v29 offset:30720
    buffer_load_dwordx4 v61, s[8:11], s51 offen lds
    v_mfma_f32_16x16x32_bf16 v[208:211], a[124:127], a[96:99], v[208:211]
    ds_read_b128 a[64:67], v29 offset:32768
    v_mfma_f32_16x16x32_bf16 v[212:215], a[128:131], a[96:99], v[212:215]
    ds_read_b128 a[68:71], v29 offset:34816
    buffer_load_dwordx4 v62, s[8:11], s51 offen offset:1024 lds
    v_mfma_f32_16x16x32_bf16 v[216:219], a[132:135], a[96:99], v[216:219]
    v_mfma_f32_16x16x32_bf16 v[220:223], a[136:139], a[96:99], v[220:223]
    buffer_load_dwordx4 v63, s[8:11], s51 offen offset:2048 lds
    v_mfma_f32_16x16x32_bf16 v[224:227], a[124:127], a[100:103], v[224:227]
    v_mfma_f32_16x16x32_bf16 v[228:231], a[128:131], a[100:103], v[228:231]
    v_mfma_f32_16x16x32_bf16 v[232:235], a[132:135], a[100:103], v[232:235]
    buffer_load_dwordx4 v64, s[8:11], s51 offen offset:3072 lds
    v_mfma_f32_16x16x32_bf16 v[236:239], a[136:139], a[100:103], v[236:239]
    v_mfma_f32_16x16x32_bf16 v[240:243], a[124:127], a[104:107], v[240:243]
    s_add_u32 s51, s51, 262144
    v_mfma_f32_16x16x32_bf16 v[244:247], a[128:131], a[104:107], v[244:247]
    v_mfma_f32_16x16x32_bf16 v[248:251], a[132:135], a[104:107], v[248:251]
    s_and_b32 s51, s51, 0x3fffff
    v_mfma_f32_16x16x32_bf16 v[252:255], a[136:139], a[104:107], v[252:255]
    s_waitcnt vmcnt(9)
    s_waitcnt lgkmcnt(0)
    v_mfma_f32_16x16x32_bf16 v[112:115], a[108:111], a[0:3], v[112:115]
    ds_read_b64_tr_b16 a[124:125], v30 offset:16384
    s_add_u32 m0, s53, 0
    v_mfma_f32_16x16x32_bf16 v[116:119], a[112:115], a[0:3], v[116:119]
    ds_read_b64_tr_b16 a[126:127], v30 offset:16896
    v_mfma_f32_16x16x32_bf16 v[120:123], a[116:119], a[0:3], v[120:123]
    ds_read_b64_tr_b16 a[128:129], v30 offset:16392
    v_mfma_f32_16x16x32_bf16 v[124:127], a[120:123], a[0:3], v[124:127]
    ds_read_b64_tr_b16 a[130:131], v30 offset:16904
    v_mfma_f32_16x16x32_bf16 v[128:131], a[108:111], a[4:7], v[128:131]
    ds_read_b64_tr_b16 a[132:133], v31 offset:16384
    v_mfma_f32_16x16x32_bf16 v[132:135], a[112:115], a[4:7], v[132:135]
    ds_read_b64_tr_b16 a[134:135], v31 offset:16896
    v_mfma_f32_16x16x32_bf16 v[136:139], a[116:119], a[4:7], v[136:139]
    ds_read_b64_tr_b16 a[136:137], v31 offset:16392
    buffer_load_dwordx4 v61, s[8:11], s51 offen lds
    v_mfma_f32_16x16x32_bf16 v[140:143], a[120:123], a[4:7], v[140:143]
    ds_read_b64_tr_b16 a[138:139], v31 offset:16904
    v_mfma_f32_16x16x32_bf16 v[144:147], a[108:111], a[8:11], v[144:147]
    v_mfma_f32_16x16x32_bf16 v[148:151], a[112:115], a[8:11], v[148:151]
    v_mfma_f32_16x16x32_bf16 v[152:155], a[116:119], a[8:11], v[152:155]
    v_mfma_f32_16x16x32_bf16 v[156:159], a[120:123], a[8:11], v[156:159]
    buffer_load_dwordx4 v62, s[8:11], s51 offen offset:1024 lds
    v_mfma_f32_16x16x32_bf16 v[160:163], a[108:111], a[12:15], v[160:163]
    v_mfma_f32_16x16x32_bf16 v[164:167], a[112:115], a[12:15], v[164:167]
    v_mfma_f32_16x16x32_bf16 v[168:171], a[116:119], a[12:15], v[168:171]
    v_mfma_f32_16x16x32_bf16 v[172:175], a[120:123], a[12:15], v[172:175]
    v_mfma_f32_16x16x32_bf16 v[176:179], a[108:111], a[16:19], v[176:179]
    buffer_load_dwordx4 v63, s[8:11], s51 offen offset:2048 lds
    v_mfma_f32_16x16x32_bf16 v[180:183], a[112:115], a[16:19], v[180:183]
    v_mfma_f32_16x16x32_bf16 v[184:187], a[116:119], a[16:19], v[184:187]
    v_mfma_f32_16x16x32_bf16 v[188:191], a[120:123], a[16:19], v[188:191]
    v_mfma_f32_16x16x32_bf16 v[192:195], a[108:111], a[20:23], v[192:195]
    v_mfma_f32_16x16x32_bf16 v[196:199], a[112:115], a[20:23], v[196:199]
    buffer_load_dwordx4 v64, s[8:11], s51 offen offset:3072 lds
    v_mfma_f32_16x16x32_bf16 v[200:203], a[116:119], a[20:23], v[200:203]
    v_mfma_f32_16x16x32_bf16 v[204:207], a[120:123], a[20:23], v[204:207]
    v_mfma_f32_16x16x32_bf16 v[208:211], a[108:111], a[24:27], v[208:211]
    v_mfma_f32_16x16x32_bf16 v[212:215], a[112:115], a[24:27], v[212:215]
    v_mfma_f32_16x16x32_bf16 v[216:219], a[116:119], a[24:27], v[216:219]
    s_add_u32 s51, s51, 262144
    v_mfma_f32_16x16x32_bf16 v[220:223], a[120:123], a[24:27], v[220:223]
    v_mfma_f32_16x16x32_bf16 v[224:227], a[108:111], a[28:31], v[224:227]
    v_mfma_f32_16x16x32_bf16 v[228:231], a[112:115], a[28:31], v[228:231]
    v_mfma_f32_16x16x32_bf16 v[232:235], a[116:119], a[28:31], v[232:235]
    v_mfma_f32_16x16x32_bf16 v[236:239], a[120:123], a[28:31], v[236:239]
    s_and_b32 s51, s51, 0x3fffff
    v_mfma_f32_16x16x32_bf16 v[240:243], a[108:111], a[32:35], v[240:243]
    v_mfma_f32_16x16x32_bf16 v[244:247], a[112:115], a[32:35], v[244:247]
    v_mfma_f32_16x16x32_bf16 v[248:251], a[116:119], a[32:35], v[248:251]
    v_mfma_f32_16x16x32_bf16 v[252:255], a[120:123], a[32:35], v[252:255]
    s_waitcnt vmcnt(4)
    s_waitcnt lgkmcnt(0)
    s_barrier
    v_mfma_f32_16x16x32_bf16 v[112:115], a[124:127], a[36:39], v[112:115]
    ds_read_b64_tr_b16 a[108:109], v30 offset:32768
    s_add_u32 m0, s52, 18432
    v_mfma_f32_16x16x32_bf16 v[116:119], a[128:131], a[36:39], v[116:119]
    ds_read_b64_tr_b16 a[110:111], v30 offset:33280
    v_mfma_f32_16x16x32_bf16 v[120:123], a[132:135], a[36:39], v[120:123]
    ds_read_b64_tr_b16 a[112:113], v30 offset:32776
    v_mfma_f32_16x16x32_bf16 v[124:127], a[136:139], a[36:39], v[124:127]
    ds_read_b64_tr_b16 a[114:115], v30 offset:33288
    buffer_load_dwordx4 v56, s[4:7], s50 offen lds
    v_mfma_f32_16x16x32_bf16 v[128:131], a[124:127], a[40:43], v[128:131]
    ds_read_b64_tr_b16 a[116:117], v31 offset:32768
    v_mfma_f32_16x16x32_bf16 v[132:135], a[128:131], a[40:43], v[132:135]
    ds_read_b64_tr_b16 a[118:119], v31 offset:33280
    buffer_load_dwordx4 v57, s[4:7], s50 offen offset:1024 lds
    v_mfma_f32_16x16x32_bf16 v[136:139], a[132:135], a[40:43], v[136:139]
    ds_read_b64_tr_b16 a[120:121], v31 offset:32776
    v_mfma_f32_16x16x32_bf16 v[140:143], a[136:139], a[40:43], v[140:143]
    ds_read_b64_tr_b16 a[122:123], v31 offset:33288
    buffer_load_dwordx4 v58, s[4:7], s50 offen offset:2048 lds
    v_mfma_f32_16x16x32_bf16 v[144:147], a[124:127], a[44:47], v[144:147]
    ds_read_b128 a[72:75], v28
    v_mfma_f32_16x16x32_bf16 v[148:151], a[128:131], a[44:47], v[148:151]
    ds_read_b128 a[76:79], v28 offset:2048
    s_add_u32 m0, s52, 21504
    v_mfma_f32_16x16x32_bf16 v[152:155], a[132:135], a[44:47], v[152:155]
    ds_read_b128 a[80:83], v28 offset:4096
    v_mfma_f32_16x16x32_bf16 v[156:159], a[136:139], a[44:47], v[156:159]
    ds_read_b128 a[84:87], v28 offset:6144
    v_mfma_f32_16x16x32_bf16 v[160:163], a[124:127], a[48:51], v[160:163]
    ds_read_b128 a[88:91], v28 offset:8192
    buffer_load_dwordx4 v59, s[4:7], s50 offen lds
    v_mfma_f32_16x16x32_bf16 v[164:167], a[128:131], a[48:51], v[164:167]
    ds_read_b128 a[92:95], v28 offset:10240
    v_mfma_f32_16x16x32_bf16 v[168:171], a[132:135], a[48:51], v[168:171]
    ds_read_b128 a[96:99], v28 offset:12288
    buffer_load_dwordx4 v60, s[4:7], s50 offen offset:1024 lds
    v_mfma_f32_16x16x32_bf16 v[172:175], a[136:139], a[48:51], v[172:175]
    ds_read_b128 a[100:103], v28 offset:14336
    v_mfma_f32_16x16x32_bf16 v[176:179], a[124:127], a[52:55], v[176:179]
    ds_read_b128 a[104:107], v28 offset:16384
    s_add_u32 s50, s50, 128
    v_mfma_f32_16x16x32_bf16 v[180:183], a[128:131], a[52:55], v[180:183]
    ds_read_b128 a[0:3], v29
    v_mfma_f32_16x16x32_bf16 v[184:187], a[132:135], a[52:55], v[184:187]
    ds_read_b128 a[4:7], v29 offset:2048
    s_and_b32 s50, s50, 1023
    v_mfma_f32_16x16x32_bf16 v[188:191], a[136:139], a[52:55], v[188:191]
    ds_read_b128 a[8:11], v29 offset:4096
    v_mfma_f32_16x16x32_bf16 v[192:195], a[124:127], a[56:59], v[192:195]
    ds_read_b128 a[12:15], v29 offset:6144
    v_mfma_f32_16x16x32_bf16 v[196:199], a[128:131], a[56:59], v[196:199]
    ds_read_b128 a[16:19], v29 offset:8192
    s_add_u32 m0, s53, 16384
    v_mfma_f32_16x16x32_bf16 v[200:203], a[132:135], a[56:59], v[200:203]
    ds_read_b128 a[20:23], v29 offset:10240
    v_mfma_f32_16x16x32_bf16 v[204:207], a[136:139], a[56:59], v[204:207]
    ds_read_b128 a[24:27], v29 offset:12288
    buffer_load_dwordx4 v61, s[8:11], s51 offen lds
    v_mfma_f32_16x16x32_bf16 v[208:211], a[124:127], a[60:63], v[208:211]
    ds_read_b128 a[28:31], v29 offset:14336
    v_mfma_f32_16x16x32_bf16 v[212:215], a[128:131], a[60:63], v[212:215]
    ds_read_b128 a[32:35], v29 offset:16384
    buffer_load_dwordx4 v62, s[8:11], s51 offen offset:1024 lds
    v_mfma_f32_16x16x32_bf16 v[216:219], a[132:135], a[60:63], v[216:219]
    v_mfma_f32_16x16x32_bf16 v[220:223], a[136:139], a[60:63], v[220:223]
    buffer_load_dwordx4 v63, s[8:11], s51 offen offset:2048 lds
    v_mfma_f32_16x16x32_bf16 v[224:227], a[124:127], a[64:67], v[224:227]
    v_mfma_f32_16x16x32_bf16 v[228:231], a[128:131], a[64:67], v[228:231]
    v_mfma_f32_16x16x32_bf16 v[232:235], a[132:135], a[64:67], v[232:235]
    buffer_load_dwordx4 v64, s[8:11], s51 offen offset:3072 lds
    v_mfma_f32_16x16x32_bf16 v[236:239], a[136:139], a[64:67], v[236:239]
    v_mfma_f32_16x16x32_bf16 v[240:243], a[124:127], a[68:71], v[240:243]
    s_add_u32 s51, s51, 262144
    v_mfma_f32_16x16x32_bf16 v[244:247], a[128:131], a[68:71], v[244:247]
    v_mfma_f32_16x16x32_bf16 v[248:251], a[132:135], a[68:71], v[248:251]
    s_and_b32 s51, s51, 0x3fffff
    v_mfma_f32_16x16x32_bf16 v[252:255], a[136:139], a[68:71], v[252:255]
    s_waitcnt vmcnt(9)
    s_waitcnt lgkmcnt(0)
    v_mfma_f32_16x16x32_bf16 v[112:115], a[108:111], a[72:75], v[112:115]
    ds_read_b64_tr_b16 a[124:125], v30
    s_add_u32 m0, s53, 32768
    v_mfma_f32_16x16x32_bf16 v[116:119], a[112:115], a[72:75], v[116:119]
    ds_read_b64_tr_b16 a[126:127], v30 offset:512
    v_mfma_f32_16x16x32_bf16 v[120:123], a[116:119], a[72:75], v[120:123]
    ds_read_b64_tr_b16 a[128:129], v30 offset:8
    v_mfma_f32_16x16x32_bf16 v[124:127], a[120:123], a[72:75], v[124:127]
    ds_read_b64_tr_b16 a[130:131], v30 offset:520
    v_mfma_f32_16x16x32_bf16 v[128:131], a[108:111], a[76:79], v[128:131]
    ds_read_b64_tr_b16 a[132:133], v31
    v_mfma_f32_16x16x32_bf16 v[132:135], a[112:115], a[76:79], v[132:135]
    ds_read_b64_tr_b16 a[134:135], v31 offset:512
    v_mfma_f32_16x16x32_bf16 v[136:139], a[116:119], a[76:79], v[136:139]
    ds_read_b64_tr_b16 a[136:137], v31 offset:8
    buffer_load_dwordx4 v61, s[8:11], s51 offen lds
    v_mfma_f32_16x16x32_bf16 v[140:143], a[120:123], a[76:79], v[140:143]
    ds_read_b64_tr_b16 a[138:139], v31 offset:520
    v_mfma_f32_16x16x32_bf16 v[144:147], a[108:111], a[80:83], v[144:147]
    v_mfma_f32_16x16x32_bf16 v[148:151], a[112:115], a[80:83], v[148:151]
    v_mfma_f32_16x16x32_bf16 v[152:155], a[116:119], a[80:83], v[152:155]
    v_mfma_f32_16x16x32_bf16 v[156:159], a[120:123], a[80:83], v[156:159]
    buffer_load_dwordx4 v62, s[8:11], s51 offen offset:1024 lds
    v_mfma_f32_16x16x32_bf16 v[160:163], a[108:111], a[84:87], v[160:163]
    v_mfma_f32_16x16x32_bf16 v[164:167], a[112:115], a[84:87], v[164:167]
    v_mfma_f32_16x16x32_bf16 v[168:171], a[116:119], a[84:87], v[168:171]
    v_mfma_f32_16x16x32_bf16 v[172:175], a[120:123], a[84:87], v[172:175]
    v_mfma_f32_16x16x32_bf16 v[176:179], a[108:111], a[88:91], v[176:179]
    buffer_load_dwordx4 v63, s[8:11], s51 offen offset:2048 lds
    v_mfma_f32_16x16x32_bf16 v[180:183], a[112:115], a[88:91], v[180:183]
    v_mfma_f32_16x16x32_bf16 v[184:187], a[116:119], a[88:91], v[184:187]
    v_mfma_f32_16x16x32_bf16 v[188:191], a[120:123], a[88:91], v[188:191]
    v_mfma_f32_16x16x32_bf16 v[192:195], a[108:111], a[92:95], v[192:195]
    v_mfma_f32_16x16x32_bf16 v[196:199], a[112:115], a[92:95], v[196:199]
    buffer_load_dwordx4 v64, s[8:11], s51 offen offset:3072 lds
    v_mfma_f32_16x16x32_bf16 v[200:203], a[116:119], a[92:95], v[200:203]
    v_mfma_f32_16x16x32_bf16 v[204:207], a[120:123], a[92:95], v[204:207]
    v_mfma_f32_16x16x32_bf16 v[208:211], a[108:111], a[96:99], v[208:211]
    v_mfma_f32_16x16x32_bf16 v[212:215], a[112:115], a[96:99], v[212:215]
    v_mfma_f32_16x16x32_bf16 v[216:219], a[116:119], a[96:99], v[216:219]
    s_add_u32 s51, s51, 262144
    v_mfma_f32_16x16x32_bf16 v[220:223], a[120:123], a[96:99], v[220:223]
    v_mfma_f32_16x16x32_bf16 v[224:227], a[108:111], a[100:103], v[224:227]
    v_mfma_f32_16x16x32_bf16 v[228:231], a[112:115], a[100:103], v[228:231]
    v_mfma_f32_16x16x32_bf16 v[232:235], a[116:119], a[100:103], v[232:235]
    v_mfma_f32_16x16x32_bf16 v[236:239], a[120:123], a[100:103], v[236:239]
    s_and_b32 s51, s51, 0x3fffff
    v_mfma_f32_16x16x32_bf16 v[240:243], a[108:111], a[104:107], v[240:243]
    v_mfma_f32_16x16x32_bf16 v[244:247], a[112:115], a[104:107], v[244:247]
    v_mfma_f32_16x16x32_bf16 v[248:251], a[116:119], a[104:107], v[248:251]
    v_mfma_f32_16x16x32_bf16 v[252:255], a[120:123], a[104:107], v[252:255]
    s_waitcnt vmcnt(4)
    s_waitcnt lgkmcnt(0)
    s_barrier
    v_mfma_f32_16x16x32_bf16 v[112:115], a[124:127], a[0:3], v[112:115]
    ds_read_b64_tr_b16 a[108:109], v30 offset:16384
    s_add_u32 m0, s52, 0
    v_mfma_f32_16x16x32_bf16 v[116:119], a[128:131], a[0:3], v[116:119]
    ds_read_b64_tr_b16 a[110:111], v30 offset:16896
    v_mfma_f32_16x16x32_bf16 v[120:123], a[132:135], a[0:3], v[120:123]
    ds_read_b64_tr_b16 a[112:113], v30 offset:16392
    v_mfma_f32_16x16x32_bf16 v[124:127], a[136:139], a[0:3], v[124:127]
    ds_read_b64_tr_b16 a[114:115], v30 offset:16904
    buffer_load_dwordx4 v56, s[4:7], s50 offen lds
    v_mfma_f32_16x16x32_bf16 v[128:131], a[124:127], a[4:7], v[128:131]
    ds_read_b64_tr_b16 a[116:117], v31 offset:16384
    v_mfma_f32_16x16x32_bf16 v[132:135], a[128:131], a[4:7], v[132:135]
    ds_read_b64_tr_b16 a[118:119], v31 offset:16896
    buffer_load_dwordx4 v57, s[4:7], s50 offen offset:1024 lds
    v_mfma_f32_16x16x32_bf16 v[136:139], a[132:135], a[4:7], v[136:139]
    ds_read_b64_tr_b16 a[120:121], v31 offset:16392
    v_mfma_f32_16x16x32_bf16 v[140:143], a[136:139], a[4:7], v[140:143]
    ds_read_b64_tr_b16 a[122:123], v31 offset:16904
    buffer_load_dwordx4 v58, s[4:7], s50 offen offset:2048 lds
    v_mfma_f32_16x16x32_bf16 v[144:147], a[124:127], a[8:11], v[144:147]
    ds_read_b128 a[36:39], v28 offset:18432
    v_mfma_f32_16x16x32_bf16 v[148:151], a[128:131], a[8:11], v[148:151]
    ds_read_b128 a[40:43], v28 offset:20480
    s_add_u32 m0, s52, 3072
    v_mfma_f32_16x16x32_bf16 v[152:155], a[132:135], a[8:11], v[152:155]
    ds_read_b128 a[44:47], v28 offset:22528
    v_mfma_f32_16x16x32_bf16 v[156:159], a[136:139], a[8:11], v[156:159]
    ds_read_b128 a[48:51], v28 offset:24576
    v_mfma_f32_16x16x32_bf16 v[160:163], a[124:127], a[12:15], v[160:163]
    ds_read_b128 a[52:55], v28 offset:26624
    buffer_load_dwordx4 v59, s[4:7], s50 offen lds
    v_mfma_f32_16x16x32_bf16 v[164:167], a[128:131], a[12:15], v[164:167]
    ds_read_b128 a[56:59], v28 offset:28672
    v_mfma_f32_16x16x32_bf16 v[168:171], a[132:135], a[12:15], v[168:171]
    ds_read_b128 a[60:63], v28 offset:30720
    buffer_load_dwordx4 v60, s[4:7], s50 offen offset:1024 lds
    v_mfma_f32_16x16x32_bf16 v[172:175], a[136:139], a[12:15], v[172:175]
    ds_read_b128 a[64:67], v28 offset:32768
    v_mfma_f32_16x16x32_bf16 v[176:179], a[124:127], a[16:19], v[176:179]
    ds_read_b128 a[68:71], v28 offset:34816
    s_add_u32 s50, s50, 128
    v_mfma_f32_16x16x32_bf16 v[180:183], a[128:131], a[16:19], v[180:183]
    ds_read_b128 a[72:75], v29 offset:18432
    v_mfma_f32_16x16x32_bf16 v[184:187], a[132:135], a[16:19], v[184:187]
    ds_read_b128 a[76:79], v29 offset:20480
    s_and_b32 s50, s50, 1023
    v_mfma_f32_16x16x32_bf16 v[188:191], a[136:139], a[16:19], v[188:191]
    ds_read_b128 a[80:83], v29 offset:22528
    v_mfma_f32_16x16x32_bf16 v[192:195], a[124:127], a[20:23], v[192:195]
    ds_read_b128 a[84:87], v29 offset:24576
    v_mfma_f32_16x16x32_bf16 v[196:199], a[128:131], a[20:23], v[196:199]
    ds_read_b128 a[88:91], v29 offset:26624
    s_add_u32 m0, s53, 0
    v_mfma_f32_16x16x32_bf16 v[200:203], a[132:135], a[20:23], v[200:203]
    ds_read_b128 a[92:95], v29 offset:28672
    v_mfma_f32_16x16x32_bf16 v[204:207], a[136:139], a[20:23], v[204:207]
    ds_read_b128 a[96:99], v29 offset:30720
    buffer_load_dwordx4 v61, s[8:11], s51 offen lds
    v_mfma_f32_16x16x32_bf16 v[208:211], a[124:127], a[24:27], v[208:211]
    ds_read_b128 a[100:103], v29 offset:32768
    v_mfma_f32_16x16x32_bf16 v[212:215], a[128:131], a[24:27], v[212:215]
    ds_read_b128 a[104:107], v29 offset:34816
    buffer_load_dwordx4 v62, s[8:11], s51 offen offset:1024 lds
    v_mfma_f32_16x16x32_bf16 v[216:219], a[132:135], a[24:27], v[216:219]
    v_mfma_f32_16x16x32_bf16 v[220:223], a[136:139], a[24:27], v[220:223]
    buffer_load_dwordx4 v63, s[8:11], s51 offen offset:2048 lds
    v_mfma_f32_16x16x32_bf16 v[224:227], a[124:127], a[28:31], v[224:227]
    v_mfma_f32_16x16x32_bf16 v[228:231], a[128:131], a[28:31], v[228:231]
    v_mfma_f32_16x16x32_bf16 v[232:235], a[132:135], a[28:31], v[232:235]
    buffer_load_dwordx4 v64, s[8:11], s51 offen offset:3072 lds
    v_mfma_f32_16x16x32_bf16 v[236:239], a[136:139], a[28:31], v[236:239]
    v_mfma_f32_16x16x32_bf16 v[240:243], a[124:127], a[32:35], v[240:243]
    s_add_u32 s51, s51, 262144
    v_mfma_f32_16x16x32_bf16 v[244:247], a[128:131], a[32:35], v[244:247]
    v_mfma_f32_16x16x32_bf16 v[248:251], a[132:135], a[32:35], v[248:251]
    s_and_b32 s51, s51, 0x3fffff
    v_mfma_f32_16x16x32_bf16 v[252:255], a[136:139], a[32:35], v[252:255]
    s_waitcnt vmcnt(9)
    s_waitcnt lgkmcnt(0)
    v_mfma_f32_16x16x32_bf16 v[112:115], a[108:111], a[36:39], v[112:115]
    ds_read_b64_tr_b16 a[124:125], v30 offset:32768
    s_add_u32 m0, s53, 16384
    v_mfma_f32_16x16x32_bf16 v[116:119], a[112:115], a[36:39], v[116:119]
    ds_read_b64_tr_b16 a[126:127], v30 offset:33280
    v_mfma_f32_16x16x32_bf16 v[120:123], a[116:119], a[36:39], v[120:123]
    ds_read_b64_tr_b16 a[128:129], v30 offset:32776
    v_mfma_f32_16x16x32_bf16 v[124:127], a[120:123], a[36:39], v[124:127]
    ds_read_b64_tr_b16 a[130:131], v30 offset:33288
    buffer_load_dwordx4 v61, s[8:11], s51 offen lds
    v_mfma_f32_16x16x32_bf16 v[128:131], a[108:111], a[40:43], v[128:131]
    ds_read_b64_tr_b16 a[132:133], v31 offset:32768
    v_mfma_f32_16x16x32_bf16 v[132:135], a[112:115], a[40:43], v[132:135]
    ds_read_b64_tr_b16 a[134:135], v31 offset:33280
    buffer_load_dwordx4 v62, s[8:11], s51 offen offset:1024 lds
    v_mfma_f32_16x16x32_bf16 v[136:139], a[116:119], a[40:43], v[136:139]
    ds_read_b64_tr_b16 a[136:137], v31 offset:32776
    v_mfma_f32_16x16x32_bf16 v[140:143], a[120:123], a[40:43], v[140:143]
    ds_read_b64_tr_b16 a[138:139], v31 offset:33288
    buffer_load_dwordx4 v63, s[8:11], s51 offen offset:2048 lds
    v_mfma_f32_16x16x32_bf16 v[144:147], a[108:111], a[44:47], v[144:147]
    v_mfma_f32_16x16x32_bf16 v[148:151], a[112:115], a[44:47], v[148:151]
    buffer_load_dwordx4 v64, s[8:11], s51 offen offset:3072 lds
    v_mfma_f32_16x16x32_bf16 v[152:155], a[116:119], a[44:47], v[152:155]
    v_mfma_f32_16x16x32_bf16 v[156:159], a[120:123], a[44:47], v[156:159]
    v_mfma_f32_16x16x32_bf16 v[160:163], a[108:111], a[48:51], v[160:163]
    s_add_u32 s51, s51, 262144
    v_mfma_f32_16x16x32_bf16 v[164:167], a[112:115], a[48:51], v[164:167]
    v_mfma_f32_16x16x32_bf16 v[168:171], a[116:119], a[48:51], v[168:171]
    s_and_b32 s51, s51, 0x3fffff
    v_mfma_f32_16x16x32_bf16 v[172:175], a[120:123], a[48:51], v[172:175]
    v_mfma_f32_16x16x32_bf16 v[176:179], a[108:111], a[52:55], v[176:179]
    s_add_u32 m0, s49, 0
    v_mfma_f32_16x16x32_bf16 v[180:183], a[112:115], a[52:55], v[180:183]
    v_mfma_f32_16x16x32_bf16 v[184:187], a[116:119], a[52:55], v[184:187]
    s_add_u32 s48, s46, s47
    v_mfma_f32_16x16x32_bf16 v[188:191], a[120:123], a[52:55], v[188:191]
    v_mfma_f32_16x16x32_bf16 v[192:195], a[108:111], a[56:59], v[192:195]
    v_mfma_f32_16x16x32_bf16 v[196:199], a[112:115], a[56:59], v[196:199]
    buffer_load_dwordx4 v32, s[12:15], s48 offen nt lds
    v_mfma_f32_16x16x32_bf16 v[200:203], a[116:119], a[56:59], v[200:203]
    v_mfma_f32_16x16x32_bf16 v[204:207], a[120:123], a[56:59], v[204:207]
    buffer_load_dwordx4 v33, s[12:15], s48 offen offset:1024 nt lds
    v_mfma_f32_16x16x32_bf16 v[208:211], a[108:111], a[60:63], v[208:211]
    v_mfma_f32_16x16x32_bf16 v[212:215], a[112:115], a[60:63], v[212:215]
    s_add_u32 m0, s49, 8192
    v_mfma_f32_16x16x32_bf16 v[216:219], a[116:119], a[60:63], v[216:219]
    v_mfma_f32_16x16x32_bf16 v[220:223], a[120:123], a[60:63], v[220:223]
    s_add_u32 s47, s47, s89
    v_mfma_f32_16x16x32_bf16 v[224:227], a[108:111], a[64:67], v[224:227]
    v_mfma_f32_16x16x32_bf16 v[228:231], a[112:115], a[64:67], v[228:231]
    v_mfma_f32_16x16x32_bf16 v[232:235], a[116:119], a[64:67], v[232:235]
    buffer_load_dwordx4 v22, s[16:19], s48 offen nt lds
    v_mfma_f32_16x16x32_bf16 v[236:239], a[120:123], a[64:67], v[236:239]
    v_mfma_f32_16x16x32_bf16 v[240:243], a[108:111], a[68:71], v[240:243]
    buffer_load_dwordx4 v23, s[16:19], s48 offen offset:1024 nt lds
    v_mfma_f32_16x16x32_bf16 v[244:247], a[112:115], a[68:71], v[244:247]
    v_mfma_f32_16x16x32_bf16 v[248:251], a[116:119], a[68:71], v[248:251]
    s_and_b32 s47, s47, 0x3ffff
    v_mfma_f32_16x16x32_bf16 v[252:255], a[120:123], a[68:71], v[252:255]
    s_waitcnt vmcnt(8)
    s_waitcnt lgkmcnt(0)
    s_barrier
    v_mfma_f32_16x16x32_bf16 v[112:115], a[124:127], a[72:75], v[112:115]
    ds_read_b64_tr_b16 a[108:109], v30
    s_add_u32 m0, s52, 18432
    v_mfma_f32_16x16x32_bf16 v[116:119], a[128:131], a[72:75], v[116:119]
    ds_read_b64_tr_b16 a[110:111], v30 offset:512
    v_mfma_f32_16x16x32_bf16 v[120:123], a[132:135], a[72:75], v[120:123]
    ds_read_b64_tr_b16 a[112:113], v30 offset:8
    v_mfma_f32_16x16x32_bf16 v[124:127], a[136:139], a[72:75], v[124:127]
    ds_read_b64_tr_b16 a[114:115], v30 offset:520
    buffer_load_dwordx4 v56, s[4:7], s50 offen lds
    v_mfma_f32_16x16x32_bf16 v[128:131], a[124:127], a[76:79], v[128:131]
    ds_read_b64_tr_b16 a[116:117], v31
    v_mfma_f32_16x16x32_bf16 v[132:135], a[128:131], a[76:79], v[132:135]
    ds_read_b64_tr_b16 a[118:119], v31 offset:512
    buffer_load_dwordx4 v57, s[4:7], s50 offen offset:1024 lds
    v_mfma_f32_16x16x32_bf16 v[136:139], a[132:135], a[76:79], v[136:139]
    ds_read_b64_tr_b16 a[120:121], v31 offset:8
    v_mfma_f32_16x16x32_bf16 v[140:143], a[136:139], a[76:79], v[140:143]
    ds_read_b64_tr_b16 a[122:123], v31 offset:520
    buffer_load_dwordx4 v58, s[4:7], s50 offen offset:2048 lds
    v_mfma_f32_16x16x32_bf16 v[144:147], a[124:127], a[80:83], v[144:147]
    ds_read_b128 a[0:3], v28
    v_mfma_f32_16x16x32_bf16 v[148:151], a[128:131], a[80:83], v[148:151]
    ds_read_b128 a[4:7], v28 offset:2048
    s_add_u32 m0, s52, 21504
    v_mfma_f32_16x16x32_bf16 v[152:155], a[132:135], a[80:83], v[152:155]
    ds_read_b128 a[8:11], v28 offset:4096
    v_mfma_f32_16x16x32_bf16 v[156:159], a[136:139], a[80:83], v[156:159]
    ds_read_b128 a[12:15], v28 offset:6144
    v_mfma_f32_16x16x32_bf16 v[160:163], a[124:127], a[84:87], v[160:163]
    ds_read_b128 a[16:19], v28 offset:8192
    buffer_load_dwordx4 v59, s[4:7], s50 offen lds
    v_mfma_f32_16x16x32_bf16 v[164:167], a[128:131], a[84:87], v[164:167]
    ds_read_b128 a[20:23], v28 offset:10240
    v_mfma_f32_16x16x32_bf16 v[168:171], a[132:135], a[84:87], v[168:171]
    ds_read_b128 a[24:27], v28 offset:12288
    buffer_load_dwordx4 v60, s[4:7], s50 offen offset:1024 lds
    v_mfma_f32_16x16x32_bf16 v[172:175], a[136:139], a[84:87], v[172:175]
    ds_read_b128 a[28:31], v28 offset:14336
    v_mfma_f32_16x16x32_bf16 v[176:179], a[124:127], a[88:91], v[176:179]
    ds_read_b128 a[32:35], v28 offset:16384
    s_add_u32 s50, s50, 128
    v_mfma_f32_16x16x32_bf16 v[180:183], a[128:131], a[88:91], v[180:183]
    ds_read_b128 a[36:39], v29
    v_mfma_f32_16x16x32_bf16 v[184:187], a[132:135], a[88:91], v[184:187]
    ds_read_b128 a[40:43], v29 offset:2048
    s_and_b32 s50, s50, 1023
    v_mfma_f32_16x16x32_bf16 v[188:191], a[136:139], a[88:91], v[188:191]
    ds_read_b128 a[44:47], v29 offset:4096
    v_mfma_f32_16x16x32_bf16 v[192:195], a[124:127], a[92:95], v[192:195]
    ds_read_b128 a[48:51], v29 offset:6144
    v_mfma_f32_16x16x32_bf16 v[196:199], a[128:131], a[92:95], v[196:199]
    ds_read_b128 a[52:55], v29 offset:8192
    s_add_u32 m0, s53, 32768
    v_mfma_f32_16x16x32_bf16 v[200:203], a[132:135], a[92:95], v[200:203]
    ds_read_b128 a[56:59], v29 offset:10240
    v_mfma_f32_16x16x32_bf16 v[204:207], a[136:139], a[92:95], v[204:207]
    ds_read_b128 a[60:63], v29 offset:12288
    buffer_load_dwordx4 v61, s[8:11], s51 offen lds
    v_mfma_f32_16x16x32_bf16 v[208:211], a[124:127], a[96:99], v[208:211]
    ds_read_b128 a[64:67], v29 offset:14336
    v_mfma_f32_16x16x32_bf16 v[212:215], a[128:131], a[96:99], v[212:215]
    ds_read_b128 a[68:71], v29 offset:16384
    buffer_load_dwordx4 v62, s[8:11], s51 offen offset:1024 lds
    v_mfma_f32_16x16x32_bf16 v[216:219], a[132:135], a[96:99], v[216:219]
    v_mfma_f32_16x16x32_bf16 v[220:223], a[136:139], a[96:99], v[220:223]
    buffer_load_dwordx4 v63, s[8:11], s51 offen offset:2048 lds
    v_mfma_f32_16x16x32_bf16 v[224:227], a[124:127], a[100:103], v[224:227]
    v_mfma_f32_16x16x32_bf16 v[228:231], a[128:131], a[100:103], v[228:231]
    v_mfma_f32_16x16x32_bf16 v[232:235], a[132:135], a[100:103], v[232:235]
    buffer_load_dwordx4 v64, s[8:11], s51 offen offset:3072 lds
    v_mfma_f32_16x16x32_bf16 v[236:239], a[136:139], a[100:103], v[236:239]
    v_mfma_f32_16x16x32_bf16 v[240:243], a[124:127], a[104:107], v[240:243]
    s_add_u32 s51, s51, 262144
    v_mfma_f32_16x16x32_bf16 v[244:247], a[128:131], a[104:107], v[244:247]
    v_mfma_f32_16x16x32_bf16 v[248:251], a[132:135], a[104:107], v[248:251]
    s_and_b32 s51, s51, 0x3fffff
    v_mfma_f32_16x16x32_bf16 v[252:255], a[136:139], a[104:107], v[252:255]
    s_waitcnt vmcnt(13)
    s_waitcnt lgkmcnt(0)
    v_mfma_f32_16x16x32_bf16 v[112:115], a[108:111], a[0:3], v[112:115]
    ds_read_b64_tr_b16 a[124:125], v30 offset:16384
    s_add_u32 m0, s53, 0
    v_mfma_f32_16x16x32_bf16 v[116:119], a[112:115], a[0:3], v[116:119]
    ds_read_b64_tr_b16 a[126:127], v30 offset:16896
    v_mfma_f32_16x16x32_bf16 v[120:123], a[116:119], a[0:3], v[120:123]
    ds_read_b64_tr_b16 a[128:129], v30 offset:16392
    v_mfma_f32_16x16x32_bf16 v[124:127], a[120:123], a[0:3], v[124:127]
    ds_read_b64_tr_b16 a[130:131], v30 offset:16904
    buffer_load_dwordx4 v61, s[8:11], s51 offen lds
    v_mfma_f32_16x16x32_bf16 v[128:131], a[108:111], a[4:7], v[128:131]
    ds_read_b64_tr_b16 a[132:133], v31 offset:16384
    v_mfma_f32_16x16x32_bf16 v[132:135], a[112:115], a[4:7], v[132:135]
    ds_read_b64_tr_b16 a[134:135], v31 offset:16896
    buffer_load_dwordx4 v62, s[8:11], s51 offen offset:1024 lds
    v_mfma_f32_16x16x32_bf16 v[136:139], a[116:119], a[4:7], v[136:139]
    ds_read_b64_tr_b16 a[136:137], v31 offset:16392
    v_mfma_f32_16x16x32_bf16 v[140:143], a[120:123], a[4:7], v[140:143]
    ds_read_b64_tr_b16 a[138:139], v31 offset:16904
    buffer_load_dwordx4 v63, s[8:11], s51 offen offset:2048 lds
    v_mfma_f32_16x16x32_bf16 v[144:147], a[108:111], a[8:11], v[144:147]
    v_mfma_f32_16x16x32_bf16 v[148:151], a[112:115], a[8:11], v[148:151]
    buffer_load_dwordx4 v64, s[8:11], s51 offen offset:3072 lds
    v_mfma_f32_16x16x32_bf16 v[152:155], a[116:119], a[8:11], v[152:155]
    v_mfma_f32_16x16x32_bf16 v[156:159], a[120:123], a[8:11], v[156:159]
    v_mfma_f32_16x16x32_bf16 v[160:163], a[108:111], a[12:15], v[160:163]
    s_add_u32 s51, s51, 262144
    v_mfma_f32_16x16x32_bf16 v[164:167], a[112:115], a[12:15], v[164:167]
    v_mfma_f32_16x16x32_bf16 v[168:171], a[116:119], a[12:15], v[168:171]
    s_and_b32 s51, s51, 0x3fffff
    v_mfma_f32_16x16x32_bf16 v[172:175], a[120:123], a[12:15], v[172:175]
    v_mfma_f32_16x16x32_bf16 v[176:179], a[108:111], a[16:19], v[176:179]
    s_add_u32 m0, s49, 16384
    v_mfma_f32_16x16x32_bf16 v[180:183], a[112:115], a[16:19], v[180:183]
    v_mfma_f32_16x16x32_bf16 v[184:187], a[116:119], a[16:19], v[184:187]
    s_add_u32 s48, s46, s47
    v_mfma_f32_16x16x32_bf16 v[188:191], a[120:123], a[16:19], v[188:191]
    v_mfma_f32_16x16x32_bf16 v[192:195], a[108:111], a[20:23], v[192:195]
    v_mfma_f32_16x16x32_bf16 v[196:199], a[112:115], a[20:23], v[196:199]
    buffer_load_dwordx4 v32, s[12:15], s48 offen nt lds
    v_mfma_f32_16x16x32_bf16 v[200:203], a[116:119], a[20:23], v[200:203]
    v_mfma_f32_16x16x32_bf16 v[204:207], a[120:123], a[20:23], v[204:207]
    buffer_load_dwordx4 v33, s[12:15], s48 offen offset:1024 nt lds
    v_mfma_f32_16x16x32_bf16 v[208:211], a[108:111], a[24:27], v[208:211]
    v_mfma_f32_16x16x32_bf16 v[212:215], a[112:115], a[24:27], v[212:215]
    s_add_u32 m0, s49, 24576
    v_mfma_f32_16x16x32_bf16 v[216:219], a[116:119], a[24:27], v[216:219]
    v_mfma_f32_16x16x32_bf16 v[220:223], a[120:123], a[24:27], v[220:223]
    s_add_u32 s47, s47, s89
    v_mfma_f32_16x16x32_bf16 v[224:227], a[108:111], a[28:31], v[224:227]
    v_mfma_f32_16x16x32_bf16 v[228:231], a[112:115], a[28:31], v[228:231]
    v_mfma_f32_16x16x32_bf16 v[232:235], a[116:119], a[28:31], v[232:235]
    buffer_load_dwordx4 v22, s[16:19], s48 offen nt lds
    v_mfma_f32_16x16x32_bf16 v[236:239], a[120:123], a[28:31], v[236:239]
    v_mfma_f32_16x16x32_bf16 v[240:243], a[108:111], a[32:35], v[240:243]
    buffer_load_dwordx4 v23, s[16:19], s48 offen offset:1024 nt lds
    v_mfma_f32_16x16x32_bf16 v[244:247], a[112:115], a[32:35], v[244:247]
    v_mfma_f32_16x16x32_bf16 v[248:251], a[116:119], a[32:35], v[248:251]
    s_and_b32 s47, s47, 0x3ffff
    v_mfma_f32_16x16x32_bf16 v[252:255], a[120:123], a[32:35], v[252:255]
    s_waitcnt vmcnt(8)
    s_waitcnt lgkmcnt(0)
    s_barrier
    v_mfma_f32_16x16x32_bf16 v[112:115], a[124:127], a[36:39], v[112:115]
    ds_read_b64_tr_b16 a[108:109], v30 offset:32768
    v_mfma_f32_16x16x32_bf16 v[116:119], a[128:131], a[36:39], v[116:119]
    ds_read_b64_tr_b16 a[110:111], v30 offset:33280
    v_mfma_f32_16x16x32_bf16 v[120:123], a[132:135], a[36:39], v[120:123]
    ds_read_b64_tr_b16 a[112:113], v30 offset:32776
    v_mfma_f32_16x16x32_bf16 v[124:127], a[136:139], a[36:39], v[124:127]
    ds_read_b64_tr_b16 a[114:115], v30 offset:33288
    v_mfma_f32_16x16x32_bf16 v[128:131], a[124:127], a[40:43], v[128:131]
    ds_read_b64_tr_b16 a[116:117], v31 offset:32768
    v_mfma_f32_16x16x32_bf16 v[132:135], a[128:131], a[40:43], v[132:135]
    ds_read_b64_tr_b16 a[118:119], v31 offset:33280
    v_mfma_f32_16x16x32_bf16 v[136:139], a[132:135], a[40:43], v[136:139]
    ds_read_b64_tr_b16 a[120:121], v31 offset:32776
    v_mfma_f32_16x16x32_bf16 v[140:143], a[136:139], a[40:43], v[140:143]
    ds_read_b64_tr_b16 a[122:123], v31 offset:33288
    v_mfma_f32_16x16x32_bf16 v[144:147], a[124:127], a[44:47], v[144:147]
    ds_read_b128 a[72:75], v28 offset:18432
    v_mfma_f32_16x16x32_bf16 v[148:151], a[128:131], a[44:47], v[148:151]
    ds_read_b128 a[76:79], v28 offset:20480
    v_mfma_f32_16x16x32_bf16 v[152:155], a[132:135], a[44:47], v[152:155]
    ds_read_b128 a[80:83], v28 offset:22528
    v_mfma_f32_16x16x32_bf16 v[156:159], a[136:139], a[44:47], v[156:159]
    ds_read_b128 a[84:87], v28 offset:24576
    v_mfma_f32_16x16x32_bf16 v[160:163], a[124:127], a[48:51], v[160:163]
    ds_read_b128 a[88:91], v28 offset:26624
    v_mfma_f32_16x16x32_bf16 v[164:167], a[128:131], a[48:51], v[164:167]
    ds_read_b128 a[92:95], v28 offset:28672
    v_mfma_f32_16x16x32_bf16 v[168:171], a[132:135], a[48:51], v[168:171]
    ds_read_b128 a[96:99], v28 offset:30720
    v_mfma_f32_16x16x32_bf16 v[172:175], a[136:139], a[48:51], v[172:175]
    ds_read_b128 a[100:103], v28 offset:32768
    v_mfma_f32_16x16x32_bf16 v[176:179], a[124:127], a[52:55], v[176:179]
    ds_read_b128 a[104:107], v28 offset:34816
    v_mfma_f32_16x16x32_bf16 v[180:183], a[128:131], a[52:55], v[180:183]
    ds_read_b128 a[0:3], v29 offset:18432
    v_mfma_f32_16x16x32_bf16 v[184:187], a[132:135], a[52:55], v[184:187]
    ds_read_b128 a[4:7], v29 offset:20480
    v_mfma_f32_16x16x32_bf16 v[188:191], a[136:139], a[52:55], v[188:191]
    ds_read_b128 a[8:11], v29 offset:22528
    v_mfma_f32_16x16x32_bf16 v[192:195], a[124:127], a[56:59], v[192:195]
    ds_read_b128 a[12:15], v29 offset:24576
    v_mfma_f32_16x16x32_bf16 v[196:199], a[128:131], a[56:59], v[196:199]
    ds_read_b128 a[16:19], v29 offset:26624
    v_mfma_f32_16x16x32_bf16 v[200:203], a[132:135], a[56:59], v[200:203]
    ds_read_b128 a[20:23], v29 offset:28672
    v_mfma_f32_16x16x32_bf16 v[204:207], a[136:139], a[56:59], v[204:207]
    ds_read_b128 a[24:27], v29 offset:30720
    v_mfma_f32_16x16x32_bf16 v[208:211], a[124:127], a[60:63], v[208:211]
    ds_read_b128 a[28:31], v29 offset:32768
    v_mfma_f32_16x16x32_bf16 v[212:215], a[128:131], a[60:63], v[212:215]
    ds_read_b128 a[32:35], v29 offset:34816
    v_mfma_f32_16x16x32_bf16 v[216:219], a[132:135], a[60:63], v[216:219]
    v_mfma_f32_16x16x32_bf16 v[220:223], a[136:139], a[60:63], v[220:223]
    v_mfma_f32_16x16x32_bf16 v[224:227], a[124:127], a[64:67], v[224:227]
    v_mfma_f32_16x16x32_bf16 v[228:231], a[128:131], a[64:67], v[228:231]
    v_mfma_f32_16x16x32_bf16 v[232:235], a[132:135], a[64:67], v[232:235]
    v_mfma_f32_16x16x32_bf16 v[236:239], a[136:139], a[64:67], v[236:239]
    v_mfma_f32_16x16x32_bf16 v[240:243], a[124:127], a[68:71], v[240:243]
    v_mfma_f32_16x16x32_bf16 v[244:247], a[128:131], a[68:71], v[244:247]
    v_mfma_f32_16x16x32_bf16 v[248:251], a[132:135], a[68:71], v[248:251]
    v_mfma_f32_16x16x32_bf16 v[252:255], a[136:139], a[68:71], v[252:255]
    s_waitcnt vmcnt(4)
    s_waitcnt lgkmcnt(0)
    v_mfma_f32_16x16x32_bf16 v[112:115], a[108:111], a[72:75], v[112:115]
    ds_read_b64_tr_b16 a[124:125], v30
    s_add_u32 m0, s49, 32768
    v_mfma_f32_16x16x32_bf16 v[116:119], a[112:115], a[72:75], v[116:119]
    ds_read_b64_tr_b16 a[126:127], v30 offset:512
    v_mfma_f32_16x16x32_bf16 v[120:123], a[116:119], a[72:75], v[120:123]
    ds_read_b64_tr_b16 a[128:129], v30 offset:8
    v_mfma_f32_16x16x32_bf16 v[124:127], a[120:123], a[72:75], v[124:127]
    ds_read_b64_tr_b16 a[130:131], v30 offset:520
    v_mfma_f32_16x16x32_bf16 v[128:131], a[108:111], a[76:79], v[128:131]
    ds_read_b64_tr_b16 a[132:133], v31
    s_add_u32 s48, s46, s47
    v_mfma_f32_16x16x32_bf16 v[132:135], a[112:115], a[76:79], v[132:135]
    ds_read_b64_tr_b16 a[134:135], v31 offset:512
    v_mfma_f32_16x16x32_bf16 v[136:139], a[116:119], a[76:79], v[136:139]
    ds_read_b64_tr_b16 a[136:137], v31 offset:8
    v_mfma_f32_16x16x32_bf16 v[140:143], a[120:123], a[76:79], v[140:143]
    ds_read_b64_tr_b16 a[138:139], v31 offset:520
    v_mfma_f32_16x16x32_bf16 v[144:147], a[108:111], a[80:83], v[144:147]
    ds_read_b128 v[80:83], v96
    buffer_load_dwordx4 v32, s[12:15], s48 offen nt lds
    v_mfma_f32_16x16x32_bf16 v[148:151], a[112:115], a[80:83], v[148:151]
    ds_read_b128 v[84:87], v96 offset:64
    v_mfma_f32_16x16x32_bf16 v[152:155], a[116:119], a[80:83], v[152:155]
    ds_read_b128 v[88:91], v96 offset:128
    v_mfma_f32_16x16x32_bf16 v[156:159], a[120:123], a[80:83], v[156:159]
    ds_read_b128 v[92:95], v96 offset:192
    v_mfma_f32_16x16x32_bf16 v[160:163], a[108:111], a[84:87], v[160:163]
    ds_read_b128 a[144:147], v6
    buffer_load_dwordx4 v33, s[12:15], s48 offen offset:1024 nt lds
    v_mfma_f32_16x16x32_bf16 v[164:167], a[112:115], a[84:87], v[164:167]
    ds_read_b128 a[160:163], v6 offset:4096
    v_mfma_f32_16x16x32_bf16 v[168:171], a[116:119], a[84:87], v[168:171]
    ds_read_b128 a[148:151], v7
    v_mfma_f32_16x16x32_bf16 v[172:175], a[120:123], a[84:87], v[172:175]
    ds_read_b128 a[164:167], v7 offset:4096
    v_mfma_f32_16x16x32_bf16 v[176:179], a[108:111], a[88:91], v[176:179]
    ds_read_b128 a[152:155], v8
    s_add_u32 m0, s49, 40960
    v_mfma_f32_16x16x32_bf16 v[180:183], a[112:115], a[88:91], v[180:183]
    ds_read_b128 a[168:171], v8 offset:4096
    v_mfma_f32_16x16x32_bf16 v[184:187], a[116:119], a[88:91], v[184:187]
    ds_read_b128 a[156:159], v9
    v_mfma_f32_16x16x32_bf16 v[188:191], a[120:123], a[88:91], v[188:191]
    ds_read_b128 a[172:175], v9 offset:4096
    v_mfma_f32_16x16x32_bf16 v[192:195], a[108:111], a[92:95], v[192:195]
    ds_read_b64_tr_b16 a[176:177], v10
    s_add_u32 s47, s47, s89
    v_mfma_f32_16x16x32_bf16 v[196:199], a[112:115], a[92:95], v[196:199]
    ds_read_b64_tr_b16 a[178:179], v10 offset:4096
    v_mfma_f32_16x16x32_bf16 v[200:203], a[116:119], a[92:95], v[200:203]
    ds_read_b64_tr_b16 a[180:181], v11
    v_mfma_f32_16x16x32_bf16 v[204:207], a[120:123], a[92:95], v[204:207]
    ds_read_b64_tr_b16 a[182:183], v11 offset:4096
    v_mfma_f32_16x16x32_bf16 v[208:211], a[108:111], a[96:99], v[208:211]
    ds_read_b64_tr_b16 a[184:185], v12
    buffer_load_dwordx4 v22, s[16:19], s48 offen nt lds
    v_mfma_f32_16x16x32_bf16 v[212:215], a[112:115], a[96:99], v[212:215]
    ds_read_b64_tr_b16 a[186:187], v12 offset:4096
    v_mfma_f32_16x16x32_bf16 v[216:219], a[116:119], a[96:99], v[216:219]
    ds_read_b64_tr_b16 a[188:189], v13
    v_mfma_f32_16x16x32_bf16 v[220:223], a[120:123], a[96:99], v[220:223]
    ds_read_b64_tr_b16 a[190:191], v13 offset:4096
    v_mfma_f32_16x16x32_bf16 v[224:227], a[108:111], a[100:103], v[224:227]
    ds_read_b64_tr_b16 a[192:193], v14
    buffer_load_dwordx4 v23, s[16:19], s48 offen offset:1024 nt lds
    v_mfma_f32_16x16x32_bf16 v[228:231], a[112:115], a[100:103], v[228:231]
    ds_read_b64_tr_b16 a[194:195], v14 offset:4096
    v_mfma_f32_16x16x32_bf16 v[232:235], a[116:119], a[100:103], v[232:235]
    ds_read_b64_tr_b16 a[196:197], v15
    v_mfma_f32_16x16x32_bf16 v[236:239], a[120:123], a[100:103], v[236:239]
    ds_read_b64_tr_b16 a[198:199], v15 offset:4096
    v_mfma_f32_16x16x32_bf16 v[240:243], a[108:111], a[104:107], v[240:243]
    ds_read_b64_tr_b16 a[200:201], v16
    s_and_b32 s47, s47, 0x3ffff
    v_mfma_f32_16x16x32_bf16 v[244:247], a[112:115], a[104:107], v[244:247]
    ds_read_b64_tr_b16 a[202:203], v16 offset:4096
    v_mfma_f32_16x16x32_bf16 v[248:251], a[116:119], a[104:107], v[248:251]
    ds_read_b64_tr_b16 a[204:205], v17
    v_mfma_f32_16x16x32_bf16 v[252:255], a[120:123], a[104:107], v[252:255]
    ds_read_b64_tr_b16 a[206:207], v17 offset:4096
    s_waitcnt lgkmcnt(0)
    s_barrier
    v_mfma_f32_16x16x32_bf16 v[112:115], a[124:127], a[0:3], v[112:115]
    s_add_u32 m0, s49, 49152
    s_add_u32 s48, s46, s47
    buffer_load_dwordx4 v32, s[12:15], s48 offen nt lds
    v_mfma_f32_16x16x32_bf16 v[116:119], a[128:131], a[0:3], v[116:119]
    buffer_load_dwordx4 v33, s[12:15], s48 offen offset:1024 nt lds
    s_add_u32 m0, s49, 57344
    s_add_u32 s47, s47, s89
    v_mfma_f32_16x16x32_bf16 v[120:123], a[132:135], a[0:3], v[120:123]
    buffer_load_dwordx4 v22, s[16:19], s48 offen nt lds
    buffer_load_dwordx4 v23, s[16:19], s48 offen offset:1024 nt lds
    s_and_b32 s47, s47, 0x3ffff
    v_mfma_f32_16x16x32_bf16 v[124:127], a[136:139], a[0:3], v[124:127]
    s_mov_b32 s40, 0x80008000
    v_xor_b32 v80, s40, v80
    v_xor_b32 v81, s40, v81
    v_mfma_f32_16x16x32_bf16 v[128:131], a[124:127], a[4:7], v[128:131]
    v_xor_b32 v82, s40, v82
    v_xor_b32 v83, s40, v83
    v_xor_b32 v84, s40, v84
    v_mfma_f32_16x16x32_bf16 v[132:135], a[128:131], a[4:7], v[132:135]
    v_xor_b32 v85, s40, v85
    v_xor_b32 v86, s40, v86
    v_xor_b32 v87, s40, v87
    v_mfma_f32_16x16x32_bf16 v[136:139], a[132:135], a[4:7], v[136:139]
    v_xor_b32 v88, s40, v88
    v_xor_b32 v89, s40, v89
    v_xor_b32 v90, s40, v90
    v_mfma_f32_16x16x32_bf16 v[140:143], a[136:139], a[4:7], v[140:143]
    v_xor_b32 v91, s40, v91
    v_xor_b32 v92, s40, v92
    v_xor_b32 v93, s40, v93
    v_mfma_f32_16x16x32_bf16 v[144:147], a[124:127], a[8:11], v[144:147]
    v_xor_b32 v94, s40, v94
    v_xor_b32 v95, s40, v95
    v_pk_mul_f32 v[112:113], v[112:113], v[34:35]
    v_mfma_f32_16x16x32_bf16 v[148:151], a[128:131], a[8:11], v[148:151]
    v_pk_mul_f32 v[114:115], v[114:115], v[34:35]
    v_pk_mul_f32 v[116:117], v[116:117], v[34:35]
    v_pk_mul_f32 v[118:119], v[118:119], v[34:35]
    v_mfma_f32_16x16x32_bf16 v[152:155], a[132:135], a[8:11], v[152:155]
    v_cvt_pk_bf16_f32 v112, v112, v113
    v_cvt_pk_bf16_f32 v113, v114, v115
    v_cvt_pk_bf16_f32 v114, v116, v117
    v_mfma_f32_16x16x32_bf16 v[156:159], a[136:139], a[8:11], v[156:159]
    v_cvt_pk_bf16_f32 v115, v118, v119
    ds_write_b128 v98, v[112:115]
    v_pk_mul_f32 v[120:121], v[120:121], v[34:35]
    v_mfma_f32_16x16x32_bf16 v[160:163], a[124:127], a[12:15], v[160:163]
    v_pk_mul_f32 v[122:123], v[122:123], v[34:35]
    v_pk_mul_f32 v[124:125], v[124:125], v[34:35]
    v_pk_mul_f32 v[126:127], v[126:127], v[34:35]
    v_mfma_f32_16x16x32_bf16 v[164:167], a[128:131], a[12:15], v[164:167]
    v_cvt_pk_bf16_f32 v120, v120, v121
    v_cvt_pk_bf16_f32 v121, v122, v123
    v_cvt_pk_bf16_f32 v122, v124, v125
    v_mfma_f32_16x16x32_bf16 v[168:171], a[132:135], a[12:15], v[168:171]
    v_cvt_pk_bf16_f32 v123, v126, v127
    ds_write_b128 v98, v[120:123] offset:1024
    v_pk_mul_f32 v[128:129], v[128:129], v[34:35]
    v_mfma_f32_16x16x32_bf16 v[172:175], a[136:139], a[12:15], v[172:175]
    v_pk_mul_f32 v[130:131], v[130:131], v[34:35]
    v_pk_mul_f32 v[132:133], v[132:133], v[34:35]
    v_pk_mul_f32 v[134:135], v[134:135], v[34:35]
    v_mfma_f32_16x16x32_bf16 v[176:179], a[124:127], a[16:19], v[176:179]
    v_cvt_pk_bf16_f32 v128, v128, v129
    v_cvt_pk_bf16_f32 v129, v130, v131
    v_cvt_pk_bf16_f32 v130, v132, v133
    v_mfma_f32_16x16x32_bf16 v[180:183], a[128:131], a[16:19], v[180:183]
    v_cvt_pk_bf16_f32 v131, v134, v135
    ds_write_b128 v98, v[128:131] offset:4096
    v_pk_mul_f32 v[136:137], v[136:137], v[34:35]
    v_mfma_f32_16x16x32_bf16 v[184:187], a[132:135], a[16:19], v[184:187]
    v_pk_mul_f32 v[138:139], v[138:139], v[34:35]
    v_pk_mul_f32 v[140:141], v[140:141], v[34:35]
    v_pk_mul_f32 v[142:143], v[142:143], v[34:35]
    v_mfma_f32_16x16x32_bf16 v[188:191], a[136:139], a[16:19], v[188:191]
    v_cvt_pk_bf16_f32 v136, v136, v137
    v_cvt_pk_bf16_f32 v137, v138, v139
    v_cvt_pk_bf16_f32 v138, v140, v141
    v_mfma_f32_16x16x32_bf16 v[192:195], a[124:127], a[20:23], v[192:195]
    v_cvt_pk_bf16_f32 v139, v142, v143
    ds_write_b128 v98, v[136:139] offset:5120
    v_pk_mul_f32 v[144:145], v[144:145], v[34:35]
    v_mfma_f32_16x16x32_bf16 v[196:199], a[128:131], a[20:23], v[196:199]
    v_pk_mul_f32 v[146:147], v[146:147], v[34:35]
    v_pk_mul_f32 v[148:149], v[148:149], v[34:35]
    v_pk_mul_f32 v[150:151], v[150:151], v[34:35]
    v_mfma_f32_16x16x32_bf16 v[200:203], a[132:135], a[20:23], v[200:203]
    v_cvt_pk_bf16_f32 v144, v144, v145
    v_cvt_pk_bf16_f32 v145, v146, v147
    v_cvt_pk_bf16_f32 v146, v148, v149
    v_mfma_f32_16x16x32_bf16 v[204:207], a[136:139], a[20:23], v[204:207]
    v_cvt_pk_bf16_f32 v147, v150, v151
    ds_write_b128 v98, v[144:147] offset:8192
    v_pk_mul_f32 v[152:153], v[152:153], v[34:35]
    v_mfma_f32_16x16x32_bf16 v[208:211], a[124:127], a[24:27], v[208:211]
    v_pk_mul_f32 v[154:155], v[154:155], v[34:35]
    v_pk_mul_f32 v[156:157], v[156:157], v[34:35]
    v_pk_mul_f32 v[158:159], v[158:159], v[34:35]
    v_mfma_f32_16x16x32_bf16 v[212:215], a[128:131], a[24:27], v[212:215]
    v_cvt_pk_bf16_f32 v152, v152, v153
    v_cvt_pk_bf16_f32 v153, v154, v155
    v_cvt_pk_bf16_f32 v154, v156, v157
    v_mfma_f32_16x16x32_bf16 v[216:219], a[132:135], a[24:27], v[216:219]
    v_cvt_pk_bf16_f32 v155, v158, v159
    ds_write_b128 v98, v[152:155] offset:9216
    v_pk_mul_f32 v[160:161], v[160:161], v[34:35]
    v_mfma_f32_16x16x32_bf16 v[220:223], a[136:139], a[24:27], v[220:223]
    v_pk_mul_f32 v[162:163], v[162:163], v[34:35]
    v_pk_mul_f32 v[164:165], v[164:165], v[34:35]
    v_pk_mul_f32 v[166:167], v[166:167], v[34:35]
    v_mfma_f32_16x16x32_bf16 v[224:227], a[124:127], a[28:31], v[224:227]
    v_cvt_pk_bf16_f32 v160, v160, v161
    v_cvt_pk_bf16_f32 v161, v162, v163
    v_cvt_pk_bf16_f32 v162, v164, v165
    v_mfma_f32_16x16x32_bf16 v[228:231], a[128:131], a[28:31], v[228:231]
    v_cvt_pk_bf16_f32 v163, v166, v167
    ds_write_b128 v98, v[160:163] offset:12288
    v_pk_mul_f32 v[168:169], v[168:169], v[34:35]
    v_mfma_f32_16x16x32_bf16 v[232:235], a[132:135], a[28:31], v[232:235]
    v_pk_mul_f32 v[170:171], v[170:171], v[34:35]
    v_pk_mul_f32 v[172:173], v[172:173], v[34:35]
    v_pk_mul_f32 v[174:175], v[174:175], v[34:35]
    v_mfma_f32_16x16x32_bf16 v[236:239], a[136:139], a[28:31], v[236:239]
    v_cvt_pk_bf16_f32 v168, v168, v169
    v_cvt_pk_bf16_f32 v169, v170, v171
    v_cvt_pk_bf16_f32 v170, v172, v173
    v_mfma_f32_16x16x32_bf16 v[240:243], a[124:127], a[32:35], v[240:243]
    v_cvt_pk_bf16_f32 v171, v174, v175
    ds_write_b128 v98, v[168:171] offset:13312
    v_pk_mul_f32 v[176:177], v[176:177], v[34:35]
    v_mfma_f32_16x16x32_bf16 v[244:247], a[128:131], a[32:35], v[244:247]
    v_pk_mul_f32 v[178:179], v[178:179], v[34:35]
    v_pk_mul_f32 v[180:181], v[180:181], v[34:35]
    v_pk_mul_f32 v[182:183], v[182:183], v[34:35]
    v_mfma_f32_16x16x32_bf16 v[248:251], a[132:135], a[32:35], v[248:251]
    v_cvt_pk_bf16_f32 v176, v176, v177
    v_cvt_pk_bf16_f32 v177, v178, v179
    v_cvt_pk_bf16_f32 v178, v180, v181
    v_mfma_f32_16x16x32_bf16 v[252:255], a[136:139], a[32:35], v[252:255]
    v_cvt_pk_bf16_f32 v179, v182, v183
    ds_write_b128 v98, v[176:179] offset:16384
    v_pk_mul_f32 v[184:185], v[184:185], v[34:35]
    v_pk_mul_f32 v[186:187], v[186:187], v[34:35]
    v_pk_mul_f32 v[188:189], v[188:189], v[34:35]
    v_pk_mul_f32 v[190:191], v[190:191], v[34:35]
    v_cvt_pk_bf16_f32 v184, v184, v185
    v_cvt_pk_bf16_f32 v185, v186, v187
    v_cvt_pk_bf16_f32 v186, v188, v189
    v_cvt_pk_bf16_f32 v187, v190, v191
    ds_write_b128 v98, v[184:187] offset:17408
    v_pk_mul_f32 v[192:193], v[192:193], v[34:35]
    v_pk_mul_f32 v[194:195], v[194:195], v[34:35]
    v_pk_mul_f32 v[196:197], v[196:197], v[34:35]
    v_pk_mul_f32 v[198:199], v[198:199], v[34:35]
    v_cvt_pk_bf16_f32 v192, v192, v193
    v_cvt_pk_bf16_f32 v193, v194, v195
    v_cvt_pk_bf16_f32 v194, v196, v197
    v_cvt_pk_bf16_f32 v195, v198, v199
    ds_write_b128 v98, v[192:195] offset:20480
    v_pk_mul_f32 v[200:201], v[200:201], v[34:35]
    v_pk_mul_f32 v[202:203], v[202:203], v[34:35]
    v_pk_mul_f32 v[204:205], v[204:205], v[34:35]
    v_pk_mul_f32 v[206:207], v[206:207], v[34:35]
    v_cvt_pk_bf16_f32 v200, v200, v201
    v_cvt_pk_bf16_f32 v201, v202, v203
    v_cvt_pk_bf16_f32 v202, v204, v205
    v_cvt_pk_bf16_f32 v203, v206, v207
    ds_write_b128 v98, v[200:203] offset:21504
    v_pk_mul_f32 v[208:209], v[208:209], v[34:35]
    v_pk_mul_f32 v[210:211], v[210:211], v[34:35]
    v_pk_mul_f32 v[212:213], v[212:213], v[34:35]
    v_pk_mul_f32 v[214:215], v[214:215], v[34:35]
    v_cvt_pk_bf16_f32 v208, v208, v209
    v_cvt_pk_bf16_f32 v209, v210, v211
    v_cvt_pk_bf16_f32 v210, v212, v213
    v_cvt_pk_bf16_f32 v211, v214, v215
    ds_write_b128 v98, v[208:211] offset:24576
    v_pk_mul_f32 v[216:217], v[216:217], v[34:35]
    v_pk_mul_f32 v[218:219], v[218:219], v[34:35]
    v_pk_mul_f32 v[220:221], v[220:221], v[34:35]
    v_pk_mul_f32 v[222:223], v[222:223], v[34:35]
    v_cvt_pk_bf16_f32 v216, v216, v217
    v_cvt_pk_bf16_f32 v217, v218, v219
    v_cvt_pk_bf16_f32 v218, v220, v221
    v_cvt_pk_bf16_f32 v219, v222, v223
    ds_write_b128 v98, v[216:219] offset:25600
    v_pk_mul_f32 v[224:225], v[224:225], v[34:35]
    v_pk_mul_f32 v[226:227], v[226:227], v[34:35]
    v_pk_mul_f32 v[228:229], v[228:229], v[34:35]
    v_pk_mul_f32 v[230:231], v[230:231], v[34:35]
    v_cvt_pk_bf16_f32 v224, v224, v225
    v_cvt_pk_bf16_f32 v225, v226, v227
    v_cvt_pk_bf16_f32 v226, v228, v229
    v_cvt_pk_bf16_f32 v227, v230, v231
    ds_write_b128 v98, v[224:227] offset:28672
    v_pk_mul_f32 v[232:233], v[232:233], v[34:35]
    v_pk_mul_f32 v[234:235], v[234:235], v[34:35]
    v_pk_mul_f32 v[236:237], v[236:237], v[34:35]
    v_pk_mul_f32 v[238:239], v[238:239], v[34:35]
    v_cvt_pk_bf16_f32 v232, v232, v233
    v_cvt_pk_bf16_f32 v233, v234, v235
    v_cvt_pk_bf16_f32 v234, v236, v237
    v_cvt_pk_bf16_f32 v235, v238, v239
    ds_write_b128 v98, v[232:235] offset:29696
    v_pk_mul_f32 v[240:241], v[240:241], v[34:35]
    v_pk_mul_f32 v[242:243], v[242:243], v[34:35]
    v_pk_mul_f32 v[244:245], v[244:245], v[34:35]
    v_pk_mul_f32 v[246:247], v[246:247], v[34:35]
    v_cvt_pk_bf16_f32 v240, v240, v241
    v_cvt_pk_bf16_f32 v241, v242, v243
    v_cvt_pk_bf16_f32 v242, v244, v245
    v_cvt_pk_bf16_f32 v243, v246, v247
    ds_write_b128 v98, v[240:243] offset:32768
    v_pk_mul_f32 v[248:249], v[248:249], v[34:35]
    v_pk_mul_f32 v[250:251], v[250:251], v[34:35]
    v_pk_mul_f32 v[252:253], v[252:253], v[34:35]
    v_pk_mul_f32 v[254:255], v[254:255], v[34:35]
    v_cvt_pk_bf16_f32 v248, v248, v249
    v_cvt_pk_bf16_f32 v249, v250, v251
    v_cvt_pk_bf16_f32 v250, v252, v253
    v_cvt_pk_bf16_f32 v251, v254, v255
    ds_write_b128 v98, v[248:251] offset:33792
    v_mov_b32 v3, 0x3f803f80
    v_accvgpr_write_b32 a108, v3
    v_accvgpr_write_b32 a109, v3
    v_accvgpr_write_b32 a110, v3
    v_accvgpr_write_b32 a111, v3
    s_cmp_eq_u32 s36, 2
    s_cselect_b32 s4, s16, s12
    s_cselect_b32 s5, s17, s13
    s_mov_b32 s6, 0x4000000
    s_mov_b32 s7, 0x20000
    s_cselect_b32 s49, 8192, 0
    s_cselect_b64 vcc, -1, 0
    s_nop 1
    v_cndmask_b32 v28, v18, v22, vcc
    v_cndmask_b32 v29, v19, v23, vcc
    v_cndmask_b32 v30, v20, v22, vcc
    v_cndmask_b32 v31, v21, v23, vcc
    s_lshl_b32 s47, s89, 2
    s_add_u32 s47, s57, s47
    s_and_b32 s47, s47, 0x3ffff
    s_mov_b32 s46, s69
    s_cmp_eq_u32 s36, 3
    s_cbranch_scc1 L_rC
    s_cmp_lg_u32 s36, 0
    s_cbranch_scc1 L_rB
    s_mul_i32 s39, s3, 18432
    v_add_u32 v107, s39, v97
    v_add_u32 v97, 36864, v97
    v_subrev_u32 v97, s39, v97
    v_add_u32 v106, 139264, v2
    v_add_u32 v98, s66, v101
L_main_A:
    s_mov_b32 s67, 0
    s_waitcnt vmcnt(8)
    s_waitcnt lgkmcnt(0)
    s_barrier
    s_cmp_lg_u32 s55, 0
    s_cbranch_scc1 L_np0A
    ds_read_b128 a[0:3], v107
    ds_read_b128 a[4:7], v107 offset:1024
    ds_read_b128 a[8:11], v107 offset:2048
    ds_read_b128 a[12:15], v107 offset:3072
    ds_read_b128 a[16:19], v107 offset:4096
    ds_read_b128 a[20:23], v107 offset:5120
    ds_read_b128 a[24:27], v107 offset:6144
    ds_read_b128 a[28:31], v107 offset:7168
    ds_read_b128 a[32:35], v107 offset:32768
    ds_read_b128 a[36:39], v107 offset:33792
    ds_read_b128 a[40:43], v107 offset:34816
    ds_read_b128 a[44:47], v107 offset:35840
    s_waitcnt lgkmcnt(0)
    v_mfma_f32_16x16x32_bf16 v[56:59], v[80:83], a[0:3], 0
    v_mfma_f32_16x16x32_bf16 v[56:59], v[84:87], a[4:7], v[56:59]
    v_mfma_f32_16x16x32_bf16 v[56:59], v[88:91], a[8:11], v[56:59]
    v_mfma_f32_16x16x32_bf16 v[56:59], v[92:95], a[12:15], v[56:59]
    v_mfma_f32_16x16x32_bf16 v[60:63], v[80:83], a[16:19], 0
    v_mfma_f32_16x16x32_bf16 v[60:63], v[84:87], a[20:23], v[60:63]
    v_mfma_f32_16x16x32_bf16 v[60:63], v[88:91], a[24:27], v[60:63]
    v_mfma_f32_16x16x32_bf16 v[60:63], v[92:95], a[28:31], v[60:63]
    v_mfma_f32_16x16x32_bf16 v[64:67], v[80:83], a[32:35], 0
    v_mfma_f32_16x16x32_bf16 v[64:67], v[84:87], a[36:39], v[64:67]
    v_mfma_f32_16x16x32_bf16 v[64:67], v[88:91], a[40:43], v[64:67]
    v_mfma_f32_16x16x32_bf16 v[64:67], v[92:95], a[44:47], v[64:67]
L_np0A:
    v_mfma_f32_16x16x32_bf16 v[32:35], a[144:147], a[0:3], v[56:59]
    ds_read_b128 a[112:115], v6 offset:16384
    ds_read_b128 a[128:131], v6 offset:20480
    v_mfma_f32_16x16x32_bf16 v[36:39], a[160:163], a[0:3], v[56:59]
    ds_read_b128 a[116:119], v7 offset:16384
    ds_read_b128 a[132:135], v7 offset:20480
    v_mfma_f32_16x16x32_bf16 v[32:35], a[148:151], a[4:7], v[32:35]
    ds_read_b128 a[120:123], v8 offset:16384
    ds_read_b128 a[136:139], v8 offset:20480
    v_mfma_f32_16x16x32_bf16 v[36:39], a[164:167], a[4:7], v[36:39]
    ds_read_b128 a[124:127], v9 offset:16384
    ds_read_b128 a[140:143], v9 offset:20480
    v_mfma_f32_16x16x32_bf16 v[32:35], a[152:155], a[8:11], v[32:35]
    ds_read_b64_tr_b16 a[208:209], v10 offset:16384
    ds_read_b64_tr_b16 a[210:211], v10 offset:20480
    v_mfma_f32_16x16x32_bf16 v[36:39], a[168:171], a[8:11], v[36:39]
    ds_read_b64_tr_b16 a[212:213], v11 offset:16384
    ds_read_b64_tr_b16 a[214:215], v11 offset:20480
    v_mfma_f32_16x16x32_bf16 v[32:35], a[156:159], a[12:15], v[32:35]
    ds_read_b64_tr_b16 a[216:217], v12 offset:16384
    ds_read_b64_tr_b16 a[218:219], v12 offset:20480
    v_mfma_f32_16x16x32_bf16 v[36:39], a[172:175], a[12:15], v[36:39]
    ds_read_b64_tr_b16 a[220:221], v13 offset:16384
    ds_read_b64_tr_b16 a[222:223], v13 offset:20480
    ds_read_b64_tr_b16 a[224:225], v14 offset:16384
    ds_read_b64_tr_b16 a[226:227], v14 offset:20480
    ds_read_b64_tr_b16 a[228:229], v15 offset:16384
    ds_read_b64_tr_b16 a[230:231], v15 offset:20480
    ds_read_b64_tr_b16 a[232:233], v16 offset:16384
    ds_read_b64_tr_b16 a[234:235], v16 offset:20480
    ds_read_b64_tr_b16 a[236:237], v17 offset:16384
    ds_read_b64_tr_b16 a[238:239], v17 offset:20480
    v_mfma_f32_16x16x32_bf16 v[40:43], a[144:147], a[16:19], v[60:63]
    v_exp_f32 v32, v32
    v_mfma_f32_16x16x32_bf16 v[44:47], a[160:163], a[16:19], v[60:63]
    v_mfma_f32_16x16x32_bf16 v[40:43], a[148:151], a[20:23], v[40:43]
    v_exp_f32 v33, v33
    v_mfma_f32_16x16x32_bf16 v[44:47], a[164:167], a[20:23], v[44:47]
    v_cvt_pk_bf16_f32 v48, v32, v33
    v_mfma_f32_16x16x32_bf16 v[40:43], a[152:155], a[24:27], v[40:43]
    v_exp_f32 v34, v34
    v_mfma_f32_16x16x32_bf16 v[44:47], a[168:171], a[24:27], v[44:47]
    v_mfma_f32_16x16x32_bf16 v[40:43], a[156:159], a[28:31], v[40:43]
    v_exp_f32 v35, v35
    v_mfma_f32_16x16x32_bf16 v[44:47], a[172:175], a[28:31], v[44:47]
    v_cvt_pk_bf16_f32 v49, v34, v35
    v_exp_f32 v36, v36
    v_exp_f32 v37, v37
    s_nop 0
    v_cvt_pk_bf16_f32 v50, v36, v37
    v_exp_f32 v38, v38
    v_exp_f32 v39, v39
    s_nop 0
    v_cvt_pk_bf16_f32 v51, v38, v39
    v_mfma_f32_16x16x32_bf16 v[32:35], a[144:147], a[32:35], v[64:67]
    v_exp_f32 v40, v40
    v_mfma_f32_16x16x32_bf16 v[36:39], a[160:163], a[32:35], v[64:67]
    v_mfma_f32_16x16x32_bf16 v[32:35], a[148:151], a[36:39], v[32:35]
    v_exp_f32 v41, v41
    v_mfma_f32_16x16x32_bf16 v[36:39], a[164:167], a[36:39], v[36:39]
    v_cvt_pk_bf16_f32 v52, v40, v41
    v_mfma_f32_16x16x32_bf16 v[32:35], a[152:155], a[40:43], v[32:35]
    v_exp_f32 v42, v42
    v_mfma_f32_16x16x32_bf16 v[36:39], a[168:171], a[40:43], v[36:39]
    v_mfma_f32_16x16x32_bf16 v[32:35], a[156:159], a[44:47], v[32:35]
    v_exp_f32 v43, v43
    v_mfma_f32_16x16x32_bf16 v[36:39], a[172:175], a[44:47], v[36:39]
    v_cvt_pk_bf16_f32 v53, v42, v43
    v_mfma_f32_16x16x32_bf16 v[160:163], a[176:179], v[48:51], 0
    v_exp_f32 v44, v44
    v_mfma_f32_16x16x32_bf16 v[164:167], a[180:183], v[48:51], 0
    v_mfma_f32_16x16x32_bf16 v[168:171], a[184:187], v[48:51], 0
    v_exp_f32 v45, v45
    v_mfma_f32_16x16x32_bf16 v[172:175], a[188:191], v[48:51], 0
    v_cvt_pk_bf16_f32 v54, v44, v45
    v_mfma_f32_16x16x32_bf16 v[176:179], a[192:195], v[48:51], 0
    v_exp_f32 v46, v46
    v_mfma_f32_16x16x32_bf16 v[180:183], a[196:199], v[48:51], 0
    v_mfma_f32_16x16x32_bf16 v[184:187], a[200:203], v[48:51], 0
    v_exp_f32 v47, v47
    v_mfma_f32_16x16x32_bf16 v[188:191], a[204:207], v[48:51], 0
    v_cvt_pk_bf16_f32 v55, v46, v47
    v_mfma_f32_16x16x32_bf16 a[96:99], a[108:111], v[48:51], 0
    s_waitcnt lgkmcnt(15)
    v_mfma_f32_16x16x32_bf16 v[40:43], a[112:115], a[0:3], v[56:59]
    v_exp_f32 v32, v32
    v_mfma_f32_16x16x32_bf16 v[44:47], a[128:131], a[0:3], v[56:59]
    v_mfma_f32_16x16x32_bf16 v[40:43], a[116:119], a[4:7], v[40:43]
    v_exp_f32 v33, v33
    v_mfma_f32_16x16x32_bf16 v[44:47], a[132:135], a[4:7], v[44:47]
    v_cvt_pk_bf16_f32 v48, v32, v33
    v_mfma_f32_16x16x32_bf16 v[40:43], a[120:123], a[8:11], v[40:43]
    v_exp_f32 v34, v34
    v_mfma_f32_16x16x32_bf16 v[44:47], a[136:139], a[8:11], v[44:47]
    v_mfma_f32_16x16x32_bf16 v[40:43], a[124:127], a[12:15], v[40:43]
    v_exp_f32 v35, v35
    v_mfma_f32_16x16x32_bf16 v[44:47], a[140:143], a[12:15], v[44:47]
    v_cvt_pk_bf16_f32 v49, v34, v35
    s_waitcnt vmcnt(4)
    s_waitcnt lgkmcnt(0)
    s_barrier
    v_mfma_f32_16x16x32_bf16 v[192:195], a[176:179], v[52:55], 0
    v_exp_f32 v36, v36
    v_mfma_f32_16x16x32_bf16 v[196:199], a[180:183], v[52:55], 0
    ds_read_b128 a[144:147], v6 offset:32768
    ds_read_b128 a[160:163], v6 offset:36864
    v_mfma_f32_16x16x32_bf16 v[200:203], a[184:187], v[52:55], 0
    v_exp_f32 v37, v37
    v_mfma_f32_16x16x32_bf16 v[204:207], a[188:191], v[52:55], 0
    v_cvt_pk_bf16_f32 v50, v36, v37
    ds_read_b128 a[148:151], v7 offset:32768
    v_mfma_f32_16x16x32_bf16 v[208:211], a[192:195], v[52:55], 0
    v_exp_f32 v38, v38
    v_mfma_f32_16x16x32_bf16 v[212:215], a[196:199], v[52:55], 0
    ds_read_b128 a[164:167], v7 offset:36864
    ds_read_b128 a[152:155], v8 offset:32768
    v_mfma_f32_16x16x32_bf16 v[216:219], a[200:203], v[52:55], 0
    v_exp_f32 v39, v39
    v_mfma_f32_16x16x32_bf16 v[220:223], a[204:207], v[52:55], 0
    v_cvt_pk_bf16_f32 v51, v38, v39
    ds_read_b128 a[168:171], v8 offset:36864
    v_mfma_f32_16x16x32_bf16 a[100:103], a[108:111], v[52:55], 0
    ds_read_b128 a[156:159], v9 offset:32768
    ds_read_b128 a[172:175], v9 offset:36864
    v_mfma_f32_16x16x32_bf16 v[32:35], a[112:115], a[16:19], v[60:63]
    v_exp_f32 v40, v40
    v_mfma_f32_16x16x32_bf16 v[36:39], a[128:131], a[16:19], v[60:63]
    v_mfma_f32_16x16x32_bf16 v[32:35], a[116:119], a[20:23], v[32:35]
    v_exp_f32 v41, v41
    v_mfma_f32_16x16x32_bf16 v[36:39], a[132:135], a[20:23], v[36:39]
    v_cvt_pk_bf16_f32 v52, v40, v41
    v_mfma_f32_16x16x32_bf16 v[32:35], a[120:123], a[24:27], v[32:35]
    v_exp_f32 v42, v42
    v_mfma_f32_16x16x32_bf16 v[36:39], a[136:139], a[24:27], v[36:39]
    v_mfma_f32_16x16x32_bf16 v[32:35], a[124:127], a[28:31], v[32:35]
    v_exp_f32 v43, v43
    v_mfma_f32_16x16x32_bf16 v[36:39], a[140:143], a[28:31], v[36:39]
    v_cvt_pk_bf16_f32 v53, v42, v43
    v_mfma_f32_16x16x32_bf16 v[224:227], a[176:179], v[48:51], 0
    v_exp_f32 v44, v44
    v_mfma_f32_16x16x32_bf16 v[228:231], a[180:183], v[48:51], 0
    ds_read_b64_tr_b16 a[176:177], v10 offset:32768
    ds_read_b64_tr_b16 a[178:179], v10 offset:36864
    v_mfma_f32_16x16x32_bf16 v[232:235], a[184:187], v[48:51], 0
    v_exp_f32 v45, v45
    v_mfma_f32_16x16x32_bf16 v[236:239], a[188:191], v[48:51], 0
    v_cvt_pk_bf16_f32 v54, v44, v45
    ds_read_b64_tr_b16 a[180:181], v11 offset:32768
    v_mfma_f32_16x16x32_bf16 v[240:243], a[192:195], v[48:51], 0
    v_exp_f32 v46, v46
    v_mfma_f32_16x16x32_bf16 v[244:247], a[196:199], v[48:51], 0
    ds_read_b64_tr_b16 a[182:183], v11 offset:36864
    ds_read_b64_tr_b16 a[184:185], v12 offset:32768
    v_mfma_f32_16x16x32_bf16 v[248:251], a[200:203], v[48:51], 0
    v_exp_f32 v47, v47
    v_mfma_f32_16x16x32_bf16 v[252:255], a[204:207], v[48:51], 0
    v_cvt_pk_bf16_f32 v55, v46, v47
    ds_read_b64_tr_b16 a[186:187], v12 offset:36864
    v_mfma_f32_16x16x32_bf16 a[104:107], a[108:111], v[48:51], 0
    ds_read_b64_tr_b16 a[188:189], v13 offset:32768
    ds_read_b64_tr_b16 a[190:191], v13 offset:36864
    s_waitcnt lgkmcnt(8)
    v_mfma_f32_16x16x32_bf16 v[40:43], a[144:147], a[0:3], v[56:59]
    v_exp_f32 v32, v32
    v_mfma_f32_16x16x32_bf16 v[44:47], a[160:163], a[0:3], v[56:59]
    ds_read_b64_tr_b16 a[192:193], v14 offset:32768
    ds_read_b64_tr_b16 a[194:195], v14 offset:36864
    v_mfma_f32_16x16x32_bf16 v[40:43], a[148:151], a[4:7], v[40:43]
    v_exp_f32 v33, v33
    v_mfma_f32_16x16x32_bf16 v[44:47], a[164:167], a[4:7], v[44:47]
    v_cvt_pk_bf16_f32 v48, v32, v33
    ds_read_b64_tr_b16 a[196:197], v15 offset:32768
    v_mfma_f32_16x16x32_bf16 v[40:43], a[152:155], a[8:11], v[40:43]
    v_exp_f32 v34, v34
    v_mfma_f32_16x16x32_bf16 v[44:47], a[168:171], a[8:11], v[44:47]
    ds_read_b64_tr_b16 a[198:199], v15 offset:36864
    ds_read_b64_tr_b16 a[200:201], v16 offset:32768
    v_mfma_f32_16x16x32_bf16 v[40:43], a[156:159], a[12:15], v[40:43]
    v_exp_f32 v35, v35
    v_mfma_f32_16x16x32_bf16 v[44:47], a[172:175], a[12:15], v[44:47]
    v_cvt_pk_bf16_f32 v49, v34, v35
    ds_read_b64_tr_b16 a[202:203], v16 offset:36864
    v_mfma_f32_16x16x32_bf16 v[160:163], a[208:211], v[52:55], v[160:163]
    v_exp_f32 v36, v36
    v_mfma_f32_16x16x32_bf16 v[164:167], a[212:215], v[52:55], v[164:167]
    ds_read_b64_tr_b16 a[204:205], v17 offset:32768
    ds_read_b64_tr_b16 a[206:207], v17 offset:36864
    v_mfma_f32_16x16x32_bf16 v[168:171], a[216:219], v[52:55], v[168:171]
    v_exp_f32 v37, v37
    v_mfma_f32_16x16x32_bf16 v[172:175], a[220:223], v[52:55], v[172:175]
    v_cvt_pk_bf16_f32 v50, v36, v37
    v_mfma_f32_16x16x32_bf16 v[176:179], a[224:227], v[52:55], v[176:179]
    v_exp_f32 v38, v38
    v_mfma_f32_16x16x32_bf16 v[180:183], a[228:231], v[52:55], v[180:183]
    v_mfma_f32_16x16x32_bf16 v[184:187], a[232:235], v[52:55], v[184:187]
    v_exp_f32 v39, v39
    v_mfma_f32_16x16x32_bf16 v[188:191], a[236:239], v[52:55], v[188:191]
    v_cvt_pk_bf16_f32 v51, v38, v39
    v_mfma_f32_16x16x32_bf16 a[96:99], a[108:111], v[52:55], a[96:99]
    s_waitcnt vmcnt(0)
    s_waitcnt lgkmcnt(0)
    s_barrier
    s_cmp_lg_u32 s55, 0
    s_cbranch_scc1 6f
    ds_read_b128 a[48:51], v97
    ds_read_b128 a[52:55], v97 offset:1024
    ds_read_b128 a[56:59], v97 offset:2048
    ds_read_b128 a[60:63], v97 offset:3072
    ds_read_b128 a[64:67], v97 offset:4096
    ds_read_b128 a[68:71], v97 offset:5120
    ds_read_b128 a[72:75], v97 offset:6144
    ds_read_b128 a[76:79], v97 offset:7168
    ds_read_b128 a[80:83], v97 offset:32768
    ds_read_b128 a[84:87], v97 offset:33792
    ds_read_b128 a[88:91], v97 offset:34816
    ds_read_b128 a[92:95], v97 offset:35840
6:
    v_mfma_f32_16x16x32_bf16 v[32:35], a[144:147], a[16:19], v[60:63]
    v_exp_f32 v40, v40
    v_mfma_f32_16x16x32_bf16 v[36:39], a[160:163], a[16:19], v[60:63]
    ds_read_b128 a[112:115], v6 offset:49152
    ds_read_b128 a[128:131], v6 offset:53248
    v_mfma_f32_16x16x32_bf16 v[32:35], a[148:151], a[20:23], v[32:35]
    v_exp_f32 v41, v41
    v_mfma_f32_16x16x32_bf16 v[36:39], a[164:167], a[20:23], v[36:39]
    v_cvt_pk_bf16_f32 v52, v40, v41
    ds_read_b128 a[116:119], v7 offset:49152
    v_mfma_f32_16x16x32_bf16 v[32:35], a[152:155], a[24:27], v[32:35]
    v_exp_f32 v42, v42
    v_mfma_f32_16x16x32_bf16 v[36:39], a[168:171], a[24:27], v[36:39]
    ds_read_b128 a[132:135], v7 offset:53248
    ds_read_b128 a[120:123], v8 offset:49152
    v_mfma_f32_16x16x32_bf16 v[32:35], a[156:159], a[28:31], v[32:35]
    v_exp_f32 v43, v43
    v_mfma_f32_16x16x32_bf16 v[36:39], a[172:175], a[28:31], v[36:39]
    v_cvt_pk_bf16_f32 v53, v42, v43
    ds_read_b128 a[136:139], v8 offset:53248
    v_mfma_f32_16x16x32_bf16 v[192:195], a[208:211], v[48:51], v[192:195]
    v_exp_f32 v44, v44
    v_mfma_f32_16x16x32_bf16 v[196:199], a[212:215], v[48:51], v[196:199]
    ds_read_b128 a[124:127], v9 offset:49152
    ds_read_b128 a[140:143], v9 offset:53248
    v_mfma_f32_16x16x32_bf16 v[200:203], a[216:219], v[48:51], v[200:203]
    v_exp_f32 v45, v45
    v_mfma_f32_16x16x32_bf16 v[204:207], a[220:223], v[48:51], v[204:207]
    v_cvt_pk_bf16_f32 v54, v44, v45
    ds_read_b64_tr_b16 a[208:209], v10 offset:49152
    v_mfma_f32_16x16x32_bf16 v[208:211], a[224:227], v[48:51], v[208:211]
    v_exp_f32 v46, v46
    v_mfma_f32_16x16x32_bf16 v[212:215], a[228:231], v[48:51], v[212:215]
    ds_read_b64_tr_b16 a[210:211], v10 offset:53248
    ds_read_b64_tr_b16 a[212:213], v11 offset:49152
    v_mfma_f32_16x16x32_bf16 v[216:219], a[232:235], v[48:51], v[216:219]
    v_exp_f32 v47, v47
    v_mfma_f32_16x16x32_bf16 v[220:223], a[236:239], v[48:51], v[220:223]
    v_cvt_pk_bf16_f32 v55, v46, v47
    ds_read_b64_tr_b16 a[214:215], v11 offset:53248
    v_mfma_f32_16x16x32_bf16 a[100:103], a[108:111], v[48:51], a[100:103]
    ds_read_b64_tr_b16 a[216:217], v12 offset:49152
    ds_read_b64_tr_b16 a[218:219], v12 offset:53248
    v_mfma_f32_16x16x32_bf16 v[40:43], a[144:147], a[32:35], v[64:67]
    v_exp_f32 v32, v32
    v_mfma_f32_16x16x32_bf16 v[44:47], a[160:163], a[32:35], v[64:67]
    ds_read_b64_tr_b16 a[220:221], v13 offset:49152
    ds_read_b64_tr_b16 a[222:223], v13 offset:53248
    v_mfma_f32_16x16x32_bf16 v[40:43], a[148:151], a[36:39], v[40:43]
    v_exp_f32 v33, v33
    v_mfma_f32_16x16x32_bf16 v[44:47], a[164:167], a[36:39], v[44:47]
    v_cvt_pk_bf16_f32 v48, v32, v33
    ds_read_b64_tr_b16 a[224:225], v14 offset:49152
    v_mfma_f32_16x16x32_bf16 v[40:43], a[152:155], a[40:43], v[40:43]
    v_exp_f32 v34, v34
    v_mfma_f32_16x16x32_bf16 v[44:47], a[168:171], a[40:43], v[44:47]
    ds_read_b64_tr_b16 a[226:227], v14 offset:53248
    ds_read_b64_tr_b16 a[228:229], v15 offset:49152
    v_mfma_f32_16x16x32_bf16 v[40:43], a[156:159], a[44:47], v[40:43]
    v_exp_f32 v35, v35
    v_mfma_f32_16x16x32_bf16 v[44:47], a[172:175], a[44:47], v[44:47]
    v_cvt_pk_bf16_f32 v49, v34, v35
    ds_read_b64_tr_b16 a[230:231], v15 offset:53248
    v_mfma_f32_16x16x32_bf16 v[160:163], a[176:179], v[52:55], v[160:163]
    v_exp_f32 v36, v36
    v_mfma_f32_16x16x32_bf16 v[164:167], a[180:183], v[52:55], v[164:167]
    ds_read_b64_tr_b16 a[232:233], v16 offset:49152
    ds_read_b64_tr_b16 a[234:235], v16 offset:53248
    v_mfma_f32_16x16x32_bf16 v[168:171], a[184:187], v[52:55], v[168:171]
    v_exp_f32 v37, v37
    v_mfma_f32_16x16x32_bf16 v[172:175], a[188:191], v[52:55], v[172:175]
    v_cvt_pk_bf16_f32 v50, v36, v37
    ds_read_b64_tr_b16 a[236:237], v17 offset:49152
    v_mfma_f32_16x16x32_bf16 v[176:179], a[192:195], v[52:55], v[176:179]
    v_exp_f32 v38, v38
    v_mfma_f32_16x16x32_bf16 v[180:183], a[196:199], v[52:55], v[180:183]
    ds_read_b64_tr_b16 a[238:239], v17 offset:53248
    v_mfma_f32_16x16x32_bf16 v[184:187], a[200:203], v[52:55], v[184:187]
    v_exp_f32 v39, v39
    v_mfma_f32_16x16x32_bf16 v[188:191], a[204:207], v[52:55], v[188:191]
    v_cvt_pk_bf16_f32 v51, v38, v39
    v_mfma_f32_16x16x32_bf16 a[96:99], a[108:111], v[52:55], a[96:99]
    s_waitcnt lgkmcnt(15)
    v_mfma_f32_16x16x32_bf16 v[32:35], a[112:115], a[0:3], v[56:59]
    v_exp_f32 v40, v40
    v_mfma_f32_16x16x32_bf16 v[36:39], a[128:131], a[0:3], v[56:59]
    v_mfma_f32_16x16x32_bf16 v[32:35], a[116:119], a[4:7], v[32:35]
    v_exp_f32 v41, v41
    v_mfma_f32_16x16x32_bf16 v[36:39], a[132:135], a[4:7], v[36:39]
    v_cvt_pk_bf16_f32 v52, v40, v41
    v_mfma_f32_16x16x32_bf16 v[32:35], a[120:123], a[8:11], v[32:35]
    v_exp_f32 v42, v42
    v_mfma_f32_16x16x32_bf16 v[36:39], a[136:139], a[8:11], v[36:39]
    v_mfma_f32_16x16x32_bf16 v[32:35], a[124:127], a[12:15], v[32:35]
    v_exp_f32 v43, v43
    v_mfma_f32_16x16x32_bf16 v[36:39], a[140:143], a[12:15], v[36:39]
    v_cvt_pk_bf16_f32 v53, v42, v43
    s_waitcnt lgkmcnt(0)
    s_barrier
    v_mfma_f32_16x16x32_bf16 v[192:195], a[176:179], v[48:51], v[192:195]
    v_exp_f32 v44, v44
    v_mfma_f32_16x16x32_bf16 v[196:199], a[180:183], v[48:51], v[196:199]
    ds_read_b128 a[144:147], v6
    ds_read_b128 a[160:163], v6 offset:4096
    v_mfma_f32_16x16x32_bf16 v[200:203], a[184:187], v[48:51], v[200:203]
    v_exp_f32 v45, v45
    v_mfma_f32_16x16x32_bf16 v[204:207], a[188:191], v[48:51], v[204:207]
    v_cvt_pk_bf16_f32 v54, v44, v45
    ds_read_b128 a[148:151], v7
    v_mfma_f32_16x16x32_bf16 v[208:211], a[192:195], v[48:51], v[208:211]
    v_exp_f32 v46, v46
    v_mfma_f32_16x16x32_bf16 v[212:215], a[196:199], v[48:51], v[212:215]
    ds_read_b128 a[164:167], v7 offset:4096
    ds_read_b128 a[152:155], v8
    v_mfma_f32_16x16x32_bf16 v[216:219], a[200:203], v[48:51], v[216:219]
    v_exp_f32 v47, v47
    v_mfma_f32_16x16x32_bf16 v[220:223], a[204:207], v[48:51], v[220:223]
    v_cvt_pk_bf16_f32 v55, v46, v47
    ds_read_b128 a[168:171], v8 offset:4096
    v_mfma_f32_16x16x32_bf16 a[100:103], a[108:111], v[48:51], a[100:103]
    ds_read_b128 a[156:159], v9
    ds_read_b128 a[172:175], v9 offset:4096
    v_mfma_f32_16x16x32_bf16 v[40:43], a[112:115], a[16:19], v[60:63]
    v_exp_f32 v32, v32
    v_mfma_f32_16x16x32_bf16 v[44:47], a[128:131], a[16:19], v[60:63]
    v_mfma_f32_16x16x32_bf16 v[40:43], a[116:119], a[20:23], v[40:43]
    v_exp_f32 v33, v33
    v_mfma_f32_16x16x32_bf16 v[44:47], a[132:135], a[20:23], v[44:47]
    v_cvt_pk_bf16_f32 v48, v32, v33
    v_mfma_f32_16x16x32_bf16 v[40:43], a[120:123], a[24:27], v[40:43]
    v_exp_f32 v34, v34
    v_mfma_f32_16x16x32_bf16 v[44:47], a[136:139], a[24:27], v[44:47]
    v_mfma_f32_16x16x32_bf16 v[40:43], a[124:127], a[28:31], v[40:43]
    v_exp_f32 v35, v35
    v_mfma_f32_16x16x32_bf16 v[44:47], a[140:143], a[28:31], v[44:47]
    v_cvt_pk_bf16_f32 v49, v34, v35
    v_mfma_f32_16x16x32_bf16 v[224:227], a[176:179], v[52:55], v[224:227]
    v_exp_f32 v36, v36
    v_mfma_f32_16x16x32_bf16 v[228:231], a[180:183], v[52:55], v[228:231]
    ds_read_b64_tr_b16 a[176:177], v10
    ds_read_b64_tr_b16 a[178:179], v10 offset:4096
    v_mfma_f32_16x16x32_bf16 v[232:235], a[184:187], v[52:55], v[232:235]
    v_exp_f32 v37, v37
    v_mfma_f32_16x16x32_bf16 v[236:239], a[188:191], v[52:55], v[236:239]
    v_cvt_pk_bf16_f32 v50, v36, v37
    ds_read_b64_tr_b16 a[180:181], v11
    v_mfma_f32_16x16x32_bf16 v[240:243], a[192:195], v[52:55], v[240:243]
    v_exp_f32 v38, v38
    v_mfma_f32_16x16x32_bf16 v[244:247], a[196:199], v[52:55], v[244:247]
    ds_read_b64_tr_b16 a[182:183], v11 offset:4096
    ds_read_b64_tr_b16 a[184:185], v12
    v_mfma_f32_16x16x32_bf16 v[248:251], a[200:203], v[52:55], v[248:251]
    v_exp_f32 v39, v39
    v_mfma_f32_16x16x32_bf16 v[252:255], a[204:207], v[52:55], v[252:255]
    v_cvt_pk_bf16_f32 v51, v38, v39
    ds_read_b64_tr_b16 a[186:187], v12 offset:4096
    v_mfma_f32_16x16x32_bf16 a[104:107], a[108:111], v[52:55], a[104:107]
    ds_read_b64_tr_b16 a[188:189], v13
    ds_read_b64_tr_b16 a[190:191], v13 offset:4096
    s_waitcnt lgkmcnt(8)
    v_mfma_f32_16x16x32_bf16 v[32:35], a[144:147], a[0:3], v[56:59]
    v_exp_f32 v40, v40
    v_mfma_f32_16x16x32_bf16 v[36:39], a[160:163], a[0:3], v[56:59]
    ds_read_b64_tr_b16 a[192:193], v14
    ds_read_b64_tr_b16 a[194:195], v14 offset:4096
    v_mfma_f32_16x16x32_bf16 v[32:35], a[148:151], a[4:7], v[32:35]
    v_exp_f32 v41, v41
    v_mfma_f32_16x16x32_bf16 v[36:39], a[164:167], a[4:7], v[36:39]
    v_cvt_pk_bf16_f32 v52, v40, v41
    ds_read_b64_tr_b16 a[196:197], v15
    v_mfma_f32_16x16x32_bf16 v[32:35], a[152:155], a[8:11], v[32:35]
    v_exp_f32 v42, v42
    v_mfma_f32_16x16x32_bf16 v[36:39], a[168:171], a[8:11], v[36:39]
    ds_read_b64_tr_b16 a[198:199], v15 offset:4096
    ds_read_b64_tr_b16 a[200:201], v16
    v_mfma_f32_16x16x32_bf16 v[32:35], a[156:159], a[12:15], v[32:35]
    v_exp_f32 v43, v43
    v_mfma_f32_16x16x32_bf16 v[36:39], a[172:175], a[12:15], v[36:39]
    v_cvt_pk_bf16_f32 v53, v42, v43
    ds_read_b64_tr_b16 a[202:203], v16 offset:4096
    v_mfma_f32_16x16x32_bf16 v[160:163], a[208:211], v[48:51], v[160:163]
    v_exp_f32 v44, v44
    v_mfma_f32_16x16x32_bf16 v[164:167], a[212:215], v[48:51], v[164:167]
    ds_read_b64_tr_b16 a[204:205], v17
    ds_read_b64_tr_b16 a[206:207], v17 offset:4096
    v_mfma_f32_16x16x32_bf16 v[168:171], a[216:219], v[48:51], v[168:171]
    v_exp_f32 v45, v45
    v_mfma_f32_16x16x32_bf16 v[172:175], a[220:223], v[48:51], v[172:175]
    v_cvt_pk_bf16_f32 v54, v44, v45
    v_mfma_f32_16x16x32_bf16 v[176:179], a[224:227], v[48:51], v[176:179]
    v_exp_f32 v46, v46
    v_mfma_f32_16x16x32_bf16 v[180:183], a[228:231], v[48:51], v[180:183]
    v_mfma_f32_16x16x32_bf16 v[184:187], a[232:235], v[48:51], v[184:187]
    v_exp_f32 v47, v47
    v_mfma_f32_16x16x32_bf16 v[188:191], a[236:239], v[48:51], v[188:191]
    v_cvt_pk_bf16_f32 v55, v46, v47
    v_mfma_f32_16x16x32_bf16 a[96:99], a[108:111], v[48:51], a[96:99]
    s_mov_b32 s54, 6
L_loop_A01:
    s_waitcnt lgkmcnt(0)
    s_barrier
    s_cmp_lg_u32 s54, 2
    s_cbranch_scc1 1f
    s_lshl_b32 s39, s38, 12
    v_lshlrev_b32 v109, 6, v1
    v_add_u32 v109, s39, v109
    v_min_u32 v109, L_end-L_pc-4, v109
    v_add_co_u32 v110, vcc, s82, v109
    v_mov_b32 v111, s83
    s_nop 0
    v_addc_co_u32 v111, vcc, 0, v111, vcc
    global_load_dword v107, v[110:111], off
1:
    v_mfma_f32_16x16x32_bf16 v[40:43], a[144:147], a[16:19], v[60:63]
    v_exp_f32 v32, v32
    v_mfma_f32_16x16x32_bf16 v[44:47], a[160:163], a[16:19], v[60:63]
    ds_read_b128 a[112:115], v6 offset:16384
    ds_read_b128 a[128:131], v6 offset:20480
    v_mfma_f32_16x16x32_bf16 v[40:43], a[148:151], a[20:23], v[40:43]
    v_exp_f32 v33, v33
    v_mfma_f32_16x16x32_bf16 v[44:47], a[164:167], a[20:23], v[44:47]
    v_cvt_pk_bf16_f32 v48, v32, v33
    ds_read_b128 a[116:119], v7 offset:16384
    v_mfma_f32_16x16x32_bf16 v[40:43], a[152:155], a[24:27], v[40:43]
    v_exp_f32 v34, v34
    v_mfma_f32_16x16x32_bf16 v[44:47], a[168:171], a[24:27], v[44:47]
    ds_read_b128 a[132:135], v7 offset:20480
    ds_read_b128 a[120:123], v8 offset:16384
    v_mfma_f32_16x16x32_bf16 v[40:43], a[156:159], a[28:31], v[40:43]
    v_exp_f32 v35, v35
    v_mfma_f32_16x16x32_bf16 v[44:47], a[172:175], a[28:31], v[44:47]
    v_cvt_pk_bf16_f32 v49, v34, v35
    ds_read_b128 a[136:139], v8 offset:20480
    v_mfma_f32_16x16x32_bf16 v[192:195], a[208:211], v[52:55], v[192:195]
    v_exp_f32 v36, v36
    v_mfma_f32_16x16x32_bf16 v[196:199], a[212:215], v[52:55], v[196:199]
    ds_read_b128 a[124:127], v9 offset:16384
    ds_read_b128 a[140:143], v9 offset:20480
    v_mfma_f32_16x16x32_bf16 v[200:203], a[216:219], v[52:55], v[200:203]
    v_exp_f32 v37, v37
    v_mfma_f32_16x16x32_bf16 v[204:207], a[220:223], v[52:55], v[204:207]
    v_cvt_pk_bf16_f32 v50, v36, v37
    ds_read_b64_tr_b16 a[208:209], v10 offset:16384
    v_mfma_f32_16x16x32_bf16 v[208:211], a[224:227], v[52:55], v[208:211]
    v_exp_f32 v38, v38
    v_mfma_f32_16x16x32_bf16 v[212:215], a[228:231], v[52:55], v[212:215]
    ds_read_b64_tr_b16 a[210:211], v10 offset:20480
    ds_read_b64_tr_b16 a[212:213], v11 offset:16384
    v_mfma_f32_16x16x32_bf16 v[216:219], a[232:235], v[52:55], v[216:219]
    v_exp_f32 v39, v39
    v_mfma_f32_16x16x32_bf16 v[220:223], a[236:239], v[52:55], v[220:223]
    v_cvt_pk_bf16_f32 v51, v38, v39
    ds_read_b64_tr_b16 a[214:215], v11 offset:20480
    v_mfma_f32_16x16x32_bf16 a[100:103], a[108:111], v[52:55], a[100:103]
    ds_read_b64_tr_b16 a[216:217], v12 offset:16384
    ds_read_b64_tr_b16 a[218:219], v12 offset:20480
    v_mfma_f32_16x16x32_bf16 v[32:35], a[144:147], a[32:35], v[64:67]
    v_exp_f32 v40, v40
    v_mfma_f32_16x16x32_bf16 v[36:39], a[160:163], a[32:35], v[64:67]
    ds_read_b64_tr_b16 a[220:221], v13 offset:16384
    ds_read_b64_tr_b16 a[222:223], v13 offset:20480
    v_mfma_f32_16x16x32_bf16 v[32:35], a[148:151], a[36:39], v[32:35]
    v_exp_f32 v41, v41
    v_mfma_f32_16x16x32_bf16 v[36:39], a[164:167], a[36:39], v[36:39]
    v_cvt_pk_bf16_f32 v52, v40, v41
    ds_read_b64_tr_b16 a[224:225], v14 offset:16384
    v_mfma_f32_16x16x32_bf16 v[32:35], a[152:155], a[40:43], v[32:35]
    v_exp_f32 v42, v42
    v_mfma_f32_16x16x32_bf16 v[36:39], a[168:171], a[40:43], v[36:39]
    ds_read_b64_tr_b16 a[226:227], v14 offset:20480
    ds_read_b64_tr_b16 a[228:229], v15 offset:16384
    v_mfma_f32_16x16x32_bf16 v[32:35], a[156:159], a[44:47], v[32:35]
    v_exp_f32 v43, v43
    v_mfma_f32_16x16x32_bf16 v[36:39], a[172:175], a[44:47], v[36:39]
    v_cvt_pk_bf16_f32 v53, v42, v43
    ds_read_b64_tr_b16 a[230:231], v15 offset:20480
    v_mfma_f32_16x16x32_bf16 v[160:163], a[176:179], v[48:51], v[160:163]
    v_exp_f32 v44, v44
    v_mfma_f32_16x16x32_bf16 v[164:167], a[180:183], v[48:51], v[164:167]
    ds_read_b64_tr_b16 a[232:233], v16 offset:16384
    ds_read_b64_tr_b16 a[234:235], v16 offset:20480
    v_mfma_f32_16x16x32_bf16 v[168:171], a[184:187], v[48:51], v[168:171]
    v_exp_f32 v45, v45
    v_mfma_f32_16x16x32_bf16 v[172:175], a[188:191], v[48:51], v[172:175]
    v_cvt_pk_bf16_f32 v54, v44, v45
    ds_read_b64_tr_b16 a[236:237], v17 offset:16384
    v_mfma_f32_16x16x32_bf16 v[176:179], a[192:195], v[48:51], v[176:179]
    v_exp_f32 v46, v46
    v_mfma_f32_16x16x32_bf16 v[180:183], a[196:199], v[48:51], v[180:183]
    ds_read_b64_tr_b16 a[238:239], v17 offset:20480
    v_mfma_f32_16x16x32_bf16 v[184:187], a[200:203], v[48:51], v[184:187]
    v_exp_f32 v47, v47
    v_mfma_f32_16x16x32_bf16 v[188:191], a[204:207], v[48:51], v[188:191]
    v_cvt_pk_bf16_f32 v55, v46, v47
    v_mfma_f32_16x16x32_bf16 a[96:99], a[108:111], v[48:51], a[96:99]
    s_waitcnt lgkmcnt(15)
    v_mfma_f32_16x16x32_bf16 v[40:43], a[112:115], a[0:3], v[56:59]
    v_exp_f32 v32, v32
    v_mfma_f32_16x16x32_bf16 v[44:47], a[128:131], a[0:3], v[56:59]
    v_mfma_f32_16x16x32_bf16 v[40:43], a[116:119], a[4:7], v[40:43]
    v_exp_f32 v33, v33
    v_mfma_f32_16x16x32_bf16 v[44:47], a[132:135], a[4:7], v[44:47]
    v_cvt_pk_bf16_f32 v48, v32, v33
    v_mfma_f32_16x16x32_bf16 v[40:43], a[120:123], a[8:11], v[40:43]
    v_exp_f32 v34, v34
    v_mfma_f32_16x16x32_bf16 v[44:47], a[136:139], a[8:11], v[44:47]
    v_mfma_f32_16x16x32_bf16 v[40:43], a[124:127], a[12:15], v[40:43]
    v_exp_f32 v35, v35
    v_mfma_f32_16x16x32_bf16 v[44:47], a[140:143], a[12:15], v[44:47]
    v_cvt_pk_bf16_f32 v49, v34, v35
    s_waitcnt lgkmcnt(0)
    s_barrier
    v_mfma_f32_16x16x32_bf16 v[192:195], a[176:179], v[52:55], v[192:195]
    v_exp_f32 v36, v36
    v_mfma_f32_16x16x32_bf16 v[196:199], a[180:183], v[52:55], v[196:199]
    ds_read_b128 a[144:147], v6 offset:32768
    ds_read_b128 a[160:163], v6 offset:36864
    v_mfma_f32_16x16x32_bf16 v[200:203], a[184:187], v[52:55], v[200:203]
    v_exp_f32 v37, v37
    v_mfma_f32_16x16x32_bf16 v[204:207], a[188:191], v[52:55], v[204:207]
    v_cvt_pk_bf16_f32 v50, v36, v37
    ds_read_b128 a[148:151], v7 offset:32768
    v_mfma_f32_16x16x32_bf16 v[208:211], a[192:195], v[52:55], v[208:211]
    v_exp_f32 v38, v38
    v_mfma_f32_16x16x32_bf16 v[212:215], a[196:199], v[52:55], v[212:215]
    ds_read_b128 a[164:167], v7 offset:36864
    ds_read_b128 a[152:155], v8 offset:32768
    v_mfma_f32_16x16x32_bf16 v[216:219], a[200:203], v[52:55], v[216:219]
    v_exp_f32 v39, v39
    v_mfma_f32_16x16x32_bf16 v[220:223], a[204:207], v[52:55], v[220:223]
    v_cvt_pk_bf16_f32 v51, v38, v39
    ds_read_b128 a[168:171], v8 offset:36864
    v_mfma_f32_16x16x32_bf16 a[100:103], a[108:111], v[52:55], a[100:103]
    ds_read_b128 a[156:159], v9 offset:32768
    ds_read_b128 a[172:175], v9 offset:36864
    v_mfma_f32_16x16x32_bf16 v[32:35], a[112:115], a[16:19], v[60:63]
    v_exp_f32 v40, v40
    v_mfma_f32_16x16x32_bf16 v[36:39], a[128:131], a[16:19], v[60:63]
    v_mfma_f32_16x16x32_bf16 v[32:35], a[116:119], a[20:23], v[32:35]
    v_exp_f32 v41, v41
    v_mfma_f32_16x16x32_bf16 v[36:39], a[132:135], a[20:23], v[36:39]
    v_cvt_pk_bf16_f32 v52, v40, v41
    v_mfma_f32_16x16x32_bf16 v[32:35], a[120:123], a[24:27], v[32:35]
    v_exp_f32 v42, v42
    v_mfma_f32_16x16x32_bf16 v[36:39], a[136:139], a[24:27], v[36:39]
    v_mfma_f32_16x16x32_bf16 v[32:35], a[124:127], a[28:31], v[32:35]
    v_exp_f32 v43, v43
    v_mfma_f32_16x16x32_bf16 v[36:39], a[140:143], a[28:31], v[36:39]
    v_cvt_pk_bf16_f32 v53, v42, v43
    v_mfma_f32_16x16x32_bf16 v[224:227], a[176:179], v[48:51], v[224:227]
    v_exp_f32 v44, v44
    v_mfma_f32_16x16x32_bf16 v[228:231], a[180:183], v[48:51], v[228:231]
    ds_read_b64_tr_b16 a[176:177], v10 offset:32768
    ds_read_b64_tr_b16 a[178:179], v10 offset:36864
    v_mfma_f32_16x16x32_bf16 v[232:235], a[184:187], v[48:51], v[232:235]
    v_exp_f32 v45, v45
    v_mfma_f32_16x16x32_bf16 v[236:239], a[188:191], v[48:51], v[236:239]
    v_cvt_pk_bf16_f32 v54, v44, v45
    ds_read_b64_tr_b16 a[180:181], v11 offset:32768
    v_mfma_f32_16x16x32_bf16 v[240:243], a[192:195], v[48:51], v[240:243]
    v_exp_f32 v46, v46
    v_mfma_f32_16x16x32_bf16 v[244:247], a[196:199], v[48:51], v[244:247]
    ds_read_b64_tr_b16 a[182:183], v11 offset:36864
    ds_read_b64_tr_b16 a[184:185], v12 offset:32768
    v_mfma_f32_16x16x32_bf16 v[248:251], a[200:203], v[48:51], v[248:251]
    v_exp_f32 v47, v47
    v_mfma_f32_16x16x32_bf16 v[252:255], a[204:207], v[48:51], v[252:255]
    v_cvt_pk_bf16_f32 v55, v46, v47
    ds_read_b64_tr_b16 a[186:187], v12 offset:36864
    v_mfma_f32_16x16x32_bf16 a[104:107], a[108:111], v[48:51], a[104:107]
    ds_read_b64_tr_b16 a[188:189], v13 offset:32768
    ds_read_b64_tr_b16 a[190:191], v13 offset:36864
    s_waitcnt lgkmcnt(8)
    v_mfma_f32_16x16x32_bf16 v[40:43], a[144:147], a[0:3], v[56:59]
    v_exp_f32 v32, v32
    v_mfma_f32_16x16x32_bf16 v[44:47], a[160:163], a[0:3], v[56:59]
    ds_read_b64_tr_b16 a[192:193], v14 offset:32768
    ds_read_b64_tr_b16 a[194:195], v14 offset:36864
    v_mfma_f32_16x16x32_bf16 v[40:43], a[148:151], a[4:7], v[40:43]
    v_exp_f32 v33, v33
    v_mfma_f32_16x16x32_bf16 v[44:47], a[164:167], a[4:7], v[44:47]
    v_cvt_pk_bf16_f32 v48, v32, v33
    ds_read_b64_tr_b16 a[196:197], v15 offset:32768
    v_mfma_f32_16x16x32_bf16 v[40:43], a[152:155], a[8:11], v[40:43]
    v_exp_f32 v34, v34
    v_mfma_f32_16x16x32_bf16 v[44:47], a[168:171], a[8:11], v[44:47]
    ds_read_b64_tr_b16 a[198:199], v15 offset:36864
    ds_read_b64_tr_b16 a[200:201], v16 offset:32768
    v_mfma_f32_16x16x32_bf16 v[40:43], a[156:159], a[12:15], v[40:43]
    v_exp_f32 v35, v35
    v_mfma_f32_16x16x32_bf16 v[44:47], a[172:175], a[12:15], v[44:47]
    v_cvt_pk_bf16_f32 v49, v34, v35
    ds_read_b64_tr_b16 a[202:203], v16 offset:36864
    v_mfma_f32_16x16x32_bf16 v[160:163], a[208:211], v[52:55], v[160:163]
    v_exp_f32 v36, v36
    v_mfma_f32_16x16x32_bf16 v[164:167], a[212:215], v[52:55], v[164:167]
    ds_read_b64_tr_b16 a[204:205], v17 offset:32768
    ds_read_b64_tr_b16 a[206:207], v17 offset:36864
    v_mfma_f32_16x16x32_bf16 v[168:171], a[216:219], v[52:55], v[168:171]
    v_exp_f32 v37, v37
    v_mfma_f32_16x16x32_bf16 v[172:175], a[220:223], v[52:55], v[172:175]
    v_cvt_pk_bf16_f32 v50, v36, v37
    v_mfma_f32_16x16x32_bf16 v[176:179], a[224:227], v[52:55], v[176:179]
    v_exp_f32 v38, v38
    v_mfma_f32_16x16x32_bf16 v[180:183], a[228:231], v[52:55], v[180:183]
    v_mfma_f32_16x16x32_bf16 v[184:187], a[232:235], v[52:55], v[184:187]
    v_exp_f32 v39, v39
    v_mfma_f32_16x16x32_bf16 v[188:191], a[236:239], v[52:55], v[188:191]
    v_cvt_pk_bf16_f32 v51, v38, v39
    v_mfma_f32_16x16x32_bf16 a[96:99], a[108:111], v[52:55], a[96:99]
    s_waitcnt lgkmcnt(0)
    s_barrier
    v_mfma_f32_16x16x32_bf16 v[32:35], a[144:147], a[16:19], v[60:63]
    v_exp_f32 v40, v40
    v_mfma_f32_16x16x32_bf16 v[36:39], a[160:163], a[16:19], v[60:63]
    ds_read_b128 a[112:115], v6 offset:49152
    ds_read_b128 a[128:131], v6 offset:53248
    v_mfma_f32_16x16x32_bf16 v[32:35], a[148:151], a[20:23], v[32:35]
    v_exp_f32 v41, v41
    v_mfma_f32_16x16x32_bf16 v[36:39], a[164:167], a[20:23], v[36:39]
    v_cvt_pk_bf16_f32 v52, v40, v41
    ds_read_b128 a[116:119], v7 offset:49152
    v_mfma_f32_16x16x32_bf16 v[32:35], a[152:155], a[24:27], v[32:35]
    v_exp_f32 v42, v42
    v_mfma_f32_16x16x32_bf16 v[36:39], a[168:171], a[24:27], v[36:39]
    ds_read_b128 a[132:135], v7 offset:53248
    ds_read_b128 a[120:123], v8 offset:49152
    v_mfma_f32_16x16x32_bf16 v[32:35], a[156:159], a[28:31], v[32:35]
    v_exp_f32 v43, v43
    v_mfma_f32_16x16x32_bf16 v[36:39], a[172:175], a[28:31], v[36:39]
    v_cvt_pk_bf16_f32 v53, v42, v43
    ds_read_b128 a[136:139], v8 offset:53248
    v_mfma_f32_16x16x32_bf16 v[192:195], a[208:211], v[48:51], v[192:195]
    v_exp_f32 v44, v44
    v_mfma_f32_16x16x32_bf16 v[196:199], a[212:215], v[48:51], v[196:199]
    ds_read_b128 a[124:127], v9 offset:49152
    ds_read_b128 a[140:143], v9 offset:53248
    v_mfma_f32_16x16x32_bf16 v[200:203], a[216:219], v[48:51], v[200:203]
    v_exp_f32 v45, v45
    v_mfma_f32_16x16x32_bf16 v[204:207], a[220:223], v[48:51], v[204:207]
    v_cvt_pk_bf16_f32 v54, v44, v45
    ds_read_b64_tr_b16 a[208:209], v10 offset:49152
    v_mfma_f32_16x16x32_bf16 v[208:211], a[224:227], v[48:51], v[208:211]
    v_exp_f32 v46, v46
    v_mfma_f32_16x16x32_bf16 v[212:215], a[228:231], v[48:51], v[212:215]
    ds_read_b64_tr_b16 a[210:211], v10 offset:53248
    ds_read_b64_tr_b16 a[212:213], v11 offset:49152
    v_mfma_f32_16x16x32_bf16 v[216:219], a[232:235], v[48:51], v[216:219]
    v_exp_f32 v47, v47
    v_mfma_f32_16x16x32_bf16 v[220:223], a[236:239], v[48:51], v[220:223]
    v_cvt_pk_bf16_f32 v55, v46, v47
    ds_read_b64_tr_b16 a[214:215], v11 offset:53248
    v_mfma_f32_16x16x32_bf16 a[100:103], a[108:111], v[48:51], a[100:103]
    ds_read_b64_tr_b16 a[216:217], v12 offset:49152
    ds_read_b64_tr_b16 a[218:219], v12 offset:53248
    v_mfma_f32_16x16x32_bf16 v[40:43], a[144:147], a[32:35], v[64:67]
    v_exp_f32 v32, v32
    v_mfma_f32_16x16x32_bf16 v[44:47], a[160:163], a[32:35], v[64:67]
    ds_read_b64_tr_b16 a[220:221], v13 offset:49152
    ds_read_b64_tr_b16 a[222:223], v13 offset:53248
    v_mfma_f32_16x16x32_bf16 v[40:43], a[148:151], a[36:39], v[40:43]
    v_exp_f32 v33, v33
    v_mfma_f32_16x16x32_bf16 v[44:47], a[164:167], a[36:39], v[44:47]
    v_cvt_pk_bf16_f32 v48, v32, v33
    ds_read_b64_tr_b16 a[224:225], v14 offset:49152
    v_mfma_f32_16x16x32_bf16 v[40:43], a[152:155], a[40:43], v[40:43]
    v_exp_f32 v34, v34
    v_mfma_f32_16x16x32_bf16 v[44:47], a[168:171], a[40:43], v[44:47]
    ds_read_b64_tr_b16 a[226:227], v14 offset:53248
    ds_read_b64_tr_b16 a[228:229], v15 offset:49152
    v_mfma_f32_16x16x32_bf16 v[40:43], a[156:159], a[44:47], v[40:43]
    v_exp_f32 v35, v35
    v_mfma_f32_16x16x32_bf16 v[44:47], a[172:175], a[44:47], v[44:47]
    v_cvt_pk_bf16_f32 v49, v34, v35
    ds_read_b64_tr_b16 a[230:231], v15 offset:53248
    v_mfma_f32_16x16x32_bf16 v[160:163], a[176:179], v[52:55], v[160:163]
    v_exp_f32 v36, v36
    v_mfma_f32_16x16x32_bf16 v[164:167], a[180:183], v[52:55], v[164:167]
    ds_read_b64_tr_b16 a[232:233], v16 offset:49152
    ds_read_b64_tr_b16 a[234:235], v16 offset:53248
    v_mfma_f32_16x16x32_bf16 v[168:171], a[184:187], v[52:55], v[168:171]
    v_exp_f32 v37, v37
    v_mfma_f32_16x16x32_bf16 v[172:175], a[188:191], v[52:55], v[172:175]
    v_cvt_pk_bf16_f32 v50, v36, v37
    ds_read_b64_tr_b16 a[236:237], v17 offset:49152
    v_mfma_f32_16x16x32_bf16 v[176:179], a[192:195], v[52:55], v[176:179]
    v_exp_f32 v38, v38
    v_mfma_f32_16x16x32_bf16 v[180:183], a[196:199], v[52:55], v[180:183]
    ds_read_b64_tr_b16 a[238:239], v17 offset:53248
    v_mfma_f32_16x16x32_bf16 v[184:187], a[200:203], v[52:55], v[184:187]
    v_exp_f32 v39, v39
    v_mfma_f32_16x16x32_bf16 v[188:191], a[204:207], v[52:55], v[188:191]
    v_cvt_pk_bf16_f32 v51, v38, v39
    v_mfma_f32_16x16x32_bf16 a[96:99], a[108:111], v[52:55], a[96:99]
    s_waitcnt lgkmcnt(15)
    v_mfma_f32_16x16x32_bf16 v[32:35], a[112:115], a[0:3], v[56:59]
    v_exp_f32 v40, v40
    v_mfma_f32_16x16x32_bf16 v[36:39], a[128:131], a[0:3], v[56:59]
    v_mfma_f32_16x16x32_bf16 v[32:35], a[116:119], a[4:7], v[32:35]
    v_exp_f32 v41, v41
    v_mfma_f32_16x16x32_bf16 v[36:39], a[132:135], a[4:7], v[36:39]
    v_cvt_pk_bf16_f32 v52, v40, v41
    v_mfma_f32_16x16x32_bf16 v[32:35], a[120:123], a[8:11], v[32:35]
    v_exp_f32 v42, v42
    v_mfma_f32_16x16x32_bf16 v[36:39], a[136:139], a[8:11], v[36:39]
    v_mfma_f32_16x16x32_bf16 v[32:35], a[124:127], a[12:15], v[32:35]
    v_exp_f32 v43, v43
    v_mfma_f32_16x16x32_bf16 v[36:39], a[140:143], a[12:15], v[36:39]
    v_cvt_pk_bf16_f32 v53, v42, v43
    s_waitcnt lgkmcnt(0)
    s_barrier
    v_mfma_f32_16x16x32_bf16 v[192:195], a[176:179], v[48:51], v[192:195]
    v_exp_f32 v44, v44
    v_mfma_f32_16x16x32_bf16 v[196:199], a[180:183], v[48:51], v[196:199]
    ds_read_b128 a[144:147], v6
    ds_read_b128 a[160:163], v6 offset:4096
    v_mfma_f32_16x16x32_bf16 v[200:203], a[184:187], v[48:51], v[200:203]
    v_exp_f32 v45, v45
    v_mfma_f32_16x16x32_bf16 v[204:207], a[188:191], v[48:51], v[204:207]
    v_cvt_pk_bf16_f32 v54, v44, v45
    ds_read_b128 a[148:151], v7
    v_mfma_f32_16x16x32_bf16 v[208:211], a[192:195], v[48:51], v[208:211]
    v_exp_f32 v46, v46
    v_mfma_f32_16x16x32_bf16 v[212:215], a[196:199], v[48:51], v[212:215]
    ds_read_b128 a[164:167], v7 offset:4096
    ds_read_b128 a[152:155], v8
    v_mfma_f32_16x16x32_bf16 v[216:219], a[200:203], v[48:51], v[216:219]
    v_exp_f32 v47, v47
    v_mfma_f32_16x16x32_bf16 v[220:223], a[204:207], v[48:51], v[220:223]
    v_cvt_pk_bf16_f32 v55, v46, v47
    ds_read_b128 a[168:171], v8 offset:4096
    v_mfma_f32_16x16x32_bf16 a[100:103], a[108:111], v[48:51], a[100:103]
    ds_read_b128 a[156:159], v9
    ds_read_b128 a[172:175], v9 offset:4096
    v_mfma_f32_16x16x32_bf16 v[40:43], a[112:115], a[16:19], v[60:63]
    v_exp_f32 v32, v32
    v_mfma_f32_16x16x32_bf16 v[44:47], a[128:131], a[16:19], v[60:63]
    v_mfma_f32_16x16x32_bf16 v[40:43], a[116:119], a[20:23], v[40:43]
    v_exp_f32 v33, v33
    v_mfma_f32_16x16x32_bf16 v[44:47], a[132:135], a[20:23], v[44:47]
    v_cvt_pk_bf16_f32 v48, v32, v33
    v_mfma_f32_16x16x32_bf16 v[40:43], a[120:123], a[24:27], v[40:43]
    v_exp_f32 v34, v34
    v_mfma_f32_16x16x32_bf16 v[44:47], a[136:139], a[24:27], v[44:47]
    v_mfma_f32_16x16x32_bf16 v[40:43], a[124:127], a[28:31], v[40:43]
    v_exp_f32 v35, v35
    v_mfma_f32_16x16x32_bf16 v[44:47], a[140:143], a[28:31], v[44:47]
    v_cvt_pk_bf16_f32 v49, v34, v35
    v_mfma_f32_16x16x32_bf16 v[224:227], a[176:179], v[52:55], v[224:227]
    v_exp_f32 v36, v36
    v_mfma_f32_16x16x32_bf16 v[228:231], a[180:183], v[52:55], v[228:231]
    ds_read_b64_tr_b16 a[176:177], v10
    ds_read_b64_tr_b16 a[178:179], v10 offset:4096
    v_mfma_f32_16x16x32_bf16 v[232:235], a[184:187], v[52:55], v[232:235]
    v_exp_f32 v37, v37
    v_mfma_f32_16x16x32_bf16 v[236:239], a[188:191], v[52:55], v[236:239]
    v_cvt_pk_bf16_f32 v50, v36, v37
    ds_read_b64_tr_b16 a[180:181], v11
    v_mfma_f32_16x16x32_bf16 v[240:243], a[192:195], v[52:55], v[240:243]
    v_exp_f32 v38, v38
    v_mfma_f32_16x16x32_bf16 v[244:247], a[196:199], v[52:55], v[244:247]
    ds_read_b64_tr_b16 a[182:183], v11 offset:4096
    ds_read_b64_tr_b16 a[184:185], v12
    v_mfma_f32_16x16x32_bf16 v[248:251], a[200:203], v[52:55], v[248:251]
    v_exp_f32 v39, v39
    v_mfma_f32_16x16x32_bf16 v[252:255], a[204:207], v[52:55], v[252:255]
    v_cvt_pk_bf16_f32 v51, v38, v39
    ds_read_b64_tr_b16 a[186:187], v12 offset:4096
    v_mfma_f32_16x16x32_bf16 a[104:107], a[108:111], v[52:55], a[104:107]
    ds_read_b64_tr_b16 a[188:189], v13
    ds_read_b64_tr_b16 a[190:191], v13 offset:4096
    s_waitcnt lgkmcnt(8)
    v_mfma_f32_16x16x32_bf16 v[32:35], a[144:147], a[0:3], v[56:59]
    v_exp_f32 v40, v40
    v_mfma_f32_16x16x32_bf16 v[36:39], a[160:163], a[0:3], v[56:59]
    ds_read_b64_tr_b16 a[192:193], v14
    ds_read_b64_tr_b16 a[194:195], v14 offset:4096
    v_mfma_f32_16x16x32_bf16 v[32:35], a[148:151], a[4:7], v[32:35]
    v_exp_f32 v41, v41
    v_mfma_f32_16x16x32_bf16 v[36:39], a[164:167], a[4:7], v[36:39]
    v_cvt_pk_bf16_f32 v52, v40, v41
    ds_read_b64_tr_b16 a[196:197], v15
    v_mfma_f32_16x16x32_bf16 v[32:35], a[152:155], a[8:11], v[32:35]
    v_exp_f32 v42, v42
    v_mfma_f32_16x16x32_bf16 v[36:39], a[168:171], a[8:11], v[36:39]
    ds_read_b64_tr_b16 a[198:199], v15 offset:4096
    ds_read_b64_tr_b16 a[200:201], v16
    v_mfma_f32_16x16x32_bf16 v[32:35], a[156:159], a[12:15], v[32:35]
    v_exp_f32 v43, v43
    v_mfma_f32_16x16x32_bf16 v[36:39], a[172:175], a[12:15], v[36:39]
    v_cvt_pk_bf16_f32 v53, v42, v43
    ds_read_b64_tr_b16 a[202:203], v16 offset:4096
    v_mfma_f32_16x16x32_bf16 v[160:163], a[208:211], v[48:51], v[160:163]
    v_exp_f32 v44, v44
    v_mfma_f32_16x16x32_bf16 v[164:167], a[212:215], v[48:51], v[164:167]
    ds_read_b64_tr_b16 a[204:205], v17
    ds_read_b64_tr_b16 a[206:207], v17 offset:4096
    v_mfma_f32_16x16x32_bf16 v[168:171], a[216:219], v[48:51], v[168:171]
    v_exp_f32 v45, v45
    v_mfma_f32_16x16x32_bf16 v[172:175], a[220:223], v[48:51], v[172:175]
    v_cvt_pk_bf16_f32 v54, v44, v45
    v_mfma_f32_16x16x32_bf16 v[176:179], a[224:227], v[48:51], v[176:179]
    v_exp_f32 v46, v46
    v_mfma_f32_16x16x32_bf16 v[180:183], a[228:231], v[48:51], v[180:183]
    v_mfma_f32_16x16x32_bf16 v[184:187], a[232:235], v[48:51], v[184:187]
    v_exp_f32 v47, v47
    v_mfma_f32_16x16x32_bf16 v[188:191], a[236:239], v[48:51], v[188:191]
    v_cvt_pk_bf16_f32 v55, v46, v47
    v_mfma_f32_16x16x32_bf16 a[96:99], a[108:111], v[48:51], a[96:99]
    s_sub_u32 s54, s54, 1
    s_cmp_lg_u32 s54, 0
    s_cbranch_scc1 L_loop_A01
    s_waitcnt lgkmcnt(0)
    s_barrier
    v_mfma_f32_16x16x32_bf16 v[40:43], a[144:147], a[16:19], v[60:63]
    v_exp_f32 v32, v32
    v_mfma_f32_16x16x32_bf16 v[44:47], a[160:163], a[16:19], v[60:63]
    ds_read_b128 a[112:115], v6 offset:16384
    ds_read_b128 a[128:131], v6 offset:20480
    v_mfma_f32_16x16x32_bf16 v[40:43], a[148:151], a[20:23], v[40:43]
    v_exp_f32 v33, v33
    v_mfma_f32_16x16x32_bf16 v[44:47], a[164:167], a[20:23], v[44:47]
    v_cvt_pk_bf16_f32 v48, v32, v33
    ds_read_b128 a[116:119], v7 offset:16384
    v_mfma_f32_16x16x32_bf16 v[40:43], a[152:155], a[24:27], v[40:43]
    v_exp_f32 v34, v34
    v_mfma_f32_16x16x32_bf16 v[44:47], a[168:171], a[24:27], v[44:47]
    ds_read_b128 a[132:135], v7 offset:20480
    ds_read_b128 a[120:123], v8 offset:16384
    v_mfma_f32_16x16x32_bf16 v[40:43], a[156:159], a[28:31], v[40:43]
    v_exp_f32 v35, v35
    v_mfma_f32_16x16x32_bf16 v[44:47], a[172:175], a[28:31], v[44:47]
    v_cvt_pk_bf16_f32 v49, v34, v35
    ds_read_b128 a[136:139], v8 offset:20480
    v_mfma_f32_16x16x32_bf16 v[192:195], a[208:211], v[52:55], v[192:195]
    v_exp_f32 v36, v36
    v_mfma_f32_16x16x32_bf16 v[196:199], a[212:215], v[52:55], v[196:199]
    ds_read_b128 a[124:127], v9 offset:16384
    ds_read_b128 a[140:143], v9 offset:20480
    v_mfma_f32_16x16x32_bf16 v[200:203], a[216:219], v[52:55], v[200:203]
    v_exp_f32 v37, v37
    v_mfma_f32_16x16x32_bf16 v[204:207], a[220:223], v[52:55], v[204:207]
    v_cvt_pk_bf16_f32 v50, v36, v37
    ds_read_b64_tr_b16 a[208:209], v10 offset:16384
    v_mfma_f32_16x16x32_bf16 v[208:211], a[224:227], v[52:55], v[208:211]
    v_exp_f32 v38, v38
    v_mfma_f32_16x16x32_bf16 v[212:215], a[228:231], v[52:55], v[212:215]
    ds_read_b64_tr_b16 a[210:211], v10 offset:20480
    ds_read_b64_tr_b16 a[212:213], v11 offset:16384
    v_mfma_f32_16x16x32_bf16 v[216:219], a[232:235], v[52:55], v[216:219]
    v_exp_f32 v39, v39
    v_mfma_f32_16x16x32_bf16 v[220:223], a[236:239], v[52:55], v[220:223]
    v_cvt_pk_bf16_f32 v51, v38, v39
    ds_read_b64_tr_b16 a[214:215], v11 offset:20480
    v_mfma_f32_16x16x32_bf16 a[100:103], a[108:111], v[52:55], a[100:103]
    ds_read_b64_tr_b16 a[216:217], v12 offset:16384
    ds_read_b64_tr_b16 a[218:219], v12 offset:20480
    v_mfma_f32_16x16x32_bf16 v[32:35], a[144:147], a[32:35], v[64:67]
    v_exp_f32 v40, v40
    v_mfma_f32_16x16x32_bf16 v[36:39], a[160:163], a[32:35], v[64:67]
    ds_read_b64_tr_b16 a[220:221], v13 offset:16384
    ds_read_b64_tr_b16 a[222:223], v13 offset:20480
    v_mfma_f32_16x16x32_bf16 v[32:35], a[148:151], a[36:39], v[32:35]
    v_exp_f32 v41, v41
    v_mfma_f32_16x16x32_bf16 v[36:39], a[164:167], a[36:39], v[36:39]
    v_cvt_pk_bf16_f32 v52, v40, v41
    ds_read_b64_tr_b16 a[224:225], v14 offset:16384
    v_mfma_f32_16x16x32_bf16 v[32:35], a[152:155], a[40:43], v[32:35]
    v_exp_f32 v42, v42
    v_mfma_f32_16x16x32_bf16 v[36:39], a[168:171], a[40:43], v[36:39]
    ds_read_b64_tr_b16 a[226:227], v14 offset:20480
    ds_read_b64_tr_b16 a[228:229], v15 offset:16384
    v_mfma_f32_16x16x32_bf16 v[32:35], a[156:159], a[44:47], v[32:35]
    v_exp_f32 v43, v43
    v_mfma_f32_16x16x32_bf16 v[36:39], a[172:175], a[44:47], v[36:39]
    v_cvt_pk_bf16_f32 v53, v42, v43
    ds_read_b64_tr_b16 a[230:231], v15 offset:20480
    v_mfma_f32_16x16x32_bf16 v[160:163], a[176:179], v[48:51], v[160:163]
    v_exp_f32 v44, v44
    v_mfma_f32_16x16x32_bf16 v[164:167], a[180:183], v[48:51], v[164:167]
    ds_read_b64_tr_b16 a[232:233], v16 offset:16384
    ds_read_b64_tr_b16 a[234:235], v16 offset:20480
    v_mfma_f32_16x16x32_bf16 v[168:171], a[184:187], v[48:51], v[168:171]
    v_exp_f32 v45, v45
    v_mfma_f32_16x16x32_bf16 v[172:175], a[188:191], v[48:51], v[172:175]
    v_cvt_pk_bf16_f32 v54, v44, v45
    ds_read_b64_tr_b16 a[236:237], v17 offset:16384
    v_mfma_f32_16x16x32_bf16 v[176:179], a[192:195], v[48:51], v[176:179]
    v_exp_f32 v46, v46
    v_mfma_f32_16x16x32_bf16 v[180:183], a[196:199], v[48:51], v[180:183]
    ds_read_b64_tr_b16 a[238:239], v17 offset:20480
    v_mfma_f32_16x16x32_bf16 v[184:187], a[200:203], v[48:51], v[184:187]
    v_exp_f32 v47, v47
    v_mfma_f32_16x16x32_bf16 v[188:191], a[204:207], v[48:51], v[188:191]
    v_cvt_pk_bf16_f32 v55, v46, v47
    v_mfma_f32_16x16x32_bf16 a[96:99], a[108:111], v[48:51], a[96:99]
    s_waitcnt lgkmcnt(15)
    v_mfma_f32_16x16x32_bf16 v[40:43], a[112:115], a[0:3], v[56:59]
    v_exp_f32 v32, v32
    v_mfma_f32_16x16x32_bf16 v[44:47], a[128:131], a[0:3], v[56:59]
    v_mfma_f32_16x16x32_bf16 v[40:43], a[116:119], a[4:7], v[40:43]
    v_exp_f32 v33, v33
    v_mfma_f32_16x16x32_bf16 v[44:47], a[132:135], a[4:7], v[44:47]
    v_cvt_pk_bf16_f32 v48, v32, v33
    v_mfma_f32_16x16x32_bf16 v[40:43], a[120:123], a[8:11], v[40:43]
    v_exp_f32 v34, v34
    v_mfma_f32_16x16x32_bf16 v[44:47], a[136:139], a[8:11], v[44:47]
    v_mfma_f32_16x16x32_bf16 v[40:43], a[124:127], a[12:15], v[40:43]
    v_exp_f32 v35, v35
    v_mfma_f32_16x16x32_bf16 v[44:47], a[140:143], a[12:15], v[44:47]
    v_cvt_pk_bf16_f32 v49, v34, v35
    s_waitcnt lgkmcnt(0)
    s_barrier
    v_mfma_f32_16x16x32_bf16 v[192:195], a[176:179], v[52:55], v[192:195]
    v_exp_f32 v36, v36
    v_mfma_f32_16x16x32_bf16 v[196:199], a[180:183], v[52:55], v[196:199]
    ds_read_b128 a[144:147], v6 offset:32768
    ds_read_b128 a[160:163], v6 offset:36864
    v_mfma_f32_16x16x32_bf16 v[200:203], a[184:187], v[52:55], v[200:203]
    v_exp_f32 v37, v37
    v_mfma_f32_16x16x32_bf16 v[204:207], a[188:191], v[52:55], v[204:207]
    v_cvt_pk_bf16_f32 v50, v36, v37
    ds_read_b128 a[148:151], v7 offset:32768
    v_mfma_f32_16x16x32_bf16 v[208:211], a[192:195], v[52:55], v[208:211]
    v_exp_f32 v38, v38
    v_mfma_f32_16x16x32_bf16 v[212:215], a[196:199], v[52:55], v[212:215]
    ds_read_b128 a[164:167], v7 offset:36864
    ds_read_b128 a[152:155], v8 offset:32768
    v_mfma_f32_16x16x32_bf16 v[216:219], a[200:203], v[52:55], v[216:219]
    v_exp_f32 v39, v39
    v_mfma_f32_16x16x32_bf16 v[220:223], a[204:207], v[52:55], v[220:223]
    v_cvt_pk_bf16_f32 v51, v38, v39
    ds_read_b128 a[168:171], v8 offset:36864
    v_mfma_f32_16x16x32_bf16 a[100:103], a[108:111], v[52:55], a[100:103]
    ds_read_b128 a[156:159], v9 offset:32768
    ds_read_b128 a[172:175], v9 offset:36864
    v_mfma_f32_16x16x32_bf16 v[32:35], a[112:115], a[16:19], v[60:63]
    v_exp_f32 v40, v40
    v_mfma_f32_16x16x32_bf16 v[36:39], a[128:131], a[16:19], v[60:63]
    v_mfma_f32_16x16x32_bf16 v[32:35], a[116:119], a[20:23], v[32:35]
    v_exp_f32 v41, v41
    v_mfma_f32_16x16x32_bf16 v[36:39], a[132:135], a[20:23], v[36:39]
    v_cvt_pk_bf16_f32 v52, v40, v41
    v_mfma_f32_16x16x32_bf16 v[32:35], a[120:123], a[24:27], v[32:35]
    v_exp_f32 v42, v42
    v_mfma_f32_16x16x32_bf16 v[36:39], a[136:139], a[24:27], v[36:39]
    v_mfma_f32_16x16x32_bf16 v[32:35], a[124:127], a[28:31], v[32:35]
    v_exp_f32 v43, v43
    v_mfma_f32_16x16x32_bf16 v[36:39], a[140:143], a[28:31], v[36:39]
    v_cvt_pk_bf16_f32 v53, v42, v43
    v_mfma_f32_16x16x32_bf16 v[224:227], a[176:179], v[48:51], v[224:227]
    v_exp_f32 v44, v44
    v_mfma_f32_16x16x32_bf16 v[228:231], a[180:183], v[48:51], v[228:231]
    ds_read_b64_tr_b16 a[176:177], v10 offset:32768
    ds_read_b64_tr_b16 a[178:179], v10 offset:36864
    v_mfma_f32_16x16x32_bf16 v[232:235], a[184:187], v[48:51], v[232:235]
    v_exp_f32 v45, v45
    v_mfma_f32_16x16x32_bf16 v[236:239], a[188:191], v[48:51], v[236:239]
    v_cvt_pk_bf16_f32 v54, v44, v45
    ds_read_b64_tr_b16 a[180:181], v11 offset:32768
    v_mfma_f32_16x16x32_bf16 v[240:243], a[192:195], v[48:51], v[240:243]
    v_exp_f32 v46, v46
    v_mfma_f32_16x16x32_bf16 v[244:247], a[196:199], v[48:51], v[244:247]
    ds_read_b64_tr_b16 a[182:183], v11 offset:36864
    ds_read_b64_tr_b16 a[184:185], v12 offset:32768
    v_mfma_f32_16x16x32_bf16 v[248:251], a[200:203], v[48:51], v[248:251]
    v_exp_f32 v47, v47
    v_mfma_f32_16x16x32_bf16 v[252:255], a[204:207], v[48:51], v[252:255]
    v_cvt_pk_bf16_f32 v55, v46, v47
    ds_read_b64_tr_b16 a[186:187], v12 offset:36864
    v_mfma_f32_16x16x32_bf16 a[104:107], a[108:111], v[48:51], a[104:107]
    ds_read_b64_tr_b16 a[188:189], v13 offset:32768
    ds_read_b64_tr_b16 a[190:191], v13 offset:36864
    s_waitcnt lgkmcnt(8)
    v_mfma_f32_16x16x32_bf16 v[40:43], a[144:147], a[0:3], v[56:59]
    v_exp_f32 v32, v32
    v_mfma_f32_16x16x32_bf16 v[44:47], a[160:163], a[0:3], v[56:59]
    ds_read_b64_tr_b16 a[192:193], v14 offset:32768
    ds_read_b64_tr_b16 a[194:195], v14 offset:36864
    v_mfma_f32_16x16x32_bf16 v[40:43], a[148:151], a[4:7], v[40:43]
    v_exp_f32 v33, v33
    v_mfma_f32_16x16x32_bf16 v[44:47], a[164:167], a[4:7], v[44:47]
    v_cvt_pk_bf16_f32 v48, v32, v33
    ds_read_b64_tr_b16 a[196:197], v15 offset:32768
    v_mfma_f32_16x16x32_bf16 v[40:43], a[152:155], a[8:11], v[40:43]
    v_exp_f32 v34, v34
    v_mfma_f32_16x16x32_bf16 v[44:47], a[168:171], a[8:11], v[44:47]
    ds_read_b64_tr_b16 a[198:199], v15 offset:36864
    ds_read_b64_tr_b16 a[200:201], v16 offset:32768
    v_mfma_f32_16x16x32_bf16 v[40:43], a[156:159], a[12:15], v[40:43]
    v_exp_f32 v35, v35
    v_mfma_f32_16x16x32_bf16 v[44:47], a[172:175], a[12:15], v[44:47]
    v_cvt_pk_bf16_f32 v49, v34, v35
    ds_read_b64_tr_b16 a[202:203], v16 offset:36864
    v_mfma_f32_16x16x32_bf16 v[160:163], a[208:211], v[52:55], v[160:163]
    v_exp_f32 v36, v36
    v_mfma_f32_16x16x32_bf16 v[164:167], a[212:215], v[52:55], v[164:167]
    ds_read_b64_tr_b16 a[204:205], v17 offset:32768
    ds_read_b64_tr_b16 a[206:207], v17 offset:36864
    v_mfma_f32_16x16x32_bf16 v[168:171], a[216:219], v[52:55], v[168:171]
    v_exp_f32 v37, v37
    v_mfma_f32_16x16x32_bf16 v[172:175], a[220:223], v[52:55], v[172:175]
    v_cvt_pk_bf16_f32 v50, v36, v37
    v_mfma_f32_16x16x32_bf16 v[176:179], a[224:227], v[52:55], v[176:179]
    v_exp_f32 v38, v38
    v_mfma_f32_16x16x32_bf16 v[180:183], a[228:231], v[52:55], v[180:183]
    v_mfma_f32_16x16x32_bf16 v[184:187], a[232:235], v[52:55], v[184:187]
    v_exp_f32 v39, v39
    v_mfma_f32_16x16x32_bf16 v[188:191], a[236:239], v[52:55], v[188:191]
    v_cvt_pk_bf16_f32 v51, v38, v39
    v_mfma_f32_16x16x32_bf16 a[96:99], a[108:111], v[52:55], a[96:99]
    s_waitcnt lgkmcnt(0)
    s_barrier
    v_mfma_f32_16x16x32_bf16 v[32:35], a[144:147], a[16:19], v[60:63]
    v_exp_f32 v40, v40
    v_mfma_f32_16x16x32_bf16 v[36:39], a[160:163], a[16:19], v[60:63]
    ds_read_b128 a[112:115], v6 offset:49152
    ds_read_b128 a[128:131], v6 offset:53248
    v_mfma_f32_16x16x32_bf16 v[32:35], a[148:151], a[20:23], v[32:35]
    v_exp_f32 v41, v41
    v_mfma_f32_16x16x32_bf16 v[36:39], a[164:167], a[20:23], v[36:39]
    v_cvt_pk_bf16_f32 v52, v40, v41
    ds_read_b128 a[116:119], v7 offset:49152
    v_mfma_f32_16x16x32_bf16 v[32:35], a[152:155], a[24:27], v[32:35]
    v_exp_f32 v42, v42
    v_mfma_f32_16x16x32_bf16 v[36:39], a[168:171], a[24:27], v[36:39]
    ds_read_b128 a[132:135], v7 offset:53248
    ds_read_b128 a[120:123], v8 offset:49152
    v_mfma_f32_16x16x32_bf16 v[32:35], a[156:159], a[28:31], v[32:35]
    v_exp_f32 v43, v43
    v_mfma_f32_16x16x32_bf16 v[36:39], a[172:175], a[28:31], v[36:39]
    v_cvt_pk_bf16_f32 v53, v42, v43
    ds_read_b128 a[136:139], v8 offset:53248
    v_mfma_f32_16x16x32_bf16 v[192:195], a[208:211], v[48:51], v[192:195]
    v_exp_f32 v44, v44
    v_mfma_f32_16x16x32_bf16 v[196:199], a[212:215], v[48:51], v[196:199]
    ds_read_b128 a[124:127], v9 offset:49152
    ds_read_b128 a[140:143], v9 offset:53248
    v_mfma_f32_16x16x32_bf16 v[200:203], a[216:219], v[48:51], v[200:203]
    v_exp_f32 v45, v45
    v_mfma_f32_16x16x32_bf16 v[204:207], a[220:223], v[48:51], v[204:207]
    v_cvt_pk_bf16_f32 v54, v44, v45
    ds_read_b64_tr_b16 a[208:209], v10 offset:49152
    v_mfma_f32_16x16x32_bf16 v[208:211], a[224:227], v[48:51], v[208:211]
    v_exp_f32 v46, v46
    v_mfma_f32_16x16x32_bf16 v[212:215], a[228:231], v[48:51], v[212:215]
    ds_read_b64_tr_b16 a[210:211], v10 offset:53248
    ds_read_b64_tr_b16 a[212:213], v11 offset:49152
    v_mfma_f32_16x16x32_bf16 v[216:219], a[232:235], v[48:51], v[216:219]
    v_exp_f32 v47, v47
    v_mfma_f32_16x16x32_bf16 v[220:223], a[236:239], v[48:51], v[220:223]
    v_cvt_pk_bf16_f32 v55, v46, v47
    ds_read_b64_tr_b16 a[214:215], v11 offset:53248
    v_mfma_f32_16x16x32_bf16 a[100:103], a[108:111], v[48:51], a[100:103]
    ds_read_b64_tr_b16 a[216:217], v12 offset:49152
    ds_read_b64_tr_b16 a[218:219], v12 offset:53248
    v_mfma_f32_16x16x32_bf16 v[40:43], a[144:147], a[32:35], v[64:67]
    v_exp_f32 v32, v32
    v_mfma_f32_16x16x32_bf16 v[44:47], a[160:163], a[32:35], v[64:67]
    ds_read_b64_tr_b16 a[220:221], v13 offset:49152
    ds_read_b64_tr_b16 a[222:223], v13 offset:53248
    v_mfma_f32_16x16x32_bf16 v[40:43], a[148:151], a[36:39], v[40:43]
    v_exp_f32 v33, v33
    v_mfma_f32_16x16x32_bf16 v[44:47], a[164:167], a[36:39], v[44:47]
    v_cvt_pk_bf16_f32 v48, v32, v33
    ds_read_b64_tr_b16 a[224:225], v14 offset:49152
    v_mfma_f32_16x16x32_bf16 v[40:43], a[152:155], a[40:43], v[40:43]
    v_exp_f32 v34, v34
    v_mfma_f32_16x16x32_bf16 v[44:47], a[168:171], a[40:43], v[44:47]
    ds_read_b64_tr_b16 a[226:227], v14 offset:53248
    ds_read_b64_tr_b16 a[228:229], v15 offset:49152
    v_mfma_f32_16x16x32_bf16 v[40:43], a[156:159], a[44:47], v[40:43]
    v_exp_f32 v35, v35
    v_mfma_f32_16x16x32_bf16 v[44:47], a[172:175], a[44:47], v[44:47]
    v_cvt_pk_bf16_f32 v49, v34, v35
    ds_read_b64_tr_b16 a[230:231], v15 offset:53248
    v_mfma_f32_16x16x32_bf16 v[160:163], a[176:179], v[52:55], v[160:163]
    v_exp_f32 v36, v36
    v_mfma_f32_16x16x32_bf16 v[164:167], a[180:183], v[52:55], v[164:167]
    ds_read_b64_tr_b16 a[232:233], v16 offset:49152
    ds_read_b64_tr_b16 a[234:235], v16 offset:53248
    v_mfma_f32_16x16x32_bf16 v[168:171], a[184:187], v[52:55], v[168:171]
    v_exp_f32 v37, v37
    v_mfma_f32_16x16x32_bf16 v[172:175], a[188:191], v[52:55], v[172:175]
    v_cvt_pk_bf16_f32 v50, v36, v37
    ds_read_b64_tr_b16 a[236:237], v17 offset:49152
    v_mfma_f32_16x16x32_bf16 v[176:179], a[192:195], v[52:55], v[176:179]
    v_exp_f32 v38, v38
    v_mfma_f32_16x16x32_bf16 v[180:183], a[196:199], v[52:55], v[180:183]
    ds_read_b64_tr_b16 a[238:239], v17 offset:53248
    v_mfma_f32_16x16x32_bf16 v[184:187], a[200:203], v[52:55], v[184:187]
    v_exp_f32 v39, v39
    v_mfma_f32_16x16x32_bf16 v[188:191], a[204:207], v[52:55], v[188:191]
    v_cvt_pk_bf16_f32 v51, v38, v39
    v_mfma_f32_16x16x32_bf16 a[96:99], a[108:111], v[52:55], a[96:99]
    s_waitcnt lgkmcnt(15)
    v_mfma_f32_16x16x32_bf16 v[32:35], a[112:115], a[0:3], v[56:59]
    v_exp_f32 v40, v40
    v_mfma_f32_16x16x32_bf16 v[36:39], a[128:131], a[0:3], v[56:59]
    v_mfma_f32_16x16x32_bf16 v[32:35], a[116:119], a[4:7], v[32:35]
    v_exp_f32 v41, v41
    v_mfma_f32_16x16x32_bf16 v[36:39], a[132:135], a[4:7], v[36:39]
    v_cvt_pk_bf16_f32 v52, v40, v41
    v_mfma_f32_16x16x32_bf16 v[32:35], a[120:123], a[8:11], v[32:35]
    v_exp_f32 v42, v42
    v_mfma_f32_16x16x32_bf16 v[36:39], a[136:139], a[8:11], v[36:39]
    v_mfma_f32_16x16x32_bf16 v[32:35], a[124:127], a[12:15], v[32:35]
    v_exp_f32 v43, v43
    v_mfma_f32_16x16x32_bf16 v[36:39], a[140:143], a[12:15], v[36:39]
    v_cvt_pk_bf16_f32 v53, v42, v43
    s_waitcnt lgkmcnt(0)
    s_barrier
    v_mfma_f32_16x16x32_bf16 v[192:195], a[176:179], v[48:51], v[192:195]
    v_exp_f32 v44, v44
    v_mfma_f32_16x16x32_bf16 v[196:199], a[180:183], v[48:51], v[196:199]
    ds_read_b128 a[144:147], v6
    ds_read_b128 a[160:163], v6 offset:4096
    v_mfma_f32_16x16x32_bf16 v[200:203], a[184:187], v[48:51], v[200:203]
    v_exp_f32 v45, v45
    v_mfma_f32_16x16x32_bf16 v[204:207], a[188:191], v[48:51], v[204:207]
    v_cvt_pk_bf16_f32 v54, v44, v45
    ds_read_b128 a[148:151], v7
    v_mfma_f32_16x16x32_bf16 v[208:211], a[192:195], v[48:51], v[208:211]
    v_exp_f32 v46, v46
    v_mfma_f32_16x16x32_bf16 v[212:215], a[196:199], v[48:51], v[212:215]
    ds_read_b128 a[164:167], v7 offset:4096
    ds_read_b128 a[152:155], v8
    v_mfma_f32_16x16x32_bf16 v[216:219], a[200:203], v[48:51], v[216:219]
    v_exp_f32 v47, v47
    v_mfma_f32_16x16x32_bf16 v[220:223], a[204:207], v[48:51], v[220:223]
    v_cvt_pk_bf16_f32 v55, v46, v47
    ds_read_b128 a[168:171], v8 offset:4096
    v_mfma_f32_16x16x32_bf16 a[100:103], a[108:111], v[48:51], a[100:103]
    ds_read_b128 a[156:159], v9
    ds_read_b128 a[172:175], v9 offset:4096
    v_mfma_f32_16x16x32_bf16 v[40:43], a[112:115], a[16:19], v[60:63]
    v_exp_f32 v32, v32
    v_mfma_f32_16x16x32_bf16 v[44:47], a[128:131], a[16:19], v[60:63]
    ds_read_b128 v[80:83], v96
    ds_read_b128 v[84:87], v96 offset:64
    v_mfma_f32_16x16x32_bf16 v[40:43], a[116:119], a[20:23], v[40:43]
    v_exp_f32 v33, v33
    v_mfma_f32_16x16x32_bf16 v[44:47], a[132:135], a[20:23], v[44:47]
    v_cvt_pk_bf16_f32 v48, v32, v33
    ds_read_b128 v[88:91], v96 offset:128
    v_mfma_f32_16x16x32_bf16 v[40:43], a[120:123], a[24:27], v[40:43]
    v_exp_f32 v34, v34
    v_mfma_f32_16x16x32_bf16 v[44:47], a[136:139], a[24:27], v[44:47]
    ds_read_b128 v[92:95], v96 offset:192
    v_mfma_f32_16x16x32_bf16 v[40:43], a[124:127], a[28:31], v[40:43]
    v_exp_f32 v35, v35
    v_mfma_f32_16x16x32_bf16 v[44:47], a[140:143], a[28:31], v[44:47]
    v_cvt_pk_bf16_f32 v49, v34, v35
    v_mfma_f32_16x16x32_bf16 v[224:227], a[176:179], v[52:55], v[224:227]
    v_exp_f32 v36, v36
    v_mfma_f32_16x16x32_bf16 v[228:231], a[180:183], v[52:55], v[228:231]
    ds_read_b64_tr_b16 a[176:177], v10
    ds_read_b64_tr_b16 a[178:179], v10 offset:4096
    v_mfma_f32_16x16x32_bf16 v[232:235], a[184:187], v[52:55], v[232:235]
    v_exp_f32 v37, v37
    v_mfma_f32_16x16x32_bf16 v[236:239], a[188:191], v[52:55], v[236:239]
    v_cvt_pk_bf16_f32 v50, v36, v37
    ds_read_b64_tr_b16 a[180:181], v11
    v_mfma_f32_16x16x32_bf16 v[240:243], a[192:195], v[52:55], v[240:243]
    v_exp_f32 v38, v38
    v_mfma_f32_16x16x32_bf16 v[244:247], a[196:199], v[52:55], v[244:247]
    ds_read_b64_tr_b16 a[182:183], v11 offset:4096
    ds_read_b64_tr_b16 a[184:185], v12
    v_mfma_f32_16x16x32_bf16 v[248:251], a[200:203], v[52:55], v[248:251]
    v_exp_f32 v39, v39
    v_mfma_f32_16x16x32_bf16 v[252:255], a[204:207], v[52:55], v[252:255]
    v_cvt_pk_bf16_f32 v51, v38, v39
    ds_read_b64_tr_b16 a[186:187], v12 offset:4096
    v_mfma_f32_16x16x32_bf16 a[104:107], a[108:111], v[52:55], a[104:107]
    ds_read_b64_tr_b16 a[188:189], v13
    ds_read_b64_tr_b16 a[190:191], v13 offset:4096
    v_exp_f32 v40, v40
    ds_read_b64_tr_b16 a[192:193], v14
    ds_read_b64_tr_b16 a[194:195], v14 offset:4096
    ds_read_b64_tr_b16 a[196:197], v15
    v_exp_f32 v41, v41
    s_nop 0
    v_cvt_pk_bf16_f32 v52, v40, v41
    ds_read_b64_tr_b16 a[198:199], v15 offset:4096
    ds_read_b64_tr_b16 a[200:201], v16
    v_exp_f32 v42, v42
    ds_read_b64_tr_b16 a[202:203], v16 offset:4096
    ds_read_b64_tr_b16 a[204:205], v17
    ds_read_b64_tr_b16 a[206:207], v17 offset:4096
    v_exp_f32 v43, v43
    s_nop 0
    v_cvt_pk_bf16_f32 v53, v42, v43
    ds_write_b128 v106, v[224:227]
    ds_write_b128 v106, v[228:231] offset:1024
    v_mfma_f32_16x16x32_bf16 v[160:163], a[208:211], v[48:51], v[160:163]
    v_exp_f32 v44, v44
    v_mfma_f32_16x16x32_bf16 v[164:167], a[212:215], v[48:51], v[164:167]
    ds_write_b128 v106, v[232:235] offset:2048
    ds_write_b128 v106, v[236:239] offset:3072
    ds_write_b128 v106, v[240:243] offset:4096
    v_mfma_f32_16x16x32_bf16 v[168:171], a[216:219], v[48:51], v[168:171]
    v_exp_f32 v45, v45
    v_mfma_f32_16x16x32_bf16 v[172:175], a[220:223], v[48:51], v[172:175]
    v_cvt_pk_bf16_f32 v54, v44, v45
    ds_write_b128 v106, v[244:247] offset:5120
    ds_write_b128 v106, v[248:251] offset:6144
    v_mfma_f32_16x16x32_bf16 v[176:179], a[224:227], v[48:51], v[176:179]
    v_exp_f32 v46, v46
    v_mfma_f32_16x16x32_bf16 v[180:183], a[228:231], v[48:51], v[180:183]
    ds_write_b128 v106, v[252:255] offset:7168
    ds_write_b32 v106, a104 offset:8192
    v_mfma_f32_16x16x32_bf16 v[184:187], a[232:235], v[48:51], v[184:187]
    v_exp_f32 v47, v47
    v_mfma_f32_16x16x32_bf16 v[188:191], a[236:239], v[48:51], v[188:191]
    v_cvt_pk_bf16_f32 v55, v46, v47
    v_mfma_f32_16x16x32_bf16 a[96:99], a[108:111], v[48:51], a[96:99]
    s_waitcnt lgkmcnt(0)
    s_barrier
    ds_read_b128 a[112:115], v6 offset:16384
    ds_read_b128 a[128:131], v6 offset:20480
    ds_read_b128 a[116:119], v7 offset:16384
    ds_read_b128 a[132:135], v7 offset:20480
    ds_read_b128 a[120:123], v8 offset:16384
    ds_read_b128 a[136:139], v8 offset:20480
    ds_read_b128 a[124:127], v9 offset:16384
    ds_read_b128 a[140:143], v9 offset:20480
    v_mfma_f32_16x16x32_bf16 v[192:195], a[208:211], v[52:55], v[192:195]
    ds_read_b64_tr_b16 a[208:209], v10 offset:16384
    ds_read_b64_tr_b16 a[210:211], v10 offset:20480
    v_mfma_f32_16x16x32_bf16 v[196:199], a[212:215], v[52:55], v[196:199]
    ds_read_b64_tr_b16 a[212:213], v11 offset:16384
    ds_read_b64_tr_b16 a[214:215], v11 offset:20480
    v_mfma_f32_16x16x32_bf16 v[200:203], a[216:219], v[52:55], v[200:203]
    ds_read_b64_tr_b16 a[216:217], v12 offset:16384
    ds_read_b64_tr_b16 a[218:219], v12 offset:20480
    v_mfma_f32_16x16x32_bf16 v[204:207], a[220:223], v[52:55], v[204:207]
    ds_read_b64_tr_b16 a[220:221], v13 offset:16384
    ds_read_b64_tr_b16 a[222:223], v13 offset:20480
    v_mfma_f32_16x16x32_bf16 v[208:211], a[224:227], v[52:55], v[208:211]
    ds_read_b64_tr_b16 a[224:225], v14 offset:16384
    ds_read_b64_tr_b16 a[226:227], v14 offset:20480
    v_mfma_f32_16x16x32_bf16 v[212:215], a[228:231], v[52:55], v[212:215]
    ds_read_b64_tr_b16 a[228:229], v15 offset:16384
    ds_read_b64_tr_b16 a[230:231], v15 offset:20480
    v_mfma_f32_16x16x32_bf16 v[216:219], a[232:235], v[52:55], v[216:219]
    ds_read_b64_tr_b16 a[232:233], v16 offset:16384
    ds_read_b64_tr_b16 a[234:235], v16 offset:20480
    v_mfma_f32_16x16x32_bf16 v[220:223], a[236:239], v[52:55], v[220:223]
    ds_read_b64_tr_b16 a[236:237], v17 offset:16384
    ds_read_b64_tr_b16 a[238:239], v17 offset:20480
    v_mfma_f32_16x16x32_bf16 a[100:103], a[108:111], v[52:55], a[100:103]
    v_mov_b32 v3, 163776
    ds_read_b32 v108, v3 offset:32
    s_mov_b32 s39, 0x53800000
    s_mov_b64 s[70:71], 0
    v_accvgpr_read_b32 v32, a96
    s_nop 2
    v_accvgpr_read_b32 v34, a100
    v_cmp_nge_f32 s[72:73], s39, v32
    v_cmp_nle_f32 vcc, 0.5, v32
    s_or_b64 s[70:71], s[70:71], s[72:73]
    s_or_b64 s[70:71], s[70:71], vcc
    v_cmp_nge_f32 s[72:73], s39, v34
    v_cmp_nle_f32 vcc, 0.5, v34
    s_or_b64 s[70:71], s[70:71], s[72:73]
    s_or_b64 s[70:71], s[70:71], vcc
    v_rcp_f32 v32, v32
    v_rcp_f32 v34, v34
    s_or_b32 s39, s70, s71
    v_mov_b32 v3, s39
    ds_write_b32 v104, v3
    v_mov_b32 v33, v32
    v_mov_b32 v35, v34
    s_cmp_lg_u32 s68, 0
    s_cselect_b32 s70, 0x40000000, s58
    v_pk_mul_f32 v[160:161], v[160:161], v[32:33]
    v_pk_mul_f32 v[162:163], v[162:163], v[32:33]
    v_pk_mul_f32 v[164:165], v[164:165], v[32:33]
    v_pk_mul_f32 v[166:167], v[166:167], v[32:33]
    v_cvt_pk_bf16_f32 v112, v160, v161
    v_cvt_pk_bf16_f32 v113, v162, v163
    v_cvt_pk_bf16_f32 v114, v164, v165
    v_cvt_pk_bf16_f32 v115, v166, v167
    ds_write_b128 v98, v[112:115]
    s_add_u32 s39, s70, 0
    buffer_store_dwordx4 v[112:115], v2, s[20:23], s39 offen sc1
    v_pk_mul_f32 v[168:169], v[168:169], v[32:33]
    v_pk_mul_f32 v[170:171], v[170:171], v[32:33]
    v_pk_mul_f32 v[172:173], v[172:173], v[32:33]
    v_pk_mul_f32 v[174:175], v[174:175], v[32:33]
    v_cvt_pk_bf16_f32 v116, v168, v169
    v_cvt_pk_bf16_f32 v117, v170, v171
    v_cvt_pk_bf16_f32 v118, v172, v173
    v_cvt_pk_bf16_f32 v119, v174, v175
    ds_write_b128 v98, v[116:119] offset:1024
    s_add_u32 s39, s70, 0
    buffer_store_dwordx4 v[116:119], v2, s[20:23], s39 offen offset:1024 sc1
    v_pk_mul_f32 v[192:193], v[192:193], v[34:35]
    v_pk_mul_f32 v[194:195], v[194:195], v[34:35]
    v_pk_mul_f32 v[196:197], v[196:197], v[34:35]
    v_pk_mul_f32 v[198:199], v[198:199], v[34:35]
    v_cvt_pk_bf16_f32 v120, v192, v193
    v_cvt_pk_bf16_f32 v121, v194, v195
    v_cvt_pk_bf16_f32 v122, v196, v197
    v_cvt_pk_bf16_f32 v123, v198, v199
    ds_write_b128 v98, v[120:123] offset:2048
    s_add_u32 s39, s70, 2048
    buffer_store_dwordx4 v[120:123], v2, s[20:23], s39 offen sc1
    v_pk_mul_f32 v[200:201], v[200:201], v[34:35]
    v_pk_mul_f32 v[202:203], v[202:203], v[34:35]
    v_pk_mul_f32 v[204:205], v[204:205], v[34:35]
    v_pk_mul_f32 v[206:207], v[206:207], v[34:35]
    v_cvt_pk_bf16_f32 v124, v200, v201
    v_cvt_pk_bf16_f32 v125, v202, v203
    v_cvt_pk_bf16_f32 v126, v204, v205
    v_cvt_pk_bf16_f32 v127, v206, v207
    ds_write_b128 v98, v[124:127] offset:3072
    s_add_u32 s39, s70, 2048
    buffer_store_dwordx4 v[124:127], v2, s[20:23], s39 offen offset:1024 sc1
    v_pk_mul_f32 v[176:177], v[176:177], v[32:33]
    v_pk_mul_f32 v[178:179], v[178:179], v[32:33]
    v_pk_mul_f32 v[180:181], v[180:181], v[32:33]
    v_pk_mul_f32 v[182:183], v[182:183], v[32:33]
    v_cvt_pk_bf16_f32 v128, v176, v177
    v_cvt_pk_bf16_f32 v129, v178, v179
    v_cvt_pk_bf16_f32 v130, v180, v181
    v_cvt_pk_bf16_f32 v131, v182, v183
    ds_write_b128 v98, v[128:131] offset:34816
    s_add_u32 s39, s70, 18432
    buffer_store_dwordx4 v[128:131], v2, s[20:23], s39 offen sc1
    v_pk_mul_f32 v[184:185], v[184:185], v[32:33]
    v_pk_mul_f32 v[186:187], v[186:187], v[32:33]
    v_pk_mul_f32 v[188:189], v[188:189], v[32:33]
    v_pk_mul_f32 v[190:191], v[190:191], v[32:33]
    v_cvt_pk_bf16_f32 v132, v184, v185
    v_cvt_pk_bf16_f32 v133, v186, v187
    v_cvt_pk_bf16_f32 v134, v188, v189
    v_cvt_pk_bf16_f32 v135, v190, v191
    ds_write_b128 v98, v[132:135] offset:35840
    s_add_u32 s39, s70, 18432
    buffer_store_dwordx4 v[132:135], v2, s[20:23], s39 offen offset:1024 sc1
    v_pk_mul_f32 v[208:209], v[208:209], v[34:35]
    v_pk_mul_f32 v[210:211], v[210:211], v[34:35]
    v_pk_mul_f32 v[212:213], v[212:213], v[34:35]
    v_pk_mul_f32 v[214:215], v[214:215], v[34:35]
    v_cvt_pk_bf16_f32 v136, v208, v209
    v_cvt_pk_bf16_f32 v137, v210, v211
    v_cvt_pk_bf16_f32 v138, v212, v213
    v_cvt_pk_bf16_f32 v139, v214, v215
    ds_write_b128 v98, v[136:139] offset:36864
    s_add_u32 s39, s70, 20480
    buffer_store_dwordx4 v[136:139], v2, s[20:23], s39 offen sc1
    v_pk_mul_f32 v[216:217], v[216:217], v[34:35]
    v_pk_mul_f32 v[218:219], v[218:219], v[34:35]
    v_pk_mul_f32 v[220:221], v[220:221], v[34:35]
    v_pk_mul_f32 v[222:223], v[222:223], v[34:35]
    v_cvt_pk_bf16_f32 v140, v216, v217
    v_cvt_pk_bf16_f32 v141, v218, v219
    v_cvt_pk_bf16_f32 v142, v220, v221
    v_cvt_pk_bf16_f32 v143, v222, v223
    ds_write_b128 v98, v[140:143] offset:37888
    s_add_u32 s39, s70, 20480
    buffer_store_dwordx4 v[140:143], v2, s[20:23], s39 offen offset:1024 sc1
    s_waitcnt lgkmcnt(9)
    v_readfirstlane_b32 s81, v108
    s_cmp_lg_u32 s55, 0
    s_cbranch_scc1 L_np1A
    s_mov_b32 s40, 0x80008000
    v_xor_b32 v80, s40, v80
    v_xor_b32 v81, s40, v81
    v_xor_b32 v82, s40, v82
    v_xor_b32 v83, s40, v83
    v_xor_b32 v84, s40, v84
    v_xor_b32 v85, s40, v85
    v_xor_b32 v86, s40, v86
    v_xor_b32 v87, s40, v87
    v_xor_b32 v88, s40, v88
    v_xor_b32 v89, s40, v89
    v_xor_b32 v90, s40, v90
    v_xor_b32 v91, s40, v91
    v_xor_b32 v92, s40, v92
    v_xor_b32 v93, s40, v93
    v_xor_b32 v94, s40, v94
    v_xor_b32 v95, s40, v95
    v_mfma_f32_16x16x32_bf16 v[68:71], v[80:83], a[48:51], 0
    v_mfma_f32_16x16x32_bf16 v[68:71], v[84:87], a[52:55], v[68:71]
    v_mfma_f32_16x16x32_bf16 v[68:71], v[88:91], a[56:59], v[68:71]
    v_mfma_f32_16x16x32_bf16 v[68:71], v[92:95], a[60:63], v[68:71]
    v_mfma_f32_16x16x32_bf16 v[72:75], v[80:83], a[64:67], 0
    v_mfma_f32_16x16x32_bf16 v[72:75], v[84:87], a[68:71], v[72:75]
    v_mfma_f32_16x16x32_bf16 v[72:75], v[88:91], a[72:75], v[72:75]
    v_mfma_f32_16x16x32_bf16 v[72:75], v[92:95], a[76:79], v[72:75]
    v_mfma_f32_16x16x32_bf16 v[76:79], v[80:83], a[80:83], 0
    v_mfma_f32_16x16x32_bf16 v[76:79], v[84:87], a[84:87], v[76:79]
    v_mfma_f32_16x16x32_bf16 v[76:79], v[88:91], a[88:91], v[76:79]
    v_mfma_f32_16x16x32_bf16 v[76:79], v[92:95], a[92:95], v[76:79]
L_np1A:
    v_mfma_f32_16x16x32_bf16 v[32:35], a[144:147], a[48:51], v[68:71]
    v_mfma_f32_16x16x32_bf16 v[36:39], a[160:163], a[48:51], v[68:71]
    v_mfma_f32_16x16x32_bf16 v[32:35], a[148:151], a[52:55], v[32:35]
    v_mfma_f32_16x16x32_bf16 v[36:39], a[164:167], a[52:55], v[36:39]
    v_mfma_f32_16x16x32_bf16 v[32:35], a[152:155], a[56:59], v[32:35]
    v_mfma_f32_16x16x32_bf16 v[36:39], a[168:171], a[56:59], v[36:39]
    v_mfma_f32_16x16x32_bf16 v[32:35], a[156:159], a[60:63], v[32:35]
    v_mfma_f32_16x16x32_bf16 v[36:39], a[172:175], a[60:63], v[36:39]
    v_mfma_f32_16x16x32_bf16 v[40:43], a[144:147], a[64:67], v[72:75]
    s_nop 5
    v_exp_f32 v32, v32
    v_mfma_f32_16x16x32_bf16 v[44:47], a[160:163], a[64:67], v[72:75]
    v_mfma_f32_16x16x32_bf16 v[40:43], a[148:151], a[68:71], v[40:43]
    v_exp_f32 v33, v33
    v_mfma_f32_16x16x32_bf16 v[44:47], a[164:167], a[68:71], v[44:47]
    v_cvt_pk_bf16_f32 v48, v32, v33
    v_mfma_f32_16x16x32_bf16 v[40:43], a[152:155], a[72:75], v[40:43]
    v_exp_f32 v34, v34
    v_mfma_f32_16x16x32_bf16 v[44:47], a[168:171], a[72:75], v[44:47]
    v_mfma_f32_16x16x32_bf16 v[40:43], a[156:159], a[76:79], v[40:43]
    v_exp_f32 v35, v35
    v_mfma_f32_16x16x32_bf16 v[44:47], a[172:175], a[76:79], v[44:47]
    v_cvt_pk_bf16_f32 v49, v34, v35
    v_exp_f32 v36, v36
    v_exp_f32 v37, v37
    s_nop 0
    v_cvt_pk_bf16_f32 v50, v36, v37
    v_exp_f32 v38, v38
    v_exp_f32 v39, v39
    s_nop 0
    v_cvt_pk_bf16_f32 v51, v38, v39
    v_mfma_f32_16x16x32_bf16 v[32:35], a[144:147], a[80:83], v[76:79]
    v_exp_f32 v40, v40
    v_mfma_f32_16x16x32_bf16 v[36:39], a[160:163], a[80:83], v[76:79]
    v_mfma_f32_16x16x32_bf16 v[32:35], a[148:151], a[84:87], v[32:35]
    v_exp_f32 v41, v41
    v_mfma_f32_16x16x32_bf16 v[36:39], a[164:167], a[84:87], v[36:39]
    v_cvt_pk_bf16_f32 v52, v40, v41
    v_mfma_f32_16x16x32_bf16 v[32:35], a[152:155], a[88:91], v[32:35]
    v_exp_f32 v42, v42
    v_mfma_f32_16x16x32_bf16 v[36:39], a[168:171], a[88:91], v[36:39]
    v_mfma_f32_16x16x32_bf16 v[32:35], a[156:159], a[92:95], v[32:35]
    v_exp_f32 v43, v43
    v_mfma_f32_16x16x32_bf16 v[36:39], a[172:175], a[92:95], v[36:39]
    v_cvt_pk_bf16_f32 v53, v42, v43
    v_mfma_f32_16x16x32_bf16 v[160:163], a[176:179], v[48:51], 0
    v_exp_f32 v44, v44
    v_mfma_f32_16x16x32_bf16 v[164:167], a[180:183], v[48:51], 0
    v_mfma_f32_16x16x32_bf16 v[168:171], a[184:187], v[48:51], 0
    v_exp_f32 v45, v45
    v_mfma_f32_16x16x32_bf16 v[172:175], a[188:191], v[48:51], 0
    v_cvt_pk_bf16_f32 v54, v44, v45
    v_mfma_f32_16x16x32_bf16 v[176:179], a[192:195], v[48:51], 0
    v_exp_f32 v46, v46
    v_mfma_f32_16x16x32_bf16 v[180:183], a[196:199], v[48:51], 0
    v_mfma_f32_16x16x32_bf16 v[184:187], a[200:203], v[48:51], 0
    v_exp_f32 v47, v47
    v_mfma_f32_16x16x32_bf16 v[188:191], a[204:207], v[48:51], 0
    v_cvt_pk_bf16_f32 v55, v46, v47
    v_mfma_f32_16x16x32_bf16 a[96:99], a[108:111], v[48:51], 0
    v_mfma_f32_16x16x32_bf16 v[40:43], a[112:115], a[48:51], v[68:71]
    v_exp_f32 v32, v32
    v_mfma_f32_16x16x32_bf16 v[44:47], a[128:131], a[48:51], v[68:71]
    v_mfma_f32_16x16x32_bf16 v[40:43], a[116:119], a[52:55], v[40:43]
    v_exp_f32 v33, v33
    v_mfma_f32_16x16x32_bf16 v[44:47], a[132:135], a[52:55], v[44:47]
    v_cvt_pk_bf16_f32 v48, v32, v33
    v_mfma_f32_16x16x32_bf16 v[40:43], a[120:123], a[56:59], v[40:43]
    v_exp_f32 v34, v34
    v_mfma_f32_16x16x32_bf16 v[44:47], a[136:139], a[56:59], v[44:47]
    v_mfma_f32_16x16x32_bf16 v[40:43], a[124:127], a[60:63], v[40:43]
    v_exp_f32 v35, v35
    v_mfma_f32_16x16x32_bf16 v[44:47], a[140:143], a[60:63], v[44:47]
    v_cvt_pk_bf16_f32 v49, v34, v35
    s_waitcnt lgkmcnt(0)
    s_barrier
    v_mfma_f32_16x16x32_bf16 v[192:195], a[176:179], v[52:55], 0
    v_exp_f32 v36, v36
    v_mfma_f32_16x16x32_bf16 v[196:199], a[180:183], v[52:55], 0
    ds_read_b128 a[144:147], v6 offset:32768
    s_add_u32 s77, s43, 0
    ds_read_b128 a[160:163], v6 offset:36864
    v_mfma_f32_16x16x32_bf16 v[200:203], a[184:187], v[52:55], 0
    v_exp_f32 v37, v37
    v_mfma_f32_16x16x32_bf16 v[204:207], a[188:191], v[52:55], 0
    v_cvt_pk_bf16_f32 v50, v36, v37
    ds_read_b128 a[148:151], v7 offset:32768
    s_and_b32 s77, s77, 3
    v_mfma_f32_16x16x32_bf16 v[208:211], a[192:195], v[52:55], 0
    v_exp_f32 v38, v38
    v_mfma_f32_16x16x32_bf16 v[212:215], a[196:199], v[52:55], 0
    ds_read_b128 a[164:167], v7 offset:36864
    s_lshl_b32 s77, s77, 2
    ds_read_b128 a[152:155], v8 offset:32768
    v_mfma_f32_16x16x32_bf16 v[216:219], a[200:203], v[52:55], 0
    v_exp_f32 v39, v39
    v_mfma_f32_16x16x32_bf16 v[220:223], a[204:207], v[52:55], 0
    v_cvt_pk_bf16_f32 v51, v38, v39
    ds_read_b128 a[168:171], v8 offset:36864
    s_add_u32 s77, s77, 0
    v_mfma_f32_16x16x32_bf16 a[100:103], a[108:111], v[52:55], 0
    ds_read_b128 a[156:159], v9 offset:32768
    s_xor_b32 s77, s77, s3
    ds_read_b128 a[172:175], v9 offset:36864
    v_mfma_f32_16x16x32_bf16 v[32:35], a[112:115], a[64:67], v[72:75]
    v_exp_f32 v40, v40
    v_mfma_f32_16x16x32_bf16 v[36:39], a[128:131], a[64:67], v[72:75]
    s_lshl_b32 s77, s77, 16
    s_add_u32 s77, s77, s60
    s_mov_b32 m0, 69632
    v_mfma_f32_16x16x32_bf16 v[32:35], a[116:119], a[68:71], v[32:35]
    v_exp_f32 v41, v41
    v_mfma_f32_16x16x32_bf16 v[36:39], a[132:135], a[68:71], v[36:39]
    v_cvt_pk_bf16_f32 v52, v40, v41
    buffer_load_dwordx4 v24, s[24:27], s77 offen lds
    buffer_load_dwordx4 v25, s[24:27], s77 offen offset:1024 lds
    v_mfma_f32_16x16x32_bf16 v[32:35], a[120:123], a[72:75], v[32:35]
    v_exp_f32 v42, v42
    v_mfma_f32_16x16x32_bf16 v[36:39], a[136:139], a[72:75], v[36:39]
    buffer_load_dwordx4 v26, s[24:27], s77 offen offset:2048 lds
    buffer_load_dwordx4 v27, s[24:27], s77 offen offset:3072 lds
    s_mov_b32 m0, 73728
    v_mfma_f32_16x16x32_bf16 v[32:35], a[124:127], a[76:79], v[32:35]
    v_exp_f32 v43, v43
    v_mfma_f32_16x16x32_bf16 v[36:39], a[140:143], a[76:79], v[36:39]
    v_cvt_pk_bf16_f32 v53, v42, v43
    s_add_u32 s77, s77, 16384
    buffer_load_dwordx4 v24, s[24:27], s77 offen lds
    v_mfma_f32_16x16x32_bf16 v[224:227], a[176:179], v[48:51], 0
    v_exp_f32 v44, v44
    v_mfma_f32_16x16x32_bf16 v[228:231], a[180:183], v[48:51], 0
    ds_read_b64_tr_b16 a[176:177], v10 offset:32768
    buffer_load_dwordx4 v25, s[24:27], s77 offen offset:1024 lds
    ds_read_b64_tr_b16 a[178:179], v10 offset:36864
    v_mfma_f32_16x16x32_bf16 v[232:235], a[184:187], v[48:51], 0
    v_exp_f32 v45, v45
    v_mfma_f32_16x16x32_bf16 v[236:239], a[188:191], v[48:51], 0
    v_cvt_pk_bf16_f32 v54, v44, v45
    ds_read_b64_tr_b16 a[180:181], v11 offset:32768
    buffer_load_dwordx4 v26, s[24:27], s77 offen offset:2048 lds
    v_mfma_f32_16x16x32_bf16 v[240:243], a[192:195], v[48:51], 0
    v_exp_f32 v46, v46
    v_mfma_f32_16x16x32_bf16 v[244:247], a[196:199], v[48:51], 0
    ds_read_b64_tr_b16 a[182:183], v11 offset:36864
    buffer_load_dwordx4 v27, s[24:27], s77 offen offset:3072 lds
    ds_read_b64_tr_b16 a[184:185], v12 offset:32768
    v_mfma_f32_16x16x32_bf16 v[248:251], a[200:203], v[48:51], 0
    v_exp_f32 v47, v47
    v_mfma_f32_16x16x32_bf16 v[252:255], a[204:207], v[48:51], 0
    v_cvt_pk_bf16_f32 v55, v46, v47
    ds_read_b64_tr_b16 a[186:187], v12 offset:36864
    s_mov_b32 m0, 77824
    v_mfma_f32_16x16x32_bf16 a[104:107], a[108:111], v[48:51], 0
    ds_read_b64_tr_b16 a[188:189], v13 offset:32768
    s_add_u32 s77, s77, 16384
    ds_read_b64_tr_b16 a[190:191], v13 offset:36864
    s_waitcnt lgkmcnt(8)
    v_mfma_f32_16x16x32_bf16 v[40:43], a[144:147], a[48:51], v[68:71]
    v_exp_f32 v32, v32
    v_mfma_f32_16x16x32_bf16 v[44:47], a[160:163], a[48:51], v[68:71]
    ds_read_b64_tr_b16 a[192:193], v14 offset:32768
    buffer_load_dwordx4 v24, s[24:27], s77 offen lds
    ds_read_b64_tr_b16 a[194:195], v14 offset:36864
    v_mfma_f32_16x16x32_bf16 v[40:43], a[148:151], a[52:55], v[40:43]
    v_exp_f32 v33, v33
    v_mfma_f32_16x16x32_bf16 v[44:47], a[164:167], a[52:55], v[44:47]
    v_cvt_pk_bf16_f32 v48, v32, v33
    ds_read_b64_tr_b16 a[196:197], v15 offset:32768
    buffer_load_dwordx4 v25, s[24:27], s77 offen offset:1024 lds
    v_mfma_f32_16x16x32_bf16 v[40:43], a[152:155], a[56:59], v[40:43]
    v_exp_f32 v34, v34
    v_mfma_f32_16x16x32_bf16 v[44:47], a[168:171], a[56:59], v[44:47]
    ds_read_b64_tr_b16 a[198:199], v15 offset:36864
    buffer_load_dwordx4 v26, s[24:27], s77 offen offset:2048 lds
    ds_read_b64_tr_b16 a[200:201], v16 offset:32768
    v_mfma_f32_16x16x32_bf16 v[40:43], a[156:159], a[60:63], v[40:43]
    v_exp_f32 v35, v35
    v_mfma_f32_16x16x32_bf16 v[44:47], a[172:175], a[60:63], v[44:47]
    v_cvt_pk_bf16_f32 v49, v34, v35
    ds_read_b64_tr_b16 a[202:203], v16 offset:36864
    buffer_load_dwordx4 v27, s[24:27], s77 offen offset:3072 lds
    v_mfma_f32_16x16x32_bf16 v[160:163], a[208:211], v[52:55], v[160:163]
    v_exp_f32 v36, v36
    v_mfma_f32_16x16x32_bf16 v[164:167], a[212:215], v[52:55], v[164:167]
    ds_read_b64_tr_b16 a[204:205], v17 offset:32768
    s_mov_b32 m0, 81920
    ds_read_b64_tr_b16 a[206:207], v17 offset:36864
    v_mfma_f32_16x16x32_bf16 v[168:171], a[216:219], v[52:55], v[168:171]
    v_exp_f32 v37, v37
    v_mfma_f32_16x16x32_bf16 v[172:175], a[220:223], v[52:55], v[172:175]
    v_cvt_pk_bf16_f32 v50, v36, v37
    s_add_u32 s77, s77, 16384
    buffer_load_dwordx4 v24, s[24:27], s77 offen lds
    v_mfma_f32_16x16x32_bf16 v[176:179], a[224:227], v[52:55], v[176:179]
    v_exp_f32 v38, v38
    v_mfma_f32_16x16x32_bf16 v[180:183], a[228:231], v[52:55], v[180:183]
    buffer_load_dwordx4 v25, s[24:27], s77 offen offset:1024 lds
    buffer_load_dwordx4 v26, s[24:27], s77 offen offset:2048 lds
    buffer_load_dwordx4 v27, s[24:27], s77 offen offset:3072 lds
    v_mfma_f32_16x16x32_bf16 v[184:187], a[232:235], v[52:55], v[184:187]
    v_exp_f32 v39, v39
    v_mfma_f32_16x16x32_bf16 v[188:191], a[236:239], v[52:55], v[188:191]
    v_cvt_pk_bf16_f32 v51, v38, v39
    v_mfma_f32_16x16x32_bf16 a[96:99], a[108:111], v[52:55], a[96:99]
    s_waitcnt lgkmcnt(0)
    s_barrier
    v_mfma_f32_16x16x32_bf16 v[32:35], a[144:147], a[64:67], v[72:75]
    v_exp_f32 v40, v40
    v_mfma_f32_16x16x32_bf16 v[36:39], a[160:163], a[64:67], v[72:75]
    ds_read_b128 a[112:115], v6 offset:49152
    s_add_u32 s77, s43, 0
    ds_read_b128 a[128:131], v6 offset:53248
    v_mfma_f32_16x16x32_bf16 v[32:35], a[148:151], a[68:71], v[32:35]
    v_exp_f32 v41, v41
    v_mfma_f32_16x16x32_bf16 v[36:39], a[164:167], a[68:71], v[36:39]
    v_cvt_pk_bf16_f32 v52, v40, v41
    ds_read_b128 a[116:119], v7 offset:49152
    s_and_b32 s77, s77, 3
    v_mfma_f32_16x16x32_bf16 v[32:35], a[152:155], a[72:75], v[32:35]
    v_exp_f32 v42, v42
    v_mfma_f32_16x16x32_bf16 v[36:39], a[168:171], a[72:75], v[36:39]
    ds_read_b128 a[132:135], v7 offset:53248
    s_lshl_b32 s77, s77, 2
    ds_read_b128 a[120:123], v8 offset:49152
    v_mfma_f32_16x16x32_bf16 v[32:35], a[156:159], a[76:79], v[32:35]
    v_exp_f32 v43, v43
    v_mfma_f32_16x16x32_bf16 v[36:39], a[172:175], a[76:79], v[36:39]
    v_cvt_pk_bf16_f32 v53, v42, v43
    ds_read_b128 a[136:139], v8 offset:53248
    s_add_u32 s77, s77, 1
    v_mfma_f32_16x16x32_bf16 v[192:195], a[208:211], v[48:51], v[192:195]
    v_exp_f32 v44, v44
    v_mfma_f32_16x16x32_bf16 v[196:199], a[212:215], v[48:51], v[196:199]
    ds_read_b128 a[124:127], v9 offset:49152
    s_xor_b32 s77, s77, s3
    ds_read_b128 a[140:143], v9 offset:53248
    v_mfma_f32_16x16x32_bf16 v[200:203], a[216:219], v[48:51], v[200:203]
    v_exp_f32 v45, v45
    v_mfma_f32_16x16x32_bf16 v[204:207], a[220:223], v[48:51], v[204:207]
    v_cvt_pk_bf16_f32 v54, v44, v45
    ds_read_b64_tr_b16 a[208:209], v10 offset:49152
    s_lshl_b32 s77, s77, 16
    ds_read_b64_tr_b16 a[210:211], v10 offset:53248
    v_mfma_f32_16x16x32_bf16 v[208:211], a[224:227], v[48:51], v[208:211]
    v_exp_f32 v46, v46
    v_mfma_f32_16x16x32_bf16 v[212:215], a[228:231], v[48:51], v[212:215]
    ds_read_b64_tr_b16 a[212:213], v11 offset:49152
    s_add_u32 s77, s77, s60
    ds_read_b64_tr_b16 a[214:215], v11 offset:53248
    ds_read_b64_tr_b16 a[216:217], v12 offset:49152
    v_mfma_f32_16x16x32_bf16 v[216:219], a[232:235], v[48:51], v[216:219]
    v_exp_f32 v47, v47
    v_mfma_f32_16x16x32_bf16 v[220:223], a[236:239], v[48:51], v[220:223]
    v_cvt_pk_bf16_f32 v55, v46, v47
    ds_read_b64_tr_b16 a[218:219], v12 offset:53248
    s_mov_b32 m0, 104448
    v_mfma_f32_16x16x32_bf16 a[100:103], a[108:111], v[48:51], a[100:103]
    ds_read_b64_tr_b16 a[220:221], v13 offset:49152
    buffer_load_dwordx4 v24, s[24:27], s77 offen lds
    ds_read_b64_tr_b16 a[222:223], v13 offset:53248
    v_mfma_f32_16x16x32_bf16 v[40:43], a[144:147], a[80:83], v[76:79]
    v_exp_f32 v32, v32
    v_mfma_f32_16x16x32_bf16 v[44:47], a[160:163], a[80:83], v[76:79]
    ds_read_b64_tr_b16 a[224:225], v14 offset:49152
    buffer_load_dwordx4 v25, s[24:27], s77 offen offset:1024 lds
    ds_read_b64_tr_b16 a[226:227], v14 offset:53248
    v_mfma_f32_16x16x32_bf16 v[40:43], a[148:151], a[84:87], v[40:43]
    v_exp_f32 v33, v33
    v_mfma_f32_16x16x32_bf16 v[44:47], a[164:167], a[84:87], v[44:47]
    v_cvt_pk_bf16_f32 v48, v32, v33
    ds_read_b64_tr_b16 a[228:229], v15 offset:49152
    buffer_load_dwordx4 v26, s[24:27], s77 offen offset:2048 lds
    v_mfma_f32_16x16x32_bf16 v[40:43], a[152:155], a[88:91], v[40:43]
    v_exp_f32 v34, v34
    v_mfma_f32_16x16x32_bf16 v[44:47], a[168:171], a[88:91], v[44:47]
    ds_read_b64_tr_b16 a[230:231], v15 offset:53248
    buffer_load_dwordx4 v27, s[24:27], s77 offen offset:3072 lds
    ds_read_b64_tr_b16 a[232:233], v16 offset:49152
    v_mfma_f32_16x16x32_bf16 v[40:43], a[156:159], a[92:95], v[40:43]
    v_exp_f32 v35, v35
    v_mfma_f32_16x16x32_bf16 v[44:47], a[172:175], a[92:95], v[44:47]
    v_cvt_pk_bf16_f32 v49, v34, v35
    ds_read_b64_tr_b16 a[234:235], v16 offset:53248
    s_mov_b32 m0, 108544
    v_mfma_f32_16x16x32_bf16 v[160:163], a[176:179], v[52:55], v[160:163]
    v_exp_f32 v36, v36
    v_mfma_f32_16x16x32_bf16 v[164:167], a[180:183], v[52:55], v[164:167]
    ds_read_b64_tr_b16 a[236:237], v17 offset:49152
    s_add_u32 s77, s77, 16384
    ds_read_b64_tr_b16 a[238:239], v17 offset:53248
    v_mfma_f32_16x16x32_bf16 v[168:171], a[184:187], v[52:55], v[168:171]
    v_exp_f32 v37, v37
    v_mfma_f32_16x16x32_bf16 v[172:175], a[188:191], v[52:55], v[172:175]
    v_cvt_pk_bf16_f32 v50, v36, v37
    buffer_load_dwordx4 v24, s[24:27], s77 offen lds
    buffer_load_dwordx4 v25, s[24:27], s77 offen offset:1024 lds
    v_mfma_f32_16x16x32_bf16 v[176:179], a[192:195], v[52:55], v[176:179]
    v_exp_f32 v38, v38
    v_mfma_f32_16x16x32_bf16 v[180:183], a[196:199], v[52:55], v[180:183]
    buffer_load_dwordx4 v26, s[24:27], s77 offen offset:2048 lds
    buffer_load_dwordx4 v27, s[24:27], s77 offen offset:3072 lds
    s_mov_b32 m0, 112640
    v_mfma_f32_16x16x32_bf16 v[184:187], a[200:203], v[52:55], v[184:187]
    v_exp_f32 v39, v39
    v_mfma_f32_16x16x32_bf16 v[188:191], a[204:207], v[52:55], v[188:191]
    v_cvt_pk_bf16_f32 v51, v38, v39
    s_add_u32 s77, s77, 16384
    buffer_load_dwordx4 v24, s[24:27], s77 offen lds
    v_mfma_f32_16x16x32_bf16 a[96:99], a[108:111], v[52:55], a[96:99]
    buffer_load_dwordx4 v25, s[24:27], s77 offen offset:1024 lds
    buffer_load_dwordx4 v26, s[24:27], s77 offen offset:2048 lds
    buffer_load_dwordx4 v27, s[24:27], s77 offen offset:3072 lds
    s_waitcnt lgkmcnt(15)
    v_mfma_f32_16x16x32_bf16 v[32:35], a[112:115], a[48:51], v[68:71]
    v_exp_f32 v40, v40
    v_mfma_f32_16x16x32_bf16 v[36:39], a[128:131], a[48:51], v[68:71]
    s_mov_b32 m0, 116736
    s_add_u32 s77, s77, 16384
    buffer_load_dwordx4 v24, s[24:27], s77 offen lds
    v_mfma_f32_16x16x32_bf16 v[32:35], a[116:119], a[52:55], v[32:35]
    v_exp_f32 v41, v41
    v_mfma_f32_16x16x32_bf16 v[36:39], a[132:135], a[52:55], v[36:39]
    v_cvt_pk_bf16_f32 v52, v40, v41
    buffer_load_dwordx4 v25, s[24:27], s77 offen offset:1024 lds
    buffer_load_dwordx4 v26, s[24:27], s77 offen offset:2048 lds
    v_mfma_f32_16x16x32_bf16 v[32:35], a[120:123], a[56:59], v[32:35]
    v_exp_f32 v42, v42
    v_mfma_f32_16x16x32_bf16 v[36:39], a[136:139], a[56:59], v[36:39]
    buffer_load_dwordx4 v27, s[24:27], s77 offen offset:3072 lds
    v_mfma_f32_16x16x32_bf16 v[32:35], a[124:127], a[60:63], v[32:35]
    v_exp_f32 v43, v43
    v_mfma_f32_16x16x32_bf16 v[36:39], a[140:143], a[60:63], v[36:39]
    v_cvt_pk_bf16_f32 v53, v42, v43
    s_waitcnt lgkmcnt(0)
    s_barrier
    v_mfma_f32_16x16x32_bf16 v[192:195], a[176:179], v[48:51], v[192:195]
    v_exp_f32 v44, v44
    v_mfma_f32_16x16x32_bf16 v[196:199], a[180:183], v[48:51], v[196:199]
    ds_read_b128 a[144:147], v6
    ds_read_b128 a[160:163], v6 offset:4096
    v_mfma_f32_16x16x32_bf16 v[200:203], a[184:187], v[48:51], v[200:203]
    v_exp_f32 v45, v45
    v_mfma_f32_16x16x32_bf16 v[204:207], a[188:191], v[48:51], v[204:207]
    v_cvt_pk_bf16_f32 v54, v44, v45
    ds_read_b128 a[148:151], v7
    v_mfma_f32_16x16x32_bf16 v[208:211], a[192:195], v[48:51], v[208:211]
    v_exp_f32 v46, v46
    v_mfma_f32_16x16x32_bf16 v[212:215], a[196:199], v[48:51], v[212:215]
    ds_read_b128 a[164:167], v7 offset:4096
    ds_read_b128 a[152:155], v8
    v_mfma_f32_16x16x32_bf16 v[216:219], a[200:203], v[48:51], v[216:219]
    v_exp_f32 v47, v47
    v_mfma_f32_16x16x32_bf16 v[220:223], a[204:207], v[48:51], v[220:223]
    v_cvt_pk_bf16_f32 v55, v46, v47
    ds_read_b128 a[168:171], v8 offset:4096
    v_mfma_f32_16x16x32_bf16 a[100:103], a[108:111], v[48:51], a[100:103]
    ds_read_b128 a[156:159], v9
    ds_read_b128 a[172:175], v9 offset:4096
    v_mfma_f32_16x16x32_bf16 v[40:43], a[112:115], a[64:67], v[72:75]
    v_exp_f32 v32, v32
    v_mfma_f32_16x16x32_bf16 v[44:47], a[128:131], a[64:67], v[72:75]
    v_mfma_f32_16x16x32_bf16 v[40:43], a[116:119], a[68:71], v[40:43]
    v_exp_f32 v33, v33
    v_mfma_f32_16x16x32_bf16 v[44:47], a[132:135], a[68:71], v[44:47]
    v_cvt_pk_bf16_f32 v48, v32, v33
    v_mfma_f32_16x16x32_bf16 v[40:43], a[120:123], a[72:75], v[40:43]
    v_exp_f32 v34, v34
    v_mfma_f32_16x16x32_bf16 v[44:47], a[136:139], a[72:75], v[44:47]
    v_mfma_f32_16x16x32_bf16 v[40:43], a[124:127], a[76:79], v[40:43]
    v_exp_f32 v35, v35
    v_mfma_f32_16x16x32_bf16 v[44:47], a[140:143], a[76:79], v[44:47]
    v_cvt_pk_bf16_f32 v49, v34, v35
    v_mfma_f32_16x16x32_bf16 v[224:227], a[176:179], v[52:55], v[224:227]
    v_exp_f32 v36, v36
    v_mfma_f32_16x16x32_bf16 v[228:231], a[180:183], v[52:55], v[228:231]
    ds_read_b64_tr_b16 a[176:177], v10
    ds_read_b64_tr_b16 a[178:179], v10 offset:4096
    v_mfma_f32_16x16x32_bf16 v[232:235], a[184:187], v[52:55], v[232:235]
    v_exp_f32 v37, v37
    v_mfma_f32_16x16x32_bf16 v[236:239], a[188:191], v[52:55], v[236:239]
    v_cvt_pk_bf16_f32 v50, v36, v37
    ds_read_b64_tr_b16 a[180:181], v11
    v_mfma_f32_16x16x32_bf16 v[240:243], a[192:195], v[52:55], v[240:243]
    v_exp_f32 v38, v38
    v_mfma_f32_16x16x32_bf16 v[244:247], a[196:199], v[52:55], v[244:247]
    ds_read_b64_tr_b16 a[182:183], v11 offset:4096
    ds_read_b64_tr_b16 a[184:185], v12
    v_mfma_f32_16x16x32_bf16 v[248:251], a[200:203], v[52:55], v[248:251]
    v_exp_f32 v39, v39
    v_mfma_f32_16x16x32_bf16 v[252:255], a[204:207], v[52:55], v[252:255]
    v_cvt_pk_bf16_f32 v51, v38, v39
    ds_read_b64_tr_b16 a[186:187], v12 offset:4096
    v_mfma_f32_16x16x32_bf16 a[104:107], a[108:111], v[52:55], a[104:107]
    ds_read_b64_tr_b16 a[188:189], v13
    ds_read_b64_tr_b16 a[190:191], v13 offset:4096
    s_waitcnt lgkmcnt(8)
    v_mfma_f32_16x16x32_bf16 v[32:35], a[144:147], a[48:51], v[68:71]
    v_exp_f32 v40, v40
    v_mfma_f32_16x16x32_bf16 v[36:39], a[160:163], a[48:51], v[68:71]
    ds_read_b64_tr_b16 a[192:193], v14
    ds_read_b64_tr_b16 a[194:195], v14 offset:4096
    v_mfma_f32_16x16x32_bf16 v[32:35], a[148:151], a[52:55], v[32:35]
    v_exp_f32 v41, v41
    v_mfma_f32_16x16x32_bf16 v[36:39], a[164:167], a[52:55], v[36:39]
    v_cvt_pk_bf16_f32 v52, v40, v41
    ds_read_b64_tr_b16 a[196:197], v15
    v_mfma_f32_16x16x32_bf16 v[32:35], a[152:155], a[56:59], v[32:35]
    v_exp_f32 v42, v42
    v_mfma_f32_16x16x32_bf16 v[36:39], a[168:171], a[56:59], v[36:39]
    ds_read_b64_tr_b16 a[198:199], v15 offset:4096
    ds_read_b64_tr_b16 a[200:201], v16
    v_mfma_f32_16x16x32_bf16 v[32:35], a[156:159], a[60:63], v[32:35]
    v_exp_f32 v43, v43
    v_mfma_f32_16x16x32_bf16 v[36:39], a[172:175], a[60:63], v[36:39]
    v_cvt_pk_bf16_f32 v53, v42, v43
    ds_read_b64_tr_b16 a[202:203], v16 offset:4096
    v_mfma_f32_16x16x32_bf16 v[160:163], a[208:211], v[48:51], v[160:163]
    v_exp_f32 v44, v44
    v_mfma_f32_16x16x32_bf16 v[164:167], a[212:215], v[48:51], v[164:167]
    ds_read_b64_tr_b16 a[204:205], v17
    ds_read_b64_tr_b16 a[206:207], v17 offset:4096
    v_mfma_f32_16x16x32_bf16 v[168:171], a[216:219], v[48:51], v[168:171]
    v_exp_f32 v45, v45
    v_mfma_f32_16x16x32_bf16 v[172:175], a[220:223], v[48:51], v[172:175]
    v_cvt_pk_bf16_f32 v54, v44, v45
    v_mfma_f32_16x16x32_bf16 v[176:179], a[224:227], v[48:51], v[176:179]
    v_exp_f32 v46, v46
    v_mfma_f32_16x16x32_bf16 v[180:183], a[228:231], v[48:51], v[180:183]
    v_mfma_f32_16x16x32_bf16 v[184:187], a[232:235], v[48:51], v[184:187]
    v_exp_f32 v47, v47
    v_mfma_f32_16x16x32_bf16 v[188:191], a[236:239], v[48:51], v[188:191]
    v_cvt_pk_bf16_f32 v55, v46, v47
    v_mfma_f32_16x16x32_bf16 a[96:99], a[108:111], v[48:51], a[96:99]
    s_mov_b32 s54, 6
L_loop_A11:
    s_waitcnt vmcnt(0)
    s_waitcnt lgkmcnt(0)
    s_barrier
    s_cmp_lg_u32 s54, 2
    s_cbranch_scc1 1f
    s_lshl_b32 s39, s38, 12
    v_lshlrev_b32 v109, 6, v1
    v_add_u32 v109, s39, v109
    v_min_u32 v109, L_end-L_pc-4, v109
    v_add_co_u32 v110, vcc, s82, v109
    v_mov_b32 v111, s83
    s_nop 0
    v_addc_co_u32 v111, vcc, 0, v111, vcc
    global_load_dword v107, v[110:111], off
1:
    v_mfma_f32_16x16x32_bf16 v[40:43], a[144:147], a[64:67], v[72:75]
    v_exp_f32 v32, v32
    v_mfma_f32_16x16x32_bf16 v[44:47], a[160:163], a[64:67], v[72:75]
    ds_read_b128 a[112:115], v6 offset:16384
    ds_read_b128 a[128:131], v6 offset:20480
    v_mfma_f32_16x16x32_bf16 v[40:43], a[148:151], a[68:71], v[40:43]
    v_exp_f32 v33, v33
    v_mfma_f32_16x16x32_bf16 v[44:47], a[164:167], a[68:71], v[44:47]
    v_cvt_pk_bf16_f32 v48, v32, v33
    ds_read_b128 a[116:119], v7 offset:16384
    v_mfma_f32_16x16x32_bf16 v[40:43], a[152:155], a[72:75], v[40:43]
    v_exp_f32 v34, v34
    v_mfma_f32_16x16x32_bf16 v[44:47], a[168:171], a[72:75], v[44:47]
    ds_read_b128 a[132:135], v7 offset:20480
    ds_read_b128 a[120:123], v8 offset:16384
    v_mfma_f32_16x16x32_bf16 v[40:43], a[156:159], a[76:79], v[40:43]
    v_exp_f32 v35, v35
    v_mfma_f32_16x16x32_bf16 v[44:47], a[172:175], a[76:79], v[44:47]
    v_cvt_pk_bf16_f32 v49, v34, v35
    ds_read_b128 a[136:139], v8 offset:20480
    v_mfma_f32_16x16x32_bf16 v[192:195], a[208:211], v[52:55], v[192:195]
    v_exp_f32 v36, v36
    v_mfma_f32_16x16x32_bf16 v[196:199], a[212:215], v[52:55], v[196:199]
    ds_read_b128 a[124:127], v9 offset:16384
    ds_read_b128 a[140:143], v9 offset:20480
    v_mfma_f32_16x16x32_bf16 v[200:203], a[216:219], v[52:55], v[200:203]
    v_exp_f32 v37, v37
    v_mfma_f32_16x16x32_bf16 v[204:207], a[220:223], v[52:55], v[204:207]
    v_cvt_pk_bf16_f32 v50, v36, v37
    ds_read_b64_tr_b16 a[208:209], v10 offset:16384
    v_mfma_f32_16x16x32_bf16 v[208:211], a[224:227], v[52:55], v[208:211]
    v_exp_f32 v38, v38
    v_mfma_f32_16x16x32_bf16 v[212:215], a[228:231], v[52:55], v[212:215]
    ds_read_b64_tr_b16 a[210:211], v10 offset:20480
    ds_read_b64_tr_b16 a[212:213], v11 offset:16384
    v_mfma_f32_16x16x32_bf16 v[216:219], a[232:235], v[52:55], v[216:219]
    v_exp_f32 v39, v39
    v_mfma_f32_16x16x32_bf16 v[220:223], a[236:239], v[52:55], v[220:223]
    v_cvt_pk_bf16_f32 v51, v38, v39
    ds_read_b64_tr_b16 a[214:215], v11 offset:20480
    v_mfma_f32_16x16x32_bf16 a[100:103], a[108:111], v[52:55], a[100:103]
    ds_read_b64_tr_b16 a[216:217], v12 offset:16384
    ds_read_b64_tr_b16 a[218:219], v12 offset:20480
    v_mfma_f32_16x16x32_bf16 v[32:35], a[144:147], a[80:83], v[76:79]
    v_exp_f32 v40, v40
    v_mfma_f32_16x16x32_bf16 v[36:39], a[160:163], a[80:83], v[76:79]
    ds_read_b64_tr_b16 a[220:221], v13 offset:16384
    ds_read_b64_tr_b16 a[222:223], v13 offset:20480
    v_mfma_f32_16x16x32_bf16 v[32:35], a[148:151], a[84:87], v[32:35]
    v_exp_f32 v41, v41
    v_mfma_f32_16x16x32_bf16 v[36:39], a[164:167], a[84:87], v[36:39]
    v_cvt_pk_bf16_f32 v52, v40, v41
    ds_read_b64_tr_b16 a[224:225], v14 offset:16384
    v_mfma_f32_16x16x32_bf16 v[32:35], a[152:155], a[88:91], v[32:35]
    v_exp_f32 v42, v42
    v_mfma_f32_16x16x32_bf16 v[36:39], a[168:171], a[88:91], v[36:39]
    ds_read_b64_tr_b16 a[226:227], v14 offset:20480
    ds_read_b64_tr_b16 a[228:229], v15 offset:16384
    v_mfma_f32_16x16x32_bf16 v[32:35], a[156:159], a[92:95], v[32:35]
    v_exp_f32 v43, v43
    v_mfma_f32_16x16x32_bf16 v[36:39], a[172:175], a[92:95], v[36:39]
    v_cvt_pk_bf16_f32 v53, v42, v43
    ds_read_b64_tr_b16 a[230:231], v15 offset:20480
    v_mfma_f32_16x16x32_bf16 v[160:163], a[176:179], v[48:51], v[160:163]
    v_exp_f32 v44, v44
    v_mfma_f32_16x16x32_bf16 v[164:167], a[180:183], v[48:51], v[164:167]
    ds_read_b64_tr_b16 a[232:233], v16 offset:16384
    ds_read_b64_tr_b16 a[234:235], v16 offset:20480
    v_mfma_f32_16x16x32_bf16 v[168:171], a[184:187], v[48:51], v[168:171]
    v_exp_f32 v45, v45
    v_mfma_f32_16x16x32_bf16 v[172:175], a[188:191], v[48:51], v[172:175]
    v_cvt_pk_bf16_f32 v54, v44, v45
    ds_read_b64_tr_b16 a[236:237], v17 offset:16384
    v_mfma_f32_16x16x32_bf16 v[176:179], a[192:195], v[48:51], v[176:179]
    v_exp_f32 v46, v46
    v_mfma_f32_16x16x32_bf16 v[180:183], a[196:199], v[48:51], v[180:183]
    ds_read_b64_tr_b16 a[238:239], v17 offset:20480
    v_mfma_f32_16x16x32_bf16 v[184:187], a[200:203], v[48:51], v[184:187]
    v_exp_f32 v47, v47
    v_mfma_f32_16x16x32_bf16 v[188:191], a[204:207], v[48:51], v[188:191]
    v_cvt_pk_bf16_f32 v55, v46, v47
    v_mfma_f32_16x16x32_bf16 a[96:99], a[108:111], v[48:51], a[96:99]
    s_waitcnt lgkmcnt(15)
    v_mfma_f32_16x16x32_bf16 v[40:43], a[112:115], a[48:51], v[68:71]
    v_exp_f32 v32, v32
    v_mfma_f32_16x16x32_bf16 v[44:47], a[128:131], a[48:51], v[68:71]
    v_mfma_f32_16x16x32_bf16 v[40:43], a[116:119], a[52:55], v[40:43]
    v_exp_f32 v33, v33
    v_mfma_f32_16x16x32_bf16 v[44:47], a[132:135], a[52:55], v[44:47]
    v_cvt_pk_bf16_f32 v48, v32, v33
    v_mfma_f32_16x16x32_bf16 v[40:43], a[120:123], a[56:59], v[40:43]
    v_exp_f32 v34, v34
    v_mfma_f32_16x16x32_bf16 v[44:47], a[136:139], a[56:59], v[44:47]
    v_mfma_f32_16x16x32_bf16 v[40:43], a[124:127], a[60:63], v[40:43]
    v_exp_f32 v35, v35
    v_mfma_f32_16x16x32_bf16 v[44:47], a[140:143], a[60:63], v[44:47]
    v_cvt_pk_bf16_f32 v49, v34, v35
    s_waitcnt lgkmcnt(0)
    s_barrier
    v_mfma_f32_16x16x32_bf16 v[192:195], a[176:179], v[52:55], v[192:195]
    v_exp_f32 v36, v36
    v_mfma_f32_16x16x32_bf16 v[196:199], a[180:183], v[52:55], v[196:199]
    ds_read_b128 a[144:147], v6 offset:32768
    ds_read_b128 a[160:163], v6 offset:36864
    v_mfma_f32_16x16x32_bf16 v[200:203], a[184:187], v[52:55], v[200:203]
    v_exp_f32 v37, v37
    v_mfma_f32_16x16x32_bf16 v[204:207], a[188:191], v[52:55], v[204:207]
    v_cvt_pk_bf16_f32 v50, v36, v37
    ds_read_b128 a[148:151], v7 offset:32768
    v_mfma_f32_16x16x32_bf16 v[208:211], a[192:195], v[52:55], v[208:211]
    v_exp_f32 v38, v38
    v_mfma_f32_16x16x32_bf16 v[212:215], a[196:199], v[52:55], v[212:215]
    ds_read_b128 a[164:167], v7 offset:36864
    ds_read_b128 a[152:155], v8 offset:32768
    v_mfma_f32_16x16x32_bf16 v[216:219], a[200:203], v[52:55], v[216:219]
    v_exp_f32 v39, v39
    v_mfma_f32_16x16x32_bf16 v[220:223], a[204:207], v[52:55], v[220:223]
    v_cvt_pk_bf16_f32 v51, v38, v39
    ds_read_b128 a[168:171], v8 offset:36864
    v_mfma_f32_16x16x32_bf16 a[100:103], a[108:111], v[52:55], a[100:103]
    ds_read_b128 a[156:159], v9 offset:32768
    ds_read_b128 a[172:175], v9 offset:36864
    v_mfma_f32_16x16x32_bf16 v[32:35], a[112:115], a[64:67], v[72:75]
    v_exp_f32 v40, v40
    v_mfma_f32_16x16x32_bf16 v[36:39], a[128:131], a[64:67], v[72:75]
    v_mfma_f32_16x16x32_bf16 v[32:35], a[116:119], a[68:71], v[32:35]
    v_exp_f32 v41, v41
    v_mfma_f32_16x16x32_bf16 v[36:39], a[132:135], a[68:71], v[36:39]
    v_cvt_pk_bf16_f32 v52, v40, v41
    v_mfma_f32_16x16x32_bf16 v[32:35], a[120:123], a[72:75], v[32:35]
    v_exp_f32 v42, v42
    v_mfma_f32_16x16x32_bf16 v[36:39], a[136:139], a[72:75], v[36:39]
    v_mfma_f32_16x16x32_bf16 v[32:35], a[124:127], a[76:79], v[32:35]
    v_exp_f32 v43, v43
    v_mfma_f32_16x16x32_bf16 v[36:39], a[140:143], a[76:79], v[36:39]
    v_cvt_pk_bf16_f32 v53, v42, v43
    v_mfma_f32_16x16x32_bf16 v[224:227], a[176:179], v[48:51], v[224:227]
    v_exp_f32 v44, v44
    v_mfma_f32_16x16x32_bf16 v[228:231], a[180:183], v[48:51], v[228:231]
    ds_read_b64_tr_b16 a[176:177], v10 offset:32768
    ds_read_b64_tr_b16 a[178:179], v10 offset:36864
    v_mfma_f32_16x16x32_bf16 v[232:235], a[184:187], v[48:51], v[232:235]
    v_exp_f32 v45, v45
    v_mfma_f32_16x16x32_bf16 v[236:239], a[188:191], v[48:51], v[236:239]
    v_cvt_pk_bf16_f32 v54, v44, v45
    ds_read_b64_tr_b16 a[180:181], v11 offset:32768
    v_mfma_f32_16x16x32_bf16 v[240:243], a[192:195], v[48:51], v[240:243]
    v_exp_f32 v46, v46
    v_mfma_f32_16x16x32_bf16 v[244:247], a[196:199], v[48:51], v[244:247]
    ds_read_b64_tr_b16 a[182:183], v11 offset:36864
    ds_read_b64_tr_b16 a[184:185], v12 offset:32768
    v_mfma_f32_16x16x32_bf16 v[248:251], a[200:203], v[48:51], v[248:251]
    v_exp_f32 v47, v47
    v_mfma_f32_16x16x32_bf16 v[252:255], a[204:207], v[48:51], v[252:255]
    v_cvt_pk_bf16_f32 v55, v46, v47
    ds_read_b64_tr_b16 a[186:187], v12 offset:36864
    v_mfma_f32_16x16x32_bf16 a[104:107], a[108:111], v[48:51], a[104:107]
    ds_read_b64_tr_b16 a[188:189], v13 offset:32768
    ds_read_b64_tr_b16 a[190:191], v13 offset:36864
    s_waitcnt lgkmcnt(8)
    v_mfma_f32_16x16x32_bf16 v[40:43], a[144:147], a[48:51], v[68:71]
    v_exp_f32 v32, v32
    v_mfma_f32_16x16x32_bf16 v[44:47], a[160:163], a[48:51], v[68:71]
    ds_read_b64_tr_b16 a[192:193], v14 offset:32768
    ds_read_b64_tr_b16 a[194:195], v14 offset:36864
    v_mfma_f32_16x16x32_bf16 v[40:43], a[148:151], a[52:55], v[40:43]
    v_exp_f32 v33, v33
    v_mfma_f32_16x16x32_bf16 v[44:47], a[164:167], a[52:55], v[44:47]
    v_cvt_pk_bf16_f32 v48, v32, v33
    ds_read_b64_tr_b16 a[196:197], v15 offset:32768
    v_mfma_f32_16x16x32_bf16 v[40:43], a[152:155], a[56:59], v[40:43]
    v_exp_f32 v34, v34
    v_mfma_f32_16x16x32_bf16 v[44:47], a[168:171], a[56:59], v[44:47]
    ds_read_b64_tr_b16 a[198:199], v15 offset:36864
    ds_read_b64_tr_b16 a[200:201], v16 offset:32768
    v_mfma_f32_16x16x32_bf16 v[40:43], a[156:159], a[60:63], v[40:43]
    v_exp_f32 v35, v35
    v_mfma_f32_16x16x32_bf16 v[44:47], a[172:175], a[60:63], v[44:47]
    v_cvt_pk_bf16_f32 v49, v34, v35
    ds_read_b64_tr_b16 a[202:203], v16 offset:36864
    v_mfma_f32_16x16x32_bf16 v[160:163], a[208:211], v[52:55], v[160:163]
    v_exp_f32 v36, v36
    v_mfma_f32_16x16x32_bf16 v[164:167], a[212:215], v[52:55], v[164:167]
    ds_read_b64_tr_b16 a[204:205], v17 offset:32768
    ds_read_b64_tr_b16 a[206:207], v17 offset:36864
    v_mfma_f32_16x16x32_bf16 v[168:171], a[216:219], v[52:55], v[168:171]
    v_exp_f32 v37, v37
    v_mfma_f32_16x16x32_bf16 v[172:175], a[220:223], v[52:55], v[172:175]
    v_cvt_pk_bf16_f32 v50, v36, v37
    v_mfma_f32_16x16x32_bf16 v[176:179], a[224:227], v[52:55], v[176:179]
    v_exp_f32 v38, v38
    v_mfma_f32_16x16x32_bf16 v[180:183], a[228:231], v[52:55], v[180:183]
    v_mfma_f32_16x16x32_bf16 v[184:187], a[232:235], v[52:55], v[184:187]
    v_exp_f32 v39, v39
    v_mfma_f32_16x16x32_bf16 v[188:191], a[236:239], v[52:55], v[188:191]
    v_cvt_pk_bf16_f32 v51, v38, v39
    v_mfma_f32_16x16x32_bf16 a[96:99], a[108:111], v[52:55], a[96:99]
    s_waitcnt lgkmcnt(0)
    s_barrier
    v_mfma_f32_16x16x32_bf16 v[32:35], a[144:147], a[64:67], v[72:75]
    v_exp_f32 v40, v40
    v_mfma_f32_16x16x32_bf16 v[36:39], a[160:163], a[64:67], v[72:75]
    ds_read_b128 a[112:115], v6 offset:49152
    ds_read_b128 a[128:131], v6 offset:53248
    v_mfma_f32_16x16x32_bf16 v[32:35], a[148:151], a[68:71], v[32:35]
    v_exp_f32 v41, v41
    v_mfma_f32_16x16x32_bf16 v[36:39], a[164:167], a[68:71], v[36:39]
    v_cvt_pk_bf16_f32 v52, v40, v41
    ds_read_b128 a[116:119], v7 offset:49152
    v_mfma_f32_16x16x32_bf16 v[32:35], a[152:155], a[72:75], v[32:35]
    v_exp_f32 v42, v42
    v_mfma_f32_16x16x32_bf16 v[36:39], a[168:171], a[72:75], v[36:39]
    ds_read_b128 a[132:135], v7 offset:53248
    ds_read_b128 a[120:123], v8 offset:49152
    v_mfma_f32_16x16x32_bf16 v[32:35], a[156:159], a[76:79], v[32:35]
    v_exp_f32 v43, v43
    v_mfma_f32_16x16x32_bf16 v[36:39], a[172:175], a[76:79], v[36:39]
    v_cvt_pk_bf16_f32 v53, v42, v43
    ds_read_b128 a[136:139], v8 offset:53248
    v_mfma_f32_16x16x32_bf16 v[192:195], a[208:211], v[48:51], v[192:195]
    v_exp_f32 v44, v44
    v_mfma_f32_16x16x32_bf16 v[196:199], a[212:215], v[48:51], v[196:199]
    ds_read_b128 a[124:127], v9 offset:49152
    ds_read_b128 a[140:143], v9 offset:53248
    v_mfma_f32_16x16x32_bf16 v[200:203], a[216:219], v[48:51], v[200:203]
    v_exp_f32 v45, v45
    v_mfma_f32_16x16x32_bf16 v[204:207], a[220:223], v[48:51], v[204:207]
    v_cvt_pk_bf16_f32 v54, v44, v45
    ds_read_b64_tr_b16 a[208:209], v10 offset:49152
    v_mfma_f32_16x16x32_bf16 v[208:211], a[224:227], v[48:51], v[208:211]
    v_exp_f32 v46, v46
    v_mfma_f32_16x16x32_bf16 v[212:215], a[228:231], v[48:51], v[212:215]
    ds_read_b64_tr_b16 a[210:211], v10 offset:53248
    ds_read_b64_tr_b16 a[212:213], v11 offset:49152
    v_mfma_f32_16x16x32_bf16 v[216:219], a[232:235], v[48:51], v[216:219]
    v_exp_f32 v47, v47
    v_mfma_f32_16x16x32_bf16 v[220:223], a[236:239], v[48:51], v[220:223]
    v_cvt_pk_bf16_f32 v55, v46, v47
    ds_read_b64_tr_b16 a[214:215], v11 offset:53248
    v_mfma_f32_16x16x32_bf16 a[100:103], a[108:111], v[48:51], a[100:103]
    ds_read_b64_tr_b16 a[216:217], v12 offset:49152
    ds_read_b64_tr_b16 a[218:219], v12 offset:53248
    v_mfma_f32_16x16x32_bf16 v[40:43], a[144:147], a[80:83], v[76:79]
    v_exp_f32 v32, v32
    v_mfma_f32_16x16x32_bf16 v[44:47], a[160:163], a[80:83], v[76:79]
    ds_read_b64_tr_b16 a[220:221], v13 offset:49152
    ds_read_b64_tr_b16 a[222:223], v13 offset:53248
    v_mfma_f32_16x16x32_bf16 v[40:43], a[148:151], a[84:87], v[40:43]
    v_exp_f32 v33, v33
    v_mfma_f32_16x16x32_bf16 v[44:47], a[164:167], a[84:87], v[44:47]
    v_cvt_pk_bf16_f32 v48, v32, v33
    ds_read_b64_tr_b16 a[224:225], v14 offset:49152
    v_mfma_f32_16x16x32_bf16 v[40:43], a[152:155], a[88:91], v[40:43]
    v_exp_f32 v34, v34
    v_mfma_f32_16x16x32_bf16 v[44:47], a[168:171], a[88:91], v[44:47]
    ds_read_b64_tr_b16 a[226:227], v14 offset:53248
    ds_read_b64_tr_b16 a[228:229], v15 offset:49152
    v_mfma_f32_16x16x32_bf16 v[40:43], a[156:159], a[92:95], v[40:43]
    v_exp_f32 v35, v35
    v_mfma_f32_16x16x32_bf16 v[44:47], a[172:175], a[92:95], v[44:47]
    v_cvt_pk_bf16_f32 v49, v34, v35
    ds_read_b64_tr_b16 a[230:231], v15 offset:53248
    v_mfma_f32_16x16x32_bf16 v[160:163], a[176:179], v[52:55], v[160:163]
    v_exp_f32 v36, v36
    v_mfma_f32_16x16x32_bf16 v[164:167], a[180:183], v[52:55], v[164:167]
    ds_read_b64_tr_b16 a[232:233], v16 offset:49152
    ds_read_b64_tr_b16 a[234:235], v16 offset:53248
    v_mfma_f32_16x16x32_bf16 v[168:171], a[184:187], v[52:55], v[168:171]
    v_exp_f32 v37, v37
    v_mfma_f32_16x16x32_bf16 v[172:175], a[188:191], v[52:55], v[172:175]
    v_cvt_pk_bf16_f32 v50, v36, v37
    ds_read_b64_tr_b16 a[236:237], v17 offset:49152
    v_mfma_f32_16x16x32_bf16 v[176:179], a[192:195], v[52:55], v[176:179]
    v_exp_f32 v38, v38
    v_mfma_f32_16x16x32_bf16 v[180:183], a[196:199], v[52:55], v[180:183]
    ds_read_b64_tr_b16 a[238:239], v17 offset:53248
    v_mfma_f32_16x16x32_bf16 v[184:187], a[200:203], v[52:55], v[184:187]
    v_exp_f32 v39, v39
    v_mfma_f32_16x16x32_bf16 v[188:191], a[204:207], v[52:55], v[188:191]
    v_cvt_pk_bf16_f32 v51, v38, v39
    v_mfma_f32_16x16x32_bf16 a[96:99], a[108:111], v[52:55], a[96:99]
    s_waitcnt lgkmcnt(15)
    v_mfma_f32_16x16x32_bf16 v[32:35], a[112:115], a[48:51], v[68:71]
    v_exp_f32 v40, v40
    v_mfma_f32_16x16x32_bf16 v[36:39], a[128:131], a[48:51], v[68:71]
    v_mfma_f32_16x16x32_bf16 v[32:35], a[116:119], a[52:55], v[32:35]
    v_exp_f32 v41, v41
    v_mfma_f32_16x16x32_bf16 v[36:39], a[132:135], a[52:55], v[36:39]
    v_cvt_pk_bf16_f32 v52, v40, v41
    v_mfma_f32_16x16x32_bf16 v[32:35], a[120:123], a[56:59], v[32:35]
    v_exp_f32 v42, v42
    v_mfma_f32_16x16x32_bf16 v[36:39], a[136:139], a[56:59], v[36:39]
    v_mfma_f32_16x16x32_bf16 v[32:35], a[124:127], a[60:63], v[32:35]
    v_exp_f32 v43, v43
    v_mfma_f32_16x16x32_bf16 v[36:39], a[140:143], a[60:63], v[36:39]
    v_cvt_pk_bf16_f32 v53, v42, v43
    s_waitcnt lgkmcnt(0)
    s_barrier
    v_mfma_f32_16x16x32_bf16 v[192:195], a[176:179], v[48:51], v[192:195]
    v_exp_f32 v44, v44
    v_mfma_f32_16x16x32_bf16 v[196:199], a[180:183], v[48:51], v[196:199]
    ds_read_b128 a[144:147], v6
    ds_read_b128 a[160:163], v6 offset:4096
    v_mfma_f32_16x16x32_bf16 v[200:203], a[184:187], v[48:51], v[200:203]
    v_exp_f32 v45, v45
    v_mfma_f32_16x16x32_bf16 v[204:207], a[188:191], v[48:51], v[204:207]
    v_cvt_pk_bf16_f32 v54, v44, v45
    ds_read_b128 a[148:151], v7
    v_mfma_f32_16x16x32_bf16 v[208:211], a[192:195], v[48:51], v[208:211]
    v_exp_f32 v46, v46
    v_mfma_f32_16x16x32_bf16 v[212:215], a[196:199], v[48:51], v[212:215]
    ds_read_b128 a[164:167], v7 offset:4096
    ds_read_b128 a[152:155], v8
    v_mfma_f32_16x16x32_bf16 v[216:219], a[200:203], v[48:51], v[216:219]
    v_exp_f32 v47, v47
    v_mfma_f32_16x16x32_bf16 v[220:223], a[204:207], v[48:51], v[220:223]
    v_cvt_pk_bf16_f32 v55, v46, v47
    ds_read_b128 a[168:171], v8 offset:4096
    v_mfma_f32_16x16x32_bf16 a[100:103], a[108:111], v[48:51], a[100:103]
    ds_read_b128 a[156:159], v9
    ds_read_b128 a[172:175], v9 offset:4096
    v_mfma_f32_16x16x32_bf16 v[40:43], a[112:115], a[64:67], v[72:75]
    v_exp_f32 v32, v32
    v_mfma_f32_16x16x32_bf16 v[44:47], a[128:131], a[64:67], v[72:75]
    v_mfma_f32_16x16x32_bf16 v[40:43], a[116:119], a[68:71], v[40:43]
    v_exp_f32 v33, v33
    v_mfma_f32_16x16x32_bf16 v[44:47], a[132:135], a[68:71], v[44:47]
    v_cvt_pk_bf16_f32 v48, v32, v33
    v_mfma_f32_16x16x32_bf16 v[40:43], a[120:123], a[72:75], v[40:43]
    v_exp_f32 v34, v34
    v_mfma_f32_16x16x32_bf16 v[44:47], a[136:139], a[72:75], v[44:47]
    v_mfma_f32_16x16x32_bf16 v[40:43], a[124:127], a[76:79], v[40:43]
    v_exp_f32 v35, v35
    v_mfma_f32_16x16x32_bf16 v[44:47], a[140:143], a[76:79], v[44:47]
    v_cvt_pk_bf16_f32 v49, v34, v35
    v_mfma_f32_16x16x32_bf16 v[224:227], a[176:179], v[52:55], v[224:227]
    v_exp_f32 v36, v36
    v_mfma_f32_16x16x32_bf16 v[228:231], a[180:183], v[52:55], v[228:231]
    ds_read_b64_tr_b16 a[176:177], v10
    ds_read_b64_tr_b16 a[178:179], v10 offset:4096
    v_mfma_f32_16x16x32_bf16 v[232:235], a[184:187], v[52:55], v[232:235]
    v_exp_f32 v37, v37
    v_mfma_f32_16x16x32_bf16 v[236:239], a[188:191], v[52:55], v[236:239]
    v_cvt_pk_bf16_f32 v50, v36, v37
    ds_read_b64_tr_b16 a[180:181], v11
    v_mfma_f32_16x16x32_bf16 v[240:243], a[192:195], v[52:55], v[240:243]
    v_exp_f32 v38, v38
    v_mfma_f32_16x16x32_bf16 v[244:247], a[196:199], v[52:55], v[244:247]
    ds_read_b64_tr_b16 a[182:183], v11 offset:4096
    ds_read_b64_tr_b16 a[184:185], v12
    v_mfma_f32_16x16x32_bf16 v[248:251], a[200:203], v[52:55], v[248:251]
    v_exp_f32 v39, v39
    v_mfma_f32_16x16x32_bf16 v[252:255], a[204:207], v[52:55], v[252:255]
    v_cvt_pk_bf16_f32 v51, v38, v39
    ds_read_b64_tr_b16 a[186:187], v12 offset:4096
    v_mfma_f32_16x16x32_bf16 a[104:107], a[108:111], v[52:55], a[104:107]
    ds_read_b64_tr_b16 a[188:189], v13
    ds_read_b64_tr_b16 a[190:191], v13 offset:4096
    s_waitcnt lgkmcnt(8)
    v_mfma_f32_16x16x32_bf16 v[32:35], a[144:147], a[48:51], v[68:71]
    v_exp_f32 v40, v40
    v_mfma_f32_16x16x32_bf16 v[36:39], a[160:163], a[48:51], v[68:71]
    ds_read_b64_tr_b16 a[192:193], v14
    ds_read_b64_tr_b16 a[194:195], v14 offset:4096
    v_mfma_f32_16x16x32_bf16 v[32:35], a[148:151], a[52:55], v[32:35]
    v_exp_f32 v41, v41
    v_mfma_f32_16x16x32_bf16 v[36:39], a[164:167], a[52:55], v[36:39]
    v_cvt_pk_bf16_f32 v52, v40, v41
    ds_read_b64_tr_b16 a[196:197], v15
    v_mfma_f32_16x16x32_bf16 v[32:35], a[152:155], a[56:59], v[32:35]
    v_exp_f32 v42, v42
    v_mfma_f32_16x16x32_bf16 v[36:39], a[168:171], a[56:59], v[36:39]
    ds_read_b64_tr_b16 a[198:199], v15 offset:4096
    ds_read_b64_tr_b16 a[200:201], v16
    v_mfma_f32_16x16x32_bf16 v[32:35], a[156:159], a[60:63], v[32:35]
    v_exp_f32 v43, v43
    v_mfma_f32_16x16x32_bf16 v[36:39], a[172:175], a[60:63], v[36:39]
    v_cvt_pk_bf16_f32 v53, v42, v43
    ds_read_b64_tr_b16 a[202:203], v16 offset:4096
    v_mfma_f32_16x16x32_bf16 v[160:163], a[208:211], v[48:51], v[160:163]
    v_exp_f32 v44, v44
    v_mfma_f32_16x16x32_bf16 v[164:167], a[212:215], v[48:51], v[164:167]
    ds_read_b64_tr_b16 a[204:205], v17
    ds_read_b64_tr_b16 a[206:207], v17 offset:4096
    v_mfma_f32_16x16x32_bf16 v[168:171], a[216:219], v[48:51], v[168:171]
    v_exp_f32 v45, v45
    v_mfma_f32_16x16x32_bf16 v[172:175], a[220:223], v[48:51], v[172:175]
    v_cvt_pk_bf16_f32 v54, v44, v45
    v_mfma_f32_16x16x32_bf16 v[176:179], a[224:227], v[48:51], v[176:179]
    v_exp_f32 v46, v46
    v_mfma_f32_16x16x32_bf16 v[180:183], a[228:231], v[48:51], v[180:183]
    v_mfma_f32_16x16x32_bf16 v[184:187], a[232:235], v[48:51], v[184:187]
    v_exp_f32 v47, v47
    v_mfma_f32_16x16x32_bf16 v[188:191], a[236:239], v[48:51], v[188:191]
    v_cvt_pk_bf16_f32 v55, v46, v47
    v_mfma_f32_16x16x32_bf16 a[96:99], a[108:111], v[48:51], a[96:99]
    s_sub_u32 s54, s54, 1
    s_cmp_lg_u32 s54, 0
    s_cbranch_scc1 L_loop_A11
    s_waitcnt lgkmcnt(0)
    s_barrier
    v_mfma_f32_16x16x32_bf16 v[40:43], a[144:147], a[64:67], v[72:75]
    v_exp_f32 v32, v32
    v_mfma_f32_16x16x32_bf16 v[44:47], a[160:163], a[64:67], v[72:75]
    ds_read_b128 a[112:115], v6 offset:16384
    ds_read_b128 a[128:131], v6 offset:20480
    v_mfma_f32_16x16x32_bf16 v[40:43], a[148:151], a[68:71], v[40:43]
    v_exp_f32 v33, v33
    v_mfma_f32_16x16x32_bf16 v[44:47], a[164:167], a[68:71], v[44:47]
    v_cvt_pk_bf16_f32 v48, v32, v33
    ds_read_b128 a[116:119], v7 offset:16384
    v_mfma_f32_16x16x32_bf16 v[40:43], a[152:155], a[72:75], v[40:43]
    v_exp_f32 v34, v34
    v_mfma_f32_16x16x32_bf16 v[44:47], a[168:171], a[72:75], v[44:47]
    ds_read_b128 a[132:135], v7 offset:20480
    ds_read_b128 a[120:123], v8 offset:16384
    v_mfma_f32_16x16x32_bf16 v[40:43], a[156:159], a[76:79], v[40:43]
    v_exp_f32 v35, v35
    v_mfma_f32_16x16x32_bf16 v[44:47], a[172:175], a[76:79], v[44:47]
    v_cvt_pk_bf16_f32 v49, v34, v35
    ds_read_b128 a[136:139], v8 offset:20480
    v_mfma_f32_16x16x32_bf16 v[192:195], a[208:211], v[52:55], v[192:195]
    v_exp_f32 v36, v36
    v_mfma_f32_16x16x32_bf16 v[196:199], a[212:215], v[52:55], v[196:199]
    ds_read_b128 a[124:127], v9 offset:16384
    ds_read_b128 a[140:143], v9 offset:20480
    v_mfma_f32_16x16x32_bf16 v[200:203], a[216:219], v[52:55], v[200:203]
    v_exp_f32 v37, v37
    v_mfma_f32_16x16x32_bf16 v[204:207], a[220:223], v[52:55], v[204:207]
    v_cvt_pk_bf16_f32 v50, v36, v37
    ds_read_b64_tr_b16 a[208:209], v10 offset:16384
    v_mfma_f32_16x16x32_bf16 v[208:211], a[224:227], v[52:55], v[208:211]
    v_exp_f32 v38, v38
    v_mfma_f32_16x16x32_bf16 v[212:215], a[228:231], v[52:55], v[212:215]
    ds_read_b64_tr_b16 a[210:211], v10 offset:20480
    ds_read_b64_tr_b16 a[212:213], v11 offset:16384
    v_mfma_f32_16x16x32_bf16 v[216:219], a[232:235], v[52:55], v[216:219]
    v_exp_f32 v39, v39
    v_mfma_f32_16x16x32_bf16 v[220:223], a[236:239], v[52:55], v[220:223]
    v_cvt_pk_bf16_f32 v51, v38, v39
    ds_read_b64_tr_b16 a[214:215], v11 offset:20480
    v_mfma_f32_16x16x32_bf16 a[100:103], a[108:111], v[52:55], a[100:103]
    ds_read_b64_tr_b16 a[216:217], v12 offset:16384
    ds_read_b64_tr_b16 a[218:219], v12 offset:20480
    v_mfma_f32_16x16x32_bf16 v[32:35], a[144:147], a[80:83], v[76:79]
    v_exp_f32 v40, v40
    v_mfma_f32_16x16x32_bf16 v[36:39], a[160:163], a[80:83], v[76:79]
    ds_read_b64_tr_b16 a[220:221], v13 offset:16384
    ds_read_b64_tr_b16 a[222:223], v13 offset:20480
    v_mfma_f32_16x16x32_bf16 v[32:35], a[148:151], a[84:87], v[32:35]
    v_exp_f32 v41, v41
    v_mfma_f32_16x16x32_bf16 v[36:39], a[164:167], a[84:87], v[36:39]
    v_cvt_pk_bf16_f32 v52, v40, v41
    ds_read_b64_tr_b16 a[224:225], v14 offset:16384
    v_mfma_f32_16x16x32_bf16 v[32:35], a[152:155], a[88:91], v[32:35]
    v_exp_f32 v42, v42
    v_mfma_f32_16x16x32_bf16 v[36:39], a[168:171], a[88:91], v[36:39]
    ds_read_b64_tr_b16 a[226:227], v14 offset:20480
    ds_read_b64_tr_b16 a[228:229], v15 offset:16384
    v_mfma_f32_16x16x32_bf16 v[32:35], a[156:159], a[92:95], v[32:35]
    v_exp_f32 v43, v43
    v_mfma_f32_16x16x32_bf16 v[36:39], a[172:175], a[92:95], v[36:39]
    v_cvt_pk_bf16_f32 v53, v42, v43
    ds_read_b64_tr_b16 a[230:231], v15 offset:20480
    v_mfma_f32_16x16x32_bf16 v[160:163], a[176:179], v[48:51], v[160:163]
    v_exp_f32 v44, v44
    v_mfma_f32_16x16x32_bf16 v[164:167], a[180:183], v[48:51], v[164:167]
    ds_read_b64_tr_b16 a[232:233], v16 offset:16384
    ds_read_b64_tr_b16 a[234:235], v16 offset:20480
    v_mfma_f32_16x16x32_bf16 v[168:171], a[184:187], v[48:51], v[168:171]
    v_exp_f32 v45, v45
    v_mfma_f32_16x16x32_bf16 v[172:175], a[188:191], v[48:51], v[172:175]
    v_cvt_pk_bf16_f32 v54, v44, v45
    ds_read_b64_tr_b16 a[236:237], v17 offset:16384
    v_mfma_f32_16x16x32_bf16 v[176:179], a[192:195], v[48:51], v[176:179]
    v_exp_f32 v46, v46
    v_mfma_f32_16x16x32_bf16 v[180:183], a[196:199], v[48:51], v[180:183]
    ds_read_b64_tr_b16 a[238:239], v17 offset:20480
    v_mfma_f32_16x16x32_bf16 v[184:187], a[200:203], v[48:51], v[184:187]
    v_exp_f32 v47, v47
    v_mfma_f32_16x16x32_bf16 v[188:191], a[204:207], v[48:51], v[188:191]
    v_cvt_pk_bf16_f32 v55, v46, v47
    v_mfma_f32_16x16x32_bf16 a[96:99], a[108:111], v[48:51], a[96:99]
    s_waitcnt lgkmcnt(15)
    v_mfma_f32_16x16x32_bf16 v[40:43], a[112:115], a[48:51], v[68:71]
    v_exp_f32 v32, v32
    v_mfma_f32_16x16x32_bf16 v[44:47], a[128:131], a[48:51], v[68:71]
    v_mfma_f32_16x16x32_bf16 v[40:43], a[116:119], a[52:55], v[40:43]
    v_exp_f32 v33, v33
    v_mfma_f32_16x16x32_bf16 v[44:47], a[132:135], a[52:55], v[44:47]
    v_cvt_pk_bf16_f32 v48, v32, v33
    v_mfma_f32_16x16x32_bf16 v[40:43], a[120:123], a[56:59], v[40:43]
    v_exp_f32 v34, v34
    v_mfma_f32_16x16x32_bf16 v[44:47], a[136:139], a[56:59], v[44:47]
    v_mfma_f32_16x16x32_bf16 v[40:43], a[124:127], a[60:63], v[40:43]
    v_exp_f32 v35, v35
    v_mfma_f32_16x16x32_bf16 v[44:47], a[140:143], a[60:63], v[44:47]
    v_cvt_pk_bf16_f32 v49, v34, v35
    s_waitcnt lgkmcnt(0)
    s_barrier
    v_mfma_f32_16x16x32_bf16 v[192:195], a[176:179], v[52:55], v[192:195]
    v_exp_f32 v36, v36
    v_mfma_f32_16x16x32_bf16 v[196:199], a[180:183], v[52:55], v[196:199]
    ds_read_b128 a[144:147], v6 offset:32768
    ds_read_b128 a[160:163], v6 offset:36864
    v_mfma_f32_16x16x32_bf16 v[200:203], a[184:187], v[52:55], v[200:203]
    v_exp_f32 v37, v37
    v_mfma_f32_16x16x32_bf16 v[204:207], a[188:191], v[52:55], v[204:207]
    v_cvt_pk_bf16_f32 v50, v36, v37
    ds_read_b128 a[148:151], v7 offset:32768
    v_mfma_f32_16x16x32_bf16 v[208:211], a[192:195], v[52:55], v[208:211]
    v_exp_f32 v38, v38
    v_mfma_f32_16x16x32_bf16 v[212:215], a[196:199], v[52:55], v[212:215]
    ds_read_b128 a[164:167], v7 offset:36864
    ds_read_b128 a[152:155], v8 offset:32768
    v_mfma_f32_16x16x32_bf16 v[216:219], a[200:203], v[52:55], v[216:219]
    v_exp_f32 v39, v39
    v_mfma_f32_16x16x32_bf16 v[220:223], a[204:207], v[52:55], v[220:223]
    v_cvt_pk_bf16_f32 v51, v38, v39
    ds_read_b128 a[168:171], v8 offset:36864
    v_mfma_f32_16x16x32_bf16 a[100:103], a[108:111], v[52:55], a[100:103]
    ds_read_b128 a[156:159], v9 offset:32768
    ds_read_b128 a[172:175], v9 offset:36864
    v_mfma_f32_16x16x32_bf16 v[32:35], a[112:115], a[64:67], v[72:75]
    v_exp_f32 v40, v40
    v_mfma_f32_16x16x32_bf16 v[36:39], a[128:131], a[64:67], v[72:75]
    v_mfma_f32_16x16x32_bf16 v[32:35], a[116:119], a[68:71], v[32:35]
    v_exp_f32 v41, v41
    v_mfma_f32_16x16x32_bf16 v[36:39], a[132:135], a[68:71], v[36:39]
    v_cvt_pk_bf16_f32 v52, v40, v41
    v_mfma_f32_16x16x32_bf16 v[32:35], a[120:123], a[72:75], v[32:35]
    v_exp_f32 v42, v42
    v_mfma_f32_16x16x32_bf16 v[36:39], a[136:139], a[72:75], v[36:39]
    v_mfma_f32_16x16x32_bf16 v[32:35], a[124:127], a[76:79], v[32:35]
    v_exp_f32 v43, v43
    v_mfma_f32_16x16x32_bf16 v[36:39], a[140:143], a[76:79], v[36:39]
    v_cvt_pk_bf16_f32 v53, v42, v43
    v_mfma_f32_16x16x32_bf16 v[224:227], a[176:179], v[48:51], v[224:227]
    v_exp_f32 v44, v44
    v_mfma_f32_16x16x32_bf16 v[228:231], a[180:183], v[48:51], v[228:231]
    ds_read_b64_tr_b16 a[176:177], v10 offset:32768
    ds_read_b64_tr_b16 a[178:179], v10 offset:36864
    v_mfma_f32_16x16x32_bf16 v[232:235], a[184:187], v[48:51], v[232:235]
    v_exp_f32 v45, v45
    v_mfma_f32_16x16x32_bf16 v[236:239], a[188:191], v[48:51], v[236:239]
    v_cvt_pk_bf16_f32 v54, v44, v45
    ds_read_b64_tr_b16 a[180:181], v11 offset:32768
    v_mfma_f32_16x16x32_bf16 v[240:243], a[192:195], v[48:51], v[240:243]
    v_exp_f32 v46, v46
    v_mfma_f32_16x16x32_bf16 v[244:247], a[196:199], v[48:51], v[244:247]
    ds_read_b64_tr_b16 a[182:183], v11 offset:36864
    ds_read_b64_tr_b16 a[184:185], v12 offset:32768
    v_mfma_f32_16x16x32_bf16 v[248:251], a[200:203], v[48:51], v[248:251]
    v_exp_f32 v47, v47
    v_mfma_f32_16x16x32_bf16 v[252:255], a[204:207], v[48:51], v[252:255]
    v_cvt_pk_bf16_f32 v55, v46, v47
    ds_read_b64_tr_b16 a[186:187], v12 offset:36864
    v_mfma_f32_16x16x32_bf16 a[104:107], a[108:111], v[48:51], a[104:107]
    ds_read_b64_tr_b16 a[188:189], v13 offset:32768
    ds_read_b64_tr_b16 a[190:191], v13 offset:36864
    s_waitcnt lgkmcnt(8)
    v_mfma_f32_16x16x32_bf16 v[40:43], a[144:147], a[48:51], v[68:71]
    v_exp_f32 v32, v32
    v_mfma_f32_16x16x32_bf16 v[44:47], a[160:163], a[48:51], v[68:71]
    ds_read_b64_tr_b16 a[192:193], v14 offset:32768
    ds_read_b64_tr_b16 a[194:195], v14 offset:36864
    v_mfma_f32_16x16x32_bf16 v[40:43], a[148:151], a[52:55], v[40:43]
    v_exp_f32 v33, v33
    v_mfma_f32_16x16x32_bf16 v[44:47], a[164:167], a[52:55], v[44:47]
    v_cvt_pk_bf16_f32 v48, v32, v33
    ds_read_b64_tr_b16 a[196:197], v15 offset:32768
    v_mfma_f32_16x16x32_bf16 v[40:43], a[152:155], a[56:59], v[40:43]
    v_exp_f32 v34, v34
    v_mfma_f32_16x16x32_bf16 v[44:47], a[168:171], a[56:59], v[44:47]
    ds_read_b64_tr_b16 a[198:199], v15 offset:36864
    ds_read_b64_tr_b16 a[200:201], v16 offset:32768
    v_mfma_f32_16x16x32_bf16 v[40:43], a[156:159], a[60:63], v[40:43]
    v_exp_f32 v35, v35
    v_mfma_f32_16x16x32_bf16 v[44:47], a[172:175], a[60:63], v[44:47]
    v_cvt_pk_bf16_f32 v49, v34, v35
    ds_read_b64_tr_b16 a[202:203], v16 offset:36864
    v_mfma_f32_16x16x32_bf16 v[160:163], a[208:211], v[52:55], v[160:163]
    v_exp_f32 v36, v36
    v_mfma_f32_16x16x32_bf16 v[164:167], a[212:215], v[52:55], v[164:167]
    ds_read_b64_tr_b16 a[204:205], v17 offset:32768
    ds_read_b64_tr_b16 a[206:207], v17 offset:36864
    v_mfma_f32_16x16x32_bf16 v[168:171], a[216:219], v[52:55], v[168:171]
    v_exp_f32 v37, v37
    v_mfma_f32_16x16x32_bf16 v[172:175], a[220:223], v[52:55], v[172:175]
    v_cvt_pk_bf16_f32 v50, v36, v37
    v_mfma_f32_16x16x32_bf16 v[176:179], a[224:227], v[52:55], v[176:179]
    v_exp_f32 v38, v38
    v_mfma_f32_16x16x32_bf16 v[180:183], a[228:231], v[52:55], v[180:183]
    v_mfma_f32_16x16x32_bf16 v[184:187], a[232:235], v[52:55], v[184:187]
    v_exp_f32 v39, v39
    v_mfma_f32_16x16x32_bf16 v[188:191], a[236:239], v[52:55], v[188:191]
    v_cvt_pk_bf16_f32 v51, v38, v39
    v_mfma_f32_16x16x32_bf16 a[96:99], a[108:111], v[52:55], a[96:99]
    s_waitcnt lgkmcnt(0)
    s_barrier
    v_mfma_f32_16x16x32_bf16 v[32:35], a[144:147], a[64:67], v[72:75]
    v_exp_f32 v40, v40
    v_mfma_f32_16x16x32_bf16 v[36:39], a[160:163], a[64:67], v[72:75]
    ds_read_b128 a[112:115], v6 offset:49152
    ds_read_b128 a[128:131], v6 offset:53248
    v_mfma_f32_16x16x32_bf16 v[32:35], a[148:151], a[68:71], v[32:35]
    v_exp_f32 v41, v41
    v_mfma_f32_16x16x32_bf16 v[36:39], a[164:167], a[68:71], v[36:39]
    v_cvt_pk_bf16_f32 v52, v40, v41
    ds_read_b128 a[116:119], v7 offset:49152
    v_mfma_f32_16x16x32_bf16 v[32:35], a[152:155], a[72:75], v[32:35]
    v_exp_f32 v42, v42
    v_mfma_f32_16x16x32_bf16 v[36:39], a[168:171], a[72:75], v[36:39]
    ds_read_b128 a[132:135], v7 offset:53248
    ds_read_b128 a[120:123], v8 offset:49152
    v_mfma_f32_16x16x32_bf16 v[32:35], a[156:159], a[76:79], v[32:35]
    v_exp_f32 v43, v43
    v_mfma_f32_16x16x32_bf16 v[36:39], a[172:175], a[76:79], v[36:39]
    v_cvt_pk_bf16_f32 v53, v42, v43
    ds_read_b128 a[136:139], v8 offset:53248
    v_mfma_f32_16x16x32_bf16 v[192:195], a[208:211], v[48:51], v[192:195]
    v_exp_f32 v44, v44
    v_mfma_f32_16x16x32_bf16 v[196:199], a[212:215], v[48:51], v[196:199]
    ds_read_b128 a[124:127], v9 offset:49152
    ds_read_b128 a[140:143], v9 offset:53248
    v_mfma_f32_16x16x32_bf16 v[200:203], a[216:219], v[48:51], v[200:203]
    v_exp_f32 v45, v45
    v_mfma_f32_16x16x32_bf16 v[204:207], a[220:223], v[48:51], v[204:207]
    v_cvt_pk_bf16_f32 v54, v44, v45
    ds_read_b64_tr_b16 a[208:209], v10 offset:49152
    v_mfma_f32_16x16x32_bf16 v[208:211], a[224:227], v[48:51], v[208:211]
    v_exp_f32 v46, v46
    v_mfma_f32_16x16x32_bf16 v[212:215], a[228:231], v[48:51], v[212:215]
    ds_read_b64_tr_b16 a[210:211], v10 offset:53248
    ds_read_b64_tr_b16 a[212:213], v11 offset:49152
    v_mfma_f32_16x16x32_bf16 v[216:219], a[232:235], v[48:51], v[216:219]
    v_exp_f32 v47, v47
    v_mfma_f32_16x16x32_bf16 v[220:223], a[236:239], v[48:51], v[220:223]
    v_cvt_pk_bf16_f32 v55, v46, v47
    ds_read_b64_tr_b16 a[214:215], v11 offset:53248
    v_mfma_f32_16x16x32_bf16 a[100:103], a[108:111], v[48:51], a[100:103]
    ds_read_b64_tr_b16 a[216:217], v12 offset:49152
    ds_read_b64_tr_b16 a[218:219], v12 offset:53248
    v_mfma_f32_16x16x32_bf16 v[40:43], a[144:147], a[80:83], v[76:79]
    v_exp_f32 v32, v32
    v_mfma_f32_16x16x32_bf16 v[44:47], a[160:163], a[80:83], v[76:79]
    ds_read_b64_tr_b16 a[220:221], v13 offset:49152
    ds_read_b64_tr_b16 a[222:223], v13 offset:53248
    v_mfma_f32_16x16x32_bf16 v[40:43], a[148:151], a[84:87], v[40:43]
    v_exp_f32 v33, v33
    v_mfma_f32_16x16x32_bf16 v[44:47], a[164:167], a[84:87], v[44:47]
    v_cvt_pk_bf16_f32 v48, v32, v33
    ds_read_b64_tr_b16 a[224:225], v14 offset:49152
    v_mfma_f32_16x16x32_bf16 v[40:43], a[152:155], a[88:91], v[40:43]
    v_exp_f32 v34, v34
    v_mfma_f32_16x16x32_bf16 v[44:47], a[168:171], a[88:91], v[44:47]
    ds_read_b64_tr_b16 a[226:227], v14 offset:53248
    ds_read_b64_tr_b16 a[228:229], v15 offset:49152
    v_mfma_f32_16x16x32_bf16 v[40:43], a[156:159], a[92:95], v[40:43]
    v_exp_f32 v35, v35
    v_mfma_f32_16x16x32_bf16 v[44:47], a[172:175], a[92:95], v[44:47]
    v_cvt_pk_bf16_f32 v49, v34, v35
    ds_read_b64_tr_b16 a[230:231], v15 offset:53248
    v_mfma_f32_16x16x32_bf16 v[160:163], a[176:179], v[52:55], v[160:163]
    v_exp_f32 v36, v36
    v_mfma_f32_16x16x32_bf16 v[164:167], a[180:183], v[52:55], v[164:167]
    ds_read_b64_tr_b16 a[232:233], v16 offset:49152
    ds_read_b64_tr_b16 a[234:235], v16 offset:53248
    v_mfma_f32_16x16x32_bf16 v[168:171], a[184:187], v[52:55], v[168:171]
    v_exp_f32 v37, v37
    v_mfma_f32_16x16x32_bf16 v[172:175], a[188:191], v[52:55], v[172:175]
    v_cvt_pk_bf16_f32 v50, v36, v37
    ds_read_b64_tr_b16 a[236:237], v17 offset:49152
    v_mfma_f32_16x16x32_bf16 v[176:179], a[192:195], v[52:55], v[176:179]
    v_exp_f32 v38, v38
    v_mfma_f32_16x16x32_bf16 v[180:183], a[196:199], v[52:55], v[180:183]
    ds_read_b64_tr_b16 a[238:239], v17 offset:53248
    v_mfma_f32_16x16x32_bf16 v[184:187], a[200:203], v[52:55], v[184:187]
    v_exp_f32 v39, v39
    v_mfma_f32_16x16x32_bf16 v[188:191], a[204:207], v[52:55], v[188:191]
    v_cvt_pk_bf16_f32 v51, v38, v39
    v_mfma_f32_16x16x32_bf16 a[96:99], a[108:111], v[52:55], a[96:99]
    s_waitcnt lgkmcnt(15)
    v_mfma_f32_16x16x32_bf16 v[32:35], a[112:115], a[48:51], v[68:71]
    v_exp_f32 v40, v40
    v_mfma_f32_16x16x32_bf16 v[36:39], a[128:131], a[48:51], v[68:71]
    v_mfma_f32_16x16x32_bf16 v[32:35], a[116:119], a[52:55], v[32:35]
    v_exp_f32 v41, v41
    v_mfma_f32_16x16x32_bf16 v[36:39], a[132:135], a[52:55], v[36:39]
    v_cvt_pk_bf16_f32 v52, v40, v41
    v_mfma_f32_16x16x32_bf16 v[32:35], a[120:123], a[56:59], v[32:35]
    v_exp_f32 v42, v42
    v_mfma_f32_16x16x32_bf16 v[36:39], a[136:139], a[56:59], v[36:39]
    v_mfma_f32_16x16x32_bf16 v[32:35], a[124:127], a[60:63], v[32:35]
    v_exp_f32 v43, v43
    v_mfma_f32_16x16x32_bf16 v[36:39], a[140:143], a[60:63], v[36:39]
    v_cvt_pk_bf16_f32 v53, v42, v43
    s_waitcnt lgkmcnt(0)
    s_barrier
    v_mfma_f32_16x16x32_bf16 v[192:195], a[176:179], v[48:51], v[192:195]
    v_exp_f32 v44, v44
    v_mfma_f32_16x16x32_bf16 v[196:199], a[180:183], v[48:51], v[196:199]
    v_mfma_f32_16x16x32_bf16 v[200:203], a[184:187], v[48:51], v[200:203]
    v_exp_f32 v45, v45
    v_mfma_f32_16x16x32_bf16 v[204:207], a[188:191], v[48:51], v[204:207]
    v_cvt_pk_bf16_f32 v54, v44, v45
    v_mfma_f32_16x16x32_bf16 v[208:211], a[192:195], v[48:51], v[208:211]
    v_exp_f32 v46, v46
    v_mfma_f32_16x16x32_bf16 v[212:215], a[196:199], v[48:51], v[212:215]
    v_mfma_f32_16x16x32_bf16 v[216:219], a[200:203], v[48:51], v[216:219]
    v_exp_f32 v47, v47
    v_mfma_f32_16x16x32_bf16 v[220:223], a[204:207], v[48:51], v[220:223]
    v_cvt_pk_bf16_f32 v55, v46, v47
    v_mfma_f32_16x16x32_bf16 a[100:103], a[108:111], v[48:51], a[100:103]
    v_mfma_f32_16x16x32_bf16 v[40:43], a[112:115], a[64:67], v[72:75]
    v_exp_f32 v32, v32
    v_mfma_f32_16x16x32_bf16 v[44:47], a[128:131], a[64:67], v[72:75]
    v_mfma_f32_16x16x32_bf16 v[40:43], a[116:119], a[68:71], v[40:43]
    v_exp_f32 v33, v33
    v_mfma_f32_16x16x32_bf16 v[44:47], a[132:135], a[68:71], v[44:47]
    v_cvt_pk_bf16_f32 v48, v32, v33
    v_mfma_f32_16x16x32_bf16 v[40:43], a[120:123], a[72:75], v[40:43]
    v_exp_f32 v34, v34
    v_mfma_f32_16x16x32_bf16 v[44:47], a[136:139], a[72:75], v[44:47]
    v_mfma_f32_16x16x32_bf16 v[40:43], a[124:127], a[76:79], v[40:43]
    v_exp_f32 v35, v35
    v_mfma_f32_16x16x32_bf16 v[44:47], a[140:143], a[76:79], v[44:47]
    v_cvt_pk_bf16_f32 v49, v34, v35
    v_mfma_f32_16x16x32_bf16 v[224:227], a[176:179], v[52:55], v[224:227]
    v_exp_f32 v36, v36
    v_mfma_f32_16x16x32_bf16 v[228:231], a[180:183], v[52:55], v[228:231]
    v_mfma_f32_16x16x32_bf16 v[232:235], a[184:187], v[52:55], v[232:235]
    v_exp_f32 v37, v37
    v_mfma_f32_16x16x32_bf16 v[236:239], a[188:191], v[52:55], v[236:239]
    v_cvt_pk_bf16_f32 v50, v36, v37
    v_mfma_f32_16x16x32_bf16 v[240:243], a[192:195], v[52:55], v[240:243]
    v_exp_f32 v38, v38
    v_mfma_f32_16x16x32_bf16 v[244:247], a[196:199], v[52:55], v[244:247]
    v_mfma_f32_16x16x32_bf16 v[248:251], a[200:203], v[52:55], v[248:251]
    v_exp_f32 v39, v39
    v_mfma_f32_16x16x32_bf16 v[252:255], a[204:207], v[52:55], v[252:255]
    v_cvt_pk_bf16_f32 v51, v38, v39
    v_mfma_f32_16x16x32_bf16 a[104:107], a[108:111], v[52:55], a[104:107]
    v_exp_f32 v40, v40
    ds_write_b128 v106, v[224:227]
    ds_write_b128 v106, v[228:231] offset:1024
    v_exp_f32 v41, v41
    s_nop 0
    v_cvt_pk_bf16_f32 v52, v40, v41
    ds_write_b128 v106, v[232:235] offset:2048
    v_exp_f32 v42, v42
    ds_write_b128 v106, v[236:239] offset:3072
    ds_write_b128 v106, v[240:243] offset:4096
    v_exp_f32 v43, v43
    s_nop 0
    v_cvt_pk_bf16_f32 v53, v42, v43
    ds_write_b128 v106, v[244:247] offset:5120
    v_mfma_f32_16x16x32_bf16 v[160:163], a[208:211], v[48:51], v[160:163]
    v_exp_f32 v44, v44
    v_mfma_f32_16x16x32_bf16 v[164:167], a[212:215], v[48:51], v[164:167]
    ds_write_b128 v106, v[248:251] offset:6144
    ds_write_b128 v106, v[252:255] offset:7168
    v_mfma_f32_16x16x32_bf16 v[168:171], a[216:219], v[48:51], v[168:171]
    v_exp_f32 v45, v45
    v_mfma_f32_16x16x32_bf16 v[172:175], a[220:223], v[48:51], v[172:175]
    v_cvt_pk_bf16_f32 v54, v44, v45
    ds_write_b32 v106, a104 offset:8192
    v_mfma_f32_16x16x32_bf16 v[176:179], a[224:227], v[48:51], v[176:179]
    v_exp_f32 v46, v46
    v_mfma_f32_16x16x32_bf16 v[180:183], a[228:231], v[48:51], v[180:183]
    v_mfma_f32_16x16x32_bf16 v[184:187], a[232:235], v[48:51], v[184:187]
    v_exp_f32 v47, v47
    v_mfma_f32_16x16x32_bf16 v[188:191], a[236:239], v[48:51], v[188:191]
    v_cvt_pk_bf16_f32 v55, v46, v47
    v_mfma_f32_16x16x32_bf16 a[96:99], a[108:111], v[48:51], a[96:99]
    s_waitcnt lgkmcnt(0)
    s_barrier
    v_mfma_f32_16x16x32_bf16 v[192:195], a[208:211], v[52:55], v[192:195]
    v_mfma_f32_16x16x32_bf16 v[196:199], a[212:215], v[52:55], v[196:199]
    v_mfma_f32_16x16x32_bf16 v[200:203], a[216:219], v[52:55], v[200:203]
    v_mfma_f32_16x16x32_bf16 v[204:207], a[220:223], v[52:55], v[204:207]
    v_mfma_f32_16x16x32_bf16 v[208:211], a[224:227], v[52:55], v[208:211]
    v_mfma_f32_16x16x32_bf16 v[212:215], a[228:231], v[52:55], v[212:215]
    v_mfma_f32_16x16x32_bf16 v[216:219], a[232:235], v[52:55], v[216:219]
    v_mfma_f32_16x16x32_bf16 v[220:223], a[236:239], v[52:55], v[220:223]
    v_mfma_f32_16x16x32_bf16 a[100:103], a[108:111], v[52:55], a[100:103]
    s_mov_b32 s39, 0x53800000
    s_mov_b64 s[70:71], 0
    v_accvgpr_read_b32 v32, a96
    s_nop 4
    v_accvgpr_read_b32 v34, a100
    v_cmp_nge_f32 s[72:73], s39, v32
    v_cmp_nle_f32 vcc, 0.5, v32
    s_or_b64 s[70:71], s[70:71], s[72:73]
    s_or_b64 s[70:71], s[70:71], vcc
    v_cmp_nge_f32 s[72:73], s39, v34
    v_cmp_nle_f32 vcc, 0.5, v34
    s_or_b64 s[70:71], s[70:71], s[72:73]
    s_or_b64 s[70:71], s[70:71], vcc
    v_rcp_f32 v32, v32
    v_rcp_f32 v34, v34
    s_or_b32 s39, s70, s71
    v_mov_b32 v3, s39
    ds_write_b32 v104, v3 offset:16
    v_mov_b32 v33, v32
    v_mov_b32 v35, v34
    ds_read_b64_tr_b16 a[184:185], v99
    ds_read_b64_tr_b16 a[186:187], v99 offset:4096
    ds_read_b64_tr_b16 a[188:189], v99 offset:8
    ds_read_b64_tr_b16 a[190:191], v99 offset:4104
    v_pk_mul_f32 v[216:217], v[216:217], v[34:35]
    v_pk_mul_f32 v[218:219], v[218:219], v[34:35]
    v_pk_mul_f32 v[220:221], v[220:221], v[34:35]
    v_pk_mul_f32 v[222:223], v[222:223], v[34:35]
    v_cvt_pk_bf16_f32 v239, v222, v223
    v_cvt_pk_bf16_f32 v238, v220, v221
    v_cvt_pk_bf16_f32 v237, v218, v219
    v_cvt_pk_bf16_f32 v236, v216, v217
    s_add_u32 s39, s78, 20480
    buffer_store_dwordx4 v[236:239], v2, s[20:23], s39 offen offset:1024 sc1
    ds_read_b64_tr_b16 a[192:193], v99 offset:8192
    ds_read_b64_tr_b16 a[194:195], v99 offset:12288
    ds_read_b64_tr_b16 a[196:197], v99 offset:8200
    ds_read_b64_tr_b16 a[198:199], v99 offset:12296
    v_pk_mul_f32 v[208:209], v[208:209], v[34:35]
    v_pk_mul_f32 v[210:211], v[210:211], v[34:35]
    v_pk_mul_f32 v[212:213], v[212:213], v[34:35]
    v_pk_mul_f32 v[214:215], v[214:215], v[34:35]
    v_cvt_pk_bf16_f32 v235, v214, v215
    v_cvt_pk_bf16_f32 v234, v212, v213
    v_cvt_pk_bf16_f32 v233, v210, v211
    v_cvt_pk_bf16_f32 v232, v208, v209
    buffer_store_dwordx4 v[232:235], v2, s[20:23], s39 offen sc1
    ds_read_b128 a[112:115], v101
    ds_read_b128 a[116:119], v101 offset:1024
    ds_read_b128 a[120:123], v101 offset:2048
    ds_read_b128 a[124:127], v101 offset:3072
    v_pk_mul_f32 v[200:201], v[200:201], v[34:35]
    v_pk_mul_f32 v[202:203], v[202:203], v[34:35]
    v_pk_mul_f32 v[204:205], v[204:205], v[34:35]
    v_pk_mul_f32 v[206:207], v[206:207], v[34:35]
    v_cvt_pk_bf16_f32 v231, v206, v207
    v_cvt_pk_bf16_f32 v230, v204, v205
    v_cvt_pk_bf16_f32 v229, v202, v203
    v_cvt_pk_bf16_f32 v228, v200, v201
    s_add_u32 s39, s78, 2048
    buffer_store_dwordx4 v[228:231], v2, s[20:23], s39 offen offset:1024 sc1
    ds_read_b128 a[128:131], v101 offset:4096
    ds_read_b128 a[132:135], v101 offset:5120
    ds_read_b128 a[136:139], v101 offset:6144
    ds_read_b128 a[140:143], v101 offset:7168
    v_pk_mul_f32 v[192:193], v[192:193], v[34:35]
    v_pk_mul_f32 v[194:195], v[194:195], v[34:35]
    v_pk_mul_f32 v[196:197], v[196:197], v[34:35]
    v_pk_mul_f32 v[198:199], v[198:199], v[34:35]
    v_cvt_pk_bf16_f32 v227, v198, v199
    v_cvt_pk_bf16_f32 v226, v196, v197
    v_cvt_pk_bf16_f32 v225, v194, v195
    v_cvt_pk_bf16_f32 v224, v192, v193
    buffer_store_dwordx4 v[224:227], v2, s[20:23], s39 offen sc1
    ds_read_b128 a[144:147], v101 offset:8192
    ds_read_b128 a[148:151], v101 offset:9216
    ds_read_b128 a[152:155], v101 offset:10240
    ds_read_b128 a[156:159], v101 offset:11264
    v_pk_mul_f32 v[184:185], v[184:185], v[32:33]
    v_pk_mul_f32 v[186:187], v[186:187], v[32:33]
    v_pk_mul_f32 v[188:189], v[188:189], v[32:33]
    v_pk_mul_f32 v[190:191], v[190:191], v[32:33]
    v_cvt_pk_bf16_f32 v223, v190, v191
    v_cvt_pk_bf16_f32 v222, v188, v189
    v_cvt_pk_bf16_f32 v221, v186, v187
    v_cvt_pk_bf16_f32 v220, v184, v185
    s_add_u32 s39, s78, 18432
    buffer_store_dwordx4 v[220:223], v2, s[20:23], s39 offen offset:1024 sc1
    ds_read_b128 a[160:163], v101 offset:12288
    ds_read_b128 a[164:167], v101 offset:13312
    ds_read_b128 a[168:171], v101 offset:14336
    ds_read_b128 a[172:175], v101 offset:15360
    v_pk_mul_f32 v[176:177], v[176:177], v[32:33]
    v_pk_mul_f32 v[178:179], v[178:179], v[32:33]
    v_pk_mul_f32 v[180:181], v[180:181], v[32:33]
    v_pk_mul_f32 v[182:183], v[182:183], v[32:33]
    v_cvt_pk_bf16_f32 v219, v182, v183
    v_cvt_pk_bf16_f32 v218, v180, v181
    v_cvt_pk_bf16_f32 v217, v178, v179
    v_cvt_pk_bf16_f32 v216, v176, v177
    buffer_store_dwordx4 v[216:219], v2, s[20:23], s39 offen sc1
    ds_read_b128 a[176:179], v101 offset:16384
    ds_read_b128 a[180:183], v101 offset:17408
    v_pk_mul_f32 v[168:169], v[168:169], v[32:33]
    v_pk_mul_f32 v[170:171], v[170:171], v[32:33]
    v_pk_mul_f32 v[172:173], v[172:173], v[32:33]
    v_pk_mul_f32 v[174:175], v[174:175], v[32:33]
    v_cvt_pk_bf16_f32 v215, v174, v175
    v_cvt_pk_bf16_f32 v214, v172, v173
    v_cvt_pk_bf16_f32 v213, v170, v171
    v_cvt_pk_bf16_f32 v212, v168, v169
    s_add_u32 s39, s78, 0
    buffer_store_dwordx4 v[212:215], v2, s[20:23], s39 offen offset:1024 sc1
    v_pk_mul_f32 v[160:161], v[160:161], v[32:33]
    v_pk_mul_f32 v[162:163], v[162:163], v[32:33]
    v_pk_mul_f32 v[164:165], v[164:165], v[32:33]
    v_pk_mul_f32 v[166:167], v[166:167], v[32:33]
    v_cvt_pk_bf16_f32 v211, v166, v167
    v_cvt_pk_bf16_f32 v210, v164, v165
    v_cvt_pk_bf16_f32 v209, v162, v163
    v_cvt_pk_bf16_f32 v208, v160, v161
    buffer_store_dwordx4 v[208:211], v2, s[20:23], s39 offen sc1
    s_waitcnt lgkmcnt(0)
    s_barrier
    v_mov_b32 v4, 163776
    ds_read_b128 v[80:83], v4
    ds_read_b128 v[84:87], v4 offset:16
    s_waitcnt lgkmcnt(0)
    v_or_b32 v80, v80, v81
    v_or3_b32 v80, v80, v82, v83
    v_or3_b32 v80, v80, v84, v85
    v_or3_b32 v80, v80, v86, v87
    s_nop 0
    v_readfirstlane_b32 s39, v80
    s_nop 0
    s_andn2_b32 s39, s39, s55
    s_cmp_eq_u32 s39, 0
    s_cbranch_scc1 L_gemm
    v_mov_b32 v4, 163776
    ds_read_b128 v[80:83], v4
    s_waitcnt lgkmcnt(0)
    v_or_b32 v80, v80, v81
    v_or3_b32 v80, v80, v82, v83
    s_nop 0
    v_readfirstlane_b32 s39, v80
    s_nop 0
    s_cmp_eq_u32 s39, 0
    s_cselect_b32 s68, 1, 0
    s_mov_b32 s55, -1
    s_waitcnt vmcnt(0) lgkmcnt(0)
    v_and_b32 v3, 15, v1
    v_lshrrev_b32 v4, 4, v1
    v_xor_b32 v5, v3, v4
    v_lshlrev_b32 v5, 4, v5
    v_lshl_add_u32 v6, v3, 8, v5
    v_xor_b32 v7, 64, v6
    v_xor_b32 v8, 128, v6
    v_xor_b32 v9, 192, v6
    v_lshlrev_b32 v96, 4, v4
    v_lshrrev_b32 v3, 2, v1
    v_and_b32 v5, 7, v3
    v_lshlrev_b32 v5, 5, v5
    v_lshl_add_u32 v5, v3, 8, v5
    v_and_b32 v3, 3, v1
    v_lshl_add_u32 v5, v3, 3, v5
    v_add_u32 v10, 8192, v5
    v_xor_b32 v11, 32, v10
    v_xor_b32 v12, 64, v10
    v_xor_b32 v13, 96, v10
    v_xor_b32 v14, 128, v10
    v_xor_b32 v15, 160, v10
    v_xor_b32 v16, 192, v10
    v_xor_b32 v17, 224, v10
    v_mov_b32 v48, 0xff800000
    v_mov_b32 v49, 0xff800000
    v_mov_b32 v50, 0xff800000
    s_mov_b32 s54, 32
    s_xor_b32 s47, s69, 0
    s_mov_b32 s49, 0
L_max_A0:
    s_barrier
    s_add_u32 m0, s49, 0
    s_add_u32 s48, s47, 0
    buffer_load_dwordx4 v18, s[12:15], s48 offen nt lds
    buffer_load_dwordx4 v19, s[12:15], s48 offen offset:1024 nt lds
    buffer_load_dwordx4 v20, s[12:15], s48 offen offset:2048 nt lds
    buffer_load_dwordx4 v21, s[12:15], s48 offen offset:3072 nt lds
    s_add_u32 m0, s49, 4096
    s_add_u32 s48, s47, 4096
    buffer_load_dwordx4 v18, s[12:15], s48 offen nt lds
    buffer_load_dwordx4 v19, s[12:15], s48 offen offset:1024 nt lds
    buffer_load_dwordx4 v20, s[12:15], s48 offen offset:2048 nt lds
    buffer_load_dwordx4 v21, s[12:15], s48 offen offset:3072 nt lds
    s_waitcnt vmcnt(0)
    s_add_u32 s47, s47, 8192
    s_barrier
    ds_read_b128 a[144:147], v6
    ds_read_b128 a[160:163], v6 offset:4096
    ds_read_b128 a[148:151], v7
    ds_read_b128 a[164:167], v7 offset:4096
    ds_read_b128 a[152:155], v8
    ds_read_b128 a[168:171], v8 offset:4096
    ds_read_b128 a[156:159], v9
    ds_read_b128 a[172:175], v9 offset:4096
    s_waitcnt lgkmcnt(0)
    v_mfma_f32_16x16x32_bf16 v[32:35], a[144:147], a[0:3], 0
    v_mfma_f32_16x16x32_bf16 v[36:39], a[160:163], a[0:3], 0
    v_mfma_f32_16x16x32_bf16 v[32:35], a[148:151], a[4:7], v[32:35]
    v_mfma_f32_16x16x32_bf16 v[36:39], a[164:167], a[4:7], v[36:39]
    v_mfma_f32_16x16x32_bf16 v[32:35], a[152:155], a[8:11], v[32:35]
    v_mfma_f32_16x16x32_bf16 v[36:39], a[168:171], a[8:11], v[36:39]
    v_mfma_f32_16x16x32_bf16 v[32:35], a[156:159], a[12:15], v[32:35]
    v_mfma_f32_16x16x32_bf16 v[36:39], a[172:175], a[12:15], v[36:39]
    s_nop 6
    v_max3_f32 v48, v32, v33, v48
    v_max3_f32 v48, v34, v35, v48
    v_max3_f32 v48, v36, v37, v48
    v_max3_f32 v48, v38, v39, v48
    v_mfma_f32_16x16x32_bf16 v[32:35], a[144:147], a[16:19], 0
    v_mfma_f32_16x16x32_bf16 v[36:39], a[160:163], a[16:19], 0
    v_mfma_f32_16x16x32_bf16 v[32:35], a[148:151], a[20:23], v[32:35]
    v_mfma_f32_16x16x32_bf16 v[36:39], a[164:167], a[20:23], v[36:39]
    v_mfma_f32_16x16x32_bf16 v[32:35], a[152:155], a[24:27], v[32:35]
    v_mfma_f32_16x16x32_bf16 v[36:39], a[168:171], a[24:27], v[36:39]
    v_mfma_f32_16x16x32_bf16 v[32:35], a[156:159], a[28:31], v[32:35]
    v_mfma_f32_16x16x32_bf16 v[36:39], a[172:175], a[28:31], v[36:39]
    s_nop 6
    v_max3_f32 v49, v32, v33, v49
    v_max3_f32 v49, v34, v35, v49
    v_max3_f32 v49, v36, v37, v49
    v_max3_f32 v49, v38, v39, v49
    v_mfma_f32_16x16x32_bf16 v[32:35], a[144:147], a[32:35], 0
    v_mfma_f32_16x16x32_bf16 v[36:39], a[160:163], a[32:35], 0
    v_mfma_f32_16x16x32_bf16 v[32:35], a[148:151], a[36:39], v[32:35]
    v_mfma_f32_16x16x32_bf16 v[36:39], a[164:167], a[36:39], v[36:39]
    v_mfma_f32_16x16x32_bf16 v[32:35], a[152:155], a[40:43], v[32:35]
    v_mfma_f32_16x16x32_bf16 v[36:39], a[168:171], a[40:43], v[36:39]
    v_mfma_f32_16x16x32_bf16 v[32:35], a[156:159], a[44:47], v[32:35]
    v_mfma_f32_16x16x32_bf16 v[36:39], a[172:175], a[44:47], v[36:39]
    s_nop 6
    v_max3_f32 v50, v32, v33, v50
    v_max3_f32 v50, v34, v35, v50
    v_max3_f32 v50, v36, v37, v50
    v_max3_f32 v50, v38, v39, v50
    s_sub_u32 s54, s54, 1
    s_cmp_lg_u32 s54, 0
    s_cbranch_scc1 L_max_A0
    v_mov_b32 v3, v48
    s_nop 1
    v_permlane32_swap_b32 v3, v48
    v_max_f32 v48, v3, v48
    v_mov_b32 v3, v48
    s_nop 1
    v_permlane16_swap_b32 v3, v48
    v_max_f32 v48, v3, v48
    v_sub_f32 v56, 0, v48
    v_sub_f32 v57, 0, v48
    v_sub_f32 v58, 0, v48
    v_sub_f32 v59, 0, v48
    v_mov_b32 v3, v49
    s_nop 1
    v_permlane32_swap_b32 v3, v49
    v_max_f32 v49, v3, v49
    v_mov_b32 v3, v49
    s_nop 1
    v_permlane16_swap_b32 v3, v49
    v_max_f32 v49, v3, v49
    v_sub_f32 v60, 0, v49
    v_sub_f32 v61, 0, v49
    v_sub_f32 v62, 0, v49
    v_sub_f32 v63, 0, v49
    v_mov_b32 v3, v50
    s_nop 1
    v_permlane32_swap_b32 v3, v50
    v_max_f32 v50, v3, v50
    v_mov_b32 v3, v50
    s_nop 1
    v_permlane16_swap_b32 v3, v50
    v_max_f32 v50, v3, v50
    v_sub_f32 v64, 0, v50
    v_sub_f32 v65, 0, v50
    v_sub_f32 v66, 0, v50
    v_sub_f32 v67, 0, v50
    v_mov_b32 v48, 0xff800000
    v_mov_b32 v49, 0xff800000
    v_mov_b32 v50, 0xff800000
    s_mov_b32 s54, 32
    s_xor_b32 s47, s69, 262144
    s_mov_b32 s49, 0
L_max_A1:
    s_barrier
    s_add_u32 m0, s49, 0
    s_add_u32 s48, s47, 0
    buffer_load_dwordx4 v18, s[12:15], s48 offen nt lds
    buffer_load_dwordx4 v19, s[12:15], s48 offen offset:1024 nt lds
    buffer_load_dwordx4 v20, s[12:15], s48 offen offset:2048 nt lds
    buffer_load_dwordx4 v21, s[12:15], s48 offen offset:3072 nt lds
    s_add_u32 m0, s49, 4096
    s_add_u32 s48, s47, 4096
    buffer_load_dwordx4 v18, s[12:15], s48 offen nt lds
    buffer_load_dwordx4 v19, s[12:15], s48 offen offset:1024 nt lds
    buffer_load_dwordx4 v20, s[12:15], s48 offen offset:2048 nt lds
    buffer_load_dwordx4 v21, s[12:15], s48 offen offset:3072 nt lds
    s_waitcnt vmcnt(0)
    s_add_u32 s47, s47, 8192
    s_barrier
    ds_read_b128 a[144:147], v6
    ds_read_b128 a[160:163], v6 offset:4096
    ds_read_b128 a[148:151], v7
    ds_read_b128 a[164:167], v7 offset:4096
    ds_read_b128 a[152:155], v8
    ds_read_b128 a[168:171], v8 offset:4096
    ds_read_b128 a[156:159], v9
    ds_read_b128 a[172:175], v9 offset:4096
    s_waitcnt lgkmcnt(0)
    v_mfma_f32_16x16x32_bf16 v[32:35], a[144:147], a[48:51], 0
    v_mfma_f32_16x16x32_bf16 v[36:39], a[160:163], a[48:51], 0
    v_mfma_f32_16x16x32_bf16 v[32:35], a[148:151], a[52:55], v[32:35]
    v_mfma_f32_16x16x32_bf16 v[36:39], a[164:167], a[52:55], v[36:39]
    v_mfma_f32_16x16x32_bf16 v[32:35], a[152:155], a[56:59], v[32:35]
    v_mfma_f32_16x16x32_bf16 v[36:39], a[168:171], a[56:59], v[36:39]
    v_mfma_f32_16x16x32_bf16 v[32:35], a[156:159], a[60:63], v[32:35]
    v_mfma_f32_16x16x32_bf16 v[36:39], a[172:175], a[60:63], v[36:39]
    s_nop 6
    v_max3_f32 v48, v32, v33, v48
    v_max3_f32 v48, v34, v35, v48
    v_max3_f32 v48, v36, v37, v48
    v_max3_f32 v48, v38, v39, v48
    v_mfma_f32_16x16x32_bf16 v[32:35], a[144:147], a[64:67], 0
    v_mfma_f32_16x16x32_bf16 v[36:39], a[160:163], a[64:67], 0
    v_mfma_f32_16x16x32_bf16 v[32:35], a[148:151], a[68:71], v[32:35]
    v_mfma_f32_16x16x32_bf16 v[36:39], a[164:167], a[68:71], v[36:39]
    v_mfma_f32_16x16x32_bf16 v[32:35], a[152:155], a[72:75], v[32:35]
    v_mfma_f32_16x16x32_bf16 v[36:39], a[168:171], a[72:75], v[36:39]
    v_mfma_f32_16x16x32_bf16 v[32:35], a[156:159], a[76:79], v[32:35]
    v_mfma_f32_16x16x32_bf16 v[36:39], a[172:175], a[76:79], v[36:39]
    s_nop 6
    v_max3_f32 v49, v32, v33, v49
    v_max3_f32 v49, v34, v35, v49
    v_max3_f32 v49, v36, v37, v49
    v_max3_f32 v49, v38, v39, v49
    v_mfma_f32_16x16x32_bf16 v[32:35], a[144:147], a[80:83], 0
    v_mfma_f32_16x16x32_bf16 v[36:39], a[160:163], a[80:83], 0
    v_mfma_f32_16x16x32_bf16 v[32:35], a[148:151], a[84:87], v[32:35]
    v_mfma_f32_16x16x32_bf16 v[36:39], a[164:167], a[84:87], v[36:39]
    v_mfma_f32_16x16x32_bf16 v[32:35], a[152:155], a[88:91], v[32:35]
    v_mfma_f32_16x16x32_bf16 v[36:39], a[168:171], a[88:91], v[36:39]
    v_mfma_f32_16x16x32_bf16 v[32:35], a[156:159], a[92:95], v[32:35]
    v_mfma_f32_16x16x32_bf16 v[36:39], a[172:175], a[92:95], v[36:39]
    s_nop 6
    v_max3_f32 v50, v32, v33, v50
    v_max3_f32 v50, v34, v35, v50
    v_max3_f32 v50, v36, v37, v50
    v_max3_f32 v50, v38, v39, v50
    s_sub_u32 s54, s54, 1
    s_cmp_lg_u32 s54, 0
    s_cbranch_scc1 L_max_A1
    v_mov_b32 v3, v48
    s_nop 1
    v_permlane32_swap_b32 v3, v48
    v_max_f32 v48, v3, v48
    v_mov_b32 v3, v48
    s_nop 1
    v_permlane16_swap_b32 v3, v48
    v_max_f32 v48, v3, v48
    v_sub_f32 v68, 0, v48
    v_sub_f32 v69, 0, v48
    v_sub_f32 v70, 0, v48
    v_sub_f32 v71, 0, v48
    v_mov_b32 v3, v49
    s_nop 1
    v_permlane32_swap_b32 v3, v49
    v_max_f32 v49, v3, v49
    v_mov_b32 v3, v49
    s_nop 1
    v_permlane16_swap_b32 v3, v49
    v_max_f32 v49, v3, v49
    v_sub_f32 v72, 0, v49
    v_sub_f32 v73, 0, v49
    v_sub_f32 v74, 0, v49
    v_sub_f32 v75, 0, v49
    v_mov_b32 v3, v50
    s_nop 1
    v_permlane32_swap_b32 v3, v50
    v_max_f32 v50, v3, v50
    v_mov_b32 v3, v50
    s_nop 1
    v_permlane16_swap_b32 v3, v50
    v_max_f32 v50, v3, v50
    v_sub_f32 v76, 0, v50
    v_sub_f32 v77, 0, v50
    v_sub_f32 v78, 0, v50
    v_sub_f32 v79, 0, v50
    s_barrier
    s_mul_i32 s39, s36, s89
    s_add_u32 s47, s57, s39
    s_and_b32 s47, s47, 0x3ffff
    s_add_u32 s47, s47, s69
    s_lshl_b32 s49, s36, 14
    s_add_u32 m0, s49, 0
    s_add_u32 s48, s47, 0
    buffer_load_dwordx4 v18, s[12:15], s48 offen nt lds
    buffer_load_dwordx4 v19, s[12:15], s48 offen offset:1024 nt lds
    buffer_load_dwordx4 v20, s[12:15], s48 offen offset:2048 nt lds
    buffer_load_dwordx4 v21, s[12:15], s48 offen offset:3072 nt lds
    s_add_u32 m0, s49, 4096
    s_add_u32 s48, s47, 4096
    buffer_load_dwordx4 v18, s[12:15], s48 offen nt lds
    buffer_load_dwordx4 v19, s[12:15], s48 offen offset:1024 nt lds
    buffer_load_dwordx4 v20, s[12:15], s48 offen offset:2048 nt lds
    buffer_load_dwordx4 v21, s[12:15], s48 offen offset:3072 nt lds
    s_add_u32 m0, s49, 8192
    s_add_u32 s48, s47, 0
    buffer_load_dwordx4 v22, s[16:19], s48 offen nt lds
    buffer_load_dwordx4 v23, s[16:19], s48 offen offset:1024 nt lds
    buffer_load_dwordx4 v22, s[16:19], s48 offen offset:2048 nt lds
    buffer_load_dwordx4 v23, s[16:19], s48 offen offset:3072 nt lds
    s_add_u32 m0, s49, 12288
    s_add_u32 s48, s47, 4096
    buffer_load_dwordx4 v22, s[16:19], s48 offen nt lds
    buffer_load_dwordx4 v23, s[16:19], s48 offen offset:1024 nt lds
    buffer_load_dwordx4 v22, s[16:19], s48 offen offset:2048 nt lds
    buffer_load_dwordx4 v23, s[16:19], s48 offen offset:3072 nt lds
    s_cmp_eq_u32 s36, 2
    s_cselect_b32 s4, s16, s12
    s_cselect_b32 s5, s17, s13
    s_mov_b32 s6, 0x4000000
    s_mov_b32 s7, 0x20000
    s_cselect_b32 s49, 8192, 0
    s_cselect_b64 vcc, -1, 0
    s_nop 1
    v_cndmask_b32 v28, v18, v22, vcc
    v_cndmask_b32 v29, v19, v23, vcc
    v_cndmask_b32 v30, v20, v22, vcc
    v_cndmask_b32 v31, v21, v23, vcc
    s_lshl_b32 s47, s89, 2
    s_add_u32 s47, s57, s47
    s_and_b32 s47, s47, 0x3ffff
    s_mov_b32 s46, s69
    s_waitcnt vmcnt(0)
    s_barrier
    ds_read_b128 a[144:147], v6
    ds_read_b128 a[160:163], v6 offset:4096
    ds_read_b128 a[148:151], v7
    ds_read_b128 a[164:167], v7 offset:4096
    ds_read_b128 a[152:155], v8
    ds_read_b128 a[168:171], v8 offset:4096
    ds_read_b128 a[156:159], v9
    ds_read_b128 a[172:175], v9 offset:4096
    ds_read_b64_tr_b16 a[176:177], v10
    ds_read_b64_tr_b16 a[178:179], v10 offset:4096
    ds_read_b64_tr_b16 a[180:181], v11
    ds_read_b64_tr_b16 a[182:183], v11 offset:4096
    ds_read_b64_tr_b16 a[184:185], v12
    ds_read_b64_tr_b16 a[186:187], v12 offset:4096
    ds_read_b64_tr_b16 a[188:189], v13
    ds_read_b64_tr_b16 a[190:191], v13 offset:4096
    ds_read_b64_tr_b16 a[192:193], v14
    ds_read_b64_tr_b16 a[194:195], v14 offset:4096
    ds_read_b64_tr_b16 a[196:197], v15
    ds_read_b64_tr_b16 a[198:199], v15 offset:4096
    ds_read_b64_tr_b16 a[200:201], v16
    ds_read_b64_tr_b16 a[202:203], v16 offset:4096
    ds_read_b64_tr_b16 a[204:205], v17
    ds_read_b64_tr_b16 a[206:207], v17 offset:4096
    s_waitcnt lgkmcnt(0)
    s_nop 7
    s_branch L_main_A
L_rB:
    s_mul_i32 s39, s3, 18432
    v_add_u32 v107, s39, v97
    v_add_u32 v97, 36864, v97
    v_subrev_u32 v97, s39, v97
    v_add_u32 v106, 139264, v2
    v_add_u32 v98, s66, v101
L_main_B:
    s_mov_b32 s67, 0
    s_waitcnt vmcnt(8)
    s_waitcnt lgkmcnt(0)
    s_barrier
    s_add_u32 m0, s49, 0
    s_add_u32 s48, s46, s47
    buffer_load_dwordx4 v28, s[4:7], s48 offen nt lds
    buffer_load_dwordx4 v29, s[4:7], s48 offen offset:1024 nt lds
    s_cmp_lg_u32 s55, 0
    s_cbranch_scc1 L_np0B
    ds_read_b128 a[0:3], v107
    ds_read_b128 a[4:7], v107 offset:1024
    ds_read_b128 a[8:11], v107 offset:2048
    ds_read_b128 a[12:15], v107 offset:3072
    ds_read_b128 a[16:19], v107 offset:4096
    ds_read_b128 a[20:23], v107 offset:5120
    ds_read_b128 a[24:27], v107 offset:6144
    ds_read_b128 a[28:31], v107 offset:7168
    s_waitcnt lgkmcnt(0)
    v_mfma_f32_16x16x32_bf16 v[56:59], v[80:83], a[0:3], 0
    v_mfma_f32_16x16x32_bf16 v[56:59], v[84:87], a[4:7], v[56:59]
    v_mfma_f32_16x16x32_bf16 v[56:59], v[88:91], a[8:11], v[56:59]
    v_mfma_f32_16x16x32_bf16 v[56:59], v[92:95], a[12:15], v[56:59]
    v_mfma_f32_16x16x32_bf16 v[60:63], v[80:83], a[16:19], 0
    v_mfma_f32_16x16x32_bf16 v[60:63], v[84:87], a[20:23], v[60:63]
    v_mfma_f32_16x16x32_bf16 v[60:63], v[88:91], a[24:27], v[60:63]
    v_mfma_f32_16x16x32_bf16 v[60:63], v[92:95], a[28:31], v[60:63]
L_np0B:
    v_mfma_f32_16x16x32_bf16 v[32:35], a[144:147], a[0:3], v[56:59]
    ds_read_b128 a[112:115], v6 offset:16384
    v_mfma_f32_16x16x32_bf16 v[36:39], a[160:163], a[0:3], v[56:59]
    ds_read_b128 a[128:131], v6 offset:20480
    buffer_load_dwordx4 v30, s[4:7], s48 offen offset:2048 nt lds
    v_mfma_f32_16x16x32_bf16 v[32:35], a[148:151], a[4:7], v[32:35]
    ds_read_b128 a[116:119], v7 offset:16384
    s_waitcnt vmcnt(10)
    v_mfma_f32_16x16x32_bf16 v[36:39], a[164:167], a[4:7], v[36:39]
    ds_read_b128 a[132:135], v7 offset:20480
    buffer_load_dwordx4 v31, s[4:7], s48 offen offset:3072 nt lds
    v_mfma_f32_16x16x32_bf16 v[32:35], a[152:155], a[8:11], v[32:35]
    ds_read_b128 a[120:123], v8 offset:16384
    s_xor_b32 m0, m0, 4096
    v_mfma_f32_16x16x32_bf16 v[36:39], a[168:171], a[8:11], v[36:39]
    ds_read_b128 a[136:139], v8 offset:20480
    s_xor_b32 s48, s48, 4096
    v_mfma_f32_16x16x32_bf16 v[32:35], a[156:159], a[12:15], v[32:35]
    ds_read_b128 a[124:127], v9 offset:16384
    s_waitcnt vmcnt(10)
    v_mfma_f32_16x16x32_bf16 v[36:39], a[172:175], a[12:15], v[36:39]
    ds_read_b128 a[140:143], v9 offset:20480
    buffer_load_dwordx4 v28, s[4:7], s48 offen nt lds
    ds_read_b64_tr_b16 a[208:209], v10 offset:16384
    s_waitcnt vmcnt(10)
    ds_read_b64_tr_b16 a[210:211], v10 offset:20480
    buffer_load_dwordx4 v29, s[4:7], s48 offen offset:1024 nt lds
    ds_read_b64_tr_b16 a[212:213], v11 offset:16384
    s_waitcnt vmcnt(10)
    ds_read_b64_tr_b16 a[214:215], v11 offset:20480
    buffer_load_dwordx4 v30, s[4:7], s48 offen offset:2048 nt lds
    ds_read_b64_tr_b16 a[216:217], v12 offset:16384
    s_waitcnt vmcnt(10)
    ds_read_b64_tr_b16 a[218:219], v12 offset:20480
    buffer_load_dwordx4 v31, s[4:7], s48 offen offset:3072 nt lds
    ds_read_b64_tr_b16 a[220:221], v13 offset:16384
    s_add_u32 s47, s47, s89
    ds_read_b64_tr_b16 a[222:223], v13 offset:20480
    s_and_b32 s47, s47, 0x3ffff
    ds_read_b64_tr_b16 a[224:225], v14 offset:16384
    ds_read_b64_tr_b16 a[226:227], v14 offset:20480
    v_mfma_f32_16x16x32_bf16 v[40:43], a[144:147], a[16:19], v[60:63]
    v_exp_f32 v32, v32
    v_mfma_f32_16x16x32_bf16 v[44:47], a[160:163], a[16:19], v[60:63]
    ds_read_b64_tr_b16 a[228:229], v15 offset:16384
    ds_read_b64_tr_b16 a[230:231], v15 offset:20480
    v_mfma_f32_16x16x32_bf16 v[40:43], a[148:151], a[20:23], v[40:43]
    v_exp_f32 v33, v33
    v_mfma_f32_16x16x32_bf16 v[44:47], a[164:167], a[20:23], v[44:47]
    v_cvt_pk_bf16_f32 v48, v32, v33
    ds_read_b64_tr_b16 a[232:233], v16 offset:16384
    v_mfma_f32_16x16x32_bf16 v[40:43], a[152:155], a[24:27], v[40:43]
    v_exp_f32 v34, v34
    v_mfma_f32_16x16x32_bf16 v[44:47], a[168:171], a[24:27], v[44:47]
    ds_read_b64_tr_b16 a[234:235], v16 offset:20480
    ds_read_b64_tr_b16 a[236:237], v17 offset:16384
    v_mfma_f32_16x16x32_bf16 v[40:43], a[156:159], a[28:31], v[40:43]
    v_exp_f32 v35, v35
    v_mfma_f32_16x16x32_bf16 v[44:47], a[172:175], a[28:31], v[44:47]
    v_cvt_pk_bf16_f32 v49, v34, v35
    ds_read_b64_tr_b16 a[238:239], v17 offset:20480
    v_exp_f32 v36, v36
    v_exp_f32 v37, v37
    s_nop 0
    v_cvt_pk_bf16_f32 v50, v36, v37
    v_exp_f32 v38, v38
    v_exp_f32 v39, v39
    s_nop 0
    v_cvt_pk_bf16_f32 v51, v38, v39
    s_waitcnt lgkmcnt(15)
    v_mfma_f32_16x16x32_bf16 v[32:35], a[112:115], a[0:3], v[56:59]
    v_exp_f32 v40, v40
    v_mfma_f32_16x16x32_bf16 v[36:39], a[128:131], a[0:3], v[56:59]
    v_mfma_f32_16x16x32_bf16 v[32:35], a[116:119], a[4:7], v[32:35]
    v_exp_f32 v41, v41
    v_mfma_f32_16x16x32_bf16 v[36:39], a[132:135], a[4:7], v[36:39]
    v_cvt_pk_bf16_f32 v52, v40, v41
    v_mfma_f32_16x16x32_bf16 v[32:35], a[120:123], a[8:11], v[32:35]
    v_exp_f32 v42, v42
    v_mfma_f32_16x16x32_bf16 v[36:39], a[136:139], a[8:11], v[36:39]
    v_mfma_f32_16x16x32_bf16 v[32:35], a[124:127], a[12:15], v[32:35]
    v_exp_f32 v43, v43
    v_mfma_f32_16x16x32_bf16 v[36:39], a[140:143], a[12:15], v[36:39]
    v_cvt_pk_bf16_f32 v53, v42, v43
    v_mfma_f32_16x16x32_bf16 v[160:163], a[176:179], v[48:51], 0
    v_exp_f32 v44, v44
    v_mfma_f32_16x16x32_bf16 v[164:167], a[180:183], v[48:51], 0
    v_mfma_f32_16x16x32_bf16 v[168:171], a[184:187], v[48:51], 0
    v_exp_f32 v45, v45
    v_mfma_f32_16x16x32_bf16 v[172:175], a[188:191], v[48:51], 0
    v_cvt_pk_bf16_f32 v54, v44, v45
    v_mfma_f32_16x16x32_bf16 v[176:179], a[192:195], v[48:51], 0
    v_exp_f32 v46, v46
    v_mfma_f32_16x16x32_bf16 v[180:183], a[196:199], v[48:51], 0
    v_mfma_f32_16x16x32_bf16 v[184:187], a[200:203], v[48:51], 0
    v_exp_f32 v47, v47
    v_mfma_f32_16x16x32_bf16 v[188:191], a[204:207], v[48:51], 0
    v_cvt_pk_bf16_f32 v55, v46, v47
    v_mfma_f32_16x16x32_bf16 a[96:99], a[108:111], v[48:51], 0
    s_waitcnt lgkmcnt(0)
    s_barrier
    v_mfma_f32_16x16x32_bf16 v[40:43], a[112:115], a[16:19], v[60:63]
    v_exp_f32 v32, v32
    v_mfma_f32_16x16x32_bf16 v[44:47], a[128:131], a[16:19], v[60:63]
    ds_read_b128 a[144:147], v6 offset:32768
    s_add_u32 m0, s49, 16384
    ds_read_b128 a[160:163], v6 offset:36864
    ds_read_b128 a[148:151], v7 offset:32768
    v_mfma_f32_16x16x32_bf16 v[40:43], a[116:119], a[20:23], v[40:43]
    v_exp_f32 v33, v33
    v_mfma_f32_16x16x32_bf16 v[44:47], a[132:135], a[20:23], v[44:47]
    v_cvt_pk_bf16_f32 v48, v32, v33
    ds_read_b128 a[164:167], v7 offset:36864
    s_add_u32 s48, s46, s47
    ds_read_b128 a[152:155], v8 offset:32768
    v_mfma_f32_16x16x32_bf16 v[40:43], a[120:123], a[24:27], v[40:43]
    v_exp_f32 v34, v34
    v_mfma_f32_16x16x32_bf16 v[44:47], a[136:139], a[24:27], v[44:47]
    ds_read_b128 a[168:171], v8 offset:36864
    s_waitcnt vmcnt(10)
    ds_read_b128 a[156:159], v9 offset:32768
    ds_read_b128 a[172:175], v9 offset:36864
    v_mfma_f32_16x16x32_bf16 v[40:43], a[124:127], a[28:31], v[40:43]
    v_exp_f32 v35, v35
    v_mfma_f32_16x16x32_bf16 v[44:47], a[140:143], a[28:31], v[44:47]
    v_cvt_pk_bf16_f32 v49, v34, v35
    buffer_load_dwordx4 v28, s[4:7], s48 offen nt lds
    s_waitcnt vmcnt(10)
    buffer_load_dwordx4 v29, s[4:7], s48 offen offset:1024 nt lds
    v_mfma_f32_16x16x32_bf16 v[192:195], a[176:179], v[52:55], 0
    v_exp_f32 v36, v36
    v_mfma_f32_16x16x32_bf16 v[196:199], a[180:183], v[52:55], 0
    ds_read_b64_tr_b16 a[176:177], v10 offset:32768
    s_waitcnt vmcnt(10)
    ds_read_b64_tr_b16 a[178:179], v10 offset:36864
    v_mfma_f32_16x16x32_bf16 v[200:203], a[184:187], v[52:55], 0
    v_exp_f32 v37, v37
    v_mfma_f32_16x16x32_bf16 v[204:207], a[188:191], v[52:55], 0
    v_cvt_pk_bf16_f32 v50, v36, v37
    ds_read_b64_tr_b16 a[180:181], v11 offset:32768
    buffer_load_dwordx4 v30, s[4:7], s48 offen offset:2048 nt lds
    v_mfma_f32_16x16x32_bf16 v[208:211], a[192:195], v[52:55], 0
    v_exp_f32 v38, v38
    v_mfma_f32_16x16x32_bf16 v[212:215], a[196:199], v[52:55], 0
    ds_read_b64_tr_b16 a[182:183], v11 offset:36864
    s_waitcnt vmcnt(10)
    ds_read_b64_tr_b16 a[184:185], v12 offset:32768
    v_mfma_f32_16x16x32_bf16 v[216:219], a[200:203], v[52:55], 0
    v_exp_f32 v39, v39
    v_mfma_f32_16x16x32_bf16 v[220:223], a[204:207], v[52:55], 0
    v_cvt_pk_bf16_f32 v51, v38, v39
    ds_read_b64_tr_b16 a[186:187], v12 offset:36864
    buffer_load_dwordx4 v31, s[4:7], s48 offen offset:3072 nt lds
    v_mfma_f32_16x16x32_bf16 a[100:103], a[108:111], v[52:55], 0
    ds_read_b64_tr_b16 a[188:189], v13 offset:32768
    s_xor_b32 m0, m0, 4096
    ds_read_b64_tr_b16 a[190:191], v13 offset:36864
    s_waitcnt lgkmcnt(8)
    v_mfma_f32_16x16x32_bf16 v[32:35], a[144:147], a[0:3], v[56:59]
    v_exp_f32 v40, v40
    v_mfma_f32_16x16x32_bf16 v[36:39], a[160:163], a[0:3], v[56:59]
    ds_read_b64_tr_b16 a[192:193], v14 offset:32768
    s_xor_b32 s48, s48, 4096
    ds_read_b64_tr_b16 a[194:195], v14 offset:36864
    v_mfma_f32_16x16x32_bf16 v[32:35], a[148:151], a[4:7], v[32:35]
    v_exp_f32 v41, v41
    v_mfma_f32_16x16x32_bf16 v[36:39], a[164:167], a[4:7], v[36:39]
    v_cvt_pk_bf16_f32 v52, v40, v41
    ds_read_b64_tr_b16 a[196:197], v15 offset:32768
    s_waitcnt vmcnt(10)
    v_mfma_f32_16x16x32_bf16 v[32:35], a[152:155], a[8:11], v[32:35]
    v_exp_f32 v42, v42
    v_mfma_f32_16x16x32_bf16 v[36:39], a[168:171], a[8:11], v[36:39]
    ds_read_b64_tr_b16 a[198:199], v15 offset:36864
    buffer_load_dwordx4 v28, s[4:7], s48 offen nt lds
    ds_read_b64_tr_b16 a[200:201], v16 offset:32768
    v_mfma_f32_16x16x32_bf16 v[32:35], a[156:159], a[12:15], v[32:35]
    v_exp_f32 v43, v43
    v_mfma_f32_16x16x32_bf16 v[36:39], a[172:175], a[12:15], v[36:39]
    v_cvt_pk_bf16_f32 v53, v42, v43
    ds_read_b64_tr_b16 a[202:203], v16 offset:36864
    s_waitcnt vmcnt(10)
    v_mfma_f32_16x16x32_bf16 v[160:163], a[208:211], v[48:51], v[160:163]
    v_exp_f32 v44, v44
    v_mfma_f32_16x16x32_bf16 v[164:167], a[212:215], v[48:51], v[164:167]
    ds_read_b64_tr_b16 a[204:205], v17 offset:32768
    buffer_load_dwordx4 v29, s[4:7], s48 offen offset:1024 nt lds
    ds_read_b64_tr_b16 a[206:207], v17 offset:36864
    v_mfma_f32_16x16x32_bf16 v[168:171], a[216:219], v[48:51], v[168:171]
    v_exp_f32 v45, v45
    v_mfma_f32_16x16x32_bf16 v[172:175], a[220:223], v[48:51], v[172:175]
    v_cvt_pk_bf16_f32 v54, v44, v45
    s_waitcnt vmcnt(10)
    buffer_load_dwordx4 v30, s[4:7], s48 offen offset:2048 nt lds
    v_mfma_f32_16x16x32_bf16 v[176:179], a[224:227], v[48:51], v[176:179]
    v_exp_f32 v46, v46
    v_mfma_f32_16x16x32_bf16 v[180:183], a[228:231], v[48:51], v[180:183]
    s_waitcnt vmcnt(10)
    buffer_load_dwordx4 v31, s[4:7], s48 offen offset:3072 nt lds
    s_add_u32 s47, s47, s89
    v_mfma_f32_16x16x32_bf16 v[184:187], a[232:235], v[48:51], v[184:187]
    v_exp_f32 v47, v47
    v_mfma_f32_16x16x32_bf16 v[188:191], a[236:239], v[48:51], v[188:191]
    v_cvt_pk_bf16_f32 v55, v46, v47
    s_and_b32 s47, s47, 0x3ffff
    v_mfma_f32_16x16x32_bf16 a[96:99], a[108:111], v[48:51], a[96:99]
    s_waitcnt lgkmcnt(0)
    s_barrier
    s_cmp_lg_u32 s55, 0
    s_cbranch_scc1 6f
    ds_read_b128 a[48:51], v97
    ds_read_b128 a[52:55], v97 offset:1024
    ds_read_b128 a[56:59], v97 offset:2048
    ds_read_b128 a[60:63], v97 offset:3072
    ds_read_b128 a[64:67], v97 offset:4096
    ds_read_b128 a[68:71], v97 offset:5120
    ds_read_b128 a[72:75], v97 offset:6144
    ds_read_b128 a[76:79], v97 offset:7168
6:
    v_mfma_f32_16x16x32_bf16 v[40:43], a[144:147], a[16:19], v[60:63]
    v_exp_f32 v32, v32
    v_mfma_f32_16x16x32_bf16 v[44:47], a[160:163], a[16:19], v[60:63]
    ds_read_b128 a[112:115], v6 offset:49152
    s_add_u32 m0, s49, 32768
    ds_read_b128 a[128:131], v6 offset:53248
    ds_read_b128 a[116:119], v7 offset:49152
    v_mfma_f32_16x16x32_bf16 v[40:43], a[148:151], a[20:23], v[40:43]
    v_exp_f32 v33, v33
    v_mfma_f32_16x16x32_bf16 v[44:47], a[164:167], a[20:23], v[44:47]
    v_cvt_pk_bf16_f32 v48, v32, v33
    ds_read_b128 a[132:135], v7 offset:53248
    s_add_u32 s48, s46, s47
    ds_read_b128 a[120:123], v8 offset:49152
    v_mfma_f32_16x16x32_bf16 v[40:43], a[152:155], a[24:27], v[40:43]
    v_exp_f32 v34, v34
    v_mfma_f32_16x16x32_bf16 v[44:47], a[168:171], a[24:27], v[44:47]
    ds_read_b128 a[136:139], v8 offset:53248
    s_waitcnt vmcnt(10)
    ds_read_b128 a[124:127], v9 offset:49152
    ds_read_b128 a[140:143], v9 offset:53248
    v_mfma_f32_16x16x32_bf16 v[40:43], a[156:159], a[28:31], v[40:43]
    v_exp_f32 v35, v35
    v_mfma_f32_16x16x32_bf16 v[44:47], a[172:175], a[28:31], v[44:47]
    v_cvt_pk_bf16_f32 v49, v34, v35
    buffer_load_dwordx4 v28, s[4:7], s48 offen nt lds
    s_waitcnt vmcnt(10)
    buffer_load_dwordx4 v29, s[4:7], s48 offen offset:1024 nt lds
    v_mfma_f32_16x16x32_bf16 v[192:195], a[208:211], v[52:55], v[192:195]
    v_exp_f32 v36, v36
    v_mfma_f32_16x16x32_bf16 v[196:199], a[212:215], v[52:55], v[196:199]
    ds_read_b64_tr_b16 a[208:209], v10 offset:49152
    s_waitcnt vmcnt(10)
    ds_read_b64_tr_b16 a[210:211], v10 offset:53248
    v_mfma_f32_16x16x32_bf16 v[200:203], a[216:219], v[52:55], v[200:203]
    v_exp_f32 v37, v37
    v_mfma_f32_16x16x32_bf16 v[204:207], a[220:223], v[52:55], v[204:207]
    v_cvt_pk_bf16_f32 v50, v36, v37
    ds_read_b64_tr_b16 a[212:213], v11 offset:49152
    buffer_load_dwordx4 v30, s[4:7], s48 offen offset:2048 nt lds
    v_mfma_f32_16x16x32_bf16 v[208:211], a[224:227], v[52:55], v[208:211]
    v_exp_f32 v38, v38
    v_mfma_f32_16x16x32_bf16 v[212:215], a[228:231], v[52:55], v[212:215]
    ds_read_b64_tr_b16 a[214:215], v11 offset:53248
    s_waitcnt vmcnt(10)
    ds_read_b64_tr_b16 a[216:217], v12 offset:49152
    v_mfma_f32_16x16x32_bf16 v[216:219], a[232:235], v[52:55], v[216:219]
    v_exp_f32 v39, v39
    v_mfma_f32_16x16x32_bf16 v[220:223], a[236:239], v[52:55], v[220:223]
    v_cvt_pk_bf16_f32 v51, v38, v39
    ds_read_b64_tr_b16 a[218:219], v12 offset:53248
    buffer_load_dwordx4 v31, s[4:7], s48 offen offset:3072 nt lds
    v_mfma_f32_16x16x32_bf16 a[100:103], a[108:111], v[52:55], a[100:103]
    ds_read_b64_tr_b16 a[220:221], v13 offset:49152
    s_xor_b32 m0, m0, 4096
    ds_read_b64_tr_b16 a[222:223], v13 offset:53248
    s_waitcnt lgkmcnt(8)
    v_mfma_f32_16x16x32_bf16 v[32:35], a[112:115], a[0:3], v[56:59]
    v_exp_f32 v40, v40
    v_mfma_f32_16x16x32_bf16 v[36:39], a[128:131], a[0:3], v[56:59]
    ds_read_b64_tr_b16 a[224:225], v14 offset:49152
    s_xor_b32 s48, s48, 4096
    ds_read_b64_tr_b16 a[226:227], v14 offset:53248
    v_mfma_f32_16x16x32_bf16 v[32:35], a[116:119], a[4:7], v[32:35]
    v_exp_f32 v41, v41
    v_mfma_f32_16x16x32_bf16 v[36:39], a[132:135], a[4:7], v[36:39]
    v_cvt_pk_bf16_f32 v52, v40, v41
    ds_read_b64_tr_b16 a[228:229], v15 offset:49152
    s_waitcnt vmcnt(10)
    v_mfma_f32_16x16x32_bf16 v[32:35], a[120:123], a[8:11], v[32:35]
    v_exp_f32 v42, v42
    v_mfma_f32_16x16x32_bf16 v[36:39], a[136:139], a[8:11], v[36:39]
    ds_read_b64_tr_b16 a[230:231], v15 offset:53248
    buffer_load_dwordx4 v28, s[4:7], s48 offen nt lds
    ds_read_b64_tr_b16 a[232:233], v16 offset:49152
    v_mfma_f32_16x16x32_bf16 v[32:35], a[124:127], a[12:15], v[32:35]
    v_exp_f32 v43, v43
    v_mfma_f32_16x16x32_bf16 v[36:39], a[140:143], a[12:15], v[36:39]
    v_cvt_pk_bf16_f32 v53, v42, v43
    ds_read_b64_tr_b16 a[234:235], v16 offset:53248
    s_waitcnt vmcnt(10)
    v_mfma_f32_16x16x32_bf16 v[160:163], a[176:179], v[48:51], v[160:163]
    v_exp_f32 v44, v44
    v_mfma_f32_16x16x32_bf16 v[164:167], a[180:183], v[48:51], v[164:167]
    ds_read_b64_tr_b16 a[236:237], v17 offset:49152
    buffer_load_dwordx4 v29, s[4:7], s48 offen offset:1024 nt lds
    ds_read_b64_tr_b16 a[238:239], v17 offset:53248
    v_mfma_f32_16x16x32_bf16 v[168:171], a[184:187], v[48:51], v[168:171]
    v_exp_f32 v45, v45
    v_mfma_f32_16x16x32_bf16 v[172:175], a[188:191], v[48:51], v[172:175]
    v_cvt_pk_bf16_f32 v54, v44, v45
    s_waitcnt vmcnt(10)
    buffer_load_dwordx4 v30, s[4:7], s48 offen offset:2048 nt lds
    v_mfma_f32_16x16x32_bf16 v[176:179], a[192:195], v[48:51], v[176:179]
    v_exp_f32 v46, v46
    v_mfma_f32_16x16x32_bf16 v[180:183], a[196:199], v[48:51], v[180:183]
    s_waitcnt vmcnt(10)
    buffer_load_dwordx4 v31, s[4:7], s48 offen offset:3072 nt lds
    s_add_u32 s47, s47, s89
    v_mfma_f32_16x16x32_bf16 v[184:187], a[200:203], v[48:51], v[184:187]
    v_exp_f32 v47, v47
    v_mfma_f32_16x16x32_bf16 v[188:191], a[204:207], v[48:51], v[188:191]
    v_cvt_pk_bf16_f32 v55, v46, v47
    s_and_b32 s47, s47, 0x3ffff
    v_mfma_f32_16x16x32_bf16 a[96:99], a[108:111], v[48:51], a[96:99]
    s_waitcnt lgkmcnt(0)
    s_barrier
    v_mfma_f32_16x16x32_bf16 v[40:43], a[112:115], a[16:19], v[60:63]
    v_exp_f32 v32, v32
    v_mfma_f32_16x16x32_bf16 v[44:47], a[128:131], a[16:19], v[60:63]
    ds_read_b128 a[144:147], v6
    s_add_u32 m0, s49, 49152
    ds_read_b128 a[160:163], v6 offset:4096
    ds_read_b128 a[148:151], v7
    v_mfma_f32_16x16x32_bf16 v[40:43], a[116:119], a[20:23], v[40:43]
    v_exp_f32 v33, v33
    v_mfma_f32_16x16x32_bf16 v[44:47], a[132:135], a[20:23], v[44:47]
    v_cvt_pk_bf16_f32 v48, v32, v33
    ds_read_b128 a[164:167], v7 offset:4096
    s_add_u32 s48, s46, s47
    ds_read_b128 a[152:155], v8
    v_mfma_f32_16x16x32_bf16 v[40:43], a[120:123], a[24:27], v[40:43]
    v_exp_f32 v34, v34
    v_mfma_f32_16x16x32_bf16 v[44:47], a[136:139], a[24:27], v[44:47]
    ds_read_b128 a[168:171], v8 offset:4096
    s_waitcnt vmcnt(10)
    ds_read_b128 a[156:159], v9
    ds_read_b128 a[172:175], v9 offset:4096
    v_mfma_f32_16x16x32_bf16 v[40:43], a[124:127], a[28:31], v[40:43]
    v_exp_f32 v35, v35
    v_mfma_f32_16x16x32_bf16 v[44:47], a[140:143], a[28:31], v[44:47]
    v_cvt_pk_bf16_f32 v49, v34, v35
    buffer_load_dwordx4 v28, s[4:7], s48 offen nt lds
    s_waitcnt vmcnt(10)
    buffer_load_dwordx4 v29, s[4:7], s48 offen offset:1024 nt lds
    v_mfma_f32_16x16x32_bf16 v[192:195], a[176:179], v[52:55], v[192:195]
    v_exp_f32 v36, v36
    v_mfma_f32_16x16x32_bf16 v[196:199], a[180:183], v[52:55], v[196:199]
    ds_read_b64_tr_b16 a[176:177], v10
    s_waitcnt vmcnt(10)
    ds_read_b64_tr_b16 a[178:179], v10 offset:4096
    v_mfma_f32_16x16x32_bf16 v[200:203], a[184:187], v[52:55], v[200:203]
    v_exp_f32 v37, v37
    v_mfma_f32_16x16x32_bf16 v[204:207], a[188:191], v[52:55], v[204:207]
    v_cvt_pk_bf16_f32 v50, v36, v37
    ds_read_b64_tr_b16 a[180:181], v11
    buffer_load_dwordx4 v30, s[4:7], s48 offen offset:2048 nt lds
    v_mfma_f32_16x16x32_bf16 v[208:211], a[192:195], v[52:55], v[208:211]
    v_exp_f32 v38, v38
    v_mfma_f32_16x16x32_bf16 v[212:215], a[196:199], v[52:55], v[212:215]
    ds_read_b64_tr_b16 a[182:183], v11 offset:4096
    s_waitcnt vmcnt(10)
    ds_read_b64_tr_b16 a[184:185], v12
    v_mfma_f32_16x16x32_bf16 v[216:219], a[200:203], v[52:55], v[216:219]
    v_exp_f32 v39, v39
    v_mfma_f32_16x16x32_bf16 v[220:223], a[204:207], v[52:55], v[220:223]
    v_cvt_pk_bf16_f32 v51, v38, v39
    ds_read_b64_tr_b16 a[186:187], v12 offset:4096
    buffer_load_dwordx4 v31, s[4:7], s48 offen offset:3072 nt lds
    v_mfma_f32_16x16x32_bf16 a[100:103], a[108:111], v[52:55], a[100:103]
    ds_read_b64_tr_b16 a[188:189], v13
    s_xor_b32 m0, m0, 4096
    ds_read_b64_tr_b16 a[190:191], v13 offset:4096
    s_waitcnt lgkmcnt(8)
    v_mfma_f32_16x16x32_bf16 v[32:35], a[144:147], a[0:3], v[56:59]
    v_exp_f32 v40, v40
    v_mfma_f32_16x16x32_bf16 v[36:39], a[160:163], a[0:3], v[56:59]
    ds_read_b64_tr_b16 a[192:193], v14
    s_xor_b32 s48, s48, 4096
    ds_read_b64_tr_b16 a[194:195], v14 offset:4096
    v_mfma_f32_16x16x32_bf16 v[32:35], a[148:151], a[4:7], v[32:35]
    v_exp_f32 v41, v41
    v_mfma_f32_16x16x32_bf16 v[36:39], a[164:167], a[4:7], v[36:39]
    v_cvt_pk_bf16_f32 v52, v40, v41
    ds_read_b64_tr_b16 a[196:197], v15
    s_waitcnt vmcnt(10)
    v_mfma_f32_16x16x32_bf16 v[32:35], a[152:155], a[8:11], v[32:35]
    v_exp_f32 v42, v42
    v_mfma_f32_16x16x32_bf16 v[36:39], a[168:171], a[8:11], v[36:39]
    ds_read_b64_tr_b16 a[198:199], v15 offset:4096
    buffer_load_dwordx4 v28, s[4:7], s48 offen nt lds
    ds_read_b64_tr_b16 a[200:201], v16
    v_mfma_f32_16x16x32_bf16 v[32:35], a[156:159], a[12:15], v[32:35]
    v_exp_f32 v43, v43
    v_mfma_f32_16x16x32_bf16 v[36:39], a[172:175], a[12:15], v[36:39]
    v_cvt_pk_bf16_f32 v53, v42, v43
    ds_read_b64_tr_b16 a[202:203], v16 offset:4096
    s_waitcnt vmcnt(10)
    v_mfma_f32_16x16x32_bf16 v[160:163], a[208:211], v[48:51], v[160:163]
    v_exp_f32 v44, v44
    v_mfma_f32_16x16x32_bf16 v[164:167], a[212:215], v[48:51], v[164:167]
    ds_read_b64_tr_b16 a[204:205], v17
    buffer_load_dwordx4 v29, s[4:7], s48 offen offset:1024 nt lds
    ds_read_b64_tr_b16 a[206:207], v17 offset:4096
    v_mfma_f32_16x16x32_bf16 v[168:171], a[216:219], v[48:51], v[168:171]
    v_exp_f32 v45, v45
    v_mfma_f32_16x16x32_bf16 v[172:175], a[220:223], v[48:51], v[172:175]
    v_cvt_pk_bf16_f32 v54, v44, v45
    s_waitcnt vmcnt(10)
    buffer_load_dwordx4 v30, s[4:7], s48 offen offset:2048 nt lds
    v_mfma_f32_16x16x32_bf16 v[176:179], a[224:227], v[48:51], v[176:179]
    v_exp_f32 v46, v46
    v_mfma_f32_16x16x32_bf16 v[180:183], a[228:231], v[48:51], v[180:183]
    s_waitcnt vmcnt(10)
    buffer_load_dwordx4 v31, s[4:7], s48 offen offset:3072 nt lds
    s_add_u32 s47, s47, s89
    v_mfma_f32_16x16x32_bf16 v[184:187], a[232:235], v[48:51], v[184:187]
    v_exp_f32 v47, v47
    v_mfma_f32_16x16x32_bf16 v[188:191], a[236:239], v[48:51], v[188:191]
    v_cvt_pk_bf16_f32 v55, v46, v47
    s_and_b32 s47, s47, 0x3ffff
    v_mfma_f32_16x16x32_bf16 a[96:99], a[108:111], v[48:51], a[96:99]
    s_mov_b32 s54, 6
L_loop_B01:
    s_waitcnt lgkmcnt(0)
    s_barrier
    v_mfma_f32_16x16x32_bf16 v[40:43], a[144:147], a[16:19], v[60:63]
    v_exp_f32 v32, v32
    v_mfma_f32_16x16x32_bf16 v[44:47], a[160:163], a[16:19], v[60:63]
    ds_read_b128 a[112:115], v6 offset:16384
    s_add_u32 m0, s49, 0
    ds_read_b128 a[128:131], v6 offset:20480
    ds_read_b128 a[116:119], v7 offset:16384
    v_mfma_f32_16x16x32_bf16 v[40:43], a[148:151], a[20:23], v[40:43]
    v_exp_f32 v33, v33
    v_mfma_f32_16x16x32_bf16 v[44:47], a[164:167], a[20:23], v[44:47]
    v_cvt_pk_bf16_f32 v48, v32, v33
    ds_read_b128 a[132:135], v7 offset:20480
    s_add_u32 s48, s46, s47
    ds_read_b128 a[120:123], v8 offset:16384
    v_mfma_f32_16x16x32_bf16 v[40:43], a[152:155], a[24:27], v[40:43]
    v_exp_f32 v34, v34
    v_mfma_f32_16x16x32_bf16 v[44:47], a[168:171], a[24:27], v[44:47]
    ds_read_b128 a[136:139], v8 offset:20480
    s_waitcnt vmcnt(10)
    ds_read_b128 a[124:127], v9 offset:16384
    ds_read_b128 a[140:143], v9 offset:20480
    v_mfma_f32_16x16x32_bf16 v[40:43], a[156:159], a[28:31], v[40:43]
    v_exp_f32 v35, v35
    v_mfma_f32_16x16x32_bf16 v[44:47], a[172:175], a[28:31], v[44:47]
    v_cvt_pk_bf16_f32 v49, v34, v35
    buffer_load_dwordx4 v28, s[4:7], s48 offen nt lds
    s_waitcnt vmcnt(10)
    buffer_load_dwordx4 v29, s[4:7], s48 offen offset:1024 nt lds
    v_mfma_f32_16x16x32_bf16 v[192:195], a[208:211], v[52:55], v[192:195]
    v_exp_f32 v36, v36
    v_mfma_f32_16x16x32_bf16 v[196:199], a[212:215], v[52:55], v[196:199]
    ds_read_b64_tr_b16 a[208:209], v10 offset:16384
    s_waitcnt vmcnt(10)
    ds_read_b64_tr_b16 a[210:211], v10 offset:20480
    v_mfma_f32_16x16x32_bf16 v[200:203], a[216:219], v[52:55], v[200:203]
    v_exp_f32 v37, v37
    v_mfma_f32_16x16x32_bf16 v[204:207], a[220:223], v[52:55], v[204:207]
    v_cvt_pk_bf16_f32 v50, v36, v37
    ds_read_b64_tr_b16 a[212:213], v11 offset:16384
    buffer_load_dwordx4 v30, s[4:7], s48 offen offset:2048 nt lds
    v_mfma_f32_16x16x32_bf16 v[208:211], a[224:227], v[52:55], v[208:211]
    v_exp_f32 v38, v38
    v_mfma_f32_16x16x32_bf16 v[212:215], a[228:231], v[52:55], v[212:215]
    ds_read_b64_tr_b16 a[214:215], v11 offset:20480
    s_waitcnt vmcnt(10)
    ds_read_b64_tr_b16 a[216:217], v12 offset:16384
    v_mfma_f32_16x16x32_bf16 v[216:219], a[232:235], v[52:55], v[216:219]
    v_exp_f32 v39, v39
    v_mfma_f32_16x16x32_bf16 v[220:223], a[236:239], v[52:55], v[220:223]
    v_cvt_pk_bf16_f32 v51, v38, v39
    ds_read_b64_tr_b16 a[218:219], v12 offset:20480
    buffer_load_dwordx4 v31, s[4:7], s48 offen offset:3072 nt lds
    v_mfma_f32_16x16x32_bf16 a[100:103], a[108:111], v[52:55], a[100:103]
    ds_read_b64_tr_b16 a[220:221], v13 offset:16384
    s_xor_b32 m0, m0, 4096
    ds_read_b64_tr_b16 a[222:223], v13 offset:20480
    s_waitcnt lgkmcnt(8)
    v_mfma_f32_16x16x32_bf16 v[32:35], a[112:115], a[0:3], v[56:59]
    v_exp_f32 v40, v40
    v_mfma_f32_16x16x32_bf16 v[36:39], a[128:131], a[0:3], v[56:59]
    ds_read_b64_tr_b16 a[224:225], v14 offset:16384
    s_xor_b32 s48, s48, 4096
    ds_read_b64_tr_b16 a[226:227], v14 offset:20480
    v_mfma_f32_16x16x32_bf16 v[32:35], a[116:119], a[4:7], v[32:35]
    v_exp_f32 v41, v41
    v_mfma_f32_16x16x32_bf16 v[36:39], a[132:135], a[4:7], v[36:39]
    v_cvt_pk_bf16_f32 v52, v40, v41
    ds_read_b64_tr_b16 a[228:229], v15 offset:16384
    s_waitcnt vmcnt(10)
    v_mfma_f32_16x16x32_bf16 v[32:35], a[120:123], a[8:11], v[32:35]
    v_exp_f32 v42, v42
    v_mfma_f32_16x16x32_bf16 v[36:39], a[136:139], a[8:11], v[36:39]
    ds_read_b64_tr_b16 a[230:231], v15 offset:20480
    buffer_load_dwordx4 v28, s[4:7], s48 offen nt lds
    ds_read_b64_tr_b16 a[232:233], v16 offset:16384
    v_mfma_f32_16x16x32_bf16 v[32:35], a[124:127], a[12:15], v[32:35]
    v_exp_f32 v43, v43
    v_mfma_f32_16x16x32_bf16 v[36:39], a[140:143], a[12:15], v[36:39]
    v_cvt_pk_bf16_f32 v53, v42, v43
    ds_read_b64_tr_b16 a[234:235], v16 offset:20480
    s_waitcnt vmcnt(10)
    v_mfma_f32_16x16x32_bf16 v[160:163], a[176:179], v[48:51], v[160:163]
    v_exp_f32 v44, v44
    v_mfma_f32_16x16x32_bf16 v[164:167], a[180:183], v[48:51], v[164:167]
    ds_read_b64_tr_b16 a[236:237], v17 offset:16384
    buffer_load_dwordx4 v29, s[4:7], s48 offen offset:1024 nt lds
    ds_read_b64_tr_b16 a[238:239], v17 offset:20480
    v_mfma_f32_16x16x32_bf16 v[168:171], a[184:187], v[48:51], v[168:171]
    v_exp_f32 v45, v45
    v_mfma_f32_16x16x32_bf16 v[172:175], a[188:191], v[48:51], v[172:175]
    v_cvt_pk_bf16_f32 v54, v44, v45
    s_waitcnt vmcnt(10)
    buffer_load_dwordx4 v30, s[4:7], s48 offen offset:2048 nt lds
    v_mfma_f32_16x16x32_bf16 v[176:179], a[192:195], v[48:51], v[176:179]
    v_exp_f32 v46, v46
    v_mfma_f32_16x16x32_bf16 v[180:183], a[196:199], v[48:51], v[180:183]
    s_waitcnt vmcnt(10)
    buffer_load_dwordx4 v31, s[4:7], s48 offen offset:3072 nt lds
    s_add_u32 s47, s47, s89
    v_mfma_f32_16x16x32_bf16 v[184:187], a[200:203], v[48:51], v[184:187]
    v_exp_f32 v47, v47
    v_mfma_f32_16x16x32_bf16 v[188:191], a[204:207], v[48:51], v[188:191]
    v_cvt_pk_bf16_f32 v55, v46, v47
    s_and_b32 s47, s47, 0x3ffff
    v_mfma_f32_16x16x32_bf16 a[96:99], a[108:111], v[48:51], a[96:99]
    s_waitcnt lgkmcnt(0)
    s_barrier
    v_mfma_f32_16x16x32_bf16 v[40:43], a[112:115], a[16:19], v[60:63]
    v_exp_f32 v32, v32
    v_mfma_f32_16x16x32_bf16 v[44:47], a[128:131], a[16:19], v[60:63]
    ds_read_b128 a[144:147], v6 offset:32768
    s_add_u32 m0, s49, 16384
    ds_read_b128 a[160:163], v6 offset:36864
    ds_read_b128 a[148:151], v7 offset:32768
    v_mfma_f32_16x16x32_bf16 v[40:43], a[116:119], a[20:23], v[40:43]
    v_exp_f32 v33, v33
    v_mfma_f32_16x16x32_bf16 v[44:47], a[132:135], a[20:23], v[44:47]
    v_cvt_pk_bf16_f32 v48, v32, v33
    ds_read_b128 a[164:167], v7 offset:36864
    s_add_u32 s48, s46, s47
    ds_read_b128 a[152:155], v8 offset:32768
    v_mfma_f32_16x16x32_bf16 v[40:43], a[120:123], a[24:27], v[40:43]
    v_exp_f32 v34, v34
    v_mfma_f32_16x16x32_bf16 v[44:47], a[136:139], a[24:27], v[44:47]
    ds_read_b128 a[168:171], v8 offset:36864
    s_waitcnt vmcnt(10)
    ds_read_b128 a[156:159], v9 offset:32768
    ds_read_b128 a[172:175], v9 offset:36864
    v_mfma_f32_16x16x32_bf16 v[40:43], a[124:127], a[28:31], v[40:43]
    v_exp_f32 v35, v35
    v_mfma_f32_16x16x32_bf16 v[44:47], a[140:143], a[28:31], v[44:47]
    v_cvt_pk_bf16_f32 v49, v34, v35
    buffer_load_dwordx4 v28, s[4:7], s48 offen nt lds
    s_waitcnt vmcnt(10)
    buffer_load_dwordx4 v29, s[4:7], s48 offen offset:1024 nt lds
    v_mfma_f32_16x16x32_bf16 v[192:195], a[176:179], v[52:55], v[192:195]
    v_exp_f32 v36, v36
    v_mfma_f32_16x16x32_bf16 v[196:199], a[180:183], v[52:55], v[196:199]
    ds_read_b64_tr_b16 a[176:177], v10 offset:32768
    s_waitcnt vmcnt(10)
    ds_read_b64_tr_b16 a[178:179], v10 offset:36864
    v_mfma_f32_16x16x32_bf16 v[200:203], a[184:187], v[52:55], v[200:203]
    v_exp_f32 v37, v37
    v_mfma_f32_16x16x32_bf16 v[204:207], a[188:191], v[52:55], v[204:207]
    v_cvt_pk_bf16_f32 v50, v36, v37
    ds_read_b64_tr_b16 a[180:181], v11 offset:32768
    buffer_load_dwordx4 v30, s[4:7], s48 offen offset:2048 nt lds
    v_mfma_f32_16x16x32_bf16 v[208:211], a[192:195], v[52:55], v[208:211]
    v_exp_f32 v38, v38
    v_mfma_f32_16x16x32_bf16 v[212:215], a[196:199], v[52:55], v[212:215]
    ds_read_b64_tr_b16 a[182:183], v11 offset:36864
    s_waitcnt vmcnt(10)
    ds_read_b64_tr_b16 a[184:185], v12 offset:32768
    v_mfma_f32_16x16x32_bf16 v[216:219], a[200:203], v[52:55], v[216:219]
    v_exp_f32 v39, v39
    v_mfma_f32_16x16x32_bf16 v[220:223], a[204:207], v[52:55], v[220:223]
    v_cvt_pk_bf16_f32 v51, v38, v39
    ds_read_b64_tr_b16 a[186:187], v12 offset:36864
    buffer_load_dwordx4 v31, s[4:7], s48 offen offset:3072 nt lds
    v_mfma_f32_16x16x32_bf16 a[100:103], a[108:111], v[52:55], a[100:103]
    ds_read_b64_tr_b16 a[188:189], v13 offset:32768
    s_xor_b32 m0, m0, 4096
    ds_read_b64_tr_b16 a[190:191], v13 offset:36864
    s_waitcnt lgkmcnt(8)
    v_mfma_f32_16x16x32_bf16 v[32:35], a[144:147], a[0:3], v[56:59]
    v_exp_f32 v40, v40
    v_mfma_f32_16x16x32_bf16 v[36:39], a[160:163], a[0:3], v[56:59]
    ds_read_b64_tr_b16 a[192:193], v14 offset:32768
    s_xor_b32 s48, s48, 4096
    ds_read_b64_tr_b16 a[194:195], v14 offset:36864
    v_mfma_f32_16x16x32_bf16 v[32:35], a[148:151], a[4:7], v[32:35]
    v_exp_f32 v41, v41
    v_mfma_f32_16x16x32_bf16 v[36:39], a[164:167], a[4:7], v[36:39]
    v_cvt_pk_bf16_f32 v52, v40, v41
    ds_read_b64_tr_b16 a[196:197], v15 offset:32768
    s_waitcnt vmcnt(10)
    v_mfma_f32_16x16x32_bf16 v[32:35], a[152:155], a[8:11], v[32:35]
    v_exp_f32 v42, v42
    v_mfma_f32_16x16x32_bf16 v[36:39], a[168:171], a[8:11], v[36:39]
    ds_read_b64_tr_b16 a[198:199], v15 offset:36864
    buffer_load_dwordx4 v28, s[4:7], s48 offen nt lds
    ds_read_b64_tr_b16 a[200:201], v16 offset:32768
    v_mfma_f32_16x16x32_bf16 v[32:35], a[156:159], a[12:15], v[32:35]
    v_exp_f32 v43, v43
    v_mfma_f32_16x16x32_bf16 v[36:39], a[172:175], a[12:15], v[36:39]
    v_cvt_pk_bf16_f32 v53, v42, v43
    ds_read_b64_tr_b16 a[202:203], v16 offset:36864
    s_waitcnt vmcnt(10)
    v_mfma_f32_16x16x32_bf16 v[160:163], a[208:211], v[48:51], v[160:163]
    v_exp_f32 v44, v44
    v_mfma_f32_16x16x32_bf16 v[164:167], a[212:215], v[48:51], v[164:167]
    ds_read_b64_tr_b16 a[204:205], v17 offset:32768
    buffer_load_dwordx4 v29, s[4:7], s48 offen offset:1024 nt lds
    ds_read_b64_tr_b16 a[206:207], v17 offset:36864
    v_mfma_f32_16x16x32_bf16 v[168:171], a[216:219], v[48:51], v[168:171]
    v_exp_f32 v45, v45
    v_mfma_f32_16x16x32_bf16 v[172:175], a[220:223], v[48:51], v[172:175]
    v_cvt_pk_bf16_f32 v54, v44, v45
    s_waitcnt vmcnt(10)
    buffer_load_dwordx4 v30, s[4:7], s48 offen offset:2048 nt lds
    v_mfma_f32_16x16x32_bf16 v[176:179], a[224:227], v[48:51], v[176:179]
    v_exp_f32 v46, v46
    v_mfma_f32_16x16x32_bf16 v[180:183], a[228:231], v[48:51], v[180:183]
    s_waitcnt vmcnt(10)
    buffer_load_dwordx4 v31, s[4:7], s48 offen offset:3072 nt lds
    s_add_u32 s47, s47, s89
    v_mfma_f32_16x16x32_bf16 v[184:187], a[232:235], v[48:51], v[184:187]
    v_exp_f32 v47, v47
    v_mfma_f32_16x16x32_bf16 v[188:191], a[236:239], v[48:51], v[188:191]
    v_cvt_pk_bf16_f32 v55, v46, v47
    s_and_b32 s47, s47, 0x3ffff
    v_mfma_f32_16x16x32_bf16 a[96:99], a[108:111], v[48:51], a[96:99]
    s_waitcnt lgkmcnt(0)
    s_barrier
    v_mfma_f32_16x16x32_bf16 v[40:43], a[144:147], a[16:19], v[60:63]
    v_exp_f32 v32, v32
    v_mfma_f32_16x16x32_bf16 v[44:47], a[160:163], a[16:19], v[60:63]
    ds_read_b128 a[112:115], v6 offset:49152
    s_add_u32 m0, s49, 32768
    ds_read_b128 a[128:131], v6 offset:53248
    ds_read_b128 a[116:119], v7 offset:49152
    v_mfma_f32_16x16x32_bf16 v[40:43], a[148:151], a[20:23], v[40:43]
    v_exp_f32 v33, v33
    v_mfma_f32_16x16x32_bf16 v[44:47], a[164:167], a[20:23], v[44:47]
    v_cvt_pk_bf16_f32 v48, v32, v33
    ds_read_b128 a[132:135], v7 offset:53248
    s_add_u32 s48, s46, s47
    ds_read_b128 a[120:123], v8 offset:49152
    v_mfma_f32_16x16x32_bf16 v[40:43], a[152:155], a[24:27], v[40:43]
    v_exp_f32 v34, v34
    v_mfma_f32_16x16x32_bf16 v[44:47], a[168:171], a[24:27], v[44:47]
    ds_read_b128 a[136:139], v8 offset:53248
    s_waitcnt vmcnt(10)
    ds_read_b128 a[124:127], v9 offset:49152
    ds_read_b128 a[140:143], v9 offset:53248
    v_mfma_f32_16x16x32_bf16 v[40:43], a[156:159], a[28:31], v[40:43]
    v_exp_f32 v35, v35
    v_mfma_f32_16x16x32_bf16 v[44:47], a[172:175], a[28:31], v[44:47]
    v_cvt_pk_bf16_f32 v49, v34, v35
    buffer_load_dwordx4 v28, s[4:7], s48 offen nt lds
    s_waitcnt vmcnt(10)
    buffer_load_dwordx4 v29, s[4:7], s48 offen offset:1024 nt lds
    v_mfma_f32_16x16x32_bf16 v[192:195], a[208:211], v[52:55], v[192:195]
    v_exp_f32 v36, v36
    v_mfma_f32_16x16x32_bf16 v[196:199], a[212:215], v[52:55], v[196:199]
    ds_read_b64_tr_b16 a[208:209], v10 offset:49152
    s_waitcnt vmcnt(10)
    ds_read_b64_tr_b16 a[210:211], v10 offset:53248
    v_mfma_f32_16x16x32_bf16 v[200:203], a[216:219], v[52:55], v[200:203]
    v_exp_f32 v37, v37
    v_mfma_f32_16x16x32_bf16 v[204:207], a[220:223], v[52:55], v[204:207]
    v_cvt_pk_bf16_f32 v50, v36, v37
    ds_read_b64_tr_b16 a[212:213], v11 offset:49152
    buffer_load_dwordx4 v30, s[4:7], s48 offen offset:2048 nt lds
    v_mfma_f32_16x16x32_bf16 v[208:211], a[224:227], v[52:55], v[208:211]
    v_exp_f32 v38, v38
    v_mfma_f32_16x16x32_bf16 v[212:215], a[228:231], v[52:55], v[212:215]
    ds_read_b64_tr_b16 a[214:215], v11 offset:53248
    s_waitcnt vmcnt(10)
    ds_read_b64_tr_b16 a[216:217], v12 offset:49152
    v_mfma_f32_16x16x32_bf16 v[216:219], a[232:235], v[52:55], v[216:219]
    v_exp_f32 v39, v39
    v_mfma_f32_16x16x32_bf16 v[220:223], a[236:239], v[52:55], v[220:223]
    v_cvt_pk_bf16_f32 v51, v38, v39
    ds_read_b64_tr_b16 a[218:219], v12 offset:53248
    buffer_load_dwordx4 v31, s[4:7], s48 offen offset:3072 nt lds
    v_mfma_f32_16x16x32_bf16 a[100:103], a[108:111], v[52:55], a[100:103]
    ds_read_b64_tr_b16 a[220:221], v13 offset:49152
    s_xor_b32 m0, m0, 4096
    ds_read_b64_tr_b16 a[222:223], v13 offset:53248
    s_waitcnt lgkmcnt(8)
    v_mfma_f32_16x16x32_bf16 v[32:35], a[112:115], a[0:3], v[56:59]
    v_exp_f32 v40, v40
    v_mfma_f32_16x16x32_bf16 v[36:39], a[128:131], a[0:3], v[56:59]
    ds_read_b64_tr_b16 a[224:225], v14 offset:49152
    s_xor_b32 s48, s48, 4096
    ds_read_b64_tr_b16 a[226:227], v14 offset:53248
    v_mfma_f32_16x16x32_bf16 v[32:35], a[116:119], a[4:7], v[32:35]
    v_exp_f32 v41, v41
    v_mfma_f32_16x16x32_bf16 v[36:39], a[132:135], a[4:7], v[36:39]
    v_cvt_pk_bf16_f32 v52, v40, v41
    ds_read_b64_tr_b16 a[228:229], v15 offset:49152
    s_waitcnt vmcnt(10)
    v_mfma_f32_16x16x32_bf16 v[32:35], a[120:123], a[8:11], v[32:35]
    v_exp_f32 v42, v42
    v_mfma_f32_16x16x32_bf16 v[36:39], a[136:139], a[8:11], v[36:39]
    ds_read_b64_tr_b16 a[230:231], v15 offset:53248
    buffer_load_dwordx4 v28, s[4:7], s48 offen nt lds
    ds_read_b64_tr_b16 a[232:233], v16 offset:49152
    v_mfma_f32_16x16x32_bf16 v[32:35], a[124:127], a[12:15], v[32:35]
    v_exp_f32 v43, v43
    v_mfma_f32_16x16x32_bf16 v[36:39], a[140:143], a[12:15], v[36:39]
    v_cvt_pk_bf16_f32 v53, v42, v43
    ds_read_b64_tr_b16 a[234:235], v16 offset:53248
    s_waitcnt vmcnt(10)
    v_mfma_f32_16x16x32_bf16 v[160:163], a[176:179], v[48:51], v[160:163]
    v_exp_f32 v44, v44
    v_mfma_f32_16x16x32_bf16 v[164:167], a[180:183], v[48:51], v[164:167]
    ds_read_b64_tr_b16 a[236:237], v17 offset:49152
    buffer_load_dwordx4 v29, s[4:7], s48 offen offset:1024 nt lds
    ds_read_b64_tr_b16 a[238:239], v17 offset:53248
    v_mfma_f32_16x16x32_bf16 v[168:171], a[184:187], v[48:51], v[168:171]
    v_exp_f32 v45, v45
    v_mfma_f32_16x16x32_bf16 v[172:175], a[188:191], v[48:51], v[172:175]
    v_cvt_pk_bf16_f32 v54, v44, v45
    s_waitcnt vmcnt(10)
    buffer_load_dwordx4 v30, s[4:7], s48 offen offset:2048 nt lds
    v_mfma_f32_16x16x32_bf16 v[176:179], a[192:195], v[48:51], v[176:179]
    v_exp_f32 v46, v46
    v_mfma_f32_16x16x32_bf16 v[180:183], a[196:199], v[48:51], v[180:183]
    s_waitcnt vmcnt(10)
    buffer_load_dwordx4 v31, s[4:7], s48 offen offset:3072 nt lds
    s_add_u32 s47, s47, s89
    v_mfma_f32_16x16x32_bf16 v[184:187], a[200:203], v[48:51], v[184:187]
    v_exp_f32 v47, v47
    v_mfma_f32_16x16x32_bf16 v[188:191], a[204:207], v[48:51], v[188:191]
    v_cvt_pk_bf16_f32 v55, v46, v47
    s_and_b32 s47, s47, 0x3ffff
    v_mfma_f32_16x16x32_bf16 a[96:99], a[108:111], v[48:51], a[96:99]
    s_waitcnt lgkmcnt(0)
    s_barrier
    v_mfma_f32_16x16x32_bf16 v[40:43], a[112:115], a[16:19], v[60:63]
    v_exp_f32 v32, v32
    v_mfma_f32_16x16x32_bf16 v[44:47], a[128:131], a[16:19], v[60:63]
    ds_read_b128 a[144:147], v6
    s_add_u32 m0, s49, 49152
    ds_read_b128 a[160:163], v6 offset:4096
    ds_read_b128 a[148:151], v7
    v_mfma_f32_16x16x32_bf16 v[40:43], a[116:119], a[20:23], v[40:43]
    v_exp_f32 v33, v33
    v_mfma_f32_16x16x32_bf16 v[44:47], a[132:135], a[20:23], v[44:47]
    v_cvt_pk_bf16_f32 v48, v32, v33
    ds_read_b128 a[164:167], v7 offset:4096
    s_add_u32 s48, s46, s47
    ds_read_b128 a[152:155], v8
    v_mfma_f32_16x16x32_bf16 v[40:43], a[120:123], a[24:27], v[40:43]
    v_exp_f32 v34, v34
    v_mfma_f32_16x16x32_bf16 v[44:47], a[136:139], a[24:27], v[44:47]
    ds_read_b128 a[168:171], v8 offset:4096
    s_waitcnt vmcnt(10)
    ds_read_b128 a[156:159], v9
    ds_read_b128 a[172:175], v9 offset:4096
    v_mfma_f32_16x16x32_bf16 v[40:43], a[124:127], a[28:31], v[40:43]
    v_exp_f32 v35, v35
    v_mfma_f32_16x16x32_bf16 v[44:47], a[140:143], a[28:31], v[44:47]
    v_cvt_pk_bf16_f32 v49, v34, v35
    buffer_load_dwordx4 v28, s[4:7], s48 offen nt lds
    s_waitcnt vmcnt(10)
    buffer_load_dwordx4 v29, s[4:7], s48 offen offset:1024 nt lds
    v_mfma_f32_16x16x32_bf16 v[192:195], a[176:179], v[52:55], v[192:195]
    v_exp_f32 v36, v36
    v_mfma_f32_16x16x32_bf16 v[196:199], a[180:183], v[52:55], v[196:199]
    ds_read_b64_tr_b16 a[176:177], v10
    s_waitcnt vmcnt(10)
    ds_read_b64_tr_b16 a[178:179], v10 offset:4096
    v_mfma_f32_16x16x32_bf16 v[200:203], a[184:187], v[52:55], v[200:203]
    v_exp_f32 v37, v37
    v_mfma_f32_16x16x32_bf16 v[204:207], a[188:191], v[52:55], v[204:207]
    v_cvt_pk_bf16_f32 v50, v36, v37
    ds_read_b64_tr_b16 a[180:181], v11
    buffer_load_dwordx4 v30, s[4:7], s48 offen offset:2048 nt lds
    v_mfma_f32_16x16x32_bf16 v[208:211], a[192:195], v[52:55], v[208:211]
    v_exp_f32 v38, v38
    v_mfma_f32_16x16x32_bf16 v[212:215], a[196:199], v[52:55], v[212:215]
    ds_read_b64_tr_b16 a[182:183], v11 offset:4096
    s_waitcnt vmcnt(10)
    ds_read_b64_tr_b16 a[184:185], v12
    v_mfma_f32_16x16x32_bf16 v[216:219], a[200:203], v[52:55], v[216:219]
    v_exp_f32 v39, v39
    v_mfma_f32_16x16x32_bf16 v[220:223], a[204:207], v[52:55], v[220:223]
    v_cvt_pk_bf16_f32 v51, v38, v39
    ds_read_b64_tr_b16 a[186:187], v12 offset:4096
    buffer_load_dwordx4 v31, s[4:7], s48 offen offset:3072 nt lds
    v_mfma_f32_16x16x32_bf16 a[100:103], a[108:111], v[52:55], a[100:103]
    ds_read_b64_tr_b16 a[188:189], v13
    s_xor_b32 m0, m0, 4096
    ds_read_b64_tr_b16 a[190:191], v13 offset:4096
    s_waitcnt lgkmcnt(8)
    v_mfma_f32_16x16x32_bf16 v[32:35], a[144:147], a[0:3], v[56:59]
    v_exp_f32 v40, v40
    v_mfma_f32_16x16x32_bf16 v[36:39], a[160:163], a[0:3], v[56:59]
    ds_read_b64_tr_b16 a[192:193], v14
    s_xor_b32 s48, s48, 4096
    ds_read_b64_tr_b16 a[194:195], v14 offset:4096
    v_mfma_f32_16x16x32_bf16 v[32:35], a[148:151], a[4:7], v[32:35]
    v_exp_f32 v41, v41
    v_mfma_f32_16x16x32_bf16 v[36:39], a[164:167], a[4:7], v[36:39]
    v_cvt_pk_bf16_f32 v52, v40, v41
    ds_read_b64_tr_b16 a[196:197], v15
    s_waitcnt vmcnt(10)
    v_mfma_f32_16x16x32_bf16 v[32:35], a[152:155], a[8:11], v[32:35]
    v_exp_f32 v42, v42
    v_mfma_f32_16x16x32_bf16 v[36:39], a[168:171], a[8:11], v[36:39]
    ds_read_b64_tr_b16 a[198:199], v15 offset:4096
    buffer_load_dwordx4 v28, s[4:7], s48 offen nt lds
    ds_read_b64_tr_b16 a[200:201], v16
    v_mfma_f32_16x16x32_bf16 v[32:35], a[156:159], a[12:15], v[32:35]
    v_exp_f32 v43, v43
    v_mfma_f32_16x16x32_bf16 v[36:39], a[172:175], a[12:15], v[36:39]
    v_cvt_pk_bf16_f32 v53, v42, v43
    ds_read_b64_tr_b16 a[202:203], v16 offset:4096
    s_waitcnt vmcnt(10)
    v_mfma_f32_16x16x32_bf16 v[160:163], a[208:211], v[48:51], v[160:163]
    v_exp_f32 v44, v44
    v_mfma_f32_16x16x32_bf16 v[164:167], a[212:215], v[48:51], v[164:167]
    ds_read_b64_tr_b16 a[204:205], v17
    buffer_load_dwordx4 v29, s[4:7], s48 offen offset:1024 nt lds
    ds_read_b64_tr_b16 a[206:207], v17 offset:4096
    v_mfma_f32_16x16x32_bf16 v[168:171], a[216:219], v[48:51], v[168:171]
    v_exp_f32 v45, v45
    v_mfma_f32_16x16x32_bf16 v[172:175], a[220:223], v[48:51], v[172:175]
    v_cvt_pk_bf16_f32 v54, v44, v45
    s_waitcnt vmcnt(10)
    buffer_load_dwordx4 v30, s[4:7], s48 offen offset:2048 nt lds
    v_mfma_f32_16x16x32_bf16 v[176:179], a[224:227], v[48:51], v[176:179]
    v_exp_f32 v46, v46
    v_mfma_f32_16x16x32_bf16 v[180:183], a[228:231], v[48:51], v[180:183]
    s_waitcnt vmcnt(10)
    buffer_load_dwordx4 v31, s[4:7], s48 offen offset:3072 nt lds
    s_add_u32 s47, s47, s89
    v_mfma_f32_16x16x32_bf16 v[184:187], a[232:235], v[48:51], v[184:187]
    v_exp_f32 v47, v47
    v_mfma_f32_16x16x32_bf16 v[188:191], a[236:239], v[48:51], v[188:191]
    v_cvt_pk_bf16_f32 v55, v46, v47
    s_and_b32 s47, s47, 0x3ffff
    v_mfma_f32_16x16x32_bf16 a[96:99], a[108:111], v[48:51], a[96:99]
    s_sub_u32 s54, s54, 1
    s_cmp_lg_u32 s54, 0
    s_cbranch_scc1 L_loop_B01
    s_waitcnt lgkmcnt(0)
    s_barrier
    v_mfma_f32_16x16x32_bf16 v[40:43], a[144:147], a[16:19], v[60:63]
    v_exp_f32 v32, v32
    v_mfma_f32_16x16x32_bf16 v[44:47], a[160:163], a[16:19], v[60:63]
    ds_read_b128 a[112:115], v6 offset:16384
    s_xor_b32 s46, s46, 262144
    ds_read_b128 a[128:131], v6 offset:20480
    ds_read_b128 a[116:119], v7 offset:16384
    v_mfma_f32_16x16x32_bf16 v[40:43], a[148:151], a[20:23], v[40:43]
    v_exp_f32 v33, v33
    v_mfma_f32_16x16x32_bf16 v[44:47], a[164:167], a[20:23], v[44:47]
    v_cvt_pk_bf16_f32 v48, v32, v33
    ds_read_b128 a[132:135], v7 offset:20480
    s_add_u32 m0, s49, 0
    ds_read_b128 a[120:123], v8 offset:16384
    v_mfma_f32_16x16x32_bf16 v[40:43], a[152:155], a[24:27], v[40:43]
    v_exp_f32 v34, v34
    v_mfma_f32_16x16x32_bf16 v[44:47], a[168:171], a[24:27], v[44:47]
    ds_read_b128 a[136:139], v8 offset:20480
    s_add_u32 s48, s46, s47
    ds_read_b128 a[124:127], v9 offset:16384
    ds_read_b128 a[140:143], v9 offset:20480
    v_mfma_f32_16x16x32_bf16 v[40:43], a[156:159], a[28:31], v[40:43]
    v_exp_f32 v35, v35
    v_mfma_f32_16x16x32_bf16 v[44:47], a[172:175], a[28:31], v[44:47]
    v_cvt_pk_bf16_f32 v49, v34, v35
    s_waitcnt vmcnt(10)
    buffer_load_dwordx4 v28, s[4:7], s48 offen nt lds
    s_waitcnt vmcnt(10)
    v_mfma_f32_16x16x32_bf16 v[192:195], a[208:211], v[52:55], v[192:195]
    v_exp_f32 v36, v36
    v_mfma_f32_16x16x32_bf16 v[196:199], a[212:215], v[52:55], v[196:199]
    ds_read_b64_tr_b16 a[208:209], v10 offset:16384
    buffer_load_dwordx4 v29, s[4:7], s48 offen offset:1024 nt lds
    ds_read_b64_tr_b16 a[210:211], v10 offset:20480
    ds_read_b64_tr_b16 a[212:213], v11 offset:16384
    v_mfma_f32_16x16x32_bf16 v[200:203], a[216:219], v[52:55], v[200:203]
    v_exp_f32 v37, v37
    v_mfma_f32_16x16x32_bf16 v[204:207], a[220:223], v[52:55], v[204:207]
    v_cvt_pk_bf16_f32 v50, v36, v37
    ds_read_b64_tr_b16 a[214:215], v11 offset:20480
    s_waitcnt vmcnt(10)
    v_mfma_f32_16x16x32_bf16 v[208:211], a[224:227], v[52:55], v[208:211]
    v_exp_f32 v38, v38
    v_mfma_f32_16x16x32_bf16 v[212:215], a[228:231], v[52:55], v[212:215]
    ds_read_b64_tr_b16 a[216:217], v12 offset:16384
    buffer_load_dwordx4 v30, s[4:7], s48 offen offset:2048 nt lds
    ds_read_b64_tr_b16 a[218:219], v12 offset:20480
    v_mfma_f32_16x16x32_bf16 v[216:219], a[232:235], v[52:55], v[216:219]
    v_exp_f32 v39, v39
    v_mfma_f32_16x16x32_bf16 v[220:223], a[236:239], v[52:55], v[220:223]
    v_cvt_pk_bf16_f32 v51, v38, v39
    ds_read_b64_tr_b16 a[220:221], v13 offset:16384
    s_waitcnt vmcnt(10)
    v_mfma_f32_16x16x32_bf16 a[100:103], a[108:111], v[52:55], a[100:103]
    ds_read_b64_tr_b16 a[222:223], v13 offset:20480
    buffer_load_dwordx4 v31, s[4:7], s48 offen offset:3072 nt lds
    ds_read_b64_tr_b16 a[224:225], v14 offset:16384
    s_waitcnt lgkmcnt(9)
    v_mfma_f32_16x16x32_bf16 v[32:35], a[112:115], a[0:3], v[56:59]
    v_exp_f32 v40, v40
    v_mfma_f32_16x16x32_bf16 v[36:39], a[128:131], a[0:3], v[56:59]
    ds_read_b64_tr_b16 a[226:227], v14 offset:20480
    s_xor_b32 m0, m0, 4096
    ds_read_b64_tr_b16 a[228:229], v15 offset:16384
    v_mfma_f32_16x16x32_bf16 v[32:35], a[116:119], a[4:7], v[32:35]
    v_exp_f32 v41, v41
    v_mfma_f32_16x16x32_bf16 v[36:39], a[132:135], a[4:7], v[36:39]
    v_cvt_pk_bf16_f32 v52, v40, v41
    ds_read_b64_tr_b16 a[230:231], v15 offset:20480
    s_xor_b32 s48, s48, 4096
    v_mfma_f32_16x16x32_bf16 v[32:35], a[120:123], a[8:11], v[32:35]
    v_exp_f32 v42, v42
    v_mfma_f32_16x16x32_bf16 v[36:39], a[136:139], a[8:11], v[36:39]
    ds_read_b64_tr_b16 a[232:233], v16 offset:16384
    s_waitcnt vmcnt(10)
    ds_read_b64_tr_b16 a[234:235], v16 offset:20480
    v_mfma_f32_16x16x32_bf16 v[32:35], a[124:127], a[12:15], v[32:35]
    v_exp_f32 v43, v43
    v_mfma_f32_16x16x32_bf16 v[36:39], a[140:143], a[12:15], v[36:39]
    v_cvt_pk_bf16_f32 v53, v42, v43
    ds_read_b64_tr_b16 a[236:237], v17 offset:16384
    buffer_load_dwordx4 v28, s[4:7], s48 offen nt lds
    v_mfma_f32_16x16x32_bf16 v[160:163], a[176:179], v[48:51], v[160:163]
    v_exp_f32 v44, v44
    v_mfma_f32_16x16x32_bf16 v[164:167], a[180:183], v[48:51], v[164:167]
    ds_read_b64_tr_b16 a[238:239], v17 offset:20480
    s_waitcnt vmcnt(10)
    buffer_load_dwordx4 v29, s[4:7], s48 offen offset:1024 nt lds
    v_mfma_f32_16x16x32_bf16 v[168:171], a[184:187], v[48:51], v[168:171]
    v_exp_f32 v45, v45
    v_mfma_f32_16x16x32_bf16 v[172:175], a[188:191], v[48:51], v[172:175]
    v_cvt_pk_bf16_f32 v54, v44, v45
    s_waitcnt vmcnt(10)
    buffer_load_dwordx4 v30, s[4:7], s48 offen offset:2048 nt lds
    v_mfma_f32_16x16x32_bf16 v[176:179], a[192:195], v[48:51], v[176:179]
    v_exp_f32 v46, v46
    v_mfma_f32_16x16x32_bf16 v[180:183], a[196:199], v[48:51], v[180:183]
    s_waitcnt vmcnt(10)
    buffer_load_dwordx4 v31, s[4:7], s48 offen offset:3072 nt lds
    s_add_u32 s47, s47, s89
    v_mfma_f32_16x16x32_bf16 v[184:187], a[200:203], v[48:51], v[184:187]
    v_exp_f32 v47, v47
    v_mfma_f32_16x16x32_bf16 v[188:191], a[204:207], v[48:51], v[188:191]
    v_cvt_pk_bf16_f32 v55, v46, v47
    s_and_b32 s47, s47, 0x3ffff
    v_mfma_f32_16x16x32_bf16 a[96:99], a[108:111], v[48:51], a[96:99]
    s_waitcnt lgkmcnt(0)
    s_barrier
    v_mfma_f32_16x16x32_bf16 v[40:43], a[112:115], a[16:19], v[60:63]
    v_exp_f32 v32, v32
    v_mfma_f32_16x16x32_bf16 v[44:47], a[128:131], a[16:19], v[60:63]
    ds_read_b128 a[144:147], v6 offset:32768
    s_add_u32 m0, s49, 16384
    ds_read_b128 a[160:163], v6 offset:36864
    ds_read_b128 a[148:151], v7 offset:32768
    v_mfma_f32_16x16x32_bf16 v[40:43], a[116:119], a[20:23], v[40:43]
    v_exp_f32 v33, v33
    v_mfma_f32_16x16x32_bf16 v[44:47], a[132:135], a[20:23], v[44:47]
    v_cvt_pk_bf16_f32 v48, v32, v33
    ds_read_b128 a[164:167], v7 offset:36864
    s_add_u32 s48, s46, s47
    ds_read_b128 a[152:155], v8 offset:32768
    v_mfma_f32_16x16x32_bf16 v[40:43], a[120:123], a[24:27], v[40:43]
    v_exp_f32 v34, v34
    v_mfma_f32_16x16x32_bf16 v[44:47], a[136:139], a[24:27], v[44:47]
    ds_read_b128 a[168:171], v8 offset:36864
    s_waitcnt vmcnt(10)
    ds_read_b128 a[156:159], v9 offset:32768
    ds_read_b128 a[172:175], v9 offset:36864
    v_mfma_f32_16x16x32_bf16 v[40:43], a[124:127], a[28:31], v[40:43]
    v_exp_f32 v35, v35
    v_mfma_f32_16x16x32_bf16 v[44:47], a[140:143], a[28:31], v[44:47]
    v_cvt_pk_bf16_f32 v49, v34, v35
    buffer_load_dwordx4 v28, s[4:7], s48 offen nt lds
    s_waitcnt vmcnt(10)
    buffer_load_dwordx4 v29, s[4:7], s48 offen offset:1024 nt lds
    v_mfma_f32_16x16x32_bf16 v[192:195], a[176:179], v[52:55], v[192:195]
    v_exp_f32 v36, v36
    v_mfma_f32_16x16x32_bf16 v[196:199], a[180:183], v[52:55], v[196:199]
    ds_read_b64_tr_b16 a[176:177], v10 offset:32768
    s_waitcnt vmcnt(10)
    ds_read_b64_tr_b16 a[178:179], v10 offset:36864
    v_mfma_f32_16x16x32_bf16 v[200:203], a[184:187], v[52:55], v[200:203]
    v_exp_f32 v37, v37
    v_mfma_f32_16x16x32_bf16 v[204:207], a[188:191], v[52:55], v[204:207]
    v_cvt_pk_bf16_f32 v50, v36, v37
    ds_read_b64_tr_b16 a[180:181], v11 offset:32768
    buffer_load_dwordx4 v30, s[4:7], s48 offen offset:2048 nt lds
    v_mfma_f32_16x16x32_bf16 v[208:211], a[192:195], v[52:55], v[208:211]
    v_exp_f32 v38, v38
    v_mfma_f32_16x16x32_bf16 v[212:215], a[196:199], v[52:55], v[212:215]
    ds_read_b64_tr_b16 a[182:183], v11 offset:36864
    s_waitcnt vmcnt(10)
    ds_read_b64_tr_b16 a[184:185], v12 offset:32768
    v_mfma_f32_16x16x32_bf16 v[216:219], a[200:203], v[52:55], v[216:219]
    v_exp_f32 v39, v39
    v_mfma_f32_16x16x32_bf16 v[220:223], a[204:207], v[52:55], v[220:223]
    v_cvt_pk_bf16_f32 v51, v38, v39
    ds_read_b64_tr_b16 a[186:187], v12 offset:36864
    buffer_load_dwordx4 v31, s[4:7], s48 offen offset:3072 nt lds
    v_mfma_f32_16x16x32_bf16 a[100:103], a[108:111], v[52:55], a[100:103]
    ds_read_b64_tr_b16 a[188:189], v13 offset:32768
    s_xor_b32 m0, m0, 4096
    ds_read_b64_tr_b16 a[190:191], v13 offset:36864
    s_waitcnt lgkmcnt(8)
    v_mfma_f32_16x16x32_bf16 v[32:35], a[144:147], a[0:3], v[56:59]
    v_exp_f32 v40, v40
    v_mfma_f32_16x16x32_bf16 v[36:39], a[160:163], a[0:3], v[56:59]
    ds_read_b64_tr_b16 a[192:193], v14 offset:32768
    s_xor_b32 s48, s48, 4096
    ds_read_b64_tr_b16 a[194:195], v14 offset:36864
    v_mfma_f32_16x16x32_bf16 v[32:35], a[148:151], a[4:7], v[32:35]
    v_exp_f32 v41, v41
    v_mfma_f32_16x16x32_bf16 v[36:39], a[164:167], a[4:7], v[36:39]
    v_cvt_pk_bf16_f32 v52, v40, v41
    ds_read_b64_tr_b16 a[196:197], v15 offset:32768
    s_waitcnt vmcnt(10)
    v_mfma_f32_16x16x32_bf16 v[32:35], a[152:155], a[8:11], v[32:35]
    v_exp_f32 v42, v42
    v_mfma_f32_16x16x32_bf16 v[36:39], a[168:171], a[8:11], v[36:39]
    ds_read_b64_tr_b16 a[198:199], v15 offset:36864
    buffer_load_dwordx4 v28, s[4:7], s48 offen nt lds
    ds_read_b64_tr_b16 a[200:201], v16 offset:32768
    v_mfma_f32_16x16x32_bf16 v[32:35], a[156:159], a[12:15], v[32:35]
    v_exp_f32 v43, v43
    v_mfma_f32_16x16x32_bf16 v[36:39], a[172:175], a[12:15], v[36:39]
    v_cvt_pk_bf16_f32 v53, v42, v43
    ds_read_b64_tr_b16 a[202:203], v16 offset:36864
    s_waitcnt vmcnt(10)
    v_mfma_f32_16x16x32_bf16 v[160:163], a[208:211], v[48:51], v[160:163]
    v_exp_f32 v44, v44
    v_mfma_f32_16x16x32_bf16 v[164:167], a[212:215], v[48:51], v[164:167]
    ds_read_b64_tr_b16 a[204:205], v17 offset:32768
    buffer_load_dwordx4 v29, s[4:7], s48 offen offset:1024 nt lds
    ds_read_b64_tr_b16 a[206:207], v17 offset:36864
    v_mfma_f32_16x16x32_bf16 v[168:171], a[216:219], v[48:51], v[168:171]
    v_exp_f32 v45, v45
    v_mfma_f32_16x16x32_bf16 v[172:175], a[220:223], v[48:51], v[172:175]
    v_cvt_pk_bf16_f32 v54, v44, v45
    s_waitcnt vmcnt(10)
    buffer_load_dwordx4 v30, s[4:7], s48 offen offset:2048 nt lds
    v_mfma_f32_16x16x32_bf16 v[176:179], a[224:227], v[48:51], v[176:179]
    v_exp_f32 v46, v46
    v_mfma_f32_16x16x32_bf16 v[180:183], a[228:231], v[48:51], v[180:183]
    s_waitcnt vmcnt(10)
    buffer_load_dwordx4 v31, s[4:7], s48 offen offset:3072 nt lds
    s_add_u32 s47, s47, s89
    v_mfma_f32_16x16x32_bf16 v[184:187], a[232:235], v[48:51], v[184:187]
    v_exp_f32 v47, v47
    v_mfma_f32_16x16x32_bf16 v[188:191], a[236:239], v[48:51], v[188:191]
    v_cvt_pk_bf16_f32 v55, v46, v47
    s_and_b32 s47, s47, 0x3ffff
    v_mfma_f32_16x16x32_bf16 a[96:99], a[108:111], v[48:51], a[96:99]
    s_waitcnt lgkmcnt(0)
    s_barrier
    v_mfma_f32_16x16x32_bf16 v[40:43], a[144:147], a[16:19], v[60:63]
    v_exp_f32 v32, v32
    v_mfma_f32_16x16x32_bf16 v[44:47], a[160:163], a[16:19], v[60:63]
    ds_read_b128 a[112:115], v6 offset:49152
    s_add_u32 m0, s49, 32768
    ds_read_b128 a[128:131], v6 offset:53248
    ds_read_b128 a[116:119], v7 offset:49152
    v_mfma_f32_16x16x32_bf16 v[40:43], a[148:151], a[20:23], v[40:43]
    v_exp_f32 v33, v33
    v_mfma_f32_16x16x32_bf16 v[44:47], a[164:167], a[20:23], v[44:47]
    v_cvt_pk_bf16_f32 v48, v32, v33
    ds_read_b128 a[132:135], v7 offset:53248
    s_add_u32 s48, s46, s47
    ds_read_b128 a[120:123], v8 offset:49152
    v_mfma_f32_16x16x32_bf16 v[40:43], a[152:155], a[24:27], v[40:43]
    v_exp_f32 v34, v34
    v_mfma_f32_16x16x32_bf16 v[44:47], a[168:171], a[24:27], v[44:47]
    ds_read_b128 a[136:139], v8 offset:53248
    s_waitcnt vmcnt(10)
    ds_read_b128 a[124:127], v9 offset:49152
    ds_read_b128 a[140:143], v9 offset:53248
    v_mfma_f32_16x16x32_bf16 v[40:43], a[156:159], a[28:31], v[40:43]
    v_exp_f32 v35, v35
    v_mfma_f32_16x16x32_bf16 v[44:47], a[172:175], a[28:31], v[44:47]
    v_cvt_pk_bf16_f32 v49, v34, v35
    buffer_load_dwordx4 v28, s[4:7], s48 offen nt lds
    s_waitcnt vmcnt(10)
    buffer_load_dwordx4 v29, s[4:7], s48 offen offset:1024 nt lds
    v_mfma_f32_16x16x32_bf16 v[192:195], a[208:211], v[52:55], v[192:195]
    v_exp_f32 v36, v36
    v_mfma_f32_16x16x32_bf16 v[196:199], a[212:215], v[52:55], v[196:199]
    ds_read_b64_tr_b16 a[208:209], v10 offset:49152
    s_waitcnt vmcnt(10)
    ds_read_b64_tr_b16 a[210:211], v10 offset:53248
    v_mfma_f32_16x16x32_bf16 v[200:203], a[216:219], v[52:55], v[200:203]
    v_exp_f32 v37, v37
    v_mfma_f32_16x16x32_bf16 v[204:207], a[220:223], v[52:55], v[204:207]
    v_cvt_pk_bf16_f32 v50, v36, v37
    ds_read_b64_tr_b16 a[212:213], v11 offset:49152
    buffer_load_dwordx4 v30, s[4:7], s48 offen offset:2048 nt lds
    v_mfma_f32_16x16x32_bf16 v[208:211], a[224:227], v[52:55], v[208:211]
    v_exp_f32 v38, v38
    v_mfma_f32_16x16x32_bf16 v[212:215], a[228:231], v[52:55], v[212:215]
    ds_read_b64_tr_b16 a[214:215], v11 offset:53248
    s_waitcnt vmcnt(10)
    ds_read_b64_tr_b16 a[216:217], v12 offset:49152
    v_mfma_f32_16x16x32_bf16 v[216:219], a[232:235], v[52:55], v[216:219]
    v_exp_f32 v39, v39
    v_mfma_f32_16x16x32_bf16 v[220:223], a[236:239], v[52:55], v[220:223]
    v_cvt_pk_bf16_f32 v51, v38, v39
    ds_read_b64_tr_b16 a[218:219], v12 offset:53248
    buffer_load_dwordx4 v31, s[4:7], s48 offen offset:3072 nt lds
    v_mfma_f32_16x16x32_bf16 a[100:103], a[108:111], v[52:55], a[100:103]
    ds_read_b64_tr_b16 a[220:221], v13 offset:49152
    s_xor_b32 m0, m0, 4096
    ds_read_b64_tr_b16 a[222:223], v13 offset:53248
    s_waitcnt lgkmcnt(8)
    v_mfma_f32_16x16x32_bf16 v[32:35], a[112:115], a[0:3], v[56:59]
    v_exp_f32 v40, v40
    v_mfma_f32_16x16x32_bf16 v[36:39], a[128:131], a[0:3], v[56:59]
    ds_read_b64_tr_b16 a[224:225], v14 offset:49152
    s_xor_b32 s48, s48, 4096
    ds_read_b64_tr_b16 a[226:227], v14 offset:53248
    v_mfma_f32_16x16x32_bf16 v[32:35], a[116:119], a[4:7], v[32:35]
    v_exp_f32 v41, v41
    v_mfma_f32_16x16x32_bf16 v[36:39], a[132:135], a[4:7], v[36:39]
    v_cvt_pk_bf16_f32 v52, v40, v41
    ds_read_b64_tr_b16 a[228:229], v15 offset:49152
    s_waitcnt vmcnt(10)
    v_mfma_f32_16x16x32_bf16 v[32:35], a[120:123], a[8:11], v[32:35]
    v_exp_f32 v42, v42
    v_mfma_f32_16x16x32_bf16 v[36:39], a[136:139], a[8:11], v[36:39]
    ds_read_b64_tr_b16 a[230:231], v15 offset:53248
    buffer_load_dwordx4 v28, s[4:7], s48 offen nt lds
    ds_read_b64_tr_b16 a[232:233], v16 offset:49152
    v_mfma_f32_16x16x32_bf16 v[32:35], a[124:127], a[12:15], v[32:35]
    v_exp_f32 v43, v43
    v_mfma_f32_16x16x32_bf16 v[36:39], a[140:143], a[12:15], v[36:39]
    v_cvt_pk_bf16_f32 v53, v42, v43
    ds_read_b64_tr_b16 a[234:235], v16 offset:53248
    s_waitcnt vmcnt(10)
    v_mfma_f32_16x16x32_bf16 v[160:163], a[176:179], v[48:51], v[160:163]
    v_exp_f32 v44, v44
    v_mfma_f32_16x16x32_bf16 v[164:167], a[180:183], v[48:51], v[164:167]
    ds_read_b64_tr_b16 a[236:237], v17 offset:49152
    buffer_load_dwordx4 v29, s[4:7], s48 offen offset:1024 nt lds
    ds_read_b64_tr_b16 a[238:239], v17 offset:53248
    v_mfma_f32_16x16x32_bf16 v[168:171], a[184:187], v[48:51], v[168:171]
    v_exp_f32 v45, v45
    v_mfma_f32_16x16x32_bf16 v[172:175], a[188:191], v[48:51], v[172:175]
    v_cvt_pk_bf16_f32 v54, v44, v45
    s_waitcnt vmcnt(10)
    buffer_load_dwordx4 v30, s[4:7], s48 offen offset:2048 nt lds
    v_mfma_f32_16x16x32_bf16 v[176:179], a[192:195], v[48:51], v[176:179]
    v_exp_f32 v46, v46
    v_mfma_f32_16x16x32_bf16 v[180:183], a[196:199], v[48:51], v[180:183]
    s_waitcnt vmcnt(10)
    buffer_load_dwordx4 v31, s[4:7], s48 offen offset:3072 nt lds
    s_add_u32 s47, s47, s89
    v_mfma_f32_16x16x32_bf16 v[184:187], a[200:203], v[48:51], v[184:187]
    v_exp_f32 v47, v47
    v_mfma_f32_16x16x32_bf16 v[188:191], a[204:207], v[48:51], v[188:191]
    v_cvt_pk_bf16_f32 v55, v46, v47
    s_and_b32 s47, s47, 0x3ffff
    v_mfma_f32_16x16x32_bf16 a[96:99], a[108:111], v[48:51], a[96:99]
    s_waitcnt lgkmcnt(0)
    s_barrier
    v_mfma_f32_16x16x32_bf16 v[40:43], a[112:115], a[16:19], v[60:63]
    v_exp_f32 v32, v32
    v_mfma_f32_16x16x32_bf16 v[44:47], a[128:131], a[16:19], v[60:63]
    ds_read_b128 a[144:147], v6
    s_add_u32 m0, s49, 49152
    ds_read_b128 a[160:163], v6 offset:4096
    ds_read_b128 a[148:151], v7
    v_mfma_f32_16x16x32_bf16 v[40:43], a[116:119], a[20:23], v[40:43]
    v_exp_f32 v33, v33
    v_mfma_f32_16x16x32_bf16 v[44:47], a[132:135], a[20:23], v[44:47]
    v_cvt_pk_bf16_f32 v48, v32, v33
    ds_read_b128 a[164:167], v7 offset:4096
    s_add_u32 s48, s46, s47
    ds_read_b128 a[152:155], v8
    v_mfma_f32_16x16x32_bf16 v[40:43], a[120:123], a[24:27], v[40:43]
    v_exp_f32 v34, v34
    v_mfma_f32_16x16x32_bf16 v[44:47], a[136:139], a[24:27], v[44:47]
    ds_read_b128 a[168:171], v8 offset:4096
    s_waitcnt vmcnt(10)
    ds_read_b128 a[156:159], v9
    ds_read_b128 a[172:175], v9 offset:4096
    v_mfma_f32_16x16x32_bf16 v[40:43], a[124:127], a[28:31], v[40:43]
    v_exp_f32 v35, v35
    v_mfma_f32_16x16x32_bf16 v[44:47], a[140:143], a[28:31], v[44:47]
    v_cvt_pk_bf16_f32 v49, v34, v35
    ds_read_b128 v[80:83], v96
    buffer_load_dwordx4 v28, s[4:7], s48 offen nt lds
    ds_read_b128 v[84:87], v96 offset:64
    v_mfma_f32_16x16x32_bf16 v[192:195], a[176:179], v[52:55], v[192:195]
    v_exp_f32 v36, v36
    v_mfma_f32_16x16x32_bf16 v[196:199], a[180:183], v[52:55], v[196:199]
    ds_read_b128 v[88:91], v96 offset:128
    s_waitcnt vmcnt(10)
    ds_read_b128 v[92:95], v96 offset:192
    ds_read_b64_tr_b16 a[176:177], v10
    v_mfma_f32_16x16x32_bf16 v[200:203], a[184:187], v[52:55], v[200:203]
    v_exp_f32 v37, v37
    v_mfma_f32_16x16x32_bf16 v[204:207], a[188:191], v[52:55], v[204:207]
    v_cvt_pk_bf16_f32 v50, v36, v37
    ds_read_b64_tr_b16 a[178:179], v10 offset:4096
    buffer_load_dwordx4 v29, s[4:7], s48 offen offset:1024 nt lds
    ds_read_b64_tr_b16 a[180:181], v11
    v_mfma_f32_16x16x32_bf16 v[208:211], a[192:195], v[52:55], v[208:211]
    v_exp_f32 v38, v38
    v_mfma_f32_16x16x32_bf16 v[212:215], a[196:199], v[52:55], v[212:215]
    ds_read_b64_tr_b16 a[182:183], v11 offset:4096
    s_waitcnt vmcnt(10)
    ds_read_b64_tr_b16 a[184:185], v12
    ds_read_b64_tr_b16 a[186:187], v12 offset:4096
    v_mfma_f32_16x16x32_bf16 v[216:219], a[200:203], v[52:55], v[216:219]
    v_exp_f32 v39, v39
    v_mfma_f32_16x16x32_bf16 v[220:223], a[204:207], v[52:55], v[220:223]
    v_cvt_pk_bf16_f32 v51, v38, v39
    ds_read_b64_tr_b16 a[188:189], v13
    buffer_load_dwordx4 v30, s[4:7], s48 offen offset:2048 nt lds
    ds_read_b64_tr_b16 a[190:191], v13 offset:4096
    v_mfma_f32_16x16x32_bf16 a[100:103], a[108:111], v[52:55], a[100:103]
    ds_read_b64_tr_b16 a[192:193], v14
    s_waitcnt vmcnt(10)
    ds_read_b64_tr_b16 a[194:195], v14 offset:4096
    v_exp_f32 v40, v40
    ds_read_b64_tr_b16 a[196:197], v15
    buffer_load_dwordx4 v31, s[4:7], s48 offen offset:3072 nt lds
    ds_read_b64_tr_b16 a[198:199], v15 offset:4096
    v_exp_f32 v41, v41
    s_nop 0
    v_cvt_pk_bf16_f32 v52, v40, v41
    ds_read_b64_tr_b16 a[200:201], v16
    s_xor_b32 m0, m0, 4096
    v_exp_f32 v42, v42
    ds_read_b64_tr_b16 a[202:203], v16 offset:4096
    s_xor_b32 s48, s48, 4096
    ds_read_b64_tr_b16 a[204:205], v17
    v_exp_f32 v43, v43
    s_nop 0
    v_cvt_pk_bf16_f32 v53, v42, v43
    ds_read_b64_tr_b16 a[206:207], v17 offset:4096
    s_waitcnt vmcnt(10)
    v_mfma_f32_16x16x32_bf16 v[160:163], a[208:211], v[48:51], v[160:163]
    v_exp_f32 v44, v44
    v_mfma_f32_16x16x32_bf16 v[164:167], a[212:215], v[48:51], v[164:167]
    buffer_load_dwordx4 v28, s[4:7], s48 offen nt lds
    s_waitcnt vmcnt(10)
    buffer_load_dwordx4 v29, s[4:7], s48 offen offset:1024 nt lds
    v_mfma_f32_16x16x32_bf16 v[168:171], a[216:219], v[48:51], v[168:171]
    v_exp_f32 v45, v45
    v_mfma_f32_16x16x32_bf16 v[172:175], a[220:223], v[48:51], v[172:175]
    v_cvt_pk_bf16_f32 v54, v44, v45
    s_waitcnt vmcnt(10)
    buffer_load_dwordx4 v30, s[4:7], s48 offen offset:2048 nt lds
    v_mfma_f32_16x16x32_bf16 v[176:179], a[224:227], v[48:51], v[176:179]
    v_exp_f32 v46, v46
    v_mfma_f32_16x16x32_bf16 v[180:183], a[228:231], v[48:51], v[180:183]
    s_waitcnt vmcnt(10)
    buffer_load_dwordx4 v31, s[4:7], s48 offen offset:3072 nt lds
    s_add_u32 s47, s47, s89
    v_mfma_f32_16x16x32_bf16 v[184:187], a[232:235], v[48:51], v[184:187]
    v_exp_f32 v47, v47
    v_mfma_f32_16x16x32_bf16 v[188:191], a[236:239], v[48:51], v[188:191]
    v_cvt_pk_bf16_f32 v55, v46, v47
    s_and_b32 s47, s47, 0x3ffff
    v_mfma_f32_16x16x32_bf16 a[96:99], a[108:111], v[48:51], a[96:99]
    s_waitcnt lgkmcnt(0)
    s_barrier
    ds_read_b128 a[112:115], v6 offset:16384
    s_add_u32 m0, s49, 0
    ds_read_b128 a[128:131], v6 offset:20480
    s_add_u32 s48, s46, s47
    ds_read_b128 a[116:119], v7 offset:16384
    ds_read_b128 a[132:135], v7 offset:20480
    ds_read_b128 a[120:123], v8 offset:16384
    ds_read_b128 a[136:139], v8 offset:20480
    ds_read_b128 a[124:127], v9 offset:16384
    ds_read_b128 a[140:143], v9 offset:20480
    s_waitcnt vmcnt(10)
    buffer_load_dwordx4 v28, s[4:7], s48 offen nt lds
    s_waitcnt vmcnt(10)
    buffer_load_dwordx4 v29, s[4:7], s48 offen offset:1024 nt lds
    s_waitcnt vmcnt(10)
    buffer_load_dwordx4 v30, s[4:7], s48 offen offset:2048 nt lds
    s_waitcnt vmcnt(10)
    buffer_load_dwordx4 v31, s[4:7], s48 offen offset:3072 nt lds
    s_xor_b32 m0, m0, 4096
    s_xor_b32 s48, s48, 4096
    s_waitcnt vmcnt(10)
    buffer_load_dwordx4 v28, s[4:7], s48 offen nt lds
    s_waitcnt vmcnt(10)
    buffer_load_dwordx4 v29, s[4:7], s48 offen offset:1024 nt lds
    s_waitcnt vmcnt(10)
    buffer_load_dwordx4 v30, s[4:7], s48 offen offset:2048 nt lds
    s_waitcnt vmcnt(10)
    buffer_load_dwordx4 v31, s[4:7], s48 offen offset:3072 nt lds
    s_add_u32 s47, s47, s89
    s_and_b32 s47, s47, 0x3ffff
    v_mfma_f32_16x16x32_bf16 v[192:195], a[208:211], v[52:55], v[192:195]
    ds_read_b64_tr_b16 a[208:209], v10 offset:16384
    ds_read_b64_tr_b16 a[210:211], v10 offset:20480
    v_mfma_f32_16x16x32_bf16 v[196:199], a[212:215], v[52:55], v[196:199]
    ds_read_b64_tr_b16 a[212:213], v11 offset:16384
    ds_read_b64_tr_b16 a[214:215], v11 offset:20480
    v_mfma_f32_16x16x32_bf16 v[200:203], a[216:219], v[52:55], v[200:203]
    ds_read_b64_tr_b16 a[216:217], v12 offset:16384
    ds_read_b64_tr_b16 a[218:219], v12 offset:20480
    v_mfma_f32_16x16x32_bf16 v[204:207], a[220:223], v[52:55], v[204:207]
    ds_read_b64_tr_b16 a[220:221], v13 offset:16384
    ds_read_b64_tr_b16 a[222:223], v13 offset:20480
    v_mfma_f32_16x16x32_bf16 v[208:211], a[224:227], v[52:55], v[208:211]
    ds_read_b64_tr_b16 a[224:225], v14 offset:16384
    ds_read_b64_tr_b16 a[226:227], v14 offset:20480
    v_mfma_f32_16x16x32_bf16 v[212:215], a[228:231], v[52:55], v[212:215]
    ds_read_b64_tr_b16 a[228:229], v15 offset:16384
    ds_read_b64_tr_b16 a[230:231], v15 offset:20480
    v_mfma_f32_16x16x32_bf16 v[216:219], a[232:235], v[52:55], v[216:219]
    ds_read_b64_tr_b16 a[232:233], v16 offset:16384
    ds_read_b64_tr_b16 a[234:235], v16 offset:20480
    v_mfma_f32_16x16x32_bf16 v[220:223], a[236:239], v[52:55], v[220:223]
    ds_read_b64_tr_b16 a[236:237], v17 offset:16384
    ds_read_b64_tr_b16 a[238:239], v17 offset:20480
    v_mfma_f32_16x16x32_bf16 a[100:103], a[108:111], v[52:55], a[100:103]
    v_mov_b32 v3, 163776
    ds_read_b32 v108, v3 offset:32
    s_mov_b32 s39, 0x53800000
    s_mov_b64 s[70:71], 0
    v_accvgpr_read_b32 v32, a96
    s_nop 2
    v_accvgpr_read_b32 v34, a100
    v_cmp_nge_f32 s[72:73], s39, v32
    v_cmp_nle_f32 vcc, 0.5, v32
    s_or_b64 s[70:71], s[70:71], s[72:73]
    s_or_b64 s[70:71], s[70:71], vcc
    v_cmp_nge_f32 s[72:73], s39, v34
    v_cmp_nle_f32 vcc, 0.5, v34
    s_or_b64 s[70:71], s[70:71], s[72:73]
    s_or_b64 s[70:71], s[70:71], vcc
    v_rcp_f32 v32, v32
    v_rcp_f32 v34, v34
    s_or_b32 s39, s70, s71
    v_mov_b32 v3, s39
    ds_write_b32 v104, v3
    v_mov_b32 v33, v32
    v_mov_b32 v35, v34
    s_cmp_lg_u32 s68, 0
    s_cselect_b32 s70, 0x40000000, s58
    v_pk_mul_f32 v[160:161], v[160:161], v[32:33]
    v_pk_mul_f32 v[162:163], v[162:163], v[32:33]
    v_pk_mul_f32 v[164:165], v[164:165], v[32:33]
    v_pk_mul_f32 v[166:167], v[166:167], v[32:33]
    v_cvt_pk_bf16_f32 v112, v160, v161
    v_cvt_pk_bf16_f32 v113, v162, v163
    v_cvt_pk_bf16_f32 v114, v164, v165
    v_cvt_pk_bf16_f32 v115, v166, v167
    ds_write_b128 v98, v[112:115]
    s_add_u32 s39, s70, 0
    buffer_store_dwordx4 v[112:115], v2, s[20:23], s39 offen sc1
    v_pk_mul_f32 v[168:169], v[168:169], v[32:33]
    v_pk_mul_f32 v[170:171], v[170:171], v[32:33]
    v_pk_mul_f32 v[172:173], v[172:173], v[32:33]
    v_pk_mul_f32 v[174:175], v[174:175], v[32:33]
    v_cvt_pk_bf16_f32 v116, v168, v169
    v_cvt_pk_bf16_f32 v117, v170, v171
    v_cvt_pk_bf16_f32 v118, v172, v173
    v_cvt_pk_bf16_f32 v119, v174, v175
    ds_write_b128 v98, v[116:119] offset:1024
    s_add_u32 s39, s70, 0
    buffer_store_dwordx4 v[116:119], v2, s[20:23], s39 offen offset:1024 sc1
    v_pk_mul_f32 v[192:193], v[192:193], v[34:35]
    v_pk_mul_f32 v[194:195], v[194:195], v[34:35]
    v_pk_mul_f32 v[196:197], v[196:197], v[34:35]
    v_pk_mul_f32 v[198:199], v[198:199], v[34:35]
    v_cvt_pk_bf16_f32 v120, v192, v193
    v_cvt_pk_bf16_f32 v121, v194, v195
    v_cvt_pk_bf16_f32 v122, v196, v197
    v_cvt_pk_bf16_f32 v123, v198, v199
    ds_write_b128 v98, v[120:123] offset:2048
    s_add_u32 s39, s70, 2048
    buffer_store_dwordx4 v[120:123], v2, s[20:23], s39 offen sc1
    v_pk_mul_f32 v[200:201], v[200:201], v[34:35]
    v_pk_mul_f32 v[202:203], v[202:203], v[34:35]
    v_pk_mul_f32 v[204:205], v[204:205], v[34:35]
    v_pk_mul_f32 v[206:207], v[206:207], v[34:35]
    v_cvt_pk_bf16_f32 v124, v200, v201
    v_cvt_pk_bf16_f32 v125, v202, v203
    v_cvt_pk_bf16_f32 v126, v204, v205
    v_cvt_pk_bf16_f32 v127, v206, v207
    ds_write_b128 v98, v[124:127] offset:3072
    s_add_u32 s39, s70, 2048
    buffer_store_dwordx4 v[124:127], v2, s[20:23], s39 offen offset:1024 sc1
    v_pk_mul_f32 v[176:177], v[176:177], v[32:33]
    v_pk_mul_f32 v[178:179], v[178:179], v[32:33]
    v_pk_mul_f32 v[180:181], v[180:181], v[32:33]
    v_pk_mul_f32 v[182:183], v[182:183], v[32:33]
    v_cvt_pk_bf16_f32 v128, v176, v177
    v_cvt_pk_bf16_f32 v129, v178, v179
    v_cvt_pk_bf16_f32 v130, v180, v181
    v_cvt_pk_bf16_f32 v131, v182, v183
    ds_write_b128 v98, v[128:131] offset:34816
    s_add_u32 s39, s70, 18432
    buffer_store_dwordx4 v[128:131], v2, s[20:23], s39 offen sc1
    v_pk_mul_f32 v[184:185], v[184:185], v[32:33]
    v_pk_mul_f32 v[186:187], v[186:187], v[32:33]
    v_pk_mul_f32 v[188:189], v[188:189], v[32:33]
    v_pk_mul_f32 v[190:191], v[190:191], v[32:33]
    v_cvt_pk_bf16_f32 v132, v184, v185
    v_cvt_pk_bf16_f32 v133, v186, v187
    v_cvt_pk_bf16_f32 v134, v188, v189
    v_cvt_pk_bf16_f32 v135, v190, v191
    ds_write_b128 v98, v[132:135] offset:35840
    s_add_u32 s39, s70, 18432
    buffer_store_dwordx4 v[132:135], v2, s[20:23], s39 offen offset:1024 sc1
    v_pk_mul_f32 v[208:209], v[208:209], v[34:35]
    v_pk_mul_f32 v[210:211], v[210:211], v[34:35]
    v_pk_mul_f32 v[212:213], v[212:213], v[34:35]
    v_pk_mul_f32 v[214:215], v[214:215], v[34:35]
    v_cvt_pk_bf16_f32 v136, v208, v209
    v_cvt_pk_bf16_f32 v137, v210, v211
    v_cvt_pk_bf16_f32 v138, v212, v213
    v_cvt_pk_bf16_f32 v139, v214, v215
    ds_write_b128 v98, v[136:139] offset:36864
    s_add_u32 s39, s70, 20480
    buffer_store_dwordx4 v[136:139], v2, s[20:23], s39 offen sc1
    v_pk_mul_f32 v[216:217], v[216:217], v[34:35]
    v_pk_mul_f32 v[218:219], v[218:219], v[34:35]
    v_pk_mul_f32 v[220:221], v[220:221], v[34:35]
    v_pk_mul_f32 v[222:223], v[222:223], v[34:35]
    v_cvt_pk_bf16_f32 v140, v216, v217
    v_cvt_pk_bf16_f32 v141, v218, v219
    v_cvt_pk_bf16_f32 v142, v220, v221
    v_cvt_pk_bf16_f32 v143, v222, v223
    ds_write_b128 v98, v[140:143] offset:37888
    s_add_u32 s39, s70, 20480
    buffer_store_dwordx4 v[140:143], v2, s[20:23], s39 offen offset:1024 sc1
    s_waitcnt lgkmcnt(9)
    v_readfirstlane_b32 s81, v108
    s_cmp_lg_u32 s55, 0
    s_cbranch_scc1 L_np1B
    s_mov_b32 s40, 0x80008000
    v_xor_b32 v80, s40, v80
    v_xor_b32 v81, s40, v81
    v_xor_b32 v82, s40, v82
    v_xor_b32 v83, s40, v83
    v_xor_b32 v84, s40, v84
    v_xor_b32 v85, s40, v85
    v_xor_b32 v86, s40, v86
    v_xor_b32 v87, s40, v87
    v_xor_b32 v88, s40, v88
    v_xor_b32 v89, s40, v89
    v_xor_b32 v90, s40, v90
    v_xor_b32 v91, s40, v91
    v_xor_b32 v92, s40, v92
    v_xor_b32 v93, s40, v93
    v_xor_b32 v94, s40, v94
    v_xor_b32 v95, s40, v95
    v_mfma_f32_16x16x32_bf16 v[68:71], v[80:83], a[48:51], 0
    v_mfma_f32_16x16x32_bf16 v[68:71], v[84:87], a[52:55], v[68:71]
    v_mfma_f32_16x16x32_bf16 v[68:71], v[88:91], a[56:59], v[68:71]
    v_mfma_f32_16x16x32_bf16 v[68:71], v[92:95], a[60:63], v[68:71]
    v_mfma_f32_16x16x32_bf16 v[72:75], v[80:83], a[64:67], 0
    v_mfma_f32_16x16x32_bf16 v[72:75], v[84:87], a[68:71], v[72:75]
    v_mfma_f32_16x16x32_bf16 v[72:75], v[88:91], a[72:75], v[72:75]
    v_mfma_f32_16x16x32_bf16 v[72:75], v[92:95], a[76:79], v[72:75]
L_np1B:
    v_mfma_f32_16x16x32_bf16 v[32:35], a[144:147], a[48:51], v[68:71]
    v_mfma_f32_16x16x32_bf16 v[36:39], a[160:163], a[48:51], v[68:71]
    v_mfma_f32_16x16x32_bf16 v[32:35], a[148:151], a[52:55], v[32:35]
    v_mfma_f32_16x16x32_bf16 v[36:39], a[164:167], a[52:55], v[36:39]
    v_mfma_f32_16x16x32_bf16 v[32:35], a[152:155], a[56:59], v[32:35]
    v_mfma_f32_16x16x32_bf16 v[36:39], a[168:171], a[56:59], v[36:39]
    v_mfma_f32_16x16x32_bf16 v[32:35], a[156:159], a[60:63], v[32:35]
    v_mfma_f32_16x16x32_bf16 v[36:39], a[172:175], a[60:63], v[36:39]
    v_mfma_f32_16x16x32_bf16 v[40:43], a[144:147], a[64:67], v[72:75]
    s_nop 5
    v_exp_f32 v32, v32
    v_mfma_f32_16x16x32_bf16 v[44:47], a[160:163], a[64:67], v[72:75]
    v_mfma_f32_16x16x32_bf16 v[40:43], a[148:151], a[68:71], v[40:43]
    v_exp_f32 v33, v33
    v_mfma_f32_16x16x32_bf16 v[44:47], a[164:167], a[68:71], v[44:47]
    v_cvt_pk_bf16_f32 v48, v32, v33
    v_mfma_f32_16x16x32_bf16 v[40:43], a[152:155], a[72:75], v[40:43]
    v_exp_f32 v34, v34
    v_mfma_f32_16x16x32_bf16 v[44:47], a[168:171], a[72:75], v[44:47]
    v_mfma_f32_16x16x32_bf16 v[40:43], a[156:159], a[76:79], v[40:43]
    v_exp_f32 v35, v35
    v_mfma_f32_16x16x32_bf16 v[44:47], a[172:175], a[76:79], v[44:47]
    v_cvt_pk_bf16_f32 v49, v34, v35
    v_exp_f32 v36, v36
    v_exp_f32 v37, v37
    s_nop 0
    v_cvt_pk_bf16_f32 v50, v36, v37
    v_exp_f32 v38, v38
    v_exp_f32 v39, v39
    s_nop 0
    v_cvt_pk_bf16_f32 v51, v38, v39
    v_mfma_f32_16x16x32_bf16 v[32:35], a[112:115], a[48:51], v[68:71]
    v_exp_f32 v40, v40
    v_mfma_f32_16x16x32_bf16 v[36:39], a[128:131], a[48:51], v[68:71]
    v_mfma_f32_16x16x32_bf16 v[32:35], a[116:119], a[52:55], v[32:35]
    v_exp_f32 v41, v41
    v_mfma_f32_16x16x32_bf16 v[36:39], a[132:135], a[52:55], v[36:39]
    v_cvt_pk_bf16_f32 v52, v40, v41
    v_mfma_f32_16x16x32_bf16 v[32:35], a[120:123], a[56:59], v[32:35]
    v_exp_f32 v42, v42
    v_mfma_f32_16x16x32_bf16 v[36:39], a[136:139], a[56:59], v[36:39]
    v_mfma_f32_16x16x32_bf16 v[32:35], a[124:127], a[60:63], v[32:35]
    v_exp_f32 v43, v43
    v_mfma_f32_16x16x32_bf16 v[36:39], a[140:143], a[60:63], v[36:39]
    v_cvt_pk_bf16_f32 v53, v42, v43
    v_mfma_f32_16x16x32_bf16 v[160:163], a[176:179], v[48:51], 0
    v_exp_f32 v44, v44
    v_mfma_f32_16x16x32_bf16 v[164:167], a[180:183], v[48:51], 0
    v_mfma_f32_16x16x32_bf16 v[168:171], a[184:187], v[48:51], 0
    v_exp_f32 v45, v45
    v_mfma_f32_16x16x32_bf16 v[172:175], a[188:191], v[48:51], 0
    v_cvt_pk_bf16_f32 v54, v44, v45
    v_mfma_f32_16x16x32_bf16 v[176:179], a[192:195], v[48:51], 0
    v_exp_f32 v46, v46
    v_mfma_f32_16x16x32_bf16 v[180:183], a[196:199], v[48:51], 0
    v_mfma_f32_16x16x32_bf16 v[184:187], a[200:203], v[48:51], 0
    v_exp_f32 v47, v47
    v_mfma_f32_16x16x32_bf16 v[188:191], a[204:207], v[48:51], 0
    v_cvt_pk_bf16_f32 v55, v46, v47
    v_mfma_f32_16x16x32_bf16 a[96:99], a[108:111], v[48:51], 0
    s_waitcnt lgkmcnt(0)
    s_barrier
    v_mfma_f32_16x16x32_bf16 v[40:43], a[112:115], a[64:67], v[72:75]
    v_exp_f32 v32, v32
    v_mfma_f32_16x16x32_bf16 v[44:47], a[128:131], a[64:67], v[72:75]
    ds_read_b128 a[144:147], v6 offset:32768
    s_add_u32 m0, s49, 16384
    ds_read_b128 a[160:163], v6 offset:36864
    ds_read_b128 a[148:151], v7 offset:32768
    v_mfma_f32_16x16x32_bf16 v[40:43], a[116:119], a[68:71], v[40:43]
    v_exp_f32 v33, v33
    v_mfma_f32_16x16x32_bf16 v[44:47], a[132:135], a[68:71], v[44:47]
    v_cvt_pk_bf16_f32 v48, v32, v33
    ds_read_b128 a[164:167], v7 offset:36864
    s_add_u32 s48, s46, s47
    ds_read_b128 a[152:155], v8 offset:32768
    v_mfma_f32_16x16x32_bf16 v[40:43], a[120:123], a[72:75], v[40:43]
    v_exp_f32 v34, v34
    v_mfma_f32_16x16x32_bf16 v[44:47], a[136:139], a[72:75], v[44:47]
    ds_read_b128 a[168:171], v8 offset:36864
    s_waitcnt vmcnt(10)
    ds_read_b128 a[156:159], v9 offset:32768
    ds_read_b128 a[172:175], v9 offset:36864
    v_mfma_f32_16x16x32_bf16 v[40:43], a[124:127], a[76:79], v[40:43]
    v_exp_f32 v35, v35
    v_mfma_f32_16x16x32_bf16 v[44:47], a[140:143], a[76:79], v[44:47]
    v_cvt_pk_bf16_f32 v49, v34, v35
    buffer_load_dwordx4 v28, s[4:7], s48 offen nt lds
    s_waitcnt vmcnt(10)
    buffer_load_dwordx4 v29, s[4:7], s48 offen offset:1024 nt lds
    v_mfma_f32_16x16x32_bf16 v[192:195], a[176:179], v[52:55], 0
    v_exp_f32 v36, v36
    v_mfma_f32_16x16x32_bf16 v[196:199], a[180:183], v[52:55], 0
    ds_read_b64_tr_b16 a[176:177], v10 offset:32768
    s_waitcnt vmcnt(10)
    ds_read_b64_tr_b16 a[178:179], v10 offset:36864
    v_mfma_f32_16x16x32_bf16 v[200:203], a[184:187], v[52:55], 0
    v_exp_f32 v37, v37
    v_mfma_f32_16x16x32_bf16 v[204:207], a[188:191], v[52:55], 0
    v_cvt_pk_bf16_f32 v50, v36, v37
    ds_read_b64_tr_b16 a[180:181], v11 offset:32768
    buffer_load_dwordx4 v30, s[4:7], s48 offen offset:2048 nt lds
    v_mfma_f32_16x16x32_bf16 v[208:211], a[192:195], v[52:55], 0
    v_exp_f32 v38, v38
    v_mfma_f32_16x16x32_bf16 v[212:215], a[196:199], v[52:55], 0
    ds_read_b64_tr_b16 a[182:183], v11 offset:36864
    s_waitcnt vmcnt(10)
    ds_read_b64_tr_b16 a[184:185], v12 offset:32768
    v_mfma_f32_16x16x32_bf16 v[216:219], a[200:203], v[52:55], 0
    v_exp_f32 v39, v39
    v_mfma_f32_16x16x32_bf16 v[220:223], a[204:207], v[52:55], 0
    v_cvt_pk_bf16_f32 v51, v38, v39
    ds_read_b64_tr_b16 a[186:187], v12 offset:36864
    buffer_load_dwordx4 v31, s[4:7], s48 offen offset:3072 nt lds
    v_mfma_f32_16x16x32_bf16 a[100:103], a[108:111], v[52:55], 0
    ds_read_b64_tr_b16 a[188:189], v13 offset:32768
    s_xor_b32 m0, m0, 4096
    ds_read_b64_tr_b16 a[190:191], v13 offset:36864
    s_waitcnt lgkmcnt(8)
    v_mfma_f32_16x16x32_bf16 v[32:35], a[144:147], a[48:51], v[68:71]
    v_exp_f32 v40, v40
    v_mfma_f32_16x16x32_bf16 v[36:39], a[160:163], a[48:51], v[68:71]
    ds_read_b64_tr_b16 a[192:193], v14 offset:32768
    s_xor_b32 s48, s48, 4096
    ds_read_b64_tr_b16 a[194:195], v14 offset:36864
    v_mfma_f32_16x16x32_bf16 v[32:35], a[148:151], a[52:55], v[32:35]
    v_exp_f32 v41, v41
    v_mfma_f32_16x16x32_bf16 v[36:39], a[164:167], a[52:55], v[36:39]
    v_cvt_pk_bf16_f32 v52, v40, v41
    ds_read_b64_tr_b16 a[196:197], v15 offset:32768
    s_waitcnt vmcnt(10)
    v_mfma_f32_16x16x32_bf16 v[32:35], a[152:155], a[56:59], v[32:35]
    v_exp_f32 v42, v42
    v_mfma_f32_16x16x32_bf16 v[36:39], a[168:171], a[56:59], v[36:39]
    ds_read_b64_tr_b16 a[198:199], v15 offset:36864
    buffer_load_dwordx4 v28, s[4:7], s48 offen nt lds
    ds_read_b64_tr_b16 a[200:201], v16 offset:32768
    v_mfma_f32_16x16x32_bf16 v[32:35], a[156:159], a[60:63], v[32:35]
    v_exp_f32 v43, v43
    v_mfma_f32_16x16x32_bf16 v[36:39], a[172:175], a[60:63], v[36:39]
    v_cvt_pk_bf16_f32 v53, v42, v43
    ds_read_b64_tr_b16 a[202:203], v16 offset:36864
    s_waitcnt vmcnt(10)
    v_mfma_f32_16x16x32_bf16 v[160:163], a[208:211], v[48:51], v[160:163]
    v_exp_f32 v44, v44
    v_mfma_f32_16x16x32_bf16 v[164:167], a[212:215], v[48:51], v[164:167]
    ds_read_b64_tr_b16 a[204:205], v17 offset:32768
    buffer_load_dwordx4 v29, s[4:7], s48 offen offset:1024 nt lds
    ds_read_b64_tr_b16 a[206:207], v17 offset:36864
    v_mfma_f32_16x16x32_bf16 v[168:171], a[216:219], v[48:51], v[168:171]
    v_exp_f32 v45, v45
    v_mfma_f32_16x16x32_bf16 v[172:175], a[220:223], v[48:51], v[172:175]
    v_cvt_pk_bf16_f32 v54, v44, v45
    s_waitcnt vmcnt(10)
    buffer_load_dwordx4 v30, s[4:7], s48 offen offset:2048 nt lds
    v_mfma_f32_16x16x32_bf16 v[176:179], a[224:227], v[48:51], v[176:179]
    v_exp_f32 v46, v46
    v_mfma_f32_16x16x32_bf16 v[180:183], a[228:231], v[48:51], v[180:183]
    s_waitcnt vmcnt(10)
    buffer_load_dwordx4 v31, s[4:7], s48 offen offset:3072 nt lds
    s_add_u32 s47, s47, s89
    v_mfma_f32_16x16x32_bf16 v[184:187], a[232:235], v[48:51], v[184:187]
    v_exp_f32 v47, v47
    v_mfma_f32_16x16x32_bf16 v[188:191], a[236:239], v[48:51], v[188:191]
    v_cvt_pk_bf16_f32 v55, v46, v47
    s_and_b32 s47, s47, 0x3ffff
    v_mfma_f32_16x16x32_bf16 a[96:99], a[108:111], v[48:51], a[96:99]
    s_waitcnt lgkmcnt(0)
    s_barrier
    v_mfma_f32_16x16x32_bf16 v[40:43], a[144:147], a[64:67], v[72:75]
    v_exp_f32 v32, v32
    v_mfma_f32_16x16x32_bf16 v[44:47], a[160:163], a[64:67], v[72:75]
    ds_read_b128 a[112:115], v6 offset:49152
    s_add_u32 m0, s49, 32768
    ds_read_b128 a[128:131], v6 offset:53248
    ds_read_b128 a[116:119], v7 offset:49152
    v_mfma_f32_16x16x32_bf16 v[40:43], a[148:151], a[68:71], v[40:43]
    v_exp_f32 v33, v33
    v_mfma_f32_16x16x32_bf16 v[44:47], a[164:167], a[68:71], v[44:47]
    v_cvt_pk_bf16_f32 v48, v32, v33
    ds_read_b128 a[132:135], v7 offset:53248
    s_add_u32 s48, s46, s47
    ds_read_b128 a[120:123], v8 offset:49152
    v_mfma_f32_16x16x32_bf16 v[40:43], a[152:155], a[72:75], v[40:43]
    v_exp_f32 v34, v34
    v_mfma_f32_16x16x32_bf16 v[44:47], a[168:171], a[72:75], v[44:47]
    ds_read_b128 a[136:139], v8 offset:53248
    s_waitcnt vmcnt(10)
    ds_read_b128 a[124:127], v9 offset:49152
    ds_read_b128 a[140:143], v9 offset:53248
    v_mfma_f32_16x16x32_bf16 v[40:43], a[156:159], a[76:79], v[40:43]
    v_exp_f32 v35, v35
    v_mfma_f32_16x16x32_bf16 v[44:47], a[172:175], a[76:79], v[44:47]
    v_cvt_pk_bf16_f32 v49, v34, v35
    buffer_load_dwordx4 v28, s[4:7], s48 offen nt lds
    s_waitcnt vmcnt(10)
    buffer_load_dwordx4 v29, s[4:7], s48 offen offset:1024 nt lds
    v_mfma_f32_16x16x32_bf16 v[192:195], a[208:211], v[52:55], v[192:195]
    v_exp_f32 v36, v36
    v_mfma_f32_16x16x32_bf16 v[196:199], a[212:215], v[52:55], v[196:199]
    ds_read_b64_tr_b16 a[208:209], v10 offset:49152
    s_waitcnt vmcnt(10)
    ds_read_b64_tr_b16 a[210:211], v10 offset:53248
    v_mfma_f32_16x16x32_bf16 v[200:203], a[216:219], v[52:55], v[200:203]
    v_exp_f32 v37, v37
    v_mfma_f32_16x16x32_bf16 v[204:207], a[220:223], v[52:55], v[204:207]
    v_cvt_pk_bf16_f32 v50, v36, v37
    ds_read_b64_tr_b16 a[212:213], v11 offset:49152
    buffer_load_dwordx4 v30, s[4:7], s48 offen offset:2048 nt lds
    v_mfma_f32_16x16x32_bf16 v[208:211], a[224:227], v[52:55], v[208:211]
    v_exp_f32 v38, v38
    v_mfma_f32_16x16x32_bf16 v[212:215], a[228:231], v[52:55], v[212:215]
    ds_read_b64_tr_b16 a[214:215], v11 offset:53248
    s_waitcnt vmcnt(10)
    ds_read_b64_tr_b16 a[216:217], v12 offset:49152
    v_mfma_f32_16x16x32_bf16 v[216:219], a[232:235], v[52:55], v[216:219]
    v_exp_f32 v39, v39
    v_mfma_f32_16x16x32_bf16 v[220:223], a[236:239], v[52:55], v[220:223]
    v_cvt_pk_bf16_f32 v51, v38, v39
    ds_read_b64_tr_b16 a[218:219], v12 offset:53248
    buffer_load_dwordx4 v31, s[4:7], s48 offen offset:3072 nt lds
    v_mfma_f32_16x16x32_bf16 a[100:103], a[108:111], v[52:55], a[100:103]
    ds_read_b64_tr_b16 a[220:221], v13 offset:49152
    s_xor_b32 m0, m0, 4096
    ds_read_b64_tr_b16 a[222:223], v13 offset:53248
    s_waitcnt lgkmcnt(8)
    v_mfma_f32_16x16x32_bf16 v[32:35], a[112:115], a[48:51], v[68:71]
    v_exp_f32 v40, v40
    v_mfma_f32_16x16x32_bf16 v[36:39], a[128:131], a[48:51], v[68:71]
    ds_read_b64_tr_b16 a[224:225], v14 offset:49152
    s_xor_b32 s48, s48, 4096
    ds_read_b64_tr_b16 a[226:227], v14 offset:53248
    v_mfma_f32_16x16x32_bf16 v[32:35], a[116:119], a[52:55], v[32:35]
    v_exp_f32 v41, v41
    v_mfma_f32_16x16x32_bf16 v[36:39], a[132:135], a[52:55], v[36:39]
    v_cvt_pk_bf16_f32 v52, v40, v41
    ds_read_b64_tr_b16 a[228:229], v15 offset:49152
    s_waitcnt vmcnt(10)
    v_mfma_f32_16x16x32_bf16 v[32:35], a[120:123], a[56:59], v[32:35]
    v_exp_f32 v42, v42
    v_mfma_f32_16x16x32_bf16 v[36:39], a[136:139], a[56:59], v[36:39]
    ds_read_b64_tr_b16 a[230:231], v15 offset:53248
    buffer_load_dwordx4 v28, s[4:7], s48 offen nt lds
    ds_read_b64_tr_b16 a[232:233], v16 offset:49152
    v_mfma_f32_16x16x32_bf16 v[32:35], a[124:127], a[60:63], v[32:35]
    v_exp_f32 v43, v43
    v_mfma_f32_16x16x32_bf16 v[36:39], a[140:143], a[60:63], v[36:39]
    v_cvt_pk_bf16_f32 v53, v42, v43
    ds_read_b64_tr_b16 a[234:235], v16 offset:53248
    s_waitcnt vmcnt(10)
    v_mfma_f32_16x16x32_bf16 v[160:163], a[176:179], v[48:51], v[160:163]
    v_exp_f32 v44, v44
    v_mfma_f32_16x16x32_bf16 v[164:167], a[180:183], v[48:51], v[164:167]
    ds_read_b64_tr_b16 a[236:237], v17 offset:49152
    buffer_load_dwordx4 v29, s[4:7], s48 offen offset:1024 nt lds
    ds_read_b64_tr_b16 a[238:239], v17 offset:53248
    v_mfma_f32_16x16x32_bf16 v[168:171], a[184:187], v[48:51], v[168:171]
    v_exp_f32 v45, v45
    v_mfma_f32_16x16x32_bf16 v[172:175], a[188:191], v[48:51], v[172:175]
    v_cvt_pk_bf16_f32 v54, v44, v45
    s_waitcnt vmcnt(10)
    buffer_load_dwordx4 v30, s[4:7], s48 offen offset:2048 nt lds
    v_mfma_f32_16x16x32_bf16 v[176:179], a[192:195], v[48:51], v[176:179]
    v_exp_f32 v46, v46
    v_mfma_f32_16x16x32_bf16 v[180:183], a[196:199], v[48:51], v[180:183]
    s_waitcnt vmcnt(10)
    buffer_load_dwordx4 v31, s[4:7], s48 offen offset:3072 nt lds
    s_add_u32 s47, s47, s89
    v_mfma_f32_16x16x32_bf16 v[184:187], a[200:203], v[48:51], v[184:187]
    v_exp_f32 v47, v47
    v_mfma_f32_16x16x32_bf16 v[188:191], a[204:207], v[48:51], v[188:191]
    v_cvt_pk_bf16_f32 v55, v46, v47
    s_and_b32 s47, s47, 0x3ffff
    v_mfma_f32_16x16x32_bf16 a[96:99], a[108:111], v[48:51], a[96:99]
    s_waitcnt lgkmcnt(0)
    s_barrier
    v_mfma_f32_16x16x32_bf16 v[40:43], a[112:115], a[64:67], v[72:75]
    v_exp_f32 v32, v32
    v_mfma_f32_16x16x32_bf16 v[44:47], a[128:131], a[64:67], v[72:75]
    ds_read_b128 a[144:147], v6
    s_add_u32 m0, s49, 49152
    ds_read_b128 a[160:163], v6 offset:4096
    ds_read_b128 a[148:151], v7
    v_mfma_f32_16x16x32_bf16 v[40:43], a[116:119], a[68:71], v[40:43]
    v_exp_f32 v33, v33
    v_mfma_f32_16x16x32_bf16 v[44:47], a[132:135], a[68:71], v[44:47]
    v_cvt_pk_bf16_f32 v48, v32, v33
    ds_read_b128 a[164:167], v7 offset:4096
    s_add_u32 s48, s46, s47
    ds_read_b128 a[152:155], v8
    v_mfma_f32_16x16x32_bf16 v[40:43], a[120:123], a[72:75], v[40:43]
    v_exp_f32 v34, v34
    v_mfma_f32_16x16x32_bf16 v[44:47], a[136:139], a[72:75], v[44:47]
    ds_read_b128 a[168:171], v8 offset:4096
    s_waitcnt vmcnt(10)
    ds_read_b128 a[156:159], v9
    ds_read_b128 a[172:175], v9 offset:4096
    v_mfma_f32_16x16x32_bf16 v[40:43], a[124:127], a[76:79], v[40:43]
    v_exp_f32 v35, v35
    v_mfma_f32_16x16x32_bf16 v[44:47], a[140:143], a[76:79], v[44:47]
    v_cvt_pk_bf16_f32 v49, v34, v35
    buffer_load_dwordx4 v28, s[4:7], s48 offen nt lds
    s_waitcnt vmcnt(10)
    buffer_load_dwordx4 v29, s[4:7], s48 offen offset:1024 nt lds
    v_mfma_f32_16x16x32_bf16 v[192:195], a[176:179], v[52:55], v[192:195]
    v_exp_f32 v36, v36
    v_mfma_f32_16x16x32_bf16 v[196:199], a[180:183], v[52:55], v[196:199]
    ds_read_b64_tr_b16 a[176:177], v10
    s_waitcnt vmcnt(10)
    ds_read_b64_tr_b16 a[178:179], v10 offset:4096
    v_mfma_f32_16x16x32_bf16 v[200:203], a[184:187], v[52:55], v[200:203]
    v_exp_f32 v37, v37
    v_mfma_f32_16x16x32_bf16 v[204:207], a[188:191], v[52:55], v[204:207]
    v_cvt_pk_bf16_f32 v50, v36, v37
    ds_read_b64_tr_b16 a[180:181], v11
    buffer_load_dwordx4 v30, s[4:7], s48 offen offset:2048 nt lds
    v_mfma_f32_16x16x32_bf16 v[208:211], a[192:195], v[52:55], v[208:211]
    v_exp_f32 v38, v38
    v_mfma_f32_16x16x32_bf16 v[212:215], a[196:199], v[52:55], v[212:215]
    ds_read_b64_tr_b16 a[182:183], v11 offset:4096
    s_waitcnt vmcnt(10)
    ds_read_b64_tr_b16 a[184:185], v12
    v_mfma_f32_16x16x32_bf16 v[216:219], a[200:203], v[52:55], v[216:219]
    v_exp_f32 v39, v39
    v_mfma_f32_16x16x32_bf16 v[220:223], a[204:207], v[52:55], v[220:223]
    v_cvt_pk_bf16_f32 v51, v38, v39
    ds_read_b64_tr_b16 a[186:187], v12 offset:4096
    buffer_load_dwordx4 v31, s[4:7], s48 offen offset:3072 nt lds
    v_mfma_f32_16x16x32_bf16 a[100:103], a[108:111], v[52:55], a[100:103]
    ds_read_b64_tr_b16 a[188:189], v13
    s_xor_b32 m0, m0, 4096
    ds_read_b64_tr_b16 a[190:191], v13 offset:4096
    s_waitcnt lgkmcnt(8)
    v_mfma_f32_16x16x32_bf16 v[32:35], a[144:147], a[48:51], v[68:71]
    v_exp_f32 v40, v40
    v_mfma_f32_16x16x32_bf16 v[36:39], a[160:163], a[48:51], v[68:71]
    ds_read_b64_tr_b16 a[192:193], v14
    s_xor_b32 s48, s48, 4096
    ds_read_b64_tr_b16 a[194:195], v14 offset:4096
    v_mfma_f32_16x16x32_bf16 v[32:35], a[148:151], a[52:55], v[32:35]
    v_exp_f32 v41, v41
    v_mfma_f32_16x16x32_bf16 v[36:39], a[164:167], a[52:55], v[36:39]
    v_cvt_pk_bf16_f32 v52, v40, v41
    ds_read_b64_tr_b16 a[196:197], v15
    s_waitcnt vmcnt(10)
    v_mfma_f32_16x16x32_bf16 v[32:35], a[152:155], a[56:59], v[32:35]
    v_exp_f32 v42, v42
    v_mfma_f32_16x16x32_bf16 v[36:39], a[168:171], a[56:59], v[36:39]
    ds_read_b64_tr_b16 a[198:199], v15 offset:4096
    buffer_load_dwordx4 v28, s[4:7], s48 offen nt lds
    ds_read_b64_tr_b16 a[200:201], v16
    v_mfma_f32_16x16x32_bf16 v[32:35], a[156:159], a[60:63], v[32:35]
    v_exp_f32 v43, v43
    v_mfma_f32_16x16x32_bf16 v[36:39], a[172:175], a[60:63], v[36:39]
    v_cvt_pk_bf16_f32 v53, v42, v43
    ds_read_b64_tr_b16 a[202:203], v16 offset:4096
    s_waitcnt vmcnt(10)
    v_mfma_f32_16x16x32_bf16 v[160:163], a[208:211], v[48:51], v[160:163]
    v_exp_f32 v44, v44
    v_mfma_f32_16x16x32_bf16 v[164:167], a[212:215], v[48:51], v[164:167]
    ds_read_b64_tr_b16 a[204:205], v17
    buffer_load_dwordx4 v29, s[4:7], s48 offen offset:1024 nt lds
    ds_read_b64_tr_b16 a[206:207], v17 offset:4096
    v_mfma_f32_16x16x32_bf16 v[168:171], a[216:219], v[48:51], v[168:171]
    v_exp_f32 v45, v45
    v_mfma_f32_16x16x32_bf16 v[172:175], a[220:223], v[48:51], v[172:175]
    v_cvt_pk_bf16_f32 v54, v44, v45
    s_waitcnt vmcnt(10)
    buffer_load_dwordx4 v30, s[4:7], s48 offen offset:2048 nt lds
    v_mfma_f32_16x16x32_bf16 v[176:179], a[224:227], v[48:51], v[176:179]
    v_exp_f32 v46, v46
    v_mfma_f32_16x16x32_bf16 v[180:183], a[228:231], v[48:51], v[180:183]
    s_waitcnt vmcnt(10)
    buffer_load_dwordx4 v31, s[4:7], s48 offen offset:3072 nt lds
    s_add_u32 s47, s47, s89
    v_mfma_f32_16x16x32_bf16 v[184:187], a[232:235], v[48:51], v[184:187]
    v_exp_f32 v47, v47
    v_mfma_f32_16x16x32_bf16 v[188:191], a[236:239], v[48:51], v[188:191]
    v_cvt_pk_bf16_f32 v55, v46, v47
    s_and_b32 s47, s47, 0x3ffff
    v_mfma_f32_16x16x32_bf16 a[96:99], a[108:111], v[48:51], a[96:99]
    s_mov_b32 s54, 6
L_loop_B11:
    s_waitcnt lgkmcnt(0)
    s_barrier
    v_mfma_f32_16x16x32_bf16 v[40:43], a[144:147], a[64:67], v[72:75]
    v_exp_f32 v32, v32
    v_mfma_f32_16x16x32_bf16 v[44:47], a[160:163], a[64:67], v[72:75]
    ds_read_b128 a[112:115], v6 offset:16384
    s_add_u32 m0, s49, 0
    ds_read_b128 a[128:131], v6 offset:20480
    ds_read_b128 a[116:119], v7 offset:16384
    v_mfma_f32_16x16x32_bf16 v[40:43], a[148:151], a[68:71], v[40:43]
    v_exp_f32 v33, v33
    v_mfma_f32_16x16x32_bf16 v[44:47], a[164:167], a[68:71], v[44:47]
    v_cvt_pk_bf16_f32 v48, v32, v33
    ds_read_b128 a[132:135], v7 offset:20480
    s_add_u32 s48, s46, s47
    ds_read_b128 a[120:123], v8 offset:16384
    v_mfma_f32_16x16x32_bf16 v[40:43], a[152:155], a[72:75], v[40:43]
    v_exp_f32 v34, v34
    v_mfma_f32_16x16x32_bf16 v[44:47], a[168:171], a[72:75], v[44:47]
    ds_read_b128 a[136:139], v8 offset:20480
    s_waitcnt vmcnt(10)
    ds_read_b128 a[124:127], v9 offset:16384
    ds_read_b128 a[140:143], v9 offset:20480
    v_mfma_f32_16x16x32_bf16 v[40:43], a[156:159], a[76:79], v[40:43]
    v_exp_f32 v35, v35
    v_mfma_f32_16x16x32_bf16 v[44:47], a[172:175], a[76:79], v[44:47]
    v_cvt_pk_bf16_f32 v49, v34, v35
    buffer_load_dwordx4 v28, s[4:7], s48 offen nt lds
    s_waitcnt vmcnt(10)
    buffer_load_dwordx4 v29, s[4:7], s48 offen offset:1024 nt lds
    v_mfma_f32_16x16x32_bf16 v[192:195], a[208:211], v[52:55], v[192:195]
    v_exp_f32 v36, v36
    v_mfma_f32_16x16x32_bf16 v[196:199], a[212:215], v[52:55], v[196:199]
    ds_read_b64_tr_b16 a[208:209], v10 offset:16384
    s_waitcnt vmcnt(10)
    ds_read_b64_tr_b16 a[210:211], v10 offset:20480
    v_mfma_f32_16x16x32_bf16 v[200:203], a[216:219], v[52:55], v[200:203]
    v_exp_f32 v37, v37
    v_mfma_f32_16x16x32_bf16 v[204:207], a[220:223], v[52:55], v[204:207]
    v_cvt_pk_bf16_f32 v50, v36, v37
    ds_read_b64_tr_b16 a[212:213], v11 offset:16384
    buffer_load_dwordx4 v30, s[4:7], s48 offen offset:2048 nt lds
    v_mfma_f32_16x16x32_bf16 v[208:211], a[224:227], v[52:55], v[208:211]
    v_exp_f32 v38, v38
    v_mfma_f32_16x16x32_bf16 v[212:215], a[228:231], v[52:55], v[212:215]
    ds_read_b64_tr_b16 a[214:215], v11 offset:20480
    s_waitcnt vmcnt(10)
    ds_read_b64_tr_b16 a[216:217], v12 offset:16384
    v_mfma_f32_16x16x32_bf16 v[216:219], a[232:235], v[52:55], v[216:219]
    v_exp_f32 v39, v39
    v_mfma_f32_16x16x32_bf16 v[220:223], a[236:239], v[52:55], v[220:223]
    v_cvt_pk_bf16_f32 v51, v38, v39
    ds_read_b64_tr_b16 a[218:219], v12 offset:20480
    buffer_load_dwordx4 v31, s[4:7], s48 offen offset:3072 nt lds
    v_mfma_f32_16x16x32_bf16 a[100:103], a[108:111], v[52:55], a[100:103]
    ds_read_b64_tr_b16 a[220:221], v13 offset:16384
    s_xor_b32 m0, m0, 4096
    ds_read_b64_tr_b16 a[222:223], v13 offset:20480
    s_waitcnt lgkmcnt(8)
    v_mfma_f32_16x16x32_bf16 v[32:35], a[112:115], a[48:51], v[68:71]
    v_exp_f32 v40, v40
    v_mfma_f32_16x16x32_bf16 v[36:39], a[128:131], a[48:51], v[68:71]
    ds_read_b64_tr_b16 a[224:225], v14 offset:16384
    s_xor_b32 s48, s48, 4096
    ds_read_b64_tr_b16 a[226:227], v14 offset:20480
    v_mfma_f32_16x16x32_bf16 v[32:35], a[116:119], a[52:55], v[32:35]
    v_exp_f32 v41, v41
    v_mfma_f32_16x16x32_bf16 v[36:39], a[132:135], a[52:55], v[36:39]
    v_cvt_pk_bf16_f32 v52, v40, v41
    ds_read_b64_tr_b16 a[228:229], v15 offset:16384
    s_waitcnt vmcnt(10)
    v_mfma_f32_16x16x32_bf16 v[32:35], a[120:123], a[56:59], v[32:35]
    v_exp_f32 v42, v42
    v_mfma_f32_16x16x32_bf16 v[36:39], a[136:139], a[56:59], v[36:39]
    ds_read_b64_tr_b16 a[230:231], v15 offset:20480
    buffer_load_dwordx4 v28, s[4:7], s48 offen nt lds
    ds_read_b64_tr_b16 a[232:233], v16 offset:16384
    v_mfma_f32_16x16x32_bf16 v[32:35], a[124:127], a[60:63], v[32:35]
    v_exp_f32 v43, v43
    v_mfma_f32_16x16x32_bf16 v[36:39], a[140:143], a[60:63], v[36:39]
    v_cvt_pk_bf16_f32 v53, v42, v43
    ds_read_b64_tr_b16 a[234:235], v16 offset:20480
    s_waitcnt vmcnt(10)
    v_mfma_f32_16x16x32_bf16 v[160:163], a[176:179], v[48:51], v[160:163]
    v_exp_f32 v44, v44
    v_mfma_f32_16x16x32_bf16 v[164:167], a[180:183], v[48:51], v[164:167]
    ds_read_b64_tr_b16 a[236:237], v17 offset:16384
    buffer_load_dwordx4 v29, s[4:7], s48 offen offset:1024 nt lds
    ds_read_b64_tr_b16 a[238:239], v17 offset:20480
    v_mfma_f32_16x16x32_bf16 v[168:171], a[184:187], v[48:51], v[168:171]
    v_exp_f32 v45, v45
    v_mfma_f32_16x16x32_bf16 v[172:175], a[188:191], v[48:51], v[172:175]
    v_cvt_pk_bf16_f32 v54, v44, v45
    s_waitcnt vmcnt(10)
    buffer_load_dwordx4 v30, s[4:7], s48 offen offset:2048 nt lds
    v_mfma_f32_16x16x32_bf16 v[176:179], a[192:195], v[48:51], v[176:179]
    v_exp_f32 v46, v46
    v_mfma_f32_16x16x32_bf16 v[180:183], a[196:199], v[48:51], v[180:183]
    s_waitcnt vmcnt(10)
    buffer_load_dwordx4 v31, s[4:7], s48 offen offset:3072 nt lds
    s_add_u32 s47, s47, s89
    v_mfma_f32_16x16x32_bf16 v[184:187], a[200:203], v[48:51], v[184:187]
    v_exp_f32 v47, v47
    v_mfma_f32_16x16x32_bf16 v[188:191], a[204:207], v[48:51], v[188:191]
    v_cvt_pk_bf16_f32 v55, v46, v47
    s_and_b32 s47, s47, 0x3ffff
    v_mfma_f32_16x16x32_bf16 a[96:99], a[108:111], v[48:51], a[96:99]
    s_waitcnt lgkmcnt(0)
    s_barrier
    v_mfma_f32_16x16x32_bf16 v[40:43], a[112:115], a[64:67], v[72:75]
    v_exp_f32 v32, v32
    v_mfma_f32_16x16x32_bf16 v[44:47], a[128:131], a[64:67], v[72:75]
    ds_read_b128 a[144:147], v6 offset:32768
    s_add_u32 m0, s49, 16384
    ds_read_b128 a[160:163], v6 offset:36864
    ds_read_b128 a[148:151], v7 offset:32768
    v_mfma_f32_16x16x32_bf16 v[40:43], a[116:119], a[68:71], v[40:43]
    v_exp_f32 v33, v33
    v_mfma_f32_16x16x32_bf16 v[44:47], a[132:135], a[68:71], v[44:47]
    v_cvt_pk_bf16_f32 v48, v32, v33
    ds_read_b128 a[164:167], v7 offset:36864
    s_add_u32 s48, s46, s47
    ds_read_b128 a[152:155], v8 offset:32768
    v_mfma_f32_16x16x32_bf16 v[40:43], a[120:123], a[72:75], v[40:43]
    v_exp_f32 v34, v34
    v_mfma_f32_16x16x32_bf16 v[44:47], a[136:139], a[72:75], v[44:47]
    ds_read_b128 a[168:171], v8 offset:36864
    s_waitcnt vmcnt(10)
    ds_read_b128 a[156:159], v9 offset:32768
    ds_read_b128 a[172:175], v9 offset:36864
    v_mfma_f32_16x16x32_bf16 v[40:43], a[124:127], a[76:79], v[40:43]
    v_exp_f32 v35, v35
    v_mfma_f32_16x16x32_bf16 v[44:47], a[140:143], a[76:79], v[44:47]
    v_cvt_pk_bf16_f32 v49, v34, v35
    buffer_load_dwordx4 v28, s[4:7], s48 offen nt lds
    s_waitcnt vmcnt(10)
    buffer_load_dwordx4 v29, s[4:7], s48 offen offset:1024 nt lds
    v_mfma_f32_16x16x32_bf16 v[192:195], a[176:179], v[52:55], v[192:195]
    v_exp_f32 v36, v36
    v_mfma_f32_16x16x32_bf16 v[196:199], a[180:183], v[52:55], v[196:199]
    ds_read_b64_tr_b16 a[176:177], v10 offset:32768
    s_waitcnt vmcnt(10)
    ds_read_b64_tr_b16 a[178:179], v10 offset:36864
    v_mfma_f32_16x16x32_bf16 v[200:203], a[184:187], v[52:55], v[200:203]
    v_exp_f32 v37, v37
    v_mfma_f32_16x16x32_bf16 v[204:207], a[188:191], v[52:55], v[204:207]
    v_cvt_pk_bf16_f32 v50, v36, v37
    ds_read_b64_tr_b16 a[180:181], v11 offset:32768
    buffer_load_dwordx4 v30, s[4:7], s48 offen offset:2048 nt lds
    v_mfma_f32_16x16x32_bf16 v[208:211], a[192:195], v[52:55], v[208:211]
    v_exp_f32 v38, v38
    v_mfma_f32_16x16x32_bf16 v[212:215], a[196:199], v[52:55], v[212:215]
    ds_read_b64_tr_b16 a[182:183], v11 offset:36864
    s_waitcnt vmcnt(10)
    ds_read_b64_tr_b16 a[184:185], v12 offset:32768
    v_mfma_f32_16x16x32_bf16 v[216:219], a[200:203], v[52:55], v[216:219]
    v_exp_f32 v39, v39
    v_mfma_f32_16x16x32_bf16 v[220:223], a[204:207], v[52:55], v[220:223]
    v_cvt_pk_bf16_f32 v51, v38, v39
    ds_read_b64_tr_b16 a[186:187], v12 offset:36864
    buffer_load_dwordx4 v31, s[4:7], s48 offen offset:3072 nt lds
    v_mfma_f32_16x16x32_bf16 a[100:103], a[108:111], v[52:55], a[100:103]
    ds_read_b64_tr_b16 a[188:189], v13 offset:32768
    s_xor_b32 m0, m0, 4096
    ds_read_b64_tr_b16 a[190:191], v13 offset:36864
    s_waitcnt lgkmcnt(8)
    v_mfma_f32_16x16x32_bf16 v[32:35], a[144:147], a[48:51], v[68:71]
    v_exp_f32 v40, v40
    v_mfma_f32_16x16x32_bf16 v[36:39], a[160:163], a[48:51], v[68:71]
    ds_read_b64_tr_b16 a[192:193], v14 offset:32768
    s_xor_b32 s48, s48, 4096
    ds_read_b64_tr_b16 a[194:195], v14 offset:36864
    v_mfma_f32_16x16x32_bf16 v[32:35], a[148:151], a[52:55], v[32:35]
    v_exp_f32 v41, v41
    v_mfma_f32_16x16x32_bf16 v[36:39], a[164:167], a[52:55], v[36:39]
    v_cvt_pk_bf16_f32 v52, v40, v41
    ds_read_b64_tr_b16 a[196:197], v15 offset:32768
    s_waitcnt vmcnt(10)
    v_mfma_f32_16x16x32_bf16 v[32:35], a[152:155], a[56:59], v[32:35]
    v_exp_f32 v42, v42
    v_mfma_f32_16x16x32_bf16 v[36:39], a[168:171], a[56:59], v[36:39]
    ds_read_b64_tr_b16 a[198:199], v15 offset:36864
    buffer_load_dwordx4 v28, s[4:7], s48 offen nt lds
    ds_read_b64_tr_b16 a[200:201], v16 offset:32768
    v_mfma_f32_16x16x32_bf16 v[32:35], a[156:159], a[60:63], v[32:35]
    v_exp_f32 v43, v43
    v_mfma_f32_16x16x32_bf16 v[36:39], a[172:175], a[60:63], v[36:39]
    v_cvt_pk_bf16_f32 v53, v42, v43
    ds_read_b64_tr_b16 a[202:203], v16 offset:36864
    s_waitcnt vmcnt(10)
    v_mfma_f32_16x16x32_bf16 v[160:163], a[208:211], v[48:51], v[160:163]
    v_exp_f32 v44, v44
    v_mfma_f32_16x16x32_bf16 v[164:167], a[212:215], v[48:51], v[164:167]
    ds_read_b64_tr_b16 a[204:205], v17 offset:32768
    buffer_load_dwordx4 v29, s[4:7], s48 offen offset:1024 nt lds
    ds_read_b64_tr_b16 a[206:207], v17 offset:36864
    v_mfma_f32_16x16x32_bf16 v[168:171], a[216:219], v[48:51], v[168:171]
    v_exp_f32 v45, v45
    v_mfma_f32_16x16x32_bf16 v[172:175], a[220:223], v[48:51], v[172:175]
    v_cvt_pk_bf16_f32 v54, v44, v45
    s_waitcnt vmcnt(10)
    buffer_load_dwordx4 v30, s[4:7], s48 offen offset:2048 nt lds
    v_mfma_f32_16x16x32_bf16 v[176:179], a[224:227], v[48:51], v[176:179]
    v_exp_f32 v46, v46
    v_mfma_f32_16x16x32_bf16 v[180:183], a[228:231], v[48:51], v[180:183]
    s_waitcnt vmcnt(10)
    buffer_load_dwordx4 v31, s[4:7], s48 offen offset:3072 nt lds
    s_add_u32 s47, s47, s89
    v_mfma_f32_16x16x32_bf16 v[184:187], a[232:235], v[48:51], v[184:187]
    v_exp_f32 v47, v47
    v_mfma_f32_16x16x32_bf16 v[188:191], a[236:239], v[48:51], v[188:191]
    v_cvt_pk_bf16_f32 v55, v46, v47
    s_and_b32 s47, s47, 0x3ffff
    v_mfma_f32_16x16x32_bf16 a[96:99], a[108:111], v[48:51], a[96:99]
    s_waitcnt lgkmcnt(0)
    s_barrier
    v_mfma_f32_16x16x32_bf16 v[40:43], a[144:147], a[64:67], v[72:75]
    v_exp_f32 v32, v32
    v_mfma_f32_16x16x32_bf16 v[44:47], a[160:163], a[64:67], v[72:75]
    ds_read_b128 a[112:115], v6 offset:49152
    s_add_u32 m0, s49, 32768
    ds_read_b128 a[128:131], v6 offset:53248
    ds_read_b128 a[116:119], v7 offset:49152
    v_mfma_f32_16x16x32_bf16 v[40:43], a[148:151], a[68:71], v[40:43]
    v_exp_f32 v33, v33
    v_mfma_f32_16x16x32_bf16 v[44:47], a[164:167], a[68:71], v[44:47]
    v_cvt_pk_bf16_f32 v48, v32, v33
    ds_read_b128 a[132:135], v7 offset:53248
    s_add_u32 s48, s46, s47
    ds_read_b128 a[120:123], v8 offset:49152
    v_mfma_f32_16x16x32_bf16 v[40:43], a[152:155], a[72:75], v[40:43]
    v_exp_f32 v34, v34
    v_mfma_f32_16x16x32_bf16 v[44:47], a[168:171], a[72:75], v[44:47]
    ds_read_b128 a[136:139], v8 offset:53248
    s_waitcnt vmcnt(10)
    ds_read_b128 a[124:127], v9 offset:49152
    ds_read_b128 a[140:143], v9 offset:53248
    v_mfma_f32_16x16x32_bf16 v[40:43], a[156:159], a[76:79], v[40:43]
    v_exp_f32 v35, v35
    v_mfma_f32_16x16x32_bf16 v[44:47], a[172:175], a[76:79], v[44:47]
    v_cvt_pk_bf16_f32 v49, v34, v35
    buffer_load_dwordx4 v28, s[4:7], s48 offen nt lds
    s_waitcnt vmcnt(10)
    buffer_load_dwordx4 v29, s[4:7], s48 offen offset:1024 nt lds
    v_mfma_f32_16x16x32_bf16 v[192:195], a[208:211], v[52:55], v[192:195]
    v_exp_f32 v36, v36
    v_mfma_f32_16x16x32_bf16 v[196:199], a[212:215], v[52:55], v[196:199]
    ds_read_b64_tr_b16 a[208:209], v10 offset:49152
    s_waitcnt vmcnt(10)
    ds_read_b64_tr_b16 a[210:211], v10 offset:53248
    v_mfma_f32_16x16x32_bf16 v[200:203], a[216:219], v[52:55], v[200:203]
    v_exp_f32 v37, v37
    v_mfma_f32_16x16x32_bf16 v[204:207], a[220:223], v[52:55], v[204:207]
    v_cvt_pk_bf16_f32 v50, v36, v37
    ds_read_b64_tr_b16 a[212:213], v11 offset:49152
    buffer_load_dwordx4 v30, s[4:7], s48 offen offset:2048 nt lds
    v_mfma_f32_16x16x32_bf16 v[208:211], a[224:227], v[52:55], v[208:211]
    v_exp_f32 v38, v38
    v_mfma_f32_16x16x32_bf16 v[212:215], a[228:231], v[52:55], v[212:215]
    ds_read_b64_tr_b16 a[214:215], v11 offset:53248
    s_waitcnt vmcnt(10)
    ds_read_b64_tr_b16 a[216:217], v12 offset:49152
    v_mfma_f32_16x16x32_bf16 v[216:219], a[232:235], v[52:55], v[216:219]
    v_exp_f32 v39, v39
    v_mfma_f32_16x16x32_bf16 v[220:223], a[236:239], v[52:55], v[220:223]
    v_cvt_pk_bf16_f32 v51, v38, v39
    ds_read_b64_tr_b16 a[218:219], v12 offset:53248
    buffer_load_dwordx4 v31, s[4:7], s48 offen offset:3072 nt lds
    v_mfma_f32_16x16x32_bf16 a[100:103], a[108:111], v[52:55], a[100:103]
    ds_read_b64_tr_b16 a[220:221], v13 offset:49152
    s_xor_b32 m0, m0, 4096
    ds_read_b64_tr_b16 a[222:223], v13 offset:53248
    s_waitcnt lgkmcnt(8)
    v_mfma_f32_16x16x32_bf16 v[32:35], a[112:115], a[48:51], v[68:71]
    v_exp_f32 v40, v40
    v_mfma_f32_16x16x32_bf16 v[36:39], a[128:131], a[48:51], v[68:71]
    ds_read_b64_tr_b16 a[224:225], v14 offset:49152
    s_xor_b32 s48, s48, 4096
    ds_read_b64_tr_b16 a[226:227], v14 offset:53248
    v_mfma_f32_16x16x32_bf16 v[32:35], a[116:119], a[52:55], v[32:35]
    v_exp_f32 v41, v41
    v_mfma_f32_16x16x32_bf16 v[36:39], a[132:135], a[52:55], v[36:39]
    v_cvt_pk_bf16_f32 v52, v40, v41
    ds_read_b64_tr_b16 a[228:229], v15 offset:49152
    s_waitcnt vmcnt(10)
    v_mfma_f32_16x16x32_bf16 v[32:35], a[120:123], a[56:59], v[32:35]
    v_exp_f32 v42, v42
    v_mfma_f32_16x16x32_bf16 v[36:39], a[136:139], a[56:59], v[36:39]
    ds_read_b64_tr_b16 a[230:231], v15 offset:53248
    buffer_load_dwordx4 v28, s[4:7], s48 offen nt lds
    ds_read_b64_tr_b16 a[232:233], v16 offset:49152
    v_mfma_f32_16x16x32_bf16 v[32:35], a[124:127], a[60:63], v[32:35]
    v_exp_f32 v43, v43
    v_mfma_f32_16x16x32_bf16 v[36:39], a[140:143], a[60:63], v[36:39]
    v_cvt_pk_bf16_f32 v53, v42, v43
    ds_read_b64_tr_b16 a[234:235], v16 offset:53248
    s_waitcnt vmcnt(10)
    v_mfma_f32_16x16x32_bf16 v[160:163], a[176:179], v[48:51], v[160:163]
    v_exp_f32 v44, v44
    v_mfma_f32_16x16x32_bf16 v[164:167], a[180:183], v[48:51], v[164:167]
    ds_read_b64_tr_b16 a[236:237], v17 offset:49152
    buffer_load_dwordx4 v29, s[4:7], s48 offen offset:1024 nt lds
    ds_read_b64_tr_b16 a[238:239], v17 offset:53248
    v_mfma_f32_16x16x32_bf16 v[168:171], a[184:187], v[48:51], v[168:171]
    v_exp_f32 v45, v45
    v_mfma_f32_16x16x32_bf16 v[172:175], a[188:191], v[48:51], v[172:175]
    v_cvt_pk_bf16_f32 v54, v44, v45
    s_waitcnt vmcnt(10)
    buffer_load_dwordx4 v30, s[4:7], s48 offen offset:2048 nt lds
    v_mfma_f32_16x16x32_bf16 v[176:179], a[192:195], v[48:51], v[176:179]
    v_exp_f32 v46, v46
    v_mfma_f32_16x16x32_bf16 v[180:183], a[196:199], v[48:51], v[180:183]
    s_waitcnt vmcnt(10)
    buffer_load_dwordx4 v31, s[4:7], s48 offen offset:3072 nt lds
    s_add_u32 s47, s47, s89
    v_mfma_f32_16x16x32_bf16 v[184:187], a[200:203], v[48:51], v[184:187]
    v_exp_f32 v47, v47
    v_mfma_f32_16x16x32_bf16 v[188:191], a[204:207], v[48:51], v[188:191]
    v_cvt_pk_bf16_f32 v55, v46, v47
    s_and_b32 s47, s47, 0x3ffff
    v_mfma_f32_16x16x32_bf16 a[96:99], a[108:111], v[48:51], a[96:99]
    s_waitcnt lgkmcnt(0)
    s_barrier
    v_mfma_f32_16x16x32_bf16 v[40:43], a[112:115], a[64:67], v[72:75]
    v_exp_f32 v32, v32
    v_mfma_f32_16x16x32_bf16 v[44:47], a[128:131], a[64:67], v[72:75]
    ds_read_b128 a[144:147], v6
    s_add_u32 m0, s49, 49152
    ds_read_b128 a[160:163], v6 offset:4096
    ds_read_b128 a[148:151], v7
    v_mfma_f32_16x16x32_bf16 v[40:43], a[116:119], a[68:71], v[40:43]
    v_exp_f32 v33, v33
    v_mfma_f32_16x16x32_bf16 v[44:47], a[132:135], a[68:71], v[44:47]
    v_cvt_pk_bf16_f32 v48, v32, v33
    ds_read_b128 a[164:167], v7 offset:4096
    s_add_u32 s48, s46, s47
    ds_read_b128 a[152:155], v8
    v_mfma_f32_16x16x32_bf16 v[40:43], a[120:123], a[72:75], v[40:43]
    v_exp_f32 v34, v34
    v_mfma_f32_16x16x32_bf16 v[44:47], a[136:139], a[72:75], v[44:47]
    ds_read_b128 a[168:171], v8 offset:4096
    s_waitcnt vmcnt(10)
    ds_read_b128 a[156:159], v9
    ds_read_b128 a[172:175], v9 offset:4096
    v_mfma_f32_16x16x32_bf16 v[40:43], a[124:127], a[76:79], v[40:43]
    v_exp_f32 v35, v35
    v_mfma_f32_16x16x32_bf16 v[44:47], a[140:143], a[76:79], v[44:47]
    v_cvt_pk_bf16_f32 v49, v34, v35
    buffer_load_dwordx4 v28, s[4:7], s48 offen nt lds
    s_waitcnt vmcnt(10)
    buffer_load_dwordx4 v29, s[4:7], s48 offen offset:1024 nt lds
    v_mfma_f32_16x16x32_bf16 v[192:195], a[176:179], v[52:55], v[192:195]
    v_exp_f32 v36, v36
    v_mfma_f32_16x16x32_bf16 v[196:199], a[180:183], v[52:55], v[196:199]
    ds_read_b64_tr_b16 a[176:177], v10
    s_waitcnt vmcnt(10)
    ds_read_b64_tr_b16 a[178:179], v10 offset:4096
    v_mfma_f32_16x16x32_bf16 v[200:203], a[184:187], v[52:55], v[200:203]
    v_exp_f32 v37, v37
    v_mfma_f32_16x16x32_bf16 v[204:207], a[188:191], v[52:55], v[204:207]
    v_cvt_pk_bf16_f32 v50, v36, v37
    ds_read_b64_tr_b16 a[180:181], v11
    buffer_load_dwordx4 v30, s[4:7], s48 offen offset:2048 nt lds
    v_mfma_f32_16x16x32_bf16 v[208:211], a[192:195], v[52:55], v[208:211]
    v_exp_f32 v38, v38
    v_mfma_f32_16x16x32_bf16 v[212:215], a[196:199], v[52:55], v[212:215]
    ds_read_b64_tr_b16 a[182:183], v11 offset:4096
    s_waitcnt vmcnt(10)
    ds_read_b64_tr_b16 a[184:185], v12
    v_mfma_f32_16x16x32_bf16 v[216:219], a[200:203], v[52:55], v[216:219]
    v_exp_f32 v39, v39
    v_mfma_f32_16x16x32_bf16 v[220:223], a[204:207], v[52:55], v[220:223]
    v_cvt_pk_bf16_f32 v51, v38, v39
    ds_read_b64_tr_b16 a[186:187], v12 offset:4096
    buffer_load_dwordx4 v31, s[4:7], s48 offen offset:3072 nt lds
    v_mfma_f32_16x16x32_bf16 a[100:103], a[108:111], v[52:55], a[100:103]
    ds_read_b64_tr_b16 a[188:189], v13
    s_xor_b32 m0, m0, 4096
    ds_read_b64_tr_b16 a[190:191], v13 offset:4096
    s_waitcnt lgkmcnt(8)
    v_mfma_f32_16x16x32_bf16 v[32:35], a[144:147], a[48:51], v[68:71]
    v_exp_f32 v40, v40
    v_mfma_f32_16x16x32_bf16 v[36:39], a[160:163], a[48:51], v[68:71]
    ds_read_b64_tr_b16 a[192:193], v14
    s_xor_b32 s48, s48, 4096
    ds_read_b64_tr_b16 a[194:195], v14 offset:4096
    v_mfma_f32_16x16x32_bf16 v[32:35], a[148:151], a[52:55], v[32:35]
    v_exp_f32 v41, v41
    v_mfma_f32_16x16x32_bf16 v[36:39], a[164:167], a[52:55], v[36:39]
    v_cvt_pk_bf16_f32 v52, v40, v41
    ds_read_b64_tr_b16 a[196:197], v15
    s_waitcnt vmcnt(10)
    v_mfma_f32_16x16x32_bf16 v[32:35], a[152:155], a[56:59], v[32:35]
    v_exp_f32 v42, v42
    v_mfma_f32_16x16x32_bf16 v[36:39], a[168:171], a[56:59], v[36:39]
    ds_read_b64_tr_b16 a[198:199], v15 offset:4096
    buffer_load_dwordx4 v28, s[4:7], s48 offen nt lds
    ds_read_b64_tr_b16 a[200:201], v16
    v_mfma_f32_16x16x32_bf16 v[32:35], a[156:159], a[60:63], v[32:35]
    v_exp_f32 v43, v43
    v_mfma_f32_16x16x32_bf16 v[36:39], a[172:175], a[60:63], v[36:39]
    v_cvt_pk_bf16_f32 v53, v42, v43
    ds_read_b64_tr_b16 a[202:203], v16 offset:4096
    s_waitcnt vmcnt(10)
    v_mfma_f32_16x16x32_bf16 v[160:163], a[208:211], v[48:51], v[160:163]
    v_exp_f32 v44, v44
    v_mfma_f32_16x16x32_bf16 v[164:167], a[212:215], v[48:51], v[164:167]
    ds_read_b64_tr_b16 a[204:205], v17
    buffer_load_dwordx4 v29, s[4:7], s48 offen offset:1024 nt lds
    ds_read_b64_tr_b16 a[206:207], v17 offset:4096
    v_mfma_f32_16x16x32_bf16 v[168:171], a[216:219], v[48:51], v[168:171]
    v_exp_f32 v45, v45
    v_mfma_f32_16x16x32_bf16 v[172:175], a[220:223], v[48:51], v[172:175]
    v_cvt_pk_bf16_f32 v54, v44, v45
    s_waitcnt vmcnt(10)
    buffer_load_dwordx4 v30, s[4:7], s48 offen offset:2048 nt lds
    v_mfma_f32_16x16x32_bf16 v[176:179], a[224:227], v[48:51], v[176:179]
    v_exp_f32 v46, v46
    v_mfma_f32_16x16x32_bf16 v[180:183], a[228:231], v[48:51], v[180:183]
    s_waitcnt vmcnt(10)
    buffer_load_dwordx4 v31, s[4:7], s48 offen offset:3072 nt lds
    s_add_u32 s47, s47, s89
    v_mfma_f32_16x16x32_bf16 v[184:187], a[232:235], v[48:51], v[184:187]
    v_exp_f32 v47, v47
    v_mfma_f32_16x16x32_bf16 v[188:191], a[236:239], v[48:51], v[188:191]
    v_cvt_pk_bf16_f32 v55, v46, v47
    s_and_b32 s47, s47, 0x3ffff
    v_mfma_f32_16x16x32_bf16 a[96:99], a[108:111], v[48:51], a[96:99]
    s_sub_u32 s54, s54, 1
    s_cmp_lg_u32 s54, 0
    s_cbranch_scc1 L_loop_B11
    s_waitcnt lgkmcnt(0)
    s_barrier
    v_mfma_f32_16x16x32_bf16 v[40:43], a[144:147], a[64:67], v[72:75]
    v_exp_f32 v32, v32
    v_mfma_f32_16x16x32_bf16 v[44:47], a[160:163], a[64:67], v[72:75]
    ds_read_b128 a[112:115], v6 offset:16384
    s_sub_u32 s40, s36, 1
    ds_read_b128 a[128:131], v6 offset:20480
    ds_read_b128 a[116:119], v7 offset:16384
    v_mfma_f32_16x16x32_bf16 v[40:43], a[148:151], a[68:71], v[40:43]
    v_exp_f32 v33, v33
    v_mfma_f32_16x16x32_bf16 v[44:47], a[164:167], a[68:71], v[44:47]
    v_cvt_pk_bf16_f32 v48, v32, v33
    ds_read_b128 a[132:135], v7 offset:20480
    s_add_u32 s77, s43, 1
    ds_read_b128 a[120:123], v8 offset:16384
    v_mfma_f32_16x16x32_bf16 v[40:43], a[152:155], a[72:75], v[40:43]
    v_exp_f32 v34, v34
    v_mfma_f32_16x16x32_bf16 v[44:47], a[168:171], a[72:75], v[44:47]
    ds_read_b128 a[136:139], v8 offset:20480
    s_and_b32 s77, s77, 3
    ds_read_b128 a[124:127], v9 offset:16384
    ds_read_b128 a[140:143], v9 offset:20480
    v_mfma_f32_16x16x32_bf16 v[40:43], a[156:159], a[76:79], v[40:43]
    v_exp_f32 v35, v35
    v_mfma_f32_16x16x32_bf16 v[44:47], a[172:175], a[76:79], v[44:47]
    v_cvt_pk_bf16_f32 v49, v34, v35
    s_lshl_b32 s77, s77, 2
    s_add_u32 s77, s77, 0
    s_xor_b32 s77, s77, s3
    v_mfma_f32_16x16x32_bf16 v[192:195], a[208:211], v[52:55], v[192:195]
    v_exp_f32 v36, v36
    v_mfma_f32_16x16x32_bf16 v[196:199], a[212:215], v[52:55], v[196:199]
    ds_read_b64_tr_b16 a[208:209], v10 offset:16384
    s_lshl_b32 s77, s77, 16
    ds_read_b64_tr_b16 a[210:211], v10 offset:20480
    v_mfma_f32_16x16x32_bf16 v[200:203], a[216:219], v[52:55], v[200:203]
    v_exp_f32 v37, v37
    v_mfma_f32_16x16x32_bf16 v[204:207], a[220:223], v[52:55], v[204:207]
    v_cvt_pk_bf16_f32 v50, v36, v37
    ds_read_b64_tr_b16 a[212:213], v11 offset:16384
    s_add_u32 s77, s77, s60
    v_mfma_f32_16x16x32_bf16 v[208:211], a[224:227], v[52:55], v[208:211]
    v_exp_f32 v38, v38
    v_mfma_f32_16x16x32_bf16 v[212:215], a[228:231], v[52:55], v[212:215]
    ds_read_b64_tr_b16 a[214:215], v11 offset:20480
    s_lshl_b32 s41, s40, 15
    ds_read_b64_tr_b16 a[216:217], v12 offset:16384
    v_mfma_f32_16x16x32_bf16 v[216:219], a[232:235], v[52:55], v[216:219]
    v_exp_f32 v39, v39
    v_mfma_f32_16x16x32_bf16 v[220:223], a[236:239], v[52:55], v[220:223]
    v_cvt_pk_bf16_f32 v51, v38, v39
    ds_read_b64_tr_b16 a[218:219], v12 offset:20480
    s_add_u32 s77, s77, s41
    v_mfma_f32_16x16x32_bf16 a[100:103], a[108:111], v[52:55], a[100:103]
    ds_read_b64_tr_b16 a[220:221], v13 offset:16384
    s_lshl_b32 s41, s40, 13
    ds_read_b64_tr_b16 a[222:223], v13 offset:20480
    s_waitcnt lgkmcnt(8)
    v_mfma_f32_16x16x32_bf16 v[32:35], a[112:115], a[48:51], v[68:71]
    v_exp_f32 v40, v40
    v_mfma_f32_16x16x32_bf16 v[36:39], a[128:131], a[48:51], v[68:71]
    ds_read_b64_tr_b16 a[224:225], v14 offset:16384
    s_add_u32 m0, s41, 0
    ds_read_b64_tr_b16 a[226:227], v14 offset:20480
    v_mfma_f32_16x16x32_bf16 v[32:35], a[116:119], a[52:55], v[32:35]
    v_exp_f32 v41, v41
    v_mfma_f32_16x16x32_bf16 v[36:39], a[132:135], a[52:55], v[36:39]
    v_cvt_pk_bf16_f32 v52, v40, v41
    ds_read_b64_tr_b16 a[228:229], v15 offset:16384
    buffer_load_dwordx4 v24, s[24:27], s77 offen lds
    v_mfma_f32_16x16x32_bf16 v[32:35], a[120:123], a[56:59], v[32:35]
    v_exp_f32 v42, v42
    v_mfma_f32_16x16x32_bf16 v[36:39], a[136:139], a[56:59], v[36:39]
    ds_read_b64_tr_b16 a[230:231], v15 offset:20480
    buffer_load_dwordx4 v25, s[24:27], s77 offen offset:1024 lds
    ds_read_b64_tr_b16 a[232:233], v16 offset:16384
    v_mfma_f32_16x16x32_bf16 v[32:35], a[124:127], a[60:63], v[32:35]
    v_exp_f32 v43, v43
    v_mfma_f32_16x16x32_bf16 v[36:39], a[140:143], a[60:63], v[36:39]
    v_cvt_pk_bf16_f32 v53, v42, v43
    ds_read_b64_tr_b16 a[234:235], v16 offset:20480
    buffer_load_dwordx4 v26, s[24:27], s77 offen offset:2048 lds
    v_mfma_f32_16x16x32_bf16 v[160:163], a[176:179], v[48:51], v[160:163]
    v_exp_f32 v44, v44
    v_mfma_f32_16x16x32_bf16 v[164:167], a[180:183], v[48:51], v[164:167]
    ds_read_b64_tr_b16 a[236:237], v17 offset:16384
    buffer_load_dwordx4 v27, s[24:27], s77 offen offset:3072 lds
    ds_read_b64_tr_b16 a[238:239], v17 offset:20480
    v_mfma_f32_16x16x32_bf16 v[168:171], a[184:187], v[48:51], v[168:171]
    v_exp_f32 v45, v45
    v_mfma_f32_16x16x32_bf16 v[172:175], a[188:191], v[48:51], v[172:175]
    v_cvt_pk_bf16_f32 v54, v44, v45
    s_add_u32 m0, s41, 4096
    s_add_u32 s77, s77, 16384
    v_mfma_f32_16x16x32_bf16 v[176:179], a[192:195], v[48:51], v[176:179]
    v_exp_f32 v46, v46
    v_mfma_f32_16x16x32_bf16 v[180:183], a[196:199], v[48:51], v[180:183]
    buffer_load_dwordx4 v24, s[24:27], s77 offen lds
    buffer_load_dwordx4 v25, s[24:27], s77 offen offset:1024 lds
    buffer_load_dwordx4 v26, s[24:27], s77 offen offset:2048 lds
    v_mfma_f32_16x16x32_bf16 v[184:187], a[200:203], v[48:51], v[184:187]
    v_exp_f32 v47, v47
    v_mfma_f32_16x16x32_bf16 v[188:191], a[204:207], v[48:51], v[188:191]
    v_cvt_pk_bf16_f32 v55, v46, v47
    buffer_load_dwordx4 v27, s[24:27], s77 offen offset:3072 lds
    v_mfma_f32_16x16x32_bf16 a[96:99], a[108:111], v[48:51], a[96:99]
    s_waitcnt vmcnt(16)
    s_waitcnt lgkmcnt(0)
    s_barrier
    v_mfma_f32_16x16x32_bf16 v[40:43], a[112:115], a[64:67], v[72:75]
    v_exp_f32 v32, v32
    v_mfma_f32_16x16x32_bf16 v[44:47], a[128:131], a[64:67], v[72:75]
    ds_read_b128 a[144:147], v6 offset:32768
    s_sub_u32 s40, s36, 1
    ds_read_b128 a[160:163], v6 offset:36864
    ds_read_b128 a[148:151], v7 offset:32768
    v_mfma_f32_16x16x32_bf16 v[40:43], a[116:119], a[68:71], v[40:43]
    v_exp_f32 v33, v33
    v_mfma_f32_16x16x32_bf16 v[44:47], a[132:135], a[68:71], v[44:47]
    v_cvt_pk_bf16_f32 v48, v32, v33
    ds_read_b128 a[164:167], v7 offset:36864
    s_add_u32 s77, s43, 1
    ds_read_b128 a[152:155], v8 offset:32768
    v_mfma_f32_16x16x32_bf16 v[40:43], a[120:123], a[72:75], v[40:43]
    v_exp_f32 v34, v34
    v_mfma_f32_16x16x32_bf16 v[44:47], a[136:139], a[72:75], v[44:47]
    ds_read_b128 a[168:171], v8 offset:36864
    s_and_b32 s77, s77, 3
    ds_read_b128 a[156:159], v9 offset:32768
    ds_read_b128 a[172:175], v9 offset:36864
    v_mfma_f32_16x16x32_bf16 v[40:43], a[124:127], a[76:79], v[40:43]
    v_exp_f32 v35, v35
    v_mfma_f32_16x16x32_bf16 v[44:47], a[140:143], a[76:79], v[44:47]
    v_cvt_pk_bf16_f32 v49, v34, v35
    s_lshl_b32 s77, s77, 2
    s_add_u32 s77, s77, 1
    s_xor_b32 s77, s77, s3
    v_mfma_f32_16x16x32_bf16 v[192:195], a[176:179], v[52:55], v[192:195]
    v_exp_f32 v36, v36
    v_mfma_f32_16x16x32_bf16 v[196:199], a[180:183], v[52:55], v[196:199]
    ds_read_b64_tr_b16 a[176:177], v10 offset:32768
    s_lshl_b32 s77, s77, 16
    ds_read_b64_tr_b16 a[178:179], v10 offset:36864
    v_mfma_f32_16x16x32_bf16 v[200:203], a[184:187], v[52:55], v[200:203]
    v_exp_f32 v37, v37
    v_mfma_f32_16x16x32_bf16 v[204:207], a[188:191], v[52:55], v[204:207]
    v_cvt_pk_bf16_f32 v50, v36, v37
    ds_read_b64_tr_b16 a[180:181], v11 offset:32768
    s_add_u32 s77, s77, s60
    v_mfma_f32_16x16x32_bf16 v[208:211], a[192:195], v[52:55], v[208:211]
    v_exp_f32 v38, v38
    v_mfma_f32_16x16x32_bf16 v[212:215], a[196:199], v[52:55], v[212:215]
    ds_read_b64_tr_b16 a[182:183], v11 offset:36864
    s_lshl_b32 s41, s40, 15
    ds_read_b64_tr_b16 a[184:185], v12 offset:32768
    v_mfma_f32_16x16x32_bf16 v[216:219], a[200:203], v[52:55], v[216:219]
    v_exp_f32 v39, v39
    v_mfma_f32_16x16x32_bf16 v[220:223], a[204:207], v[52:55], v[220:223]
    v_cvt_pk_bf16_f32 v51, v38, v39
    ds_read_b64_tr_b16 a[186:187], v12 offset:36864
    s_add_u32 s77, s77, s41
    v_mfma_f32_16x16x32_bf16 a[100:103], a[108:111], v[52:55], a[100:103]
    ds_read_b64_tr_b16 a[188:189], v13 offset:32768
    s_lshl_b32 s41, s40, 13
    ds_read_b64_tr_b16 a[190:191], v13 offset:36864
    s_waitcnt lgkmcnt(8)
    v_mfma_f32_16x16x32_bf16 v[32:35], a[144:147], a[48:51], v[68:71]
    v_exp_f32 v40, v40
    v_mfma_f32_16x16x32_bf16 v[36:39], a[160:163], a[48:51], v[68:71]
    ds_read_b64_tr_b16 a[192:193], v14 offset:32768
    s_add_u32 m0, s41, 16384
    ds_read_b64_tr_b16 a[194:195], v14 offset:36864
    v_mfma_f32_16x16x32_bf16 v[32:35], a[148:151], a[52:55], v[32:35]
    v_exp_f32 v41, v41
    v_mfma_f32_16x16x32_bf16 v[36:39], a[164:167], a[52:55], v[36:39]
    v_cvt_pk_bf16_f32 v52, v40, v41
    ds_read_b64_tr_b16 a[196:197], v15 offset:32768
    buffer_load_dwordx4 v24, s[24:27], s77 offen lds
    v_mfma_f32_16x16x32_bf16 v[32:35], a[152:155], a[56:59], v[32:35]
    v_exp_f32 v42, v42
    v_mfma_f32_16x16x32_bf16 v[36:39], a[168:171], a[56:59], v[36:39]
    ds_read_b64_tr_b16 a[198:199], v15 offset:36864
    buffer_load_dwordx4 v25, s[24:27], s77 offen offset:1024 lds
    ds_read_b64_tr_b16 a[200:201], v16 offset:32768
    v_mfma_f32_16x16x32_bf16 v[32:35], a[156:159], a[60:63], v[32:35]
    v_exp_f32 v43, v43
    v_mfma_f32_16x16x32_bf16 v[36:39], a[172:175], a[60:63], v[36:39]
    v_cvt_pk_bf16_f32 v53, v42, v43
    ds_read_b64_tr_b16 a[202:203], v16 offset:36864
    buffer_load_dwordx4 v26, s[24:27], s77 offen offset:2048 lds
    v_mfma_f32_16x16x32_bf16 v[160:163], a[208:211], v[48:51], v[160:163]
    v_exp_f32 v44, v44
    v_mfma_f32_16x16x32_bf16 v[164:167], a[212:215], v[48:51], v[164:167]
    ds_read_b64_tr_b16 a[204:205], v17 offset:32768
    buffer_load_dwordx4 v27, s[24:27], s77 offen offset:3072 lds
    ds_read_b64_tr_b16 a[206:207], v17 offset:36864
    v_mfma_f32_16x16x32_bf16 v[168:171], a[216:219], v[48:51], v[168:171]
    v_exp_f32 v45, v45
    v_mfma_f32_16x16x32_bf16 v[172:175], a[220:223], v[48:51], v[172:175]
    v_cvt_pk_bf16_f32 v54, v44, v45
    s_add_u32 m0, s41, 20480
    s_add_u32 s77, s77, 16384
    v_mfma_f32_16x16x32_bf16 v[176:179], a[224:227], v[48:51], v[176:179]
    v_exp_f32 v46, v46
    v_mfma_f32_16x16x32_bf16 v[180:183], a[228:231], v[48:51], v[180:183]
    buffer_load_dwordx4 v24, s[24:27], s77 offen lds
    buffer_load_dwordx4 v25, s[24:27], s77 offen offset:1024 lds
    buffer_load_dwordx4 v26, s[24:27], s77 offen offset:2048 lds
    v_mfma_f32_16x16x32_bf16 v[184:187], a[232:235], v[48:51], v[184:187]
    v_exp_f32 v47, v47
    v_mfma_f32_16x16x32_bf16 v[188:191], a[236:239], v[48:51], v[188:191]
    v_cvt_pk_bf16_f32 v55, v46, v47
    buffer_load_dwordx4 v27, s[24:27], s77 offen offset:3072 lds
    v_mfma_f32_16x16x32_bf16 a[96:99], a[108:111], v[48:51], a[96:99]
    s_waitcnt vmcnt(16)
    s_waitcnt lgkmcnt(0)
    s_barrier
    v_mfma_f32_16x16x32_bf16 v[40:43], a[144:147], a[64:67], v[72:75]
    v_exp_f32 v32, v32
    v_mfma_f32_16x16x32_bf16 v[44:47], a[160:163], a[64:67], v[72:75]
    ds_read_b128 a[112:115], v6 offset:49152
    s_sub_u32 s40, s36, 1
    ds_read_b128 a[128:131], v6 offset:53248
    ds_read_b128 a[116:119], v7 offset:49152
    v_mfma_f32_16x16x32_bf16 v[40:43], a[148:151], a[68:71], v[40:43]
    v_exp_f32 v33, v33
    v_mfma_f32_16x16x32_bf16 v[44:47], a[164:167], a[68:71], v[44:47]
    v_cvt_pk_bf16_f32 v48, v32, v33
    ds_read_b128 a[132:135], v7 offset:53248
    s_add_u32 s76, s43, 1
    ds_read_b128 a[120:123], v8 offset:49152
    v_mfma_f32_16x16x32_bf16 v[40:43], a[152:155], a[72:75], v[40:43]
    v_exp_f32 v34, v34
    v_mfma_f32_16x16x32_bf16 v[44:47], a[168:171], a[72:75], v[44:47]
    ds_read_b128 a[136:139], v8 offset:53248
    s_and_b32 s76, s76, 3
    ds_read_b128 a[124:127], v9 offset:49152
    ds_read_b128 a[140:143], v9 offset:53248
    v_mfma_f32_16x16x32_bf16 v[40:43], a[156:159], a[76:79], v[40:43]
    v_exp_f32 v35, v35
    v_mfma_f32_16x16x32_bf16 v[44:47], a[172:175], a[76:79], v[44:47]
    v_cvt_pk_bf16_f32 v49, v34, v35
    s_lshl_b32 s76, s76, 2
    s_add_u32 s76, s76, 0
    s_xor_b32 s76, s76, s3
    v_mfma_f32_16x16x32_bf16 v[192:195], a[208:211], v[52:55], v[192:195]
    v_exp_f32 v36, v36
    v_mfma_f32_16x16x32_bf16 v[196:199], a[212:215], v[52:55], v[196:199]
    ds_read_b64_tr_b16 a[208:209], v10 offset:49152
    s_mul_i32 s76, s76, 18432
    ds_read_b64_tr_b16 a[210:211], v10 offset:53248
    v_mfma_f32_16x16x32_bf16 v[200:203], a[216:219], v[52:55], v[200:203]
    v_exp_f32 v37, v37
    v_mfma_f32_16x16x32_bf16 v[204:207], a[220:223], v[52:55], v[204:207]
    v_cvt_pk_bf16_f32 v50, v36, v37
    ds_read_b64_tr_b16 a[212:213], v11 offset:49152
    s_add_u32 s76, s76, s59
    v_mfma_f32_16x16x32_bf16 v[208:211], a[224:227], v[52:55], v[208:211]
    v_exp_f32 v38, v38
    v_mfma_f32_16x16x32_bf16 v[212:215], a[228:231], v[52:55], v[212:215]
    ds_read_b64_tr_b16 a[214:215], v11 offset:53248
    s_mul_i32 s41, s40, 8192
    ds_read_b64_tr_b16 a[216:217], v12 offset:49152
    v_mfma_f32_16x16x32_bf16 v[216:219], a[232:235], v[52:55], v[216:219]
    v_exp_f32 v39, v39
    v_mfma_f32_16x16x32_bf16 v[220:223], a[236:239], v[52:55], v[220:223]
    v_cvt_pk_bf16_f32 v51, v38, v39
    ds_read_b64_tr_b16 a[218:219], v12 offset:53248
    s_add_u32 s76, s76, s41
    v_mfma_f32_16x16x32_bf16 a[100:103], a[108:111], v[52:55], a[100:103]
    ds_read_b64_tr_b16 a[220:221], v13 offset:49152
    s_add_u32 s76, s76, 0
    ds_read_b64_tr_b16 a[222:223], v13 offset:53248
    s_waitcnt lgkmcnt(8)
    v_mfma_f32_16x16x32_bf16 v[32:35], a[112:115], a[48:51], v[68:71]
    v_exp_f32 v40, v40
    v_mfma_f32_16x16x32_bf16 v[36:39], a[128:131], a[48:51], v[68:71]
    ds_read_b64_tr_b16 a[224:225], v14 offset:49152
    s_add_u32 m0, s41, 32768
    ds_read_b64_tr_b16 a[226:227], v14 offset:53248
    v_mfma_f32_16x16x32_bf16 v[32:35], a[116:119], a[52:55], v[32:35]
    v_exp_f32 v41, v41
    v_mfma_f32_16x16x32_bf16 v[36:39], a[132:135], a[52:55], v[36:39]
    v_cvt_pk_bf16_f32 v52, v40, v41
    ds_read_b64_tr_b16 a[228:229], v15 offset:49152
    buffer_load_dwordx4 v2, s[20:23], s76 offen sc1 lds
    v_mfma_f32_16x16x32_bf16 v[32:35], a[120:123], a[56:59], v[32:35]
    v_exp_f32 v42, v42
    v_mfma_f32_16x16x32_bf16 v[36:39], a[136:139], a[56:59], v[36:39]
    ds_read_b64_tr_b16 a[230:231], v15 offset:53248
    buffer_load_dwordx4 v2, s[20:23], s76 offen offset:1024 sc1 lds
    ds_read_b64_tr_b16 a[232:233], v16 offset:49152
    v_mfma_f32_16x16x32_bf16 v[32:35], a[124:127], a[60:63], v[32:35]
    v_exp_f32 v43, v43
    v_mfma_f32_16x16x32_bf16 v[36:39], a[140:143], a[60:63], v[36:39]
    v_cvt_pk_bf16_f32 v53, v42, v43
    ds_read_b64_tr_b16 a[234:235], v16 offset:53248
    buffer_load_dwordx4 v2, s[20:23], s76 offen offset:2048 sc1 lds
    v_mfma_f32_16x16x32_bf16 v[160:163], a[176:179], v[48:51], v[160:163]
    v_exp_f32 v44, v44
    v_mfma_f32_16x16x32_bf16 v[164:167], a[180:183], v[48:51], v[164:167]
    ds_read_b64_tr_b16 a[236:237], v17 offset:49152
    buffer_load_dwordx4 v2, s[20:23], s76 offen offset:3072 sc1 lds
    ds_read_b64_tr_b16 a[238:239], v17 offset:53248
    v_mfma_f32_16x16x32_bf16 v[168:171], a[184:187], v[48:51], v[168:171]
    v_exp_f32 v45, v45
    v_mfma_f32_16x16x32_bf16 v[172:175], a[188:191], v[48:51], v[172:175]
    v_cvt_pk_bf16_f32 v54, v44, v45
    s_add_u32 m0, s41, 36864
    s_add_u32 s76, s76, 4096
    v_mfma_f32_16x16x32_bf16 v[176:179], a[192:195], v[48:51], v[176:179]
    v_exp_f32 v46, v46
    v_mfma_f32_16x16x32_bf16 v[180:183], a[196:199], v[48:51], v[180:183]
    buffer_load_dwordx4 v2, s[20:23], s76 offen sc1 lds
    buffer_load_dwordx4 v2, s[20:23], s76 offen offset:1024 sc1 lds
    buffer_load_dwordx4 v2, s[20:23], s76 offen offset:2048 sc1 lds
    v_mfma_f32_16x16x32_bf16 v[184:187], a[200:203], v[48:51], v[184:187]
    v_exp_f32 v47, v47
    v_mfma_f32_16x16x32_bf16 v[188:191], a[204:207], v[48:51], v[188:191]
    v_cvt_pk_bf16_f32 v55, v46, v47
    buffer_load_dwordx4 v2, s[20:23], s76 offen offset:3072 sc1 lds
    v_mfma_f32_16x16x32_bf16 a[96:99], a[108:111], v[48:51], a[96:99]
    s_waitcnt lgkmcnt(0)
    s_barrier
    v_mfma_f32_16x16x32_bf16 v[40:43], a[112:115], a[64:67], v[72:75]
    v_exp_f32 v32, v32
    v_mfma_f32_16x16x32_bf16 v[44:47], a[128:131], a[64:67], v[72:75]
    s_sub_u32 s40, s36, 1
    s_add_u32 s76, s43, 1
    v_mfma_f32_16x16x32_bf16 v[40:43], a[116:119], a[68:71], v[40:43]
    v_exp_f32 v33, v33
    v_mfma_f32_16x16x32_bf16 v[44:47], a[132:135], a[68:71], v[44:47]
    v_cvt_pk_bf16_f32 v48, v32, v33
    s_and_b32 s76, s76, 3
    s_lshl_b32 s76, s76, 2
    v_mfma_f32_16x16x32_bf16 v[40:43], a[120:123], a[72:75], v[40:43]
    v_exp_f32 v34, v34
    v_mfma_f32_16x16x32_bf16 v[44:47], a[136:139], a[72:75], v[44:47]
    s_add_u32 s76, s76, 0
    s_xor_b32 s76, s76, s3
    v_mfma_f32_16x16x32_bf16 v[40:43], a[124:127], a[76:79], v[40:43]
    v_exp_f32 v35, v35
    v_mfma_f32_16x16x32_bf16 v[44:47], a[140:143], a[76:79], v[44:47]
    v_cvt_pk_bf16_f32 v49, v34, v35
    s_mul_i32 s76, s76, 18432
    v_mfma_f32_16x16x32_bf16 v[192:195], a[176:179], v[52:55], v[192:195]
    v_exp_f32 v36, v36
    v_mfma_f32_16x16x32_bf16 v[196:199], a[180:183], v[52:55], v[196:199]
    s_add_u32 s76, s76, s59
    s_mul_i32 s41, s40, 10240
    v_mfma_f32_16x16x32_bf16 v[200:203], a[184:187], v[52:55], v[200:203]
    v_exp_f32 v37, v37
    v_mfma_f32_16x16x32_bf16 v[204:207], a[188:191], v[52:55], v[204:207]
    v_cvt_pk_bf16_f32 v50, v36, v37
    s_add_u32 s76, s76, s41
    v_mfma_f32_16x16x32_bf16 v[208:211], a[192:195], v[52:55], v[208:211]
    v_exp_f32 v38, v38
    v_mfma_f32_16x16x32_bf16 v[212:215], a[196:199], v[52:55], v[212:215]
    s_add_u32 s76, s76, 16384
    s_add_u32 m0, s41, 49152
    v_mfma_f32_16x16x32_bf16 v[216:219], a[200:203], v[52:55], v[216:219]
    v_exp_f32 v39, v39
    v_mfma_f32_16x16x32_bf16 v[220:223], a[204:207], v[52:55], v[220:223]
    v_cvt_pk_bf16_f32 v51, v38, v39
    buffer_load_dwordx4 v2, s[20:23], s76 offen sc1 lds
    v_mfma_f32_16x16x32_bf16 a[100:103], a[108:111], v[52:55], a[100:103]
    buffer_load_dwordx4 v2, s[20:23], s76 offen offset:1024 sc1 lds
    buffer_load_dwordx4 v2, s[20:23], s76 offen offset:2048 sc1 lds
    v_exp_f32 v40, v40
    buffer_load_dwordx4 v2, s[20:23], s76 offen offset:3072 sc1 lds
    s_add_u32 m0, s41, 53248
    v_exp_f32 v41, v41
    s_nop 0
    v_cvt_pk_bf16_f32 v52, v40, v41
    s_add_u32 s76, s76, 4096
    v_exp_f32 v42, v42
    buffer_load_dwordx4 v2, s[20:23], s76 offen sc1 lds
    buffer_load_dwordx4 v2, s[20:23], s76 offen offset:1024 sc1 lds
    v_exp_f32 v43, v43
    s_nop 0
    v_cvt_pk_bf16_f32 v53, v42, v43
    buffer_load_dwordx4 v2, s[20:23], s76 offen offset:2048 sc1 lds
    v_mfma_f32_16x16x32_bf16 v[160:163], a[208:211], v[48:51], v[160:163]
    v_exp_f32 v44, v44
    v_mfma_f32_16x16x32_bf16 v[164:167], a[212:215], v[48:51], v[164:167]
    buffer_load_dwordx4 v2, s[20:23], s76 offen offset:3072 sc1 lds
    s_add_u32 m0, s41, 57344
    v_mfma_f32_16x16x32_bf16 v[168:171], a[216:219], v[48:51], v[168:171]
    v_exp_f32 v45, v45
    v_mfma_f32_16x16x32_bf16 v[172:175], a[220:223], v[48:51], v[172:175]
    v_cvt_pk_bf16_f32 v54, v44, v45
    s_add_u32 s76, s76, 4096
    v_mfma_f32_16x16x32_bf16 v[176:179], a[224:227], v[48:51], v[176:179]
    v_exp_f32 v46, v46
    v_mfma_f32_16x16x32_bf16 v[180:183], a[228:231], v[48:51], v[180:183]
    buffer_load_dwordx4 v2, s[20:23], s76 offen sc1 lds
    buffer_load_dwordx4 v2, s[20:23], s76 offen offset:1024 sc1 lds
    v_mfma_f32_16x16x32_bf16 v[184:187], a[232:235], v[48:51], v[184:187]
    v_exp_f32 v47, v47
    v_mfma_f32_16x16x32_bf16 v[188:191], a[236:239], v[48:51], v[188:191]
    v_cvt_pk_bf16_f32 v55, v46, v47
    v_mfma_f32_16x16x32_bf16 a[96:99], a[108:111], v[48:51], a[96:99]
    s_barrier
    v_mfma_f32_16x16x32_bf16 v[192:195], a[208:211], v[52:55], v[192:195]
    v_mfma_f32_16x16x32_bf16 v[196:199], a[212:215], v[52:55], v[196:199]
    v_mfma_f32_16x16x32_bf16 v[200:203], a[216:219], v[52:55], v[200:203]
    v_mfma_f32_16x16x32_bf16 v[204:207], a[220:223], v[52:55], v[204:207]
    v_mfma_f32_16x16x32_bf16 v[208:211], a[224:227], v[52:55], v[208:211]
    v_mfma_f32_16x16x32_bf16 v[212:215], a[228:231], v[52:55], v[212:215]
    v_mfma_f32_16x16x32_bf16 v[216:219], a[232:235], v[52:55], v[216:219]
    v_mfma_f32_16x16x32_bf16 v[220:223], a[236:239], v[52:55], v[220:223]
    v_mfma_f32_16x16x32_bf16 a[100:103], a[108:111], v[52:55], a[100:103]
    s_mov_b32 s39, 0x53800000
    s_mov_b64 s[70:71], 0
    v_accvgpr_read_b32 v32, a96
    s_nop 4
    v_accvgpr_read_b32 v34, a100
    v_cmp_nge_f32 s[72:73], s39, v32
    v_cmp_nle_f32 vcc, 0.5, v32
    s_or_b64 s[70:71], s[70:71], s[72:73]
    s_or_b64 s[70:71], s[70:71], vcc
    v_cmp_nge_f32 s[72:73], s39, v34
    v_cmp_nle_f32 vcc, 0.5, v34
    s_or_b64 s[70:71], s[70:71], s[72:73]
    s_or_b64 s[70:71], s[70:71], vcc
    v_rcp_f32 v32, v32
    v_rcp_f32 v34, v34
    s_or_b32 s39, s70, s71
    v_mov_b32 v3, s39
    ds_write_b32 v104, v3 offset:16
    v_mov_b32 v33, v32
    v_mov_b32 v35, v34
    ds_read_b64_tr_b16 a[184:185], v99
    ds_read_b64_tr_b16 a[186:187], v99 offset:4096
    ds_read_b64_tr_b16 a[188:189], v99 offset:8
    ds_read_b64_tr_b16 a[190:191], v99 offset:4104
    v_pk_mul_f32 v[216:217], v[216:217], v[34:35]
    v_pk_mul_f32 v[218:219], v[218:219], v[34:35]
    v_pk_mul_f32 v[220:221], v[220:221], v[34:35]
    v_pk_mul_f32 v[222:223], v[222:223], v[34:35]
    v_cvt_pk_bf16_f32 v239, v222, v223
    v_cvt_pk_bf16_f32 v238, v220, v221
    v_cvt_pk_bf16_f32 v237, v218, v219
    v_cvt_pk_bf16_f32 v236, v216, v217
    s_add_u32 s39, s78, 20480
    buffer_store_dwordx4 v[236:239], v2, s[20:23], s39 offen offset:1024 sc1
    ds_read_b64_tr_b16 a[192:193], v99 offset:8192
    ds_read_b64_tr_b16 a[194:195], v99 offset:12288
    ds_read_b64_tr_b16 a[196:197], v99 offset:8200
    ds_read_b64_tr_b16 a[198:199], v99 offset:12296
    v_pk_mul_f32 v[208:209], v[208:209], v[34:35]
    v_pk_mul_f32 v[210:211], v[210:211], v[34:35]
    v_pk_mul_f32 v[212:213], v[212:213], v[34:35]
    v_pk_mul_f32 v[214:215], v[214:215], v[34:35]
    v_cvt_pk_bf16_f32 v235, v214, v215
    v_cvt_pk_bf16_f32 v234, v212, v213
    v_cvt_pk_bf16_f32 v233, v210, v211
    v_cvt_pk_bf16_f32 v232, v208, v209
    buffer_store_dwordx4 v[232:235], v2, s[20:23], s39 offen sc1
    ds_read_b128 a[112:115], v101
    ds_read_b128 a[116:119], v101 offset:1024
    ds_read_b128 a[120:123], v101 offset:2048
    ds_read_b128 a[124:127], v101 offset:3072
    v_pk_mul_f32 v[200:201], v[200:201], v[34:35]
    v_pk_mul_f32 v[202:203], v[202:203], v[34:35]
    v_pk_mul_f32 v[204:205], v[204:205], v[34:35]
    v_pk_mul_f32 v[206:207], v[206:207], v[34:35]
    v_cvt_pk_bf16_f32 v231, v206, v207
    v_cvt_pk_bf16_f32 v230, v204, v205
    v_cvt_pk_bf16_f32 v229, v202, v203
    v_cvt_pk_bf16_f32 v228, v200, v201
    s_add_u32 s39, s78, 2048
    buffer_store_dwordx4 v[228:231], v2, s[20:23], s39 offen offset:1024 sc1
    ds_read_b128 a[128:131], v101 offset:4096
    ds_read_b128 a[132:135], v101 offset:5120
    ds_read_b128 a[136:139], v101 offset:6144
    ds_read_b128 a[140:143], v101 offset:7168
    v_pk_mul_f32 v[192:193], v[192:193], v[34:35]
    v_pk_mul_f32 v[194:195], v[194:195], v[34:35]
    v_pk_mul_f32 v[196:197], v[196:197], v[34:35]
    v_pk_mul_f32 v[198:199], v[198:199], v[34:35]
    v_cvt_pk_bf16_f32 v227, v198, v199
    v_cvt_pk_bf16_f32 v226, v196, v197
    v_cvt_pk_bf16_f32 v225, v194, v195
    v_cvt_pk_bf16_f32 v224, v192, v193
    buffer_store_dwordx4 v[224:227], v2, s[20:23], s39 offen sc1
    ds_read_b128 a[144:147], v101 offset:8192
    ds_read_b128 a[148:151], v101 offset:9216
    ds_read_b128 a[152:155], v101 offset:10240
    ds_read_b128 a[156:159], v101 offset:11264
    v_pk_mul_f32 v[184:185], v[184:185], v[32:33]
    v_pk_mul_f32 v[186:187], v[186:187], v[32:33]
    v_pk_mul_f32 v[188:189], v[188:189], v[32:33]
    v_pk_mul_f32 v[190:191], v[190:191], v[32:33]
    v_cvt_pk_bf16_f32 v223, v190, v191
    v_cvt_pk_bf16_f32 v222, v188, v189
    v_cvt_pk_bf16_f32 v221, v186, v187
    v_cvt_pk_bf16_f32 v220, v184, v185
    s_add_u32 s39, s78, 18432
    buffer_store_dwordx4 v[220:223], v2, s[20:23], s39 offen offset:1024 sc1
    ds_read_b128 a[160:163], v101 offset:12288
    ds_read_b128 a[164:167], v101 offset:13312
    ds_read_b128 a[168:171], v101 offset:14336
    ds_read_b128 a[172:175], v101 offset:15360
    v_pk_mul_f32 v[176:177], v[176:177], v[32:33]
    v_pk_mul_f32 v[178:179], v[178:179], v[32:33]
    v_pk_mul_f32 v[180:181], v[180:181], v[32:33]
    v_pk_mul_f32 v[182:183], v[182:183], v[32:33]
    v_cvt_pk_bf16_f32 v219, v182, v183
    v_cvt_pk_bf16_f32 v218, v180, v181
    v_cvt_pk_bf16_f32 v217, v178, v179
    v_cvt_pk_bf16_f32 v216, v176, v177
    buffer_store_dwordx4 v[216:219], v2, s[20:23], s39 offen sc1
    ds_read_b128 a[176:179], v101 offset:16384
    ds_read_b128 a[180:183], v101 offset:17408
    v_pk_mul_f32 v[168:169], v[168:169], v[32:33]
    v_pk_mul_f32 v[170:171], v[170:171], v[32:33]
    v_pk_mul_f32 v[172:173], v[172:173], v[32:33]
    v_pk_mul_f32 v[174:175], v[174:175], v[32:33]
    v_cvt_pk_bf16_f32 v215, v174, v175
    v_cvt_pk_bf16_f32 v214, v172, v173
    v_cvt_pk_bf16_f32 v213, v170, v171
    v_cvt_pk_bf16_f32 v212, v168, v169
    s_add_u32 s39, s78, 0
    buffer_store_dwordx4 v[212:215], v2, s[20:23], s39 offen offset:1024 sc1
    v_pk_mul_f32 v[160:161], v[160:161], v[32:33]
    v_pk_mul_f32 v[162:163], v[162:163], v[32:33]
    v_pk_mul_f32 v[164:165], v[164:165], v[32:33]
    v_pk_mul_f32 v[166:167], v[166:167], v[32:33]
    v_cvt_pk_bf16_f32 v211, v166, v167
    v_cvt_pk_bf16_f32 v210, v164, v165
    v_cvt_pk_bf16_f32 v209, v162, v163
    v_cvt_pk_bf16_f32 v208, v160, v161
    buffer_store_dwordx4 v[208:211], v2, s[20:23], s39 offen sc1
    s_waitcnt vmcnt(26)
    s_waitcnt lgkmcnt(0)
    s_barrier
    v_mov_b32 v4, 163776
    ds_read_b128 v[80:83], v4
    ds_read_b128 v[84:87], v4 offset:16
    s_waitcnt lgkmcnt(0)
    v_or_b32 v80, v80, v81
    v_or3_b32 v80, v80, v82, v83
    v_or3_b32 v80, v80, v84, v85
    v_or3_b32 v80, v80, v86, v87
    s_nop 0
    v_readfirstlane_b32 s39, v80
    s_nop 0
    s_andn2_b32 s39, s39, s55
    s_cmp_eq_u32 s39, 0
    s_cbranch_scc1 L_gemm
    v_mov_b32 v4, 163776
    ds_read_b128 v[80:83], v4
    s_waitcnt lgkmcnt(0)
    v_or_b32 v80, v80, v81
    v_or3_b32 v80, v80, v82, v83
    s_nop 0
    v_readfirstlane_b32 s39, v80
    s_nop 0
    s_cmp_eq_u32 s39, 0
    s_cselect_b32 s68, 1, 0
    s_mov_b32 s55, -1
    s_waitcnt vmcnt(0) lgkmcnt(0)
    v_and_b32 v3, 15, v1
    v_lshrrev_b32 v4, 4, v1
    v_xor_b32 v5, v3, v4
    v_lshlrev_b32 v5, 4, v5
    v_lshl_add_u32 v6, v3, 8, v5
    v_xor_b32 v7, 64, v6
    v_xor_b32 v8, 128, v6
    v_xor_b32 v9, 192, v6
    v_lshlrev_b32 v96, 4, v4
    v_lshrrev_b32 v3, 2, v1
    v_and_b32 v5, 7, v3
    v_lshlrev_b32 v5, 5, v5
    v_lshl_add_u32 v5, v3, 8, v5
    v_and_b32 v3, 3, v1
    v_lshl_add_u32 v5, v3, 3, v5
    v_add_u32 v10, 8192, v5
    v_xor_b32 v11, 32, v10
    v_xor_b32 v12, 64, v10
    v_xor_b32 v13, 96, v10
    v_xor_b32 v14, 128, v10
    v_xor_b32 v15, 160, v10
    v_xor_b32 v16, 192, v10
    v_xor_b32 v17, 224, v10
    v_mov_b32 v48, 0xff800000
    v_mov_b32 v49, 0xff800000
    s_mov_b32 s54, 32
    s_xor_b32 s47, s69, 0
    s_mov_b32 s49, 0
L_max_B0:
    s_barrier
    s_add_u32 s47, s47, 8192
    s_barrier
    ds_read_b128 a[144:147], v6
    ds_read_b128 a[160:163], v6 offset:4096
    ds_read_b128 a[148:151], v7
    ds_read_b128 a[164:167], v7 offset:4096
    ds_read_b128 a[152:155], v8
    ds_read_b128 a[168:171], v8 offset:4096
    ds_read_b128 a[156:159], v9
    ds_read_b128 a[172:175], v9 offset:4096
    s_waitcnt lgkmcnt(0)
    v_mfma_f32_16x16x32_bf16 v[32:35], a[144:147], a[0:3], 0
    v_mfma_f32_16x16x32_bf16 v[36:39], a[160:163], a[0:3], 0
    v_mfma_f32_16x16x32_bf16 v[32:35], a[148:151], a[4:7], v[32:35]
    v_mfma_f32_16x16x32_bf16 v[36:39], a[164:167], a[4:7], v[36:39]
    v_mfma_f32_16x16x32_bf16 v[32:35], a[152:155], a[8:11], v[32:35]
    v_mfma_f32_16x16x32_bf16 v[36:39], a[168:171], a[8:11], v[36:39]
    v_mfma_f32_16x16x32_bf16 v[32:35], a[156:159], a[12:15], v[32:35]
    v_mfma_f32_16x16x32_bf16 v[36:39], a[172:175], a[12:15], v[36:39]
    s_nop 6
    v_max3_f32 v48, v32, v33, v48
    v_max3_f32 v48, v34, v35, v48
    v_max3_f32 v48, v36, v37, v48
    v_max3_f32 v48, v38, v39, v48
    v_mfma_f32_16x16x32_bf16 v[32:35], a[144:147], a[16:19], 0
    v_mfma_f32_16x16x32_bf16 v[36:39], a[160:163], a[16:19], 0
    v_mfma_f32_16x16x32_bf16 v[32:35], a[148:151], a[20:23], v[32:35]
    v_mfma_f32_16x16x32_bf16 v[36:39], a[164:167], a[20:23], v[36:39]
    v_mfma_f32_16x16x32_bf16 v[32:35], a[152:155], a[24:27], v[32:35]
    v_mfma_f32_16x16x32_bf16 v[36:39], a[168:171], a[24:27], v[36:39]
    v_mfma_f32_16x16x32_bf16 v[32:35], a[156:159], a[28:31], v[32:35]
    v_mfma_f32_16x16x32_bf16 v[36:39], a[172:175], a[28:31], v[36:39]
    s_nop 6
    v_max3_f32 v49, v32, v33, v49
    v_max3_f32 v49, v34, v35, v49
    v_max3_f32 v49, v36, v37, v49
    v_max3_f32 v49, v38, v39, v49
    s_sub_u32 s54, s54, 1
    s_cmp_lg_u32 s54, 0
    s_cbranch_scc1 L_max_B0
    v_mov_b32 v3, v48
    s_nop 1
    v_permlane32_swap_b32 v3, v48
    v_max_f32 v48, v3, v48
    v_mov_b32 v3, v48
    s_nop 1
    v_permlane16_swap_b32 v3, v48
    v_max_f32 v48, v3, v48
    v_sub_f32 v56, 0, v48
    v_sub_f32 v57, 0, v48
    v_sub_f32 v58, 0, v48
    v_sub_f32 v59, 0, v48
    v_mov_b32 v3, v49
    s_nop 1
    v_permlane32_swap_b32 v3, v49
    v_max_f32 v49, v3, v49
    v_mov_b32 v3, v49
    s_nop 1
    v_permlane16_swap_b32 v3, v49
    v_max_f32 v49, v3, v49
    v_sub_f32 v60, 0, v49
    v_sub_f32 v61, 0, v49
    v_sub_f32 v62, 0, v49
    v_sub_f32 v63, 0, v49
    v_mov_b32 v48, 0xff800000
    v_mov_b32 v49, 0xff800000
    s_mov_b32 s54, 32
    s_xor_b32 s47, s69, 262144
    s_mov_b32 s49, 0
L_max_B1:
    s_barrier
    s_add_u32 s47, s47, 8192
    s_barrier
    ds_read_b128 a[144:147], v6
    ds_read_b128 a[160:163], v6 offset:4096
    ds_read_b128 a[148:151], v7
    ds_read_b128 a[164:167], v7 offset:4096
    ds_read_b128 a[152:155], v8
    ds_read_b128 a[168:171], v8 offset:4096
    ds_read_b128 a[156:159], v9
    ds_read_b128 a[172:175], v9 offset:4096
    s_waitcnt lgkmcnt(0)
    v_mfma_f32_16x16x32_bf16 v[32:35], a[144:147], a[48:51], 0
    v_mfma_f32_16x16x32_bf16 v[36:39], a[160:163], a[48:51], 0
    v_mfma_f32_16x16x32_bf16 v[32:35], a[148:151], a[52:55], v[32:35]
    v_mfma_f32_16x16x32_bf16 v[36:39], a[164:167], a[52:55], v[36:39]
    v_mfma_f32_16x16x32_bf16 v[32:35], a[152:155], a[56:59], v[32:35]
    v_mfma_f32_16x16x32_bf16 v[36:39], a[168:171], a[56:59], v[36:39]
    v_mfma_f32_16x16x32_bf16 v[32:35], a[156:159], a[60:63], v[32:35]
    v_mfma_f32_16x16x32_bf16 v[36:39], a[172:175], a[60:63], v[36:39]
    s_nop 6
    v_max3_f32 v48, v32, v33, v48
    v_max3_f32 v48, v34, v35, v48
    v_max3_f32 v48, v36, v37, v48
    v_max3_f32 v48, v38, v39, v48
    v_mfma_f32_16x16x32_bf16 v[32:35], a[144:147], a[64:67], 0
    v_mfma_f32_16x16x32_bf16 v[36:39], a[160:163], a[64:67], 0
    v_mfma_f32_16x16x32_bf16 v[32:35], a[148:151], a[68:71], v[32:35]
    v_mfma_f32_16x16x32_bf16 v[36:39], a[164:167], a[68:71], v[36:39]
    v_mfma_f32_16x16x32_bf16 v[32:35], a[152:155], a[72:75], v[32:35]
    v_mfma_f32_16x16x32_bf16 v[36:39], a[168:171], a[72:75], v[36:39]
    v_mfma_f32_16x16x32_bf16 v[32:35], a[156:159], a[76:79], v[32:35]
    v_mfma_f32_16x16x32_bf16 v[36:39], a[172:175], a[76:79], v[36:39]
    s_nop 6
    v_max3_f32 v49, v32, v33, v49
    v_max3_f32 v49, v34, v35, v49
    v_max3_f32 v49, v36, v37, v49
    v_max3_f32 v49, v38, v39, v49
    s_sub_u32 s54, s54, 1
    s_cmp_lg_u32 s54, 0
    s_cbranch_scc1 L_max_B1
    v_mov_b32 v3, v48
    s_nop 1
    v_permlane32_swap_b32 v3, v48
    v_max_f32 v48, v3, v48
    v_mov_b32 v3, v48
    s_nop 1
    v_permlane16_swap_b32 v3, v48
    v_max_f32 v48, v3, v48
    v_sub_f32 v68, 0, v48
    v_sub_f32 v69, 0, v48
    v_sub_f32 v70, 0, v48
    v_sub_f32 v71, 0, v48
    v_mov_b32 v3, v49
    s_nop 1
    v_permlane32_swap_b32 v3, v49
    v_max_f32 v49, v3, v49
    v_mov_b32 v3, v49
    s_nop 1
    v_permlane16_swap_b32 v3, v49
    v_max_f32 v49, v3, v49
    v_sub_f32 v72, 0, v49
    v_sub_f32 v73, 0, v49
    v_sub_f32 v74, 0, v49
    v_sub_f32 v75, 0, v49
    s_barrier
    s_mul_i32 s39, s36, s89
    s_add_u32 s47, s57, s39
    s_and_b32 s47, s47, 0x3ffff
    s_add_u32 s47, s47, s69
    s_lshl_b32 s49, s36, 14
    s_add_u32 m0, s49, 0
    s_add_u32 s48, s47, 0
    buffer_load_dwordx4 v18, s[12:15], s48 offen nt lds
    buffer_load_dwordx4 v19, s[12:15], s48 offen offset:1024 nt lds
    buffer_load_dwordx4 v20, s[12:15], s48 offen offset:2048 nt lds
    buffer_load_dwordx4 v21, s[12:15], s48 offen offset:3072 nt lds
    s_add_u32 m0, s49, 4096
    s_add_u32 s48, s47, 4096
    buffer_load_dwordx4 v18, s[12:15], s48 offen nt lds
    buffer_load_dwordx4 v19, s[12:15], s48 offen offset:1024 nt lds
    buffer_load_dwordx4 v20, s[12:15], s48 offen offset:2048 nt lds
    buffer_load_dwordx4 v21, s[12:15], s48 offen offset:3072 nt lds
    s_add_u32 m0, s49, 8192
    s_add_u32 s48, s47, 0
    buffer_load_dwordx4 v22, s[16:19], s48 offen nt lds
    buffer_load_dwordx4 v23, s[16:19], s48 offen offset:1024 nt lds
    buffer_load_dwordx4 v22, s[16:19], s48 offen offset:2048 nt lds
    buffer_load_dwordx4 v23, s[16:19], s48 offen offset:3072 nt lds
    s_add_u32 m0, s49, 12288
    s_add_u32 s48, s47, 4096
    buffer_load_dwordx4 v22, s[16:19], s48 offen nt lds
    buffer_load_dwordx4 v23, s[16:19], s48 offen offset:1024 nt lds
    buffer_load_dwordx4 v22, s[16:19], s48 offen offset:2048 nt lds
    buffer_load_dwordx4 v23, s[16:19], s48 offen offset:3072 nt lds
    s_cmp_eq_u32 s36, 2
    s_cselect_b32 s4, s16, s12
    s_cselect_b32 s5, s17, s13
    s_mov_b32 s6, 0x4000000
    s_mov_b32 s7, 0x20000
    s_cselect_b32 s49, 8192, 0
    s_cselect_b64 vcc, -1, 0
    s_nop 1
    v_cndmask_b32 v28, v18, v22, vcc
    v_cndmask_b32 v29, v19, v23, vcc
    v_cndmask_b32 v30, v20, v22, vcc
    v_cndmask_b32 v31, v21, v23, vcc
    s_lshl_b32 s47, s89, 2
    s_add_u32 s47, s57, s47
    s_and_b32 s47, s47, 0x3ffff
    s_mov_b32 s46, s69
    s_waitcnt vmcnt(0)
    s_barrier
    ds_read_b128 a[144:147], v6
    ds_read_b128 a[160:163], v6 offset:4096
    ds_read_b128 a[148:151], v7
    ds_read_b128 a[164:167], v7 offset:4096
    ds_read_b128 a[152:155], v8
    ds_read_b128 a[168:171], v8 offset:4096
    ds_read_b128 a[156:159], v9
    ds_read_b128 a[172:175], v9 offset:4096
    ds_read_b64_tr_b16 a[176:177], v10
    ds_read_b64_tr_b16 a[178:179], v10 offset:4096
    ds_read_b64_tr_b16 a[180:181], v11
    ds_read_b64_tr_b16 a[182:183], v11 offset:4096
    ds_read_b64_tr_b16 a[184:185], v12
    ds_read_b64_tr_b16 a[186:187], v12 offset:4096
    ds_read_b64_tr_b16 a[188:189], v13
    ds_read_b64_tr_b16 a[190:191], v13 offset:4096
    ds_read_b64_tr_b16 a[192:193], v14
    ds_read_b64_tr_b16 a[194:195], v14 offset:4096
    ds_read_b64_tr_b16 a[196:197], v15
    ds_read_b64_tr_b16 a[198:199], v15 offset:4096
    ds_read_b64_tr_b16 a[200:201], v16
    ds_read_b64_tr_b16 a[202:203], v16 offset:4096
    ds_read_b64_tr_b16 a[204:205], v17
    ds_read_b64_tr_b16 a[206:207], v17 offset:4096
    s_waitcnt lgkmcnt(0)
    s_nop 7
    s_branch L_main_B
L_rC:
    s_mul_i32 s39, s3, 18432
    v_add_u32 v107, s39, v97
    v_add_u32 v97, 36864, v97
    v_subrev_u32 v97, s39, v97
    v_add_u32 v106, 139264, v2
    v_add_u32 v98, s66, v101
L_main_C:
    s_mov_b32 s67, 0
    s_waitcnt vmcnt(8)
    s_waitcnt lgkmcnt(0)
    s_barrier
    s_cmp_lg_u32 s55, 0
    s_cbranch_scc1 L_np0C
    ds_read_b128 a[0:3], v107
    ds_read_b128 a[4:7], v107 offset:1024
    ds_read_b128 a[8:11], v107 offset:2048
    ds_read_b128 a[12:15], v107 offset:3072
    ds_read_b128 a[16:19], v107 offset:4096
    ds_read_b128 a[20:23], v107 offset:5120
    ds_read_b128 a[24:27], v107 offset:6144
    ds_read_b128 a[28:31], v107 offset:7168
    ds_read_b128 a[32:35], v107 offset:8192
    ds_read_b128 a[36:39], v107 offset:9216
    ds_read_b128 a[40:43], v107 offset:10240
    ds_read_b128 a[44:47], v107 offset:11264
    s_waitcnt lgkmcnt(0)
    v_mfma_f32_16x16x32_bf16 v[56:59], v[80:83], a[0:3], 0
    v_mfma_f32_16x16x32_bf16 v[56:59], v[84:87], a[4:7], v[56:59]
    v_mfma_f32_16x16x32_bf16 v[56:59], v[88:91], a[8:11], v[56:59]
    v_mfma_f32_16x16x32_bf16 v[56:59], v[92:95], a[12:15], v[56:59]
    v_mfma_f32_16x16x32_bf16 v[60:63], v[80:83], a[16:19], 0
    v_mfma_f32_16x16x32_bf16 v[60:63], v[84:87], a[20:23], v[60:63]
    v_mfma_f32_16x16x32_bf16 v[60:63], v[88:91], a[24:27], v[60:63]
    v_mfma_f32_16x16x32_bf16 v[60:63], v[92:95], a[28:31], v[60:63]
    v_mfma_f32_16x16x32_bf16 v[64:67], v[80:83], a[32:35], 0
    v_mfma_f32_16x16x32_bf16 v[64:67], v[84:87], a[36:39], v[64:67]
    v_mfma_f32_16x16x32_bf16 v[64:67], v[88:91], a[40:43], v[64:67]
    v_mfma_f32_16x16x32_bf16 v[64:67], v[92:95], a[44:47], v[64:67]
L_np0C:
    v_mfma_f32_16x16x32_bf16 v[32:35], a[144:147], a[0:3], v[56:59]
    ds_read_b128 a[112:115], v6 offset:16384
    ds_read_b128 a[128:131], v6 offset:20480
    v_mfma_f32_16x16x32_bf16 v[36:39], a[160:163], a[0:3], v[56:59]
    ds_read_b128 a[116:119], v7 offset:16384
    ds_read_b128 a[132:135], v7 offset:20480
    v_mfma_f32_16x16x32_bf16 v[32:35], a[148:151], a[4:7], v[32:35]
    ds_read_b128 a[120:123], v8 offset:16384
    ds_read_b128 a[136:139], v8 offset:20480
    v_mfma_f32_16x16x32_bf16 v[36:39], a[164:167], a[4:7], v[36:39]
    ds_read_b128 a[124:127], v9 offset:16384
    ds_read_b128 a[140:143], v9 offset:20480
    v_mfma_f32_16x16x32_bf16 v[32:35], a[152:155], a[8:11], v[32:35]
    ds_read_b64_tr_b16 a[208:209], v10 offset:16384
    ds_read_b64_tr_b16 a[210:211], v10 offset:20480
    v_mfma_f32_16x16x32_bf16 v[36:39], a[168:171], a[8:11], v[36:39]
    ds_read_b64_tr_b16 a[212:213], v11 offset:16384
    ds_read_b64_tr_b16 a[214:215], v11 offset:20480
    v_mfma_f32_16x16x32_bf16 v[32:35], a[156:159], a[12:15], v[32:35]
    ds_read_b64_tr_b16 a[216:217], v12 offset:16384
    ds_read_b64_tr_b16 a[218:219], v12 offset:20480
    v_mfma_f32_16x16x32_bf16 v[36:39], a[172:175], a[12:15], v[36:39]
    ds_read_b64_tr_b16 a[220:221], v13 offset:16384
    ds_read_b64_tr_b16 a[222:223], v13 offset:20480
    ds_read_b64_tr_b16 a[224:225], v14 offset:16384
    ds_read_b64_tr_b16 a[226:227], v14 offset:20480
    ds_read_b64_tr_b16 a[228:229], v15 offset:16384
    ds_read_b64_tr_b16 a[230:231], v15 offset:20480
    ds_read_b64_tr_b16 a[232:233], v16 offset:16384
    ds_read_b64_tr_b16 a[234:235], v16 offset:20480
    ds_read_b64_tr_b16 a[236:237], v17 offset:16384
    ds_read_b64_tr_b16 a[238:239], v17 offset:20480
    v_mfma_f32_16x16x32_bf16 v[40:43], a[144:147], a[16:19], v[60:63]
    v_exp_f32 v32, v32
    v_mfma_f32_16x16x32_bf16 v[44:47], a[160:163], a[16:19], v[60:63]
    v_mfma_f32_16x16x32_bf16 v[40:43], a[148:151], a[20:23], v[40:43]
    v_exp_f32 v33, v33
    v_mfma_f32_16x16x32_bf16 v[44:47], a[164:167], a[20:23], v[44:47]
    v_cvt_pk_bf16_f32 v48, v32, v33
    v_mfma_f32_16x16x32_bf16 v[40:43], a[152:155], a[24:27], v[40:43]
    v_exp_f32 v34, v34
    v_mfma_f32_16x16x32_bf16 v[44:47], a[168:171], a[24:27], v[44:47]
    v_mfma_f32_16x16x32_bf16 v[40:43], a[156:159], a[28:31], v[40:43]
    v_exp_f32 v35, v35
    v_mfma_f32_16x16x32_bf16 v[44:47], a[172:175], a[28:31], v[44:47]
    v_cvt_pk_bf16_f32 v49, v34, v35
    v_exp_f32 v36, v36
    v_exp_f32 v37, v37
    s_nop 0
    v_cvt_pk_bf16_f32 v50, v36, v37
    v_exp_f32 v38, v38
    v_exp_f32 v39, v39
    s_nop 0
    v_cvt_pk_bf16_f32 v51, v38, v39
    s_waitcnt lgkmcnt(15)
    v_mfma_f32_16x16x32_bf16 v[32:35], a[112:115], a[0:3], v[56:59]
    v_exp_f32 v40, v40
    v_mfma_f32_16x16x32_bf16 v[36:39], a[128:131], a[0:3], v[56:59]
    v_mfma_f32_16x16x32_bf16 v[32:35], a[116:119], a[4:7], v[32:35]
    v_exp_f32 v41, v41
    v_mfma_f32_16x16x32_bf16 v[36:39], a[132:135], a[4:7], v[36:39]
    v_cvt_pk_bf16_f32 v52, v40, v41
    v_mfma_f32_16x16x32_bf16 v[32:35], a[120:123], a[8:11], v[32:35]
    v_exp_f32 v42, v42
    v_mfma_f32_16x16x32_bf16 v[36:39], a[136:139], a[8:11], v[36:39]
    v_mfma_f32_16x16x32_bf16 v[32:35], a[124:127], a[12:15], v[32:35]
    v_exp_f32 v43, v43
    v_mfma_f32_16x16x32_bf16 v[36:39], a[140:143], a[12:15], v[36:39]
    v_cvt_pk_bf16_f32 v53, v42, v43
    v_mfma_f32_16x16x32_bf16 v[160:163], a[176:179], v[48:51], 0
    v_exp_f32 v44, v44
    v_mfma_f32_16x16x32_bf16 v[164:167], a[180:183], v[48:51], 0
    v_mfma_f32_16x16x32_bf16 v[168:171], a[184:187], v[48:51], 0
    v_exp_f32 v45, v45
    v_mfma_f32_16x16x32_bf16 v[172:175], a[188:191], v[48:51], 0
    v_cvt_pk_bf16_f32 v54, v44, v45
    v_mfma_f32_16x16x32_bf16 v[176:179], a[192:195], v[48:51], 0
    v_exp_f32 v46, v46
    v_mfma_f32_16x16x32_bf16 v[180:183], a[196:199], v[48:51], 0
    v_mfma_f32_16x16x32_bf16 v[184:187], a[200:203], v[48:51], 0
    v_exp_f32 v47, v47
    v_mfma_f32_16x16x32_bf16 v[188:191], a[204:207], v[48:51], 0
    v_cvt_pk_bf16_f32 v55, v46, v47
    v_mfma_f32_16x16x32_bf16 a[96:99], a[108:111], v[48:51], 0
    v_mfma_f32_16x16x32_bf16 v[40:43], a[112:115], a[16:19], v[60:63]
    v_exp_f32 v32, v32
    v_mfma_f32_16x16x32_bf16 v[44:47], a[128:131], a[16:19], v[60:63]
    v_mfma_f32_16x16x32_bf16 v[40:43], a[116:119], a[20:23], v[40:43]
    v_exp_f32 v33, v33
    v_mfma_f32_16x16x32_bf16 v[44:47], a[132:135], a[20:23], v[44:47]
    v_cvt_pk_bf16_f32 v48, v32, v33
    v_mfma_f32_16x16x32_bf16 v[40:43], a[120:123], a[24:27], v[40:43]
    v_exp_f32 v34, v34
    v_mfma_f32_16x16x32_bf16 v[44:47], a[136:139], a[24:27], v[44:47]
    v_mfma_f32_16x16x32_bf16 v[40:43], a[124:127], a[28:31], v[40:43]
    v_exp_f32 v35, v35
    v_mfma_f32_16x16x32_bf16 v[44:47], a[140:143], a[28:31], v[44:47]
    v_cvt_pk_bf16_f32 v49, v34, v35
    s_waitcnt vmcnt(4)
    s_waitcnt lgkmcnt(0)
    s_barrier
    v_mfma_f32_16x16x32_bf16 v[192:195], a[176:179], v[52:55], 0
    v_exp_f32 v36, v36
    v_mfma_f32_16x16x32_bf16 v[196:199], a[180:183], v[52:55], 0
    ds_read_b128 a[144:147], v6 offset:32768
    ds_read_b128 a[160:163], v6 offset:36864
    v_mfma_f32_16x16x32_bf16 v[200:203], a[184:187], v[52:55], 0
    v_exp_f32 v37, v37
    v_mfma_f32_16x16x32_bf16 v[204:207], a[188:191], v[52:55], 0
    v_cvt_pk_bf16_f32 v50, v36, v37
    ds_read_b128 a[148:151], v7 offset:32768
    v_mfma_f32_16x16x32_bf16 v[208:211], a[192:195], v[52:55], 0
    v_exp_f32 v38, v38
    v_mfma_f32_16x16x32_bf16 v[212:215], a[196:199], v[52:55], 0
    ds_read_b128 a[164:167], v7 offset:36864
    ds_read_b128 a[152:155], v8 offset:32768
    v_mfma_f32_16x16x32_bf16 v[216:219], a[200:203], v[52:55], 0
    v_exp_f32 v39, v39
    v_mfma_f32_16x16x32_bf16 v[220:223], a[204:207], v[52:55], 0
    v_cvt_pk_bf16_f32 v51, v38, v39
    ds_read_b128 a[168:171], v8 offset:36864
    v_mfma_f32_16x16x32_bf16 a[100:103], a[108:111], v[52:55], 0
    ds_read_b128 a[156:159], v9 offset:32768
    ds_read_b128 a[172:175], v9 offset:36864
    v_mfma_f32_16x16x32_bf16 v[32:35], a[112:115], a[32:35], v[64:67]
    v_exp_f32 v40, v40
    v_mfma_f32_16x16x32_bf16 v[36:39], a[128:131], a[32:35], v[64:67]
    ds_read_b64_tr_b16 a[176:177], v10 offset:32768
    ds_read_b64_tr_b16 a[178:179], v10 offset:36864
    v_mfma_f32_16x16x32_bf16 v[32:35], a[116:119], a[36:39], v[32:35]
    v_exp_f32 v41, v41
    v_mfma_f32_16x16x32_bf16 v[36:39], a[132:135], a[36:39], v[36:39]
    v_cvt_pk_bf16_f32 v52, v40, v41
    ds_read_b64_tr_b16 a[180:181], v11 offset:32768
    v_mfma_f32_16x16x32_bf16 v[32:35], a[120:123], a[40:43], v[32:35]
    v_exp_f32 v42, v42
    v_mfma_f32_16x16x32_bf16 v[36:39], a[136:139], a[40:43], v[36:39]
    ds_read_b64_tr_b16 a[182:183], v11 offset:36864
    ds_read_b64_tr_b16 a[184:185], v12 offset:32768
    v_mfma_f32_16x16x32_bf16 v[32:35], a[124:127], a[44:47], v[32:35]
    v_exp_f32 v43, v43
    v_mfma_f32_16x16x32_bf16 v[36:39], a[140:143], a[44:47], v[36:39]
    v_cvt_pk_bf16_f32 v53, v42, v43
    ds_read_b64_tr_b16 a[186:187], v12 offset:36864
    v_mfma_f32_16x16x32_bf16 v[160:163], a[208:211], v[48:51], v[160:163]
    v_exp_f32 v44, v44
    v_mfma_f32_16x16x32_bf16 v[164:167], a[212:215], v[48:51], v[164:167]
    ds_read_b64_tr_b16 a[188:189], v13 offset:32768
    ds_read_b64_tr_b16 a[190:191], v13 offset:36864
    v_mfma_f32_16x16x32_bf16 v[168:171], a[216:219], v[48:51], v[168:171]
    v_exp_f32 v45, v45
    v_mfma_f32_16x16x32_bf16 v[172:175], a[220:223], v[48:51], v[172:175]
    v_cvt_pk_bf16_f32 v54, v44, v45
    ds_read_b64_tr_b16 a[192:193], v14 offset:32768
    v_mfma_f32_16x16x32_bf16 v[176:179], a[224:227], v[48:51], v[176:179]
    v_exp_f32 v46, v46
    v_mfma_f32_16x16x32_bf16 v[180:183], a[228:231], v[48:51], v[180:183]
    ds_read_b64_tr_b16 a[194:195], v14 offset:36864
    ds_read_b64_tr_b16 a[196:197], v15 offset:32768
    v_mfma_f32_16x16x32_bf16 v[184:187], a[232:235], v[48:51], v[184:187]
    v_exp_f32 v47, v47
    v_mfma_f32_16x16x32_bf16 v[188:191], a[236:239], v[48:51], v[188:191]
    v_cvt_pk_bf16_f32 v55, v46, v47
    ds_read_b64_tr_b16 a[198:199], v15 offset:36864
    v_mfma_f32_16x16x32_bf16 a[96:99], a[108:111], v[48:51], a[96:99]
    ds_read_b64_tr_b16 a[200:201], v16 offset:32768
    ds_read_b64_tr_b16 a[202:203], v16 offset:36864
    s_waitcnt lgkmcnt(14)
    v_mfma_f32_16x16x32_bf16 v[40:43], a[144:147], a[0:3], v[56:59]
    v_exp_f32 v32, v32
    v_mfma_f32_16x16x32_bf16 v[44:47], a[160:163], a[0:3], v[56:59]
    ds_read_b64_tr_b16 a[204:205], v17 offset:32768
    ds_read_b64_tr_b16 a[206:207], v17 offset:36864
    v_mfma_f32_16x16x32_bf16 v[40:43], a[148:151], a[4:7], v[40:43]
    v_exp_f32 v33, v33
    v_mfma_f32_16x16x32_bf16 v[44:47], a[164:167], a[4:7], v[44:47]
    v_cvt_pk_bf16_f32 v48, v32, v33
    v_mfma_f32_16x16x32_bf16 v[40:43], a[152:155], a[8:11], v[40:43]
    v_exp_f32 v34, v34
    v_mfma_f32_16x16x32_bf16 v[44:47], a[168:171], a[8:11], v[44:47]
    v_mfma_f32_16x16x32_bf16 v[40:43], a[156:159], a[12:15], v[40:43]
    v_exp_f32 v35, v35
    v_mfma_f32_16x16x32_bf16 v[44:47], a[172:175], a[12:15], v[44:47]
    v_cvt_pk_bf16_f32 v49, v34, v35
    v_mfma_f32_16x16x32_bf16 v[192:195], a[208:211], v[52:55], v[192:195]
    v_exp_f32 v36, v36
    v_mfma_f32_16x16x32_bf16 v[196:199], a[212:215], v[52:55], v[196:199]
    v_mfma_f32_16x16x32_bf16 v[200:203], a[216:219], v[52:55], v[200:203]
    v_exp_f32 v37, v37
    v_mfma_f32_16x16x32_bf16 v[204:207], a[220:223], v[52:55], v[204:207]
    v_cvt_pk_bf16_f32 v50, v36, v37
    v_mfma_f32_16x16x32_bf16 v[208:211], a[224:227], v[52:55], v[208:211]
    v_exp_f32 v38, v38
    v_mfma_f32_16x16x32_bf16 v[212:215], a[228:231], v[52:55], v[212:215]
    v_mfma_f32_16x16x32_bf16 v[216:219], a[232:235], v[52:55], v[216:219]
    v_exp_f32 v39, v39
    v_mfma_f32_16x16x32_bf16 v[220:223], a[236:239], v[52:55], v[220:223]
    v_cvt_pk_bf16_f32 v51, v38, v39
    v_mfma_f32_16x16x32_bf16 a[100:103], a[108:111], v[52:55], a[100:103]
    s_waitcnt vmcnt(0)
    s_waitcnt lgkmcnt(0)
    s_barrier
    s_cmp_lg_u32 s55, 0
    s_cbranch_scc1 6f
    ds_read_b128 a[48:51], v97
    ds_read_b128 a[52:55], v97 offset:1024
    ds_read_b128 a[56:59], v97 offset:2048
    ds_read_b128 a[60:63], v97 offset:3072
    ds_read_b128 a[64:67], v97 offset:4096
    ds_read_b128 a[68:71], v97 offset:5120
    ds_read_b128 a[72:75], v97 offset:6144
    ds_read_b128 a[76:79], v97 offset:7168
    ds_read_b128 a[80:83], v97 offset:8192
    ds_read_b128 a[84:87], v97 offset:9216
    ds_read_b128 a[88:91], v97 offset:10240
    ds_read_b128 a[92:95], v97 offset:11264
6:
    v_mfma_f32_16x16x32_bf16 v[32:35], a[144:147], a[16:19], v[60:63]
    v_exp_f32 v40, v40
    v_mfma_f32_16x16x32_bf16 v[36:39], a[160:163], a[16:19], v[60:63]
    ds_read_b128 a[112:115], v6 offset:49152
    ds_read_b128 a[128:131], v6 offset:53248
    v_mfma_f32_16x16x32_bf16 v[32:35], a[148:151], a[20:23], v[32:35]
    v_exp_f32 v41, v41
    v_mfma_f32_16x16x32_bf16 v[36:39], a[164:167], a[20:23], v[36:39]
    v_cvt_pk_bf16_f32 v52, v40, v41
    ds_read_b128 a[116:119], v7 offset:49152
    v_mfma_f32_16x16x32_bf16 v[32:35], a[152:155], a[24:27], v[32:35]
    v_exp_f32 v42, v42
    v_mfma_f32_16x16x32_bf16 v[36:39], a[168:171], a[24:27], v[36:39]
    ds_read_b128 a[132:135], v7 offset:53248
    ds_read_b128 a[120:123], v8 offset:49152
    v_mfma_f32_16x16x32_bf16 v[32:35], a[156:159], a[28:31], v[32:35]
    v_exp_f32 v43, v43
    v_mfma_f32_16x16x32_bf16 v[36:39], a[172:175], a[28:31], v[36:39]
    v_cvt_pk_bf16_f32 v53, v42, v43
    ds_read_b128 a[136:139], v8 offset:53248
    v_mfma_f32_16x16x32_bf16 v[224:227], a[208:211], v[48:51], 0
    v_exp_f32 v44, v44
    v_mfma_f32_16x16x32_bf16 v[228:231], a[212:215], v[48:51], 0
    ds_read_b128 a[124:127], v9 offset:49152
    ds_read_b128 a[140:143], v9 offset:53248
    v_mfma_f32_16x16x32_bf16 v[232:235], a[216:219], v[48:51], 0
    v_exp_f32 v45, v45
    v_mfma_f32_16x16x32_bf16 v[236:239], a[220:223], v[48:51], 0
    v_cvt_pk_bf16_f32 v54, v44, v45
    ds_read_b64_tr_b16 a[208:209], v10 offset:49152
    v_mfma_f32_16x16x32_bf16 v[240:243], a[224:227], v[48:51], 0
    v_exp_f32 v46, v46
    v_mfma_f32_16x16x32_bf16 v[244:247], a[228:231], v[48:51], 0
    ds_read_b64_tr_b16 a[210:211], v10 offset:53248
    ds_read_b64_tr_b16 a[212:213], v11 offset:49152
    v_mfma_f32_16x16x32_bf16 v[248:251], a[232:235], v[48:51], 0
    v_exp_f32 v47, v47
    v_mfma_f32_16x16x32_bf16 v[252:255], a[236:239], v[48:51], 0
    v_cvt_pk_bf16_f32 v55, v46, v47
    ds_read_b64_tr_b16 a[214:215], v11 offset:53248
    v_mfma_f32_16x16x32_bf16 a[104:107], a[108:111], v[48:51], 0
    ds_read_b64_tr_b16 a[216:217], v12 offset:49152
    ds_read_b64_tr_b16 a[218:219], v12 offset:53248
    s_waitcnt lgkmcnt(6)
    v_mfma_f32_16x16x32_bf16 v[40:43], a[112:115], a[0:3], v[56:59]
    v_exp_f32 v32, v32
    v_mfma_f32_16x16x32_bf16 v[44:47], a[128:131], a[0:3], v[56:59]
    ds_read_b64_tr_b16 a[220:221], v13 offset:49152
    ds_read_b64_tr_b16 a[222:223], v13 offset:53248
    v_mfma_f32_16x16x32_bf16 v[40:43], a[116:119], a[4:7], v[40:43]
    v_exp_f32 v33, v33
    v_mfma_f32_16x16x32_bf16 v[44:47], a[132:135], a[4:7], v[44:47]
    v_cvt_pk_bf16_f32 v48, v32, v33
    ds_read_b64_tr_b16 a[224:225], v14 offset:49152
    v_mfma_f32_16x16x32_bf16 v[40:43], a[120:123], a[8:11], v[40:43]
    v_exp_f32 v34, v34
    v_mfma_f32_16x16x32_bf16 v[44:47], a[136:139], a[8:11], v[44:47]
    ds_read_b64_tr_b16 a[226:227], v14 offset:53248
    ds_read_b64_tr_b16 a[228:229], v15 offset:49152
    v_mfma_f32_16x16x32_bf16 v[40:43], a[124:127], a[12:15], v[40:43]
    v_exp_f32 v35, v35
    v_mfma_f32_16x16x32_bf16 v[44:47], a[140:143], a[12:15], v[44:47]
    v_cvt_pk_bf16_f32 v49, v34, v35
    ds_read_b64_tr_b16 a[230:231], v15 offset:53248
    v_mfma_f32_16x16x32_bf16 v[160:163], a[176:179], v[52:55], v[160:163]
    v_exp_f32 v36, v36
    v_mfma_f32_16x16x32_bf16 v[164:167], a[180:183], v[52:55], v[164:167]
    ds_read_b64_tr_b16 a[232:233], v16 offset:49152
    ds_read_b64_tr_b16 a[234:235], v16 offset:53248
    v_mfma_f32_16x16x32_bf16 v[168:171], a[184:187], v[52:55], v[168:171]
    v_exp_f32 v37, v37
    v_mfma_f32_16x16x32_bf16 v[172:175], a[188:191], v[52:55], v[172:175]
    v_cvt_pk_bf16_f32 v50, v36, v37
    ds_read_b64_tr_b16 a[236:237], v17 offset:49152
    v_mfma_f32_16x16x32_bf16 v[176:179], a[192:195], v[52:55], v[176:179]
    v_exp_f32 v38, v38
    v_mfma_f32_16x16x32_bf16 v[180:183], a[196:199], v[52:55], v[180:183]
    ds_read_b64_tr_b16 a[238:239], v17 offset:53248
    v_mfma_f32_16x16x32_bf16 v[184:187], a[200:203], v[52:55], v[184:187]
    v_exp_f32 v39, v39
    v_mfma_f32_16x16x32_bf16 v[188:191], a[204:207], v[52:55], v[188:191]
    v_cvt_pk_bf16_f32 v51, v38, v39
    v_mfma_f32_16x16x32_bf16 a[96:99], a[108:111], v[52:55], a[96:99]
    v_mfma_f32_16x16x32_bf16 v[32:35], a[112:115], a[16:19], v[60:63]
    v_exp_f32 v40, v40
    v_mfma_f32_16x16x32_bf16 v[36:39], a[128:131], a[16:19], v[60:63]
    v_mfma_f32_16x16x32_bf16 v[32:35], a[116:119], a[20:23], v[32:35]
    v_exp_f32 v41, v41
    v_mfma_f32_16x16x32_bf16 v[36:39], a[132:135], a[20:23], v[36:39]
    v_cvt_pk_bf16_f32 v52, v40, v41
    v_mfma_f32_16x16x32_bf16 v[32:35], a[120:123], a[24:27], v[32:35]
    v_exp_f32 v42, v42
    v_mfma_f32_16x16x32_bf16 v[36:39], a[136:139], a[24:27], v[36:39]
    v_mfma_f32_16x16x32_bf16 v[32:35], a[124:127], a[28:31], v[32:35]
    v_exp_f32 v43, v43
    v_mfma_f32_16x16x32_bf16 v[36:39], a[140:143], a[28:31], v[36:39]
    v_cvt_pk_bf16_f32 v53, v42, v43
    s_waitcnt vmcnt(0)
    s_cmp_lg_u32 s55, 0
    s_cbranch_scc1 6f
    v_readfirstlane_b32 s39, v108
    s_nop 0
    s_cmp_eq_u32 s39, 0
    s_cselect_b32 s39, s72, s39
    s_mov_b32 s81, s39
    v_mov_b32 v3, s39
    v_mov_b32 v4, 163776
    ds_write_b32 v4, v3 offset:32
6:
    s_waitcnt lgkmcnt(0)
    s_barrier
    v_mfma_f32_16x16x32_bf16 v[192:195], a[176:179], v[48:51], v[192:195]
    v_exp_f32 v44, v44
    v_mfma_f32_16x16x32_bf16 v[196:199], a[180:183], v[48:51], v[196:199]
    ds_read_b128 a[144:147], v6
    ds_read_b128 a[160:163], v6 offset:4096
    v_mfma_f32_16x16x32_bf16 v[200:203], a[184:187], v[48:51], v[200:203]
    v_exp_f32 v45, v45
    v_mfma_f32_16x16x32_bf16 v[204:207], a[188:191], v[48:51], v[204:207]
    v_cvt_pk_bf16_f32 v54, v44, v45
    ds_read_b128 a[148:151], v7
    v_mfma_f32_16x16x32_bf16 v[208:211], a[192:195], v[48:51], v[208:211]
    v_exp_f32 v46, v46
    v_mfma_f32_16x16x32_bf16 v[212:215], a[196:199], v[48:51], v[212:215]
    ds_read_b128 a[164:167], v7 offset:4096
    ds_read_b128 a[152:155], v8
    v_mfma_f32_16x16x32_bf16 v[216:219], a[200:203], v[48:51], v[216:219]
    v_exp_f32 v47, v47
    v_mfma_f32_16x16x32_bf16 v[220:223], a[204:207], v[48:51], v[220:223]
    v_cvt_pk_bf16_f32 v55, v46, v47
    ds_read_b128 a[168:171], v8 offset:4096
    v_mfma_f32_16x16x32_bf16 a[100:103], a[108:111], v[48:51], a[100:103]
    ds_read_b128 a[156:159], v9
    ds_read_b128 a[172:175], v9 offset:4096
    v_mfma_f32_16x16x32_bf16 v[40:43], a[112:115], a[32:35], v[64:67]
    v_exp_f32 v32, v32
    v_mfma_f32_16x16x32_bf16 v[44:47], a[128:131], a[32:35], v[64:67]
    ds_read_b64_tr_b16 a[176:177], v10
    ds_read_b64_tr_b16 a[178:179], v10 offset:4096
    v_mfma_f32_16x16x32_bf16 v[40:43], a[116:119], a[36:39], v[40:43]
    v_exp_f32 v33, v33
    v_mfma_f32_16x16x32_bf16 v[44:47], a[132:135], a[36:39], v[44:47]
    v_cvt_pk_bf16_f32 v48, v32, v33
    ds_read_b64_tr_b16 a[180:181], v11
    v_mfma_f32_16x16x32_bf16 v[40:43], a[120:123], a[40:43], v[40:43]
    v_exp_f32 v34, v34
    v_mfma_f32_16x16x32_bf16 v[44:47], a[136:139], a[40:43], v[44:47]
    ds_read_b64_tr_b16 a[182:183], v11 offset:4096
    ds_read_b64_tr_b16 a[184:185], v12
    v_mfma_f32_16x16x32_bf16 v[40:43], a[124:127], a[44:47], v[40:43]
    v_exp_f32 v35, v35
    v_mfma_f32_16x16x32_bf16 v[44:47], a[140:143], a[44:47], v[44:47]
    v_cvt_pk_bf16_f32 v49, v34, v35
    ds_read_b64_tr_b16 a[186:187], v12 offset:4096
    v_mfma_f32_16x16x32_bf16 v[160:163], a[208:211], v[52:55], v[160:163]
    v_exp_f32 v36, v36
    v_mfma_f32_16x16x32_bf16 v[164:167], a[212:215], v[52:55], v[164:167]
    ds_read_b64_tr_b16 a[188:189], v13
    ds_read_b64_tr_b16 a[190:191], v13 offset:4096
    v_mfma_f32_16x16x32_bf16 v[168:171], a[216:219], v[52:55], v[168:171]
    v_exp_f32 v37, v37
    v_mfma_f32_16x16x32_bf16 v[172:175], a[220:223], v[52:55], v[172:175]
    v_cvt_pk_bf16_f32 v50, v36, v37
    ds_read_b64_tr_b16 a[192:193], v14
    v_mfma_f32_16x16x32_bf16 v[176:179], a[224:227], v[52:55], v[176:179]
    v_exp_f32 v38, v38
    v_mfma_f32_16x16x32_bf16 v[180:183], a[228:231], v[52:55], v[180:183]
    ds_read_b64_tr_b16 a[194:195], v14 offset:4096
    ds_read_b64_tr_b16 a[196:197], v15
    v_mfma_f32_16x16x32_bf16 v[184:187], a[232:235], v[52:55], v[184:187]
    v_exp_f32 v39, v39
    v_mfma_f32_16x16x32_bf16 v[188:191], a[236:239], v[52:55], v[188:191]
    v_cvt_pk_bf16_f32 v51, v38, v39
    ds_read_b64_tr_b16 a[198:199], v15 offset:4096
    v_mfma_f32_16x16x32_bf16 a[96:99], a[108:111], v[52:55], a[96:99]
    ds_read_b64_tr_b16 a[200:201], v16
    ds_read_b64_tr_b16 a[202:203], v16 offset:4096
    s_waitcnt lgkmcnt(14)
    v_mfma_f32_16x16x32_bf16 v[32:35], a[144:147], a[0:3], v[56:59]
    v_exp_f32 v40, v40
    v_mfma_f32_16x16x32_bf16 v[36:39], a[160:163], a[0:3], v[56:59]
    ds_read_b64_tr_b16 a[204:205], v17
    ds_read_b64_tr_b16 a[206:207], v17 offset:4096
    v_mfma_f32_16x16x32_bf16 v[32:35], a[148:151], a[4:7], v[32:35]
    v_exp_f32 v41, v41
    v_mfma_f32_16x16x32_bf16 v[36:39], a[164:167], a[4:7], v[36:39]
    v_cvt_pk_bf16_f32 v52, v40, v41
    v_mfma_f32_16x16x32_bf16 v[32:35], a[152:155], a[8:11], v[32:35]
    v_exp_f32 v42, v42
    v_mfma_f32_16x16x32_bf16 v[36:39], a[168:171], a[8:11], v[36:39]
    v_mfma_f32_16x16x32_bf16 v[32:35], a[156:159], a[12:15], v[32:35]
    v_exp_f32 v43, v43
    v_mfma_f32_16x16x32_bf16 v[36:39], a[172:175], a[12:15], v[36:39]
    v_cvt_pk_bf16_f32 v53, v42, v43
    v_mfma_f32_16x16x32_bf16 v[192:195], a[208:211], v[48:51], v[192:195]
    v_exp_f32 v44, v44
    v_mfma_f32_16x16x32_bf16 v[196:199], a[212:215], v[48:51], v[196:199]
    v_mfma_f32_16x16x32_bf16 v[200:203], a[216:219], v[48:51], v[200:203]
    v_exp_f32 v45, v45
    v_mfma_f32_16x16x32_bf16 v[204:207], a[220:223], v[48:51], v[204:207]
    v_cvt_pk_bf16_f32 v54, v44, v45
    v_mfma_f32_16x16x32_bf16 v[208:211], a[224:227], v[48:51], v[208:211]
    v_exp_f32 v46, v46
    v_mfma_f32_16x16x32_bf16 v[212:215], a[228:231], v[48:51], v[212:215]
    v_mfma_f32_16x16x32_bf16 v[216:219], a[232:235], v[48:51], v[216:219]
    v_exp_f32 v47, v47
    v_mfma_f32_16x16x32_bf16 v[220:223], a[236:239], v[48:51], v[220:223]
    v_cvt_pk_bf16_f32 v55, v46, v47
    v_mfma_f32_16x16x32_bf16 a[100:103], a[108:111], v[48:51], a[100:103]
    s_mov_b32 s54, 6
L_loop_C01:
    s_waitcnt lgkmcnt(0)
    s_barrier
    v_mfma_f32_16x16x32_bf16 v[40:43], a[144:147], a[16:19], v[60:63]
    v_exp_f32 v32, v32
    v_mfma_f32_16x16x32_bf16 v[44:47], a[160:163], a[16:19], v[60:63]
    ds_read_b128 a[112:115], v6 offset:16384
    ds_read_b128 a[128:131], v6 offset:20480
    v_mfma_f32_16x16x32_bf16 v[40:43], a[148:151], a[20:23], v[40:43]
    v_exp_f32 v33, v33
    v_mfma_f32_16x16x32_bf16 v[44:47], a[164:167], a[20:23], v[44:47]
    v_cvt_pk_bf16_f32 v48, v32, v33
    ds_read_b128 a[116:119], v7 offset:16384
    v_mfma_f32_16x16x32_bf16 v[40:43], a[152:155], a[24:27], v[40:43]
    v_exp_f32 v34, v34
    v_mfma_f32_16x16x32_bf16 v[44:47], a[168:171], a[24:27], v[44:47]
    ds_read_b128 a[132:135], v7 offset:20480
    ds_read_b128 a[120:123], v8 offset:16384
    v_mfma_f32_16x16x32_bf16 v[40:43], a[156:159], a[28:31], v[40:43]
    v_exp_f32 v35, v35
    v_mfma_f32_16x16x32_bf16 v[44:47], a[172:175], a[28:31], v[44:47]
    v_cvt_pk_bf16_f32 v49, v34, v35
    ds_read_b128 a[136:139], v8 offset:20480
    v_mfma_f32_16x16x32_bf16 v[224:227], a[208:211], v[52:55], v[224:227]
    v_exp_f32 v36, v36
    v_mfma_f32_16x16x32_bf16 v[228:231], a[212:215], v[52:55], v[228:231]
    ds_read_b128 a[124:127], v9 offset:16384
    ds_read_b128 a[140:143], v9 offset:20480
    v_mfma_f32_16x16x32_bf16 v[232:235], a[216:219], v[52:55], v[232:235]
    v_exp_f32 v37, v37
    v_mfma_f32_16x16x32_bf16 v[236:239], a[220:223], v[52:55], v[236:239]
    v_cvt_pk_bf16_f32 v50, v36, v37
    ds_read_b64_tr_b16 a[208:209], v10 offset:16384
    v_mfma_f32_16x16x32_bf16 v[240:243], a[224:227], v[52:55], v[240:243]
    v_exp_f32 v38, v38
    v_mfma_f32_16x16x32_bf16 v[244:247], a[228:231], v[52:55], v[244:247]
    ds_read_b64_tr_b16 a[210:211], v10 offset:20480
    ds_read_b64_tr_b16 a[212:213], v11 offset:16384
    v_mfma_f32_16x16x32_bf16 v[248:251], a[232:235], v[52:55], v[248:251]
    v_exp_f32 v39, v39
    v_mfma_f32_16x16x32_bf16 v[252:255], a[236:239], v[52:55], v[252:255]
    v_cvt_pk_bf16_f32 v51, v38, v39
    ds_read_b64_tr_b16 a[214:215], v11 offset:20480
    v_mfma_f32_16x16x32_bf16 a[104:107], a[108:111], v[52:55], a[104:107]
    ds_read_b64_tr_b16 a[216:217], v12 offset:16384
    ds_read_b64_tr_b16 a[218:219], v12 offset:20480
    s_waitcnt lgkmcnt(6)
    v_mfma_f32_16x16x32_bf16 v[32:35], a[112:115], a[0:3], v[56:59]
    v_exp_f32 v40, v40
    v_mfma_f32_16x16x32_bf16 v[36:39], a[128:131], a[0:3], v[56:59]
    ds_read_b64_tr_b16 a[220:221], v13 offset:16384
    ds_read_b64_tr_b16 a[222:223], v13 offset:20480
    v_mfma_f32_16x16x32_bf16 v[32:35], a[116:119], a[4:7], v[32:35]
    v_exp_f32 v41, v41
    v_mfma_f32_16x16x32_bf16 v[36:39], a[132:135], a[4:7], v[36:39]
    v_cvt_pk_bf16_f32 v52, v40, v41
    ds_read_b64_tr_b16 a[224:225], v14 offset:16384
    v_mfma_f32_16x16x32_bf16 v[32:35], a[120:123], a[8:11], v[32:35]
    v_exp_f32 v42, v42
    v_mfma_f32_16x16x32_bf16 v[36:39], a[136:139], a[8:11], v[36:39]
    ds_read_b64_tr_b16 a[226:227], v14 offset:20480
    ds_read_b64_tr_b16 a[228:229], v15 offset:16384
    v_mfma_f32_16x16x32_bf16 v[32:35], a[124:127], a[12:15], v[32:35]
    v_exp_f32 v43, v43
    v_mfma_f32_16x16x32_bf16 v[36:39], a[140:143], a[12:15], v[36:39]
    v_cvt_pk_bf16_f32 v53, v42, v43
    ds_read_b64_tr_b16 a[230:231], v15 offset:20480
    v_mfma_f32_16x16x32_bf16 v[160:163], a[176:179], v[48:51], v[160:163]
    v_exp_f32 v44, v44
    v_mfma_f32_16x16x32_bf16 v[164:167], a[180:183], v[48:51], v[164:167]
    ds_read_b64_tr_b16 a[232:233], v16 offset:16384
    ds_read_b64_tr_b16 a[234:235], v16 offset:20480
    v_mfma_f32_16x16x32_bf16 v[168:171], a[184:187], v[48:51], v[168:171]
    v_exp_f32 v45, v45
    v_mfma_f32_16x16x32_bf16 v[172:175], a[188:191], v[48:51], v[172:175]
    v_cvt_pk_bf16_f32 v54, v44, v45
    ds_read_b64_tr_b16 a[236:237], v17 offset:16384
    v_mfma_f32_16x16x32_bf16 v[176:179], a[192:195], v[48:51], v[176:179]
    v_exp_f32 v46, v46
    v_mfma_f32_16x16x32_bf16 v[180:183], a[196:199], v[48:51], v[180:183]
    ds_read_b64_tr_b16 a[238:239], v17 offset:20480
    v_mfma_f32_16x16x32_bf16 v[184:187], a[200:203], v[48:51], v[184:187]
    v_exp_f32 v47, v47
    v_mfma_f32_16x16x32_bf16 v[188:191], a[204:207], v[48:51], v[188:191]
    v_cvt_pk_bf16_f32 v55, v46, v47
    v_mfma_f32_16x16x32_bf16 a[96:99], a[108:111], v[48:51], a[96:99]
    v_mfma_f32_16x16x32_bf16 v[40:43], a[112:115], a[16:19], v[60:63]
    v_exp_f32 v32, v32
    v_mfma_f32_16x16x32_bf16 v[44:47], a[128:131], a[16:19], v[60:63]
    v_mfma_f32_16x16x32_bf16 v[40:43], a[116:119], a[20:23], v[40:43]
    v_exp_f32 v33, v33
    v_mfma_f32_16x16x32_bf16 v[44:47], a[132:135], a[20:23], v[44:47]
    v_cvt_pk_bf16_f32 v48, v32, v33
    v_mfma_f32_16x16x32_bf16 v[40:43], a[120:123], a[24:27], v[40:43]
    v_exp_f32 v34, v34
    v_mfma_f32_16x16x32_bf16 v[44:47], a[136:139], a[24:27], v[44:47]
    v_mfma_f32_16x16x32_bf16 v[40:43], a[124:127], a[28:31], v[40:43]
    v_exp_f32 v35, v35
    v_mfma_f32_16x16x32_bf16 v[44:47], a[140:143], a[28:31], v[44:47]
    v_cvt_pk_bf16_f32 v49, v34, v35
    s_waitcnt lgkmcnt(0)
    s_barrier
    v_mfma_f32_16x16x32_bf16 v[192:195], a[176:179], v[52:55], v[192:195]
    v_exp_f32 v36, v36
    v_mfma_f32_16x16x32_bf16 v[196:199], a[180:183], v[52:55], v[196:199]
    ds_read_b128 a[144:147], v6 offset:32768
    ds_read_b128 a[160:163], v6 offset:36864
    v_mfma_f32_16x16x32_bf16 v[200:203], a[184:187], v[52:55], v[200:203]
    v_exp_f32 v37, v37
    v_mfma_f32_16x16x32_bf16 v[204:207], a[188:191], v[52:55], v[204:207]
    v_cvt_pk_bf16_f32 v50, v36, v37
    ds_read_b128 a[148:151], v7 offset:32768
    v_mfma_f32_16x16x32_bf16 v[208:211], a[192:195], v[52:55], v[208:211]
    v_exp_f32 v38, v38
    v_mfma_f32_16x16x32_bf16 v[212:215], a[196:199], v[52:55], v[212:215]
    ds_read_b128 a[164:167], v7 offset:36864
    ds_read_b128 a[152:155], v8 offset:32768
    v_mfma_f32_16x16x32_bf16 v[216:219], a[200:203], v[52:55], v[216:219]
    v_exp_f32 v39, v39
    v_mfma_f32_16x16x32_bf16 v[220:223], a[204:207], v[52:55], v[220:223]
    v_cvt_pk_bf16_f32 v51, v38, v39
    ds_read_b128 a[168:171], v8 offset:36864
    v_mfma_f32_16x16x32_bf16 a[100:103], a[108:111], v[52:55], a[100:103]
    ds_read_b128 a[156:159], v9 offset:32768
    ds_read_b128 a[172:175], v9 offset:36864
    v_mfma_f32_16x16x32_bf16 v[32:35], a[112:115], a[32:35], v[64:67]
    v_exp_f32 v40, v40
    v_mfma_f32_16x16x32_bf16 v[36:39], a[128:131], a[32:35], v[64:67]
    ds_read_b64_tr_b16 a[176:177], v10 offset:32768
    ds_read_b64_tr_b16 a[178:179], v10 offset:36864
    v_mfma_f32_16x16x32_bf16 v[32:35], a[116:119], a[36:39], v[32:35]
    v_exp_f32 v41, v41
    v_mfma_f32_16x16x32_bf16 v[36:39], a[132:135], a[36:39], v[36:39]
    v_cvt_pk_bf16_f32 v52, v40, v41
    ds_read_b64_tr_b16 a[180:181], v11 offset:32768
    v_mfma_f32_16x16x32_bf16 v[32:35], a[120:123], a[40:43], v[32:35]
    v_exp_f32 v42, v42
    v_mfma_f32_16x16x32_bf16 v[36:39], a[136:139], a[40:43], v[36:39]
    ds_read_b64_tr_b16 a[182:183], v11 offset:36864
    ds_read_b64_tr_b16 a[184:185], v12 offset:32768
    v_mfma_f32_16x16x32_bf16 v[32:35], a[124:127], a[44:47], v[32:35]
    v_exp_f32 v43, v43
    v_mfma_f32_16x16x32_bf16 v[36:39], a[140:143], a[44:47], v[36:39]
    v_cvt_pk_bf16_f32 v53, v42, v43
    ds_read_b64_tr_b16 a[186:187], v12 offset:36864
    v_mfma_f32_16x16x32_bf16 v[160:163], a[208:211], v[48:51], v[160:163]
    v_exp_f32 v44, v44
    v_mfma_f32_16x16x32_bf16 v[164:167], a[212:215], v[48:51], v[164:167]
    ds_read_b64_tr_b16 a[188:189], v13 offset:32768
    ds_read_b64_tr_b16 a[190:191], v13 offset:36864
    v_mfma_f32_16x16x32_bf16 v[168:171], a[216:219], v[48:51], v[168:171]
    v_exp_f32 v45, v45
    v_mfma_f32_16x16x32_bf16 v[172:175], a[220:223], v[48:51], v[172:175]
    v_cvt_pk_bf16_f32 v54, v44, v45
    ds_read_b64_tr_b16 a[192:193], v14 offset:32768
    v_mfma_f32_16x16x32_bf16 v[176:179], a[224:227], v[48:51], v[176:179]
    v_exp_f32 v46, v46
    v_mfma_f32_16x16x32_bf16 v[180:183], a[228:231], v[48:51], v[180:183]
    ds_read_b64_tr_b16 a[194:195], v14 offset:36864
    ds_read_b64_tr_b16 a[196:197], v15 offset:32768
    v_mfma_f32_16x16x32_bf16 v[184:187], a[232:235], v[48:51], v[184:187]
    v_exp_f32 v47, v47
    v_mfma_f32_16x16x32_bf16 v[188:191], a[236:239], v[48:51], v[188:191]
    v_cvt_pk_bf16_f32 v55, v46, v47
    ds_read_b64_tr_b16 a[198:199], v15 offset:36864
    v_mfma_f32_16x16x32_bf16 a[96:99], a[108:111], v[48:51], a[96:99]
    ds_read_b64_tr_b16 a[200:201], v16 offset:32768
    ds_read_b64_tr_b16 a[202:203], v16 offset:36864
    s_waitcnt lgkmcnt(14)
    v_mfma_f32_16x16x32_bf16 v[40:43], a[144:147], a[0:3], v[56:59]
    v_exp_f32 v32, v32
    v_mfma_f32_16x16x32_bf16 v[44:47], a[160:163], a[0:3], v[56:59]
    ds_read_b64_tr_b16 a[204:205], v17 offset:32768
    ds_read_b64_tr_b16 a[206:207], v17 offset:36864
    v_mfma_f32_16x16x32_bf16 v[40:43], a[148:151], a[4:7], v[40:43]
    v_exp_f32 v33, v33
    v_mfma_f32_16x16x32_bf16 v[44:47], a[164:167], a[4:7], v[44:47]
    v_cvt_pk_bf16_f32 v48, v32, v33
    v_mfma_f32_16x16x32_bf16 v[40:43], a[152:155], a[8:11], v[40:43]
    v_exp_f32 v34, v34
    v_mfma_f32_16x16x32_bf16 v[44:47], a[168:171], a[8:11], v[44:47]
    v_mfma_f32_16x16x32_bf16 v[40:43], a[156:159], a[12:15], v[40:43]
    v_exp_f32 v35, v35
    v_mfma_f32_16x16x32_bf16 v[44:47], a[172:175], a[12:15], v[44:47]
    v_cvt_pk_bf16_f32 v49, v34, v35
    v_mfma_f32_16x16x32_bf16 v[192:195], a[208:211], v[52:55], v[192:195]
    v_exp_f32 v36, v36
    v_mfma_f32_16x16x32_bf16 v[196:199], a[212:215], v[52:55], v[196:199]
    v_mfma_f32_16x16x32_bf16 v[200:203], a[216:219], v[52:55], v[200:203]
    v_exp_f32 v37, v37
    v_mfma_f32_16x16x32_bf16 v[204:207], a[220:223], v[52:55], v[204:207]
    v_cvt_pk_bf16_f32 v50, v36, v37
    v_mfma_f32_16x16x32_bf16 v[208:211], a[224:227], v[52:55], v[208:211]
    v_exp_f32 v38, v38
    v_mfma_f32_16x16x32_bf16 v[212:215], a[228:231], v[52:55], v[212:215]
    v_mfma_f32_16x16x32_bf16 v[216:219], a[232:235], v[52:55], v[216:219]
    v_exp_f32 v39, v39
    v_mfma_f32_16x16x32_bf16 v[220:223], a[236:239], v[52:55], v[220:223]
    v_cvt_pk_bf16_f32 v51, v38, v39
    v_mfma_f32_16x16x32_bf16 a[100:103], a[108:111], v[52:55], a[100:103]
    s_waitcnt lgkmcnt(0)
    s_barrier
    v_mfma_f32_16x16x32_bf16 v[32:35], a[144:147], a[16:19], v[60:63]
    v_exp_f32 v40, v40
    v_mfma_f32_16x16x32_bf16 v[36:39], a[160:163], a[16:19], v[60:63]
    ds_read_b128 a[112:115], v6 offset:49152
    ds_read_b128 a[128:131], v6 offset:53248
    v_mfma_f32_16x16x32_bf16 v[32:35], a[148:151], a[20:23], v[32:35]
    v_exp_f32 v41, v41
    v_mfma_f32_16x16x32_bf16 v[36:39], a[164:167], a[20:23], v[36:39]
    v_cvt_pk_bf16_f32 v52, v40, v41
    ds_read_b128 a[116:119], v7 offset:49152
    v_mfma_f32_16x16x32_bf16 v[32:35], a[152:155], a[24:27], v[32:35]
    v_exp_f32 v42, v42
    v_mfma_f32_16x16x32_bf16 v[36:39], a[168:171], a[24:27], v[36:39]
    ds_read_b128 a[132:135], v7 offset:53248
    ds_read_b128 a[120:123], v8 offset:49152
    v_mfma_f32_16x16x32_bf16 v[32:35], a[156:159], a[28:31], v[32:35]
    v_exp_f32 v43, v43
    v_mfma_f32_16x16x32_bf16 v[36:39], a[172:175], a[28:31], v[36:39]
    v_cvt_pk_bf16_f32 v53, v42, v43
    ds_read_b128 a[136:139], v8 offset:53248
    v_mfma_f32_16x16x32_bf16 v[224:227], a[208:211], v[48:51], v[224:227]
    v_exp_f32 v44, v44
    v_mfma_f32_16x16x32_bf16 v[228:231], a[212:215], v[48:51], v[228:231]
    ds_read_b128 a[124:127], v9 offset:49152
    ds_read_b128 a[140:143], v9 offset:53248
    v_mfma_f32_16x16x32_bf16 v[232:235], a[216:219], v[48:51], v[232:235]
    v_exp_f32 v45, v45
    v_mfma_f32_16x16x32_bf16 v[236:239], a[220:223], v[48:51], v[236:239]
    v_cvt_pk_bf16_f32 v54, v44, v45
    ds_read_b64_tr_b16 a[208:209], v10 offset:49152
    v_mfma_f32_16x16x32_bf16 v[240:243], a[224:227], v[48:51], v[240:243]
    v_exp_f32 v46, v46
    v_mfma_f32_16x16x32_bf16 v[244:247], a[228:231], v[48:51], v[244:247]
    ds_read_b64_tr_b16 a[210:211], v10 offset:53248
    ds_read_b64_tr_b16 a[212:213], v11 offset:49152
    v_mfma_f32_16x16x32_bf16 v[248:251], a[232:235], v[48:51], v[248:251]
    v_exp_f32 v47, v47
    v_mfma_f32_16x16x32_bf16 v[252:255], a[236:239], v[48:51], v[252:255]
    v_cvt_pk_bf16_f32 v55, v46, v47
    ds_read_b64_tr_b16 a[214:215], v11 offset:53248
    v_mfma_f32_16x16x32_bf16 a[104:107], a[108:111], v[48:51], a[104:107]
    ds_read_b64_tr_b16 a[216:217], v12 offset:49152
    ds_read_b64_tr_b16 a[218:219], v12 offset:53248
    s_waitcnt lgkmcnt(6)
    v_mfma_f32_16x16x32_bf16 v[40:43], a[112:115], a[0:3], v[56:59]
    v_exp_f32 v32, v32
    v_mfma_f32_16x16x32_bf16 v[44:47], a[128:131], a[0:3], v[56:59]
    ds_read_b64_tr_b16 a[220:221], v13 offset:49152
    ds_read_b64_tr_b16 a[222:223], v13 offset:53248
    v_mfma_f32_16x16x32_bf16 v[40:43], a[116:119], a[4:7], v[40:43]
    v_exp_f32 v33, v33
    v_mfma_f32_16x16x32_bf16 v[44:47], a[132:135], a[4:7], v[44:47]
    v_cvt_pk_bf16_f32 v48, v32, v33
    ds_read_b64_tr_b16 a[224:225], v14 offset:49152
    v_mfma_f32_16x16x32_bf16 v[40:43], a[120:123], a[8:11], v[40:43]
    v_exp_f32 v34, v34
    v_mfma_f32_16x16x32_bf16 v[44:47], a[136:139], a[8:11], v[44:47]
    ds_read_b64_tr_b16 a[226:227], v14 offset:53248
    ds_read_b64_tr_b16 a[228:229], v15 offset:49152
    v_mfma_f32_16x16x32_bf16 v[40:43], a[124:127], a[12:15], v[40:43]
    v_exp_f32 v35, v35
    v_mfma_f32_16x16x32_bf16 v[44:47], a[140:143], a[12:15], v[44:47]
    v_cvt_pk_bf16_f32 v49, v34, v35
    ds_read_b64_tr_b16 a[230:231], v15 offset:53248
    v_mfma_f32_16x16x32_bf16 v[160:163], a[176:179], v[52:55], v[160:163]
    v_exp_f32 v36, v36
    v_mfma_f32_16x16x32_bf16 v[164:167], a[180:183], v[52:55], v[164:167]
    ds_read_b64_tr_b16 a[232:233], v16 offset:49152
    ds_read_b64_tr_b16 a[234:235], v16 offset:53248
    v_mfma_f32_16x16x32_bf16 v[168:171], a[184:187], v[52:55], v[168:171]
    v_exp_f32 v37, v37
    v_mfma_f32_16x16x32_bf16 v[172:175], a[188:191], v[52:55], v[172:175]
    v_cvt_pk_bf16_f32 v50, v36, v37
    ds_read_b64_tr_b16 a[236:237], v17 offset:49152
    v_mfma_f32_16x16x32_bf16 v[176:179], a[192:195], v[52:55], v[176:179]
    v_exp_f32 v38, v38
    v_mfma_f32_16x16x32_bf16 v[180:183], a[196:199], v[52:55], v[180:183]
    ds_read_b64_tr_b16 a[238:239], v17 offset:53248
    v_mfma_f32_16x16x32_bf16 v[184:187], a[200:203], v[52:55], v[184:187]
    v_exp_f32 v39, v39
    v_mfma_f32_16x16x32_bf16 v[188:191], a[204:207], v[52:55], v[188:191]
    v_cvt_pk_bf16_f32 v51, v38, v39
    v_mfma_f32_16x16x32_bf16 a[96:99], a[108:111], v[52:55], a[96:99]
    v_mfma_f32_16x16x32_bf16 v[32:35], a[112:115], a[16:19], v[60:63]
    v_exp_f32 v40, v40
    v_mfma_f32_16x16x32_bf16 v[36:39], a[128:131], a[16:19], v[60:63]
    v_mfma_f32_16x16x32_bf16 v[32:35], a[116:119], a[20:23], v[32:35]
    v_exp_f32 v41, v41
    v_mfma_f32_16x16x32_bf16 v[36:39], a[132:135], a[20:23], v[36:39]
    v_cvt_pk_bf16_f32 v52, v40, v41
    v_mfma_f32_16x16x32_bf16 v[32:35], a[120:123], a[24:27], v[32:35]
    v_exp_f32 v42, v42
    v_mfma_f32_16x16x32_bf16 v[36:39], a[136:139], a[24:27], v[36:39]
    v_mfma_f32_16x16x32_bf16 v[32:35], a[124:127], a[28:31], v[32:35]
    v_exp_f32 v43, v43
    v_mfma_f32_16x16x32_bf16 v[36:39], a[140:143], a[28:31], v[36:39]
    v_cvt_pk_bf16_f32 v53, v42, v43
    s_waitcnt lgkmcnt(0)
    s_barrier
    v_mfma_f32_16x16x32_bf16 v[192:195], a[176:179], v[48:51], v[192:195]
    v_exp_f32 v44, v44
    v_mfma_f32_16x16x32_bf16 v[196:199], a[180:183], v[48:51], v[196:199]
    ds_read_b128 a[144:147], v6
    ds_read_b128 a[160:163], v6 offset:4096
    v_mfma_f32_16x16x32_bf16 v[200:203], a[184:187], v[48:51], v[200:203]
    v_exp_f32 v45, v45
    v_mfma_f32_16x16x32_bf16 v[204:207], a[188:191], v[48:51], v[204:207]
    v_cvt_pk_bf16_f32 v54, v44, v45
    ds_read_b128 a[148:151], v7
    v_mfma_f32_16x16x32_bf16 v[208:211], a[192:195], v[48:51], v[208:211]
    v_exp_f32 v46, v46
    v_mfma_f32_16x16x32_bf16 v[212:215], a[196:199], v[48:51], v[212:215]
    ds_read_b128 a[164:167], v7 offset:4096
    ds_read_b128 a[152:155], v8
    v_mfma_f32_16x16x32_bf16 v[216:219], a[200:203], v[48:51], v[216:219]
    v_exp_f32 v47, v47
    v_mfma_f32_16x16x32_bf16 v[220:223], a[204:207], v[48:51], v[220:223]
    v_cvt_pk_bf16_f32 v55, v46, v47
    ds_read_b128 a[168:171], v8 offset:4096
    v_mfma_f32_16x16x32_bf16 a[100:103], a[108:111], v[48:51], a[100:103]
    ds_read_b128 a[156:159], v9
    ds_read_b128 a[172:175], v9 offset:4096
    v_mfma_f32_16x16x32_bf16 v[40:43], a[112:115], a[32:35], v[64:67]
    v_exp_f32 v32, v32
    v_mfma_f32_16x16x32_bf16 v[44:47], a[128:131], a[32:35], v[64:67]
    ds_read_b64_tr_b16 a[176:177], v10
    ds_read_b64_tr_b16 a[178:179], v10 offset:4096
    v_mfma_f32_16x16x32_bf16 v[40:43], a[116:119], a[36:39], v[40:43]
    v_exp_f32 v33, v33
    v_mfma_f32_16x16x32_bf16 v[44:47], a[132:135], a[36:39], v[44:47]
    v_cvt_pk_bf16_f32 v48, v32, v33
    ds_read_b64_tr_b16 a[180:181], v11
    v_mfma_f32_16x16x32_bf16 v[40:43], a[120:123], a[40:43], v[40:43]
    v_exp_f32 v34, v34
    v_mfma_f32_16x16x32_bf16 v[44:47], a[136:139], a[40:43], v[44:47]
    ds_read_b64_tr_b16 a[182:183], v11 offset:4096
    ds_read_b64_tr_b16 a[184:185], v12
    v_mfma_f32_16x16x32_bf16 v[40:43], a[124:127], a[44:47], v[40:43]
    v_exp_f32 v35, v35
    v_mfma_f32_16x16x32_bf16 v[44:47], a[140:143], a[44:47], v[44:47]
    v_cvt_pk_bf16_f32 v49, v34, v35
    ds_read_b64_tr_b16 a[186:187], v12 offset:4096
    v_mfma_f32_16x16x32_bf16 v[160:163], a[208:211], v[52:55], v[160:163]
    v_exp_f32 v36, v36
    v_mfma_f32_16x16x32_bf16 v[164:167], a[212:215], v[52:55], v[164:167]
    ds_read_b64_tr_b16 a[188:189], v13
    ds_read_b64_tr_b16 a[190:191], v13 offset:4096
    v_mfma_f32_16x16x32_bf16 v[168:171], a[216:219], v[52:55], v[168:171]
    v_exp_f32 v37, v37
    v_mfma_f32_16x16x32_bf16 v[172:175], a[220:223], v[52:55], v[172:175]
    v_cvt_pk_bf16_f32 v50, v36, v37
    ds_read_b64_tr_b16 a[192:193], v14
    v_mfma_f32_16x16x32_bf16 v[176:179], a[224:227], v[52:55], v[176:179]
    v_exp_f32 v38, v38
    v_mfma_f32_16x16x32_bf16 v[180:183], a[228:231], v[52:55], v[180:183]
    ds_read_b64_tr_b16 a[194:195], v14 offset:4096
    ds_read_b64_tr_b16 a[196:197], v15
    v_mfma_f32_16x16x32_bf16 v[184:187], a[232:235], v[52:55], v[184:187]
    v_exp_f32 v39, v39
    v_mfma_f32_16x16x32_bf16 v[188:191], a[236:239], v[52:55], v[188:191]
    v_cvt_pk_bf16_f32 v51, v38, v39
    ds_read_b64_tr_b16 a[198:199], v15 offset:4096
    v_mfma_f32_16x16x32_bf16 a[96:99], a[108:111], v[52:55], a[96:99]
    ds_read_b64_tr_b16 a[200:201], v16
    ds_read_b64_tr_b16 a[202:203], v16 offset:4096
    s_waitcnt lgkmcnt(14)
    v_mfma_f32_16x16x32_bf16 v[32:35], a[144:147], a[0:3], v[56:59]
    v_exp_f32 v40, v40
    v_mfma_f32_16x16x32_bf16 v[36:39], a[160:163], a[0:3], v[56:59]
    ds_read_b64_tr_b16 a[204:205], v17
    ds_read_b64_tr_b16 a[206:207], v17 offset:4096
    v_mfma_f32_16x16x32_bf16 v[32:35], a[148:151], a[4:7], v[32:35]
    v_exp_f32 v41, v41
    v_mfma_f32_16x16x32_bf16 v[36:39], a[164:167], a[4:7], v[36:39]
    v_cvt_pk_bf16_f32 v52, v40, v41
    v_mfma_f32_16x16x32_bf16 v[32:35], a[152:155], a[8:11], v[32:35]
    v_exp_f32 v42, v42
    v_mfma_f32_16x16x32_bf16 v[36:39], a[168:171], a[8:11], v[36:39]
    v_mfma_f32_16x16x32_bf16 v[32:35], a[156:159], a[12:15], v[32:35]
    v_exp_f32 v43, v43
    v_mfma_f32_16x16x32_bf16 v[36:39], a[172:175], a[12:15], v[36:39]
    v_cvt_pk_bf16_f32 v53, v42, v43
    v_mfma_f32_16x16x32_bf16 v[192:195], a[208:211], v[48:51], v[192:195]
    v_exp_f32 v44, v44
    v_mfma_f32_16x16x32_bf16 v[196:199], a[212:215], v[48:51], v[196:199]
    v_mfma_f32_16x16x32_bf16 v[200:203], a[216:219], v[48:51], v[200:203]
    v_exp_f32 v45, v45
    v_mfma_f32_16x16x32_bf16 v[204:207], a[220:223], v[48:51], v[204:207]
    v_cvt_pk_bf16_f32 v54, v44, v45
    v_mfma_f32_16x16x32_bf16 v[208:211], a[224:227], v[48:51], v[208:211]
    v_exp_f32 v46, v46
    v_mfma_f32_16x16x32_bf16 v[212:215], a[228:231], v[48:51], v[212:215]
    v_mfma_f32_16x16x32_bf16 v[216:219], a[232:235], v[48:51], v[216:219]
    v_exp_f32 v47, v47
    v_mfma_f32_16x16x32_bf16 v[220:223], a[236:239], v[48:51], v[220:223]
    v_cvt_pk_bf16_f32 v55, v46, v47
    v_mfma_f32_16x16x32_bf16 a[100:103], a[108:111], v[48:51], a[100:103]
    s_sub_u32 s54, s54, 1
    s_cmp_lg_u32 s54, 0
    s_cbranch_scc1 L_loop_C01
    s_waitcnt lgkmcnt(0)
    s_barrier
    v_mfma_f32_16x16x32_bf16 v[40:43], a[144:147], a[16:19], v[60:63]
    v_exp_f32 v32, v32
    v_mfma_f32_16x16x32_bf16 v[44:47], a[160:163], a[16:19], v[60:63]
    ds_read_b128 a[112:115], v6 offset:16384
    ds_read_b128 a[128:131], v6 offset:20480
    v_mfma_f32_16x16x32_bf16 v[40:43], a[148:151], a[20:23], v[40:43]
    v_exp_f32 v33, v33
    v_mfma_f32_16x16x32_bf16 v[44:47], a[164:167], a[20:23], v[44:47]
    v_cvt_pk_bf16_f32 v48, v32, v33
    ds_read_b128 a[116:119], v7 offset:16384
    v_mfma_f32_16x16x32_bf16 v[40:43], a[152:155], a[24:27], v[40:43]
    v_exp_f32 v34, v34
    v_mfma_f32_16x16x32_bf16 v[44:47], a[168:171], a[24:27], v[44:47]
    ds_read_b128 a[132:135], v7 offset:20480
    ds_read_b128 a[120:123], v8 offset:16384
    v_mfma_f32_16x16x32_bf16 v[40:43], a[156:159], a[28:31], v[40:43]
    v_exp_f32 v35, v35
    v_mfma_f32_16x16x32_bf16 v[44:47], a[172:175], a[28:31], v[44:47]
    v_cvt_pk_bf16_f32 v49, v34, v35
    ds_read_b128 a[136:139], v8 offset:20480
    v_mfma_f32_16x16x32_bf16 v[224:227], a[208:211], v[52:55], v[224:227]
    v_exp_f32 v36, v36
    v_mfma_f32_16x16x32_bf16 v[228:231], a[212:215], v[52:55], v[228:231]
    ds_read_b128 a[124:127], v9 offset:16384
    ds_read_b128 a[140:143], v9 offset:20480
    v_mfma_f32_16x16x32_bf16 v[232:235], a[216:219], v[52:55], v[232:235]
    v_exp_f32 v37, v37
    v_mfma_f32_16x16x32_bf16 v[236:239], a[220:223], v[52:55], v[236:239]
    v_cvt_pk_bf16_f32 v50, v36, v37
    ds_read_b64_tr_b16 a[208:209], v10 offset:16384
    v_mfma_f32_16x16x32_bf16 v[240:243], a[224:227], v[52:55], v[240:243]
    v_exp_f32 v38, v38
    v_mfma_f32_16x16x32_bf16 v[244:247], a[228:231], v[52:55], v[244:247]
    ds_read_b64_tr_b16 a[210:211], v10 offset:20480
    ds_read_b64_tr_b16 a[212:213], v11 offset:16384
    v_mfma_f32_16x16x32_bf16 v[248:251], a[232:235], v[52:55], v[248:251]
    v_exp_f32 v39, v39
    v_mfma_f32_16x16x32_bf16 v[252:255], a[236:239], v[52:55], v[252:255]
    v_cvt_pk_bf16_f32 v51, v38, v39
    ds_read_b64_tr_b16 a[214:215], v11 offset:20480
    v_mfma_f32_16x16x32_bf16 a[104:107], a[108:111], v[52:55], a[104:107]
    ds_read_b64_tr_b16 a[216:217], v12 offset:16384
    ds_read_b64_tr_b16 a[218:219], v12 offset:20480
    s_waitcnt lgkmcnt(6)
    v_mfma_f32_16x16x32_bf16 v[32:35], a[112:115], a[0:3], v[56:59]
    v_exp_f32 v40, v40
    v_mfma_f32_16x16x32_bf16 v[36:39], a[128:131], a[0:3], v[56:59]
    ds_read_b64_tr_b16 a[220:221], v13 offset:16384
    ds_read_b64_tr_b16 a[222:223], v13 offset:20480
    v_mfma_f32_16x16x32_bf16 v[32:35], a[116:119], a[4:7], v[32:35]
    v_exp_f32 v41, v41
    v_mfma_f32_16x16x32_bf16 v[36:39], a[132:135], a[4:7], v[36:39]
    v_cvt_pk_bf16_f32 v52, v40, v41
    ds_read_b64_tr_b16 a[224:225], v14 offset:16384
    v_mfma_f32_16x16x32_bf16 v[32:35], a[120:123], a[8:11], v[32:35]
    v_exp_f32 v42, v42
    v_mfma_f32_16x16x32_bf16 v[36:39], a[136:139], a[8:11], v[36:39]
    ds_read_b64_tr_b16 a[226:227], v14 offset:20480
    ds_read_b64_tr_b16 a[228:229], v15 offset:16384
    v_mfma_f32_16x16x32_bf16 v[32:35], a[124:127], a[12:15], v[32:35]
    v_exp_f32 v43, v43
    v_mfma_f32_16x16x32_bf16 v[36:39], a[140:143], a[12:15], v[36:39]
    v_cvt_pk_bf16_f32 v53, v42, v43
    ds_read_b64_tr_b16 a[230:231], v15 offset:20480
    v_mfma_f32_16x16x32_bf16 v[160:163], a[176:179], v[48:51], v[160:163]
    v_exp_f32 v44, v44
    v_mfma_f32_16x16x32_bf16 v[164:167], a[180:183], v[48:51], v[164:167]
    ds_read_b64_tr_b16 a[232:233], v16 offset:16384
    ds_read_b64_tr_b16 a[234:235], v16 offset:20480
    v_mfma_f32_16x16x32_bf16 v[168:171], a[184:187], v[48:51], v[168:171]
    v_exp_f32 v45, v45
    v_mfma_f32_16x16x32_bf16 v[172:175], a[188:191], v[48:51], v[172:175]
    v_cvt_pk_bf16_f32 v54, v44, v45
    ds_read_b64_tr_b16 a[236:237], v17 offset:16384
    v_mfma_f32_16x16x32_bf16 v[176:179], a[192:195], v[48:51], v[176:179]
    v_exp_f32 v46, v46
    v_mfma_f32_16x16x32_bf16 v[180:183], a[196:199], v[48:51], v[180:183]
    ds_read_b64_tr_b16 a[238:239], v17 offset:20480
    v_mfma_f32_16x16x32_bf16 v[184:187], a[200:203], v[48:51], v[184:187]
    v_exp_f32 v47, v47
    v_mfma_f32_16x16x32_bf16 v[188:191], a[204:207], v[48:51], v[188:191]
    v_cvt_pk_bf16_f32 v55, v46, v47
    v_mfma_f32_16x16x32_bf16 a[96:99], a[108:111], v[48:51], a[96:99]
    v_mfma_f32_16x16x32_bf16 v[40:43], a[112:115], a[16:19], v[60:63]
    v_exp_f32 v32, v32
    v_mfma_f32_16x16x32_bf16 v[44:47], a[128:131], a[16:19], v[60:63]
    v_mfma_f32_16x16x32_bf16 v[40:43], a[116:119], a[20:23], v[40:43]
    v_exp_f32 v33, v33
    v_mfma_f32_16x16x32_bf16 v[44:47], a[132:135], a[20:23], v[44:47]
    v_cvt_pk_bf16_f32 v48, v32, v33
    v_mfma_f32_16x16x32_bf16 v[40:43], a[120:123], a[24:27], v[40:43]
    v_exp_f32 v34, v34
    v_mfma_f32_16x16x32_bf16 v[44:47], a[136:139], a[24:27], v[44:47]
    v_mfma_f32_16x16x32_bf16 v[40:43], a[124:127], a[28:31], v[40:43]
    v_exp_f32 v35, v35
    v_mfma_f32_16x16x32_bf16 v[44:47], a[140:143], a[28:31], v[44:47]
    v_cvt_pk_bf16_f32 v49, v34, v35
    s_waitcnt lgkmcnt(0)
    s_barrier
    v_mfma_f32_16x16x32_bf16 v[192:195], a[176:179], v[52:55], v[192:195]
    v_exp_f32 v36, v36
    v_mfma_f32_16x16x32_bf16 v[196:199], a[180:183], v[52:55], v[196:199]
    ds_read_b128 a[144:147], v6 offset:32768
    ds_read_b128 a[160:163], v6 offset:36864
    v_mfma_f32_16x16x32_bf16 v[200:203], a[184:187], v[52:55], v[200:203]
    v_exp_f32 v37, v37
    v_mfma_f32_16x16x32_bf16 v[204:207], a[188:191], v[52:55], v[204:207]
    v_cvt_pk_bf16_f32 v50, v36, v37
    ds_read_b128 a[148:151], v7 offset:32768
    v_mfma_f32_16x16x32_bf16 v[208:211], a[192:195], v[52:55], v[208:211]
    v_exp_f32 v38, v38
    v_mfma_f32_16x16x32_bf16 v[212:215], a[196:199], v[52:55], v[212:215]
    ds_read_b128 a[164:167], v7 offset:36864
    ds_read_b128 a[152:155], v8 offset:32768
    v_mfma_f32_16x16x32_bf16 v[216:219], a[200:203], v[52:55], v[216:219]
    v_exp_f32 v39, v39
    v_mfma_f32_16x16x32_bf16 v[220:223], a[204:207], v[52:55], v[220:223]
    v_cvt_pk_bf16_f32 v51, v38, v39
    ds_read_b128 a[168:171], v8 offset:36864
    v_mfma_f32_16x16x32_bf16 a[100:103], a[108:111], v[52:55], a[100:103]
    ds_read_b128 a[156:159], v9 offset:32768
    ds_read_b128 a[172:175], v9 offset:36864
    v_mfma_f32_16x16x32_bf16 v[32:35], a[112:115], a[32:35], v[64:67]
    v_exp_f32 v40, v40
    v_mfma_f32_16x16x32_bf16 v[36:39], a[128:131], a[32:35], v[64:67]
    ds_read_b64_tr_b16 a[176:177], v10 offset:32768
    ds_read_b64_tr_b16 a[178:179], v10 offset:36864
    v_mfma_f32_16x16x32_bf16 v[32:35], a[116:119], a[36:39], v[32:35]
    v_exp_f32 v41, v41
    v_mfma_f32_16x16x32_bf16 v[36:39], a[132:135], a[36:39], v[36:39]
    v_cvt_pk_bf16_f32 v52, v40, v41
    ds_read_b64_tr_b16 a[180:181], v11 offset:32768
    v_mfma_f32_16x16x32_bf16 v[32:35], a[120:123], a[40:43], v[32:35]
    v_exp_f32 v42, v42
    v_mfma_f32_16x16x32_bf16 v[36:39], a[136:139], a[40:43], v[36:39]
    ds_read_b64_tr_b16 a[182:183], v11 offset:36864
    ds_read_b64_tr_b16 a[184:185], v12 offset:32768
    v_mfma_f32_16x16x32_bf16 v[32:35], a[124:127], a[44:47], v[32:35]
    v_exp_f32 v43, v43
    v_mfma_f32_16x16x32_bf16 v[36:39], a[140:143], a[44:47], v[36:39]
    v_cvt_pk_bf16_f32 v53, v42, v43
    ds_read_b64_tr_b16 a[186:187], v12 offset:36864
    v_mfma_f32_16x16x32_bf16 v[160:163], a[208:211], v[48:51], v[160:163]
    v_exp_f32 v44, v44
    v_mfma_f32_16x16x32_bf16 v[164:167], a[212:215], v[48:51], v[164:167]
    ds_read_b64_tr_b16 a[188:189], v13 offset:32768
    ds_read_b64_tr_b16 a[190:191], v13 offset:36864
    v_mfma_f32_16x16x32_bf16 v[168:171], a[216:219], v[48:51], v[168:171]
    v_exp_f32 v45, v45
    v_mfma_f32_16x16x32_bf16 v[172:175], a[220:223], v[48:51], v[172:175]
    v_cvt_pk_bf16_f32 v54, v44, v45
    ds_read_b64_tr_b16 a[192:193], v14 offset:32768
    v_mfma_f32_16x16x32_bf16 v[176:179], a[224:227], v[48:51], v[176:179]
    v_exp_f32 v46, v46
    v_mfma_f32_16x16x32_bf16 v[180:183], a[228:231], v[48:51], v[180:183]
    ds_read_b64_tr_b16 a[194:195], v14 offset:36864
    ds_read_b64_tr_b16 a[196:197], v15 offset:32768
    v_mfma_f32_16x16x32_bf16 v[184:187], a[232:235], v[48:51], v[184:187]
    v_exp_f32 v47, v47
    v_mfma_f32_16x16x32_bf16 v[188:191], a[236:239], v[48:51], v[188:191]
    v_cvt_pk_bf16_f32 v55, v46, v47
    ds_read_b64_tr_b16 a[198:199], v15 offset:36864
    v_mfma_f32_16x16x32_bf16 a[96:99], a[108:111], v[48:51], a[96:99]
    ds_read_b64_tr_b16 a[200:201], v16 offset:32768
    ds_read_b64_tr_b16 a[202:203], v16 offset:36864
    s_waitcnt lgkmcnt(14)
    v_mfma_f32_16x16x32_bf16 v[40:43], a[144:147], a[0:3], v[56:59]
    v_exp_f32 v32, v32
    v_mfma_f32_16x16x32_bf16 v[44:47], a[160:163], a[0:3], v[56:59]
    ds_read_b64_tr_b16 a[204:205], v17 offset:32768
    ds_read_b64_tr_b16 a[206:207], v17 offset:36864
    v_mfma_f32_16x16x32_bf16 v[40:43], a[148:151], a[4:7], v[40:43]
    v_exp_f32 v33, v33
    v_mfma_f32_16x16x32_bf16 v[44:47], a[164:167], a[4:7], v[44:47]
    v_cvt_pk_bf16_f32 v48, v32, v33
    v_mfma_f32_16x16x32_bf16 v[40:43], a[152:155], a[8:11], v[40:43]
    v_exp_f32 v34, v34
    v_mfma_f32_16x16x32_bf16 v[44:47], a[168:171], a[8:11], v[44:47]
    v_mfma_f32_16x16x32_bf16 v[40:43], a[156:159], a[12:15], v[40:43]
    v_exp_f32 v35, v35
    v_mfma_f32_16x16x32_bf16 v[44:47], a[172:175], a[12:15], v[44:47]
    v_cvt_pk_bf16_f32 v49, v34, v35
    v_mfma_f32_16x16x32_bf16 v[192:195], a[208:211], v[52:55], v[192:195]
    v_exp_f32 v36, v36
    v_mfma_f32_16x16x32_bf16 v[196:199], a[212:215], v[52:55], v[196:199]
    v_mfma_f32_16x16x32_bf16 v[200:203], a[216:219], v[52:55], v[200:203]
    v_exp_f32 v37, v37
    v_mfma_f32_16x16x32_bf16 v[204:207], a[220:223], v[52:55], v[204:207]
    v_cvt_pk_bf16_f32 v50, v36, v37
    v_mfma_f32_16x16x32_bf16 v[208:211], a[224:227], v[52:55], v[208:211]
    v_exp_f32 v38, v38
    v_mfma_f32_16x16x32_bf16 v[212:215], a[228:231], v[52:55], v[212:215]
    v_mfma_f32_16x16x32_bf16 v[216:219], a[232:235], v[52:55], v[216:219]
    v_exp_f32 v39, v39
    v_mfma_f32_16x16x32_bf16 v[220:223], a[236:239], v[52:55], v[220:223]
    v_cvt_pk_bf16_f32 v51, v38, v39
    v_mfma_f32_16x16x32_bf16 a[100:103], a[108:111], v[52:55], a[100:103]
    s_waitcnt lgkmcnt(0)
    s_barrier
    v_mfma_f32_16x16x32_bf16 v[32:35], a[144:147], a[16:19], v[60:63]
    v_exp_f32 v40, v40
    v_mfma_f32_16x16x32_bf16 v[36:39], a[160:163], a[16:19], v[60:63]
    ds_read_b128 a[112:115], v6 offset:49152
    ds_read_b128 a[128:131], v6 offset:53248
    v_mfma_f32_16x16x32_bf16 v[32:35], a[148:151], a[20:23], v[32:35]
    v_exp_f32 v41, v41
    v_mfma_f32_16x16x32_bf16 v[36:39], a[164:167], a[20:23], v[36:39]
    v_cvt_pk_bf16_f32 v52, v40, v41
    ds_read_b128 a[116:119], v7 offset:49152
    v_mfma_f32_16x16x32_bf16 v[32:35], a[152:155], a[24:27], v[32:35]
    v_exp_f32 v42, v42
    v_mfma_f32_16x16x32_bf16 v[36:39], a[168:171], a[24:27], v[36:39]
    ds_read_b128 a[132:135], v7 offset:53248
    ds_read_b128 a[120:123], v8 offset:49152
    v_mfma_f32_16x16x32_bf16 v[32:35], a[156:159], a[28:31], v[32:35]
    v_exp_f32 v43, v43
    v_mfma_f32_16x16x32_bf16 v[36:39], a[172:175], a[28:31], v[36:39]
    v_cvt_pk_bf16_f32 v53, v42, v43
    ds_read_b128 a[136:139], v8 offset:53248
    v_mfma_f32_16x16x32_bf16 v[224:227], a[208:211], v[48:51], v[224:227]
    v_exp_f32 v44, v44
    v_mfma_f32_16x16x32_bf16 v[228:231], a[212:215], v[48:51], v[228:231]
    ds_read_b128 a[124:127], v9 offset:49152
    ds_read_b128 a[140:143], v9 offset:53248
    v_mfma_f32_16x16x32_bf16 v[232:235], a[216:219], v[48:51], v[232:235]
    v_exp_f32 v45, v45
    v_mfma_f32_16x16x32_bf16 v[236:239], a[220:223], v[48:51], v[236:239]
    v_cvt_pk_bf16_f32 v54, v44, v45
    ds_read_b64_tr_b16 a[208:209], v10 offset:49152
    v_mfma_f32_16x16x32_bf16 v[240:243], a[224:227], v[48:51], v[240:243]
    v_exp_f32 v46, v46
    v_mfma_f32_16x16x32_bf16 v[244:247], a[228:231], v[48:51], v[244:247]
    ds_read_b64_tr_b16 a[210:211], v10 offset:53248
    ds_read_b64_tr_b16 a[212:213], v11 offset:49152
    v_mfma_f32_16x16x32_bf16 v[248:251], a[232:235], v[48:51], v[248:251]
    v_exp_f32 v47, v47
    v_mfma_f32_16x16x32_bf16 v[252:255], a[236:239], v[48:51], v[252:255]
    v_cvt_pk_bf16_f32 v55, v46, v47
    ds_read_b64_tr_b16 a[214:215], v11 offset:53248
    v_mfma_f32_16x16x32_bf16 a[104:107], a[108:111], v[48:51], a[104:107]
    ds_read_b64_tr_b16 a[216:217], v12 offset:49152
    ds_read_b64_tr_b16 a[218:219], v12 offset:53248
    s_waitcnt lgkmcnt(6)
    v_mfma_f32_16x16x32_bf16 v[40:43], a[112:115], a[0:3], v[56:59]
    v_exp_f32 v32, v32
    v_mfma_f32_16x16x32_bf16 v[44:47], a[128:131], a[0:3], v[56:59]
    ds_read_b64_tr_b16 a[220:221], v13 offset:49152
    ds_read_b64_tr_b16 a[222:223], v13 offset:53248
    v_mfma_f32_16x16x32_bf16 v[40:43], a[116:119], a[4:7], v[40:43]
    v_exp_f32 v33, v33
    v_mfma_f32_16x16x32_bf16 v[44:47], a[132:135], a[4:7], v[44:47]
    v_cvt_pk_bf16_f32 v48, v32, v33
    ds_read_b64_tr_b16 a[224:225], v14 offset:49152
    v_mfma_f32_16x16x32_bf16 v[40:43], a[120:123], a[8:11], v[40:43]
    v_exp_f32 v34, v34
    v_mfma_f32_16x16x32_bf16 v[44:47], a[136:139], a[8:11], v[44:47]
    ds_read_b64_tr_b16 a[226:227], v14 offset:53248
    ds_read_b64_tr_b16 a[228:229], v15 offset:49152
    v_mfma_f32_16x16x32_bf16 v[40:43], a[124:127], a[12:15], v[40:43]
    v_exp_f32 v35, v35
    v_mfma_f32_16x16x32_bf16 v[44:47], a[140:143], a[12:15], v[44:47]
    v_cvt_pk_bf16_f32 v49, v34, v35
    ds_read_b64_tr_b16 a[230:231], v15 offset:53248
    v_mfma_f32_16x16x32_bf16 v[160:163], a[176:179], v[52:55], v[160:163]
    v_exp_f32 v36, v36
    v_mfma_f32_16x16x32_bf16 v[164:167], a[180:183], v[52:55], v[164:167]
    ds_read_b64_tr_b16 a[232:233], v16 offset:49152
    ds_read_b64_tr_b16 a[234:235], v16 offset:53248
    v_mfma_f32_16x16x32_bf16 v[168:171], a[184:187], v[52:55], v[168:171]
    v_exp_f32 v37, v37
    v_mfma_f32_16x16x32_bf16 v[172:175], a[188:191], v[52:55], v[172:175]
    v_cvt_pk_bf16_f32 v50, v36, v37
    ds_read_b64_tr_b16 a[236:237], v17 offset:49152
    v_mfma_f32_16x16x32_bf16 v[176:179], a[192:195], v[52:55], v[176:179]
    v_exp_f32 v38, v38
    v_mfma_f32_16x16x32_bf16 v[180:183], a[196:199], v[52:55], v[180:183]
    ds_read_b64_tr_b16 a[238:239], v17 offset:53248
    v_mfma_f32_16x16x32_bf16 v[184:187], a[200:203], v[52:55], v[184:187]
    v_exp_f32 v39, v39
    v_mfma_f32_16x16x32_bf16 v[188:191], a[204:207], v[52:55], v[188:191]
    v_cvt_pk_bf16_f32 v51, v38, v39
    v_mfma_f32_16x16x32_bf16 a[96:99], a[108:111], v[52:55], a[96:99]
    v_mfma_f32_16x16x32_bf16 v[32:35], a[112:115], a[16:19], v[60:63]
    v_exp_f32 v40, v40
    v_mfma_f32_16x16x32_bf16 v[36:39], a[128:131], a[16:19], v[60:63]
    v_mfma_f32_16x16x32_bf16 v[32:35], a[116:119], a[20:23], v[32:35]
    v_exp_f32 v41, v41
    v_mfma_f32_16x16x32_bf16 v[36:39], a[132:135], a[20:23], v[36:39]
    v_cvt_pk_bf16_f32 v52, v40, v41
    v_mfma_f32_16x16x32_bf16 v[32:35], a[120:123], a[24:27], v[32:35]
    v_exp_f32 v42, v42
    v_mfma_f32_16x16x32_bf16 v[36:39], a[136:139], a[24:27], v[36:39]
    v_mfma_f32_16x16x32_bf16 v[32:35], a[124:127], a[28:31], v[32:35]
    v_exp_f32 v43, v43
    v_mfma_f32_16x16x32_bf16 v[36:39], a[140:143], a[28:31], v[36:39]
    v_cvt_pk_bf16_f32 v53, v42, v43
    s_waitcnt lgkmcnt(0)
    s_barrier
    v_mfma_f32_16x16x32_bf16 v[192:195], a[176:179], v[48:51], v[192:195]
    v_exp_f32 v44, v44
    v_mfma_f32_16x16x32_bf16 v[196:199], a[180:183], v[48:51], v[196:199]
    ds_read_b128 a[144:147], v6
    ds_read_b128 a[160:163], v6 offset:4096
    v_mfma_f32_16x16x32_bf16 v[200:203], a[184:187], v[48:51], v[200:203]
    v_exp_f32 v45, v45
    v_mfma_f32_16x16x32_bf16 v[204:207], a[188:191], v[48:51], v[204:207]
    v_cvt_pk_bf16_f32 v54, v44, v45
    ds_read_b128 a[148:151], v7
    v_mfma_f32_16x16x32_bf16 v[208:211], a[192:195], v[48:51], v[208:211]
    v_exp_f32 v46, v46
    v_mfma_f32_16x16x32_bf16 v[212:215], a[196:199], v[48:51], v[212:215]
    ds_read_b128 a[164:167], v7 offset:4096
    ds_read_b128 a[152:155], v8
    v_mfma_f32_16x16x32_bf16 v[216:219], a[200:203], v[48:51], v[216:219]
    v_exp_f32 v47, v47
    v_mfma_f32_16x16x32_bf16 v[220:223], a[204:207], v[48:51], v[220:223]
    v_cvt_pk_bf16_f32 v55, v46, v47
    ds_read_b128 a[168:171], v8 offset:4096
    v_mfma_f32_16x16x32_bf16 a[100:103], a[108:111], v[48:51], a[100:103]
    ds_read_b128 a[156:159], v9
    ds_read_b128 a[172:175], v9 offset:4096
    v_mfma_f32_16x16x32_bf16 v[40:43], a[112:115], a[32:35], v[64:67]
    v_exp_f32 v32, v32
    v_mfma_f32_16x16x32_bf16 v[44:47], a[128:131], a[32:35], v[64:67]
    ds_read_b128 v[80:83], v96
    ds_read_b128 v[84:87], v96 offset:64
    v_mfma_f32_16x16x32_bf16 v[40:43], a[116:119], a[36:39], v[40:43]
    v_exp_f32 v33, v33
    v_mfma_f32_16x16x32_bf16 v[44:47], a[132:135], a[36:39], v[44:47]
    v_cvt_pk_bf16_f32 v48, v32, v33
    ds_read_b128 v[88:91], v96 offset:128
    v_mfma_f32_16x16x32_bf16 v[40:43], a[120:123], a[40:43], v[40:43]
    v_exp_f32 v34, v34
    v_mfma_f32_16x16x32_bf16 v[44:47], a[136:139], a[40:43], v[44:47]
    ds_read_b128 v[92:95], v96 offset:192
    ds_read_b64_tr_b16 a[176:177], v10
    v_mfma_f32_16x16x32_bf16 v[40:43], a[124:127], a[44:47], v[40:43]
    v_exp_f32 v35, v35
    v_mfma_f32_16x16x32_bf16 v[44:47], a[140:143], a[44:47], v[44:47]
    v_cvt_pk_bf16_f32 v49, v34, v35
    ds_read_b64_tr_b16 a[178:179], v10 offset:4096
    v_mfma_f32_16x16x32_bf16 v[160:163], a[208:211], v[52:55], v[160:163]
    v_exp_f32 v36, v36
    v_mfma_f32_16x16x32_bf16 v[164:167], a[212:215], v[52:55], v[164:167]
    ds_read_b64_tr_b16 a[180:181], v11
    ds_read_b64_tr_b16 a[182:183], v11 offset:4096
    v_mfma_f32_16x16x32_bf16 v[168:171], a[216:219], v[52:55], v[168:171]
    v_exp_f32 v37, v37
    v_mfma_f32_16x16x32_bf16 v[172:175], a[220:223], v[52:55], v[172:175]
    v_cvt_pk_bf16_f32 v50, v36, v37
    ds_read_b64_tr_b16 a[184:185], v12
    v_mfma_f32_16x16x32_bf16 v[176:179], a[224:227], v[52:55], v[176:179]
    v_exp_f32 v38, v38
    v_mfma_f32_16x16x32_bf16 v[180:183], a[228:231], v[52:55], v[180:183]
    ds_read_b64_tr_b16 a[186:187], v12 offset:4096
    ds_read_b64_tr_b16 a[188:189], v13
    v_mfma_f32_16x16x32_bf16 v[184:187], a[232:235], v[52:55], v[184:187]
    v_exp_f32 v39, v39
    v_mfma_f32_16x16x32_bf16 v[188:191], a[236:239], v[52:55], v[188:191]
    v_cvt_pk_bf16_f32 v51, v38, v39
    ds_read_b64_tr_b16 a[190:191], v13 offset:4096
    v_mfma_f32_16x16x32_bf16 a[96:99], a[108:111], v[52:55], a[96:99]
    ds_read_b64_tr_b16 a[192:193], v14
    ds_read_b64_tr_b16 a[194:195], v14 offset:4096
    v_exp_f32 v40, v40
    ds_read_b64_tr_b16 a[196:197], v15
    ds_read_b64_tr_b16 a[198:199], v15 offset:4096
    v_exp_f32 v41, v41
    s_nop 0
    v_cvt_pk_bf16_f32 v52, v40, v41
    ds_read_b64_tr_b16 a[200:201], v16
    v_exp_f32 v42, v42
    ds_read_b64_tr_b16 a[202:203], v16 offset:4096
    ds_read_b64_tr_b16 a[204:205], v17
    v_exp_f32 v43, v43
    s_nop 0
    v_cvt_pk_bf16_f32 v53, v42, v43
    ds_read_b64_tr_b16 a[206:207], v17 offset:4096
    v_mfma_f32_16x16x32_bf16 v[192:195], a[208:211], v[48:51], v[192:195]
    v_exp_f32 v44, v44
    v_mfma_f32_16x16x32_bf16 v[196:199], a[212:215], v[48:51], v[196:199]
    v_mfma_f32_16x16x32_bf16 v[200:203], a[216:219], v[48:51], v[200:203]
    v_exp_f32 v45, v45
    v_mfma_f32_16x16x32_bf16 v[204:207], a[220:223], v[48:51], v[204:207]
    v_cvt_pk_bf16_f32 v54, v44, v45
    v_mfma_f32_16x16x32_bf16 v[208:211], a[224:227], v[48:51], v[208:211]
    v_exp_f32 v46, v46
    v_mfma_f32_16x16x32_bf16 v[212:215], a[228:231], v[48:51], v[212:215]
    v_mfma_f32_16x16x32_bf16 v[216:219], a[232:235], v[48:51], v[216:219]
    v_exp_f32 v47, v47
    v_mfma_f32_16x16x32_bf16 v[220:223], a[236:239], v[48:51], v[220:223]
    v_cvt_pk_bf16_f32 v55, v46, v47
    v_mfma_f32_16x16x32_bf16 a[100:103], a[108:111], v[48:51], a[100:103]
    s_waitcnt lgkmcnt(0)
    s_barrier
    ds_read_b32 v144, v106 offset:8192
    ds_read_b128 v[112:115], v106
    ds_read_b128 v[116:119], v106 offset:1024
    ds_read_b128 v[120:123], v106 offset:2048
    ds_read_b128 v[124:127], v106 offset:3072
    ds_read_b128 v[128:131], v106 offset:4096
    ds_read_b128 v[132:135], v106 offset:5120
    ds_read_b128 v[136:139], v106 offset:6144
    ds_read_b128 v[140:143], v106 offset:7168
    ds_read_b128 a[112:115], v6 offset:16384
    ds_read_b128 a[128:131], v6 offset:20480
    ds_read_b128 a[116:119], v7 offset:16384
    ds_read_b128 a[132:135], v7 offset:20480
    ds_read_b128 a[120:123], v8 offset:16384
    ds_read_b128 a[136:139], v8 offset:20480
    ds_read_b128 a[124:127], v9 offset:16384
    ds_read_b128 a[140:143], v9 offset:20480
    v_mfma_f32_16x16x32_bf16 v[224:227], a[208:211], v[52:55], v[224:227]
    ds_read_b64_tr_b16 a[208:209], v10 offset:16384
    ds_read_b64_tr_b16 a[210:211], v10 offset:20480
    v_mfma_f32_16x16x32_bf16 v[228:231], a[212:215], v[52:55], v[228:231]
    ds_read_b64_tr_b16 a[212:213], v11 offset:16384
    ds_read_b64_tr_b16 a[214:215], v11 offset:20480
    v_mfma_f32_16x16x32_bf16 v[232:235], a[216:219], v[52:55], v[232:235]
    ds_read_b64_tr_b16 a[216:217], v12 offset:16384
    ds_read_b64_tr_b16 a[218:219], v12 offset:20480
    v_mfma_f32_16x16x32_bf16 v[236:239], a[220:223], v[52:55], v[236:239]
    ds_read_b64_tr_b16 a[220:221], v13 offset:16384
    ds_read_b64_tr_b16 a[222:223], v13 offset:20480
    v_mfma_f32_16x16x32_bf16 v[240:243], a[224:227], v[52:55], v[240:243]
    ds_read_b64_tr_b16 a[224:225], v14 offset:16384
    ds_read_b64_tr_b16 a[226:227], v14 offset:20480
    v_mfma_f32_16x16x32_bf16 v[244:247], a[228:231], v[52:55], v[244:247]
    ds_read_b64_tr_b16 a[228:229], v15 offset:16384
    ds_read_b64_tr_b16 a[230:231], v15 offset:20480
    v_mfma_f32_16x16x32_bf16 v[248:251], a[232:235], v[52:55], v[248:251]
    ds_read_b64_tr_b16 a[232:233], v16 offset:16384
    ds_read_b64_tr_b16 a[234:235], v16 offset:20480
    v_mfma_f32_16x16x32_bf16 v[252:255], a[236:239], v[52:55], v[252:255]
    ds_read_b64_tr_b16 a[236:237], v17 offset:16384
    ds_read_b64_tr_b16 a[238:239], v17 offset:20480
    v_mfma_f32_16x16x32_bf16 a[104:107], a[108:111], v[52:55], a[104:107]
    v_mov_b32 v3, 163776
    ds_read_b32 v108, v3 offset:32
    s_mov_b32 s39, 0x53800000
    s_mov_b64 s[70:71], 0
    v_accvgpr_read_b32 v32, a96
    v_accvgpr_read_b32 v34, a100
    s_nop 1
    v_accvgpr_read_b32 v36, a104
    s_waitcnt lgkmcnt(15)
    v_add_f32 v36, v36, v144
    v_cmp_nge_f32 s[72:73], s39, v32
    v_cmp_nle_f32 vcc, 0.5, v32
    s_or_b64 s[70:71], s[70:71], s[72:73]
    s_or_b64 s[70:71], s[70:71], vcc
    v_cmp_nge_f32 s[72:73], s39, v34
    v_cmp_nle_f32 vcc, 0.5, v34
    s_or_b64 s[70:71], s[70:71], s[72:73]
    s_or_b64 s[70:71], s[70:71], vcc
    v_cmp_nge_f32 s[72:73], s39, v36
    v_cmp_nle_f32 vcc, 0.5, v36
    s_or_b64 s[70:71], s[70:71], s[72:73]
    s_or_b64 s[70:71], s[70:71], vcc
    v_rcp_f32 v32, v32
    v_rcp_f32 v34, v34
    v_rcp_f32 v36, v36
    s_or_b32 s39, s70, s71
    v_mov_b32 v3, s39
    ds_write_b32 v104, v3
    v_mov_b32 v33, v32
    v_mov_b32 v35, v34
    v_mov_b32 v37, v36
    s_cmp_lg_u32 s68, 0
    s_cselect_b32 s70, 0x40000000, s58
    v_pk_add_f32 v[224:225], v[224:225], v[112:113]
    v_pk_add_f32 v[226:227], v[226:227], v[114:115]
    v_pk_add_f32 v[228:229], v[228:229], v[116:117]
    v_pk_add_f32 v[230:231], v[230:231], v[118:119]
    v_pk_add_f32 v[232:233], v[232:233], v[120:121]
    v_pk_add_f32 v[234:235], v[234:235], v[122:123]
    v_pk_add_f32 v[236:237], v[236:237], v[124:125]
    v_pk_add_f32 v[238:239], v[238:239], v[126:127]
    v_pk_add_f32 v[240:241], v[240:241], v[128:129]
    v_pk_add_f32 v[242:243], v[242:243], v[130:131]
    v_pk_add_f32 v[244:245], v[244:245], v[132:133]
    v_pk_add_f32 v[246:247], v[246:247], v[134:135]
    v_pk_add_f32 v[248:249], v[248:249], v[136:137]
    v_pk_add_f32 v[250:251], v[250:251], v[138:139]
    v_pk_add_f32 v[252:253], v[252:253], v[140:141]
    v_pk_add_f32 v[254:255], v[254:255], v[142:143]
    v_pk_mul_f32 v[160:161], v[160:161], v[32:33]
    v_pk_mul_f32 v[162:163], v[162:163], v[32:33]
    v_pk_mul_f32 v[164:165], v[164:165], v[32:33]
    v_pk_mul_f32 v[166:167], v[166:167], v[32:33]
    v_cvt_pk_bf16_f32 v112, v160, v161
    v_cvt_pk_bf16_f32 v113, v162, v163
    v_cvt_pk_bf16_f32 v114, v164, v165
    v_cvt_pk_bf16_f32 v115, v166, v167
    ds_write_b128 v98, v[112:115]
    s_add_u32 s39, s70, 0
    buffer_store_dwordx4 v[112:115], v2, s[20:23], s39 offen sc1
    v_pk_mul_f32 v[168:169], v[168:169], v[32:33]
    v_pk_mul_f32 v[170:171], v[170:171], v[32:33]
    v_pk_mul_f32 v[172:173], v[172:173], v[32:33]
    v_pk_mul_f32 v[174:175], v[174:175], v[32:33]
    v_cvt_pk_bf16_f32 v116, v168, v169
    v_cvt_pk_bf16_f32 v117, v170, v171
    v_cvt_pk_bf16_f32 v118, v172, v173
    v_cvt_pk_bf16_f32 v119, v174, v175
    ds_write_b128 v98, v[116:119] offset:1024
    s_add_u32 s39, s70, 0
    buffer_store_dwordx4 v[116:119], v2, s[20:23], s39 offen offset:1024 sc1
    v_pk_mul_f32 v[192:193], v[192:193], v[34:35]
    v_pk_mul_f32 v[194:195], v[194:195], v[34:35]
    v_pk_mul_f32 v[196:197], v[196:197], v[34:35]
    v_pk_mul_f32 v[198:199], v[198:199], v[34:35]
    v_cvt_pk_bf16_f32 v120, v192, v193
    v_cvt_pk_bf16_f32 v121, v194, v195
    v_cvt_pk_bf16_f32 v122, v196, v197
    v_cvt_pk_bf16_f32 v123, v198, v199
    ds_write_b128 v98, v[120:123] offset:2048
    s_add_u32 s39, s70, 2048
    buffer_store_dwordx4 v[120:123], v2, s[20:23], s39 offen sc1
    v_pk_mul_f32 v[200:201], v[200:201], v[34:35]
    v_pk_mul_f32 v[202:203], v[202:203], v[34:35]
    v_pk_mul_f32 v[204:205], v[204:205], v[34:35]
    v_pk_mul_f32 v[206:207], v[206:207], v[34:35]
    v_cvt_pk_bf16_f32 v124, v200, v201
    v_cvt_pk_bf16_f32 v125, v202, v203
    v_cvt_pk_bf16_f32 v126, v204, v205
    v_cvt_pk_bf16_f32 v127, v206, v207
    ds_write_b128 v98, v[124:127] offset:3072
    s_add_u32 s39, s70, 2048
    buffer_store_dwordx4 v[124:127], v2, s[20:23], s39 offen offset:1024 sc1
    v_pk_mul_f32 v[224:225], v[224:225], v[36:37]
    v_pk_mul_f32 v[226:227], v[226:227], v[36:37]
    v_pk_mul_f32 v[228:229], v[228:229], v[36:37]
    v_pk_mul_f32 v[230:231], v[230:231], v[36:37]
    v_cvt_pk_bf16_f32 v128, v224, v225
    v_cvt_pk_bf16_f32 v129, v226, v227
    v_cvt_pk_bf16_f32 v130, v228, v229
    v_cvt_pk_bf16_f32 v131, v230, v231
    ds_write_b128 v98, v[128:131] offset:4096
    s_add_u32 s39, s70, 4096
    buffer_store_dwordx4 v[128:131], v2, s[20:23], s39 offen sc1
    v_pk_mul_f32 v[232:233], v[232:233], v[36:37]
    v_pk_mul_f32 v[234:235], v[234:235], v[36:37]
    v_pk_mul_f32 v[236:237], v[236:237], v[36:37]
    v_pk_mul_f32 v[238:239], v[238:239], v[36:37]
    v_cvt_pk_bf16_f32 v132, v232, v233
    v_cvt_pk_bf16_f32 v133, v234, v235
    v_cvt_pk_bf16_f32 v134, v236, v237
    v_cvt_pk_bf16_f32 v135, v238, v239
    ds_write_b128 v98, v[132:135] offset:5120
    s_add_u32 s39, s70, 4096
    buffer_store_dwordx4 v[132:135], v2, s[20:23], s39 offen offset:1024 sc1
    v_pk_mul_f32 v[176:177], v[176:177], v[32:33]
    v_pk_mul_f32 v[178:179], v[178:179], v[32:33]
    v_pk_mul_f32 v[180:181], v[180:181], v[32:33]
    v_pk_mul_f32 v[182:183], v[182:183], v[32:33]
    v_cvt_pk_bf16_f32 v136, v176, v177
    v_cvt_pk_bf16_f32 v137, v178, v179
    v_cvt_pk_bf16_f32 v138, v180, v181
    v_cvt_pk_bf16_f32 v139, v182, v183
    ds_write_b128 v98, v[136:139] offset:34816
    s_add_u32 s39, s70, 18432
    buffer_store_dwordx4 v[136:139], v2, s[20:23], s39 offen sc1
    v_pk_mul_f32 v[184:185], v[184:185], v[32:33]
    v_pk_mul_f32 v[186:187], v[186:187], v[32:33]
    v_pk_mul_f32 v[188:189], v[188:189], v[32:33]
    v_pk_mul_f32 v[190:191], v[190:191], v[32:33]
    v_cvt_pk_bf16_f32 v140, v184, v185
    v_cvt_pk_bf16_f32 v141, v186, v187
    v_cvt_pk_bf16_f32 v142, v188, v189
    v_cvt_pk_bf16_f32 v143, v190, v191
    ds_write_b128 v98, v[140:143] offset:35840
    s_add_u32 s39, s70, 18432
    buffer_store_dwordx4 v[140:143], v2, s[20:23], s39 offen offset:1024 sc1
    v_pk_mul_f32 v[208:209], v[208:209], v[34:35]
    v_pk_mul_f32 v[210:211], v[210:211], v[34:35]
    v_pk_mul_f32 v[212:213], v[212:213], v[34:35]
    v_pk_mul_f32 v[214:215], v[214:215], v[34:35]
    v_cvt_pk_bf16_f32 v144, v208, v209
    v_cvt_pk_bf16_f32 v145, v210, v211
    v_cvt_pk_bf16_f32 v146, v212, v213
    v_cvt_pk_bf16_f32 v147, v214, v215
    ds_write_b128 v98, v[144:147] offset:36864
    s_add_u32 s39, s70, 20480
    buffer_store_dwordx4 v[144:147], v2, s[20:23], s39 offen sc1
    v_pk_mul_f32 v[216:217], v[216:217], v[34:35]
    v_pk_mul_f32 v[218:219], v[218:219], v[34:35]
    v_pk_mul_f32 v[220:221], v[220:221], v[34:35]
    v_pk_mul_f32 v[222:223], v[222:223], v[34:35]
    v_cvt_pk_bf16_f32 v148, v216, v217
    v_cvt_pk_bf16_f32 v149, v218, v219
    v_cvt_pk_bf16_f32 v150, v220, v221
    v_cvt_pk_bf16_f32 v151, v222, v223
    ds_write_b128 v98, v[148:151] offset:37888
    s_add_u32 s39, s70, 20480
    buffer_store_dwordx4 v[148:151], v2, s[20:23], s39 offen offset:1024 sc1
    v_pk_mul_f32 v[240:241], v[240:241], v[36:37]
    v_pk_mul_f32 v[242:243], v[242:243], v[36:37]
    v_pk_mul_f32 v[244:245], v[244:245], v[36:37]
    v_pk_mul_f32 v[246:247], v[246:247], v[36:37]
    v_cvt_pk_bf16_f32 v152, v240, v241
    v_cvt_pk_bf16_f32 v153, v242, v243
    v_cvt_pk_bf16_f32 v154, v244, v245
    v_cvt_pk_bf16_f32 v155, v246, v247
    ds_write_b128 v98, v[152:155] offset:38912
    s_add_u32 s39, s70, 22528
    buffer_store_dwordx4 v[152:155], v2, s[20:23], s39 offen sc1
    v_pk_mul_f32 v[248:249], v[248:249], v[36:37]
    v_pk_mul_f32 v[250:251], v[250:251], v[36:37]
    v_pk_mul_f32 v[252:253], v[252:253], v[36:37]
    v_pk_mul_f32 v[254:255], v[254:255], v[36:37]
    v_cvt_pk_bf16_f32 v156, v248, v249
    v_cvt_pk_bf16_f32 v157, v250, v251
    v_cvt_pk_bf16_f32 v158, v252, v253
    v_cvt_pk_bf16_f32 v159, v254, v255
    ds_write_b128 v98, v[156:159] offset:39936
    s_add_u32 s39, s70, 22528
    buffer_store_dwordx4 v[156:159], v2, s[20:23], s39 offen offset:1024 sc1
    s_waitcnt lgkmcnt(13)
    v_readfirstlane_b32 s81, v108
    s_cmp_lg_u32 s55, 0
    s_cbranch_scc1 L_np1C
    s_mov_b32 s40, 0x80008000
    v_xor_b32 v80, s40, v80
    v_xor_b32 v81, s40, v81
    v_xor_b32 v82, s40, v82
    v_xor_b32 v83, s40, v83
    v_xor_b32 v84, s40, v84
    v_xor_b32 v85, s40, v85
    v_xor_b32 v86, s40, v86
    v_xor_b32 v87, s40, v87
    v_xor_b32 v88, s40, v88
    v_xor_b32 v89, s40, v89
    v_xor_b32 v90, s40, v90
    v_xor_b32 v91, s40, v91
    v_xor_b32 v92, s40, v92
    v_xor_b32 v93, s40, v93
    v_xor_b32 v94, s40, v94
    v_xor_b32 v95, s40, v95
    v_mfma_f32_16x16x32_bf16 v[68:71], v[80:83], a[48:51], 0
    v_mfma_f32_16x16x32_bf16 v[68:71], v[84:87], a[52:55], v[68:71]
    v_mfma_f32_16x16x32_bf16 v[68:71], v[88:91], a[56:59], v[68:71]
    v_mfma_f32_16x16x32_bf16 v[68:71], v[92:95], a[60:63], v[68:71]
    v_mfma_f32_16x16x32_bf16 v[72:75], v[80:83], a[64:67], 0
    v_mfma_f32_16x16x32_bf16 v[72:75], v[84:87], a[68:71], v[72:75]
    v_mfma_f32_16x16x32_bf16 v[72:75], v[88:91], a[72:75], v[72:75]
    v_mfma_f32_16x16x32_bf16 v[72:75], v[92:95], a[76:79], v[72:75]
    v_mfma_f32_16x16x32_bf16 v[76:79], v[80:83], a[80:83], 0
    v_mfma_f32_16x16x32_bf16 v[76:79], v[84:87], a[84:87], v[76:79]
    v_mfma_f32_16x16x32_bf16 v[76:79], v[88:91], a[88:91], v[76:79]
    v_mfma_f32_16x16x32_bf16 v[76:79], v[92:95], a[92:95], v[76:79]
L_np1C:
    v_mfma_f32_16x16x32_bf16 v[32:35], a[144:147], a[48:51], v[68:71]
    v_mfma_f32_16x16x32_bf16 v[36:39], a[160:163], a[48:51], v[68:71]
    v_mfma_f32_16x16x32_bf16 v[32:35], a[148:151], a[52:55], v[32:35]
    v_mfma_f32_16x16x32_bf16 v[36:39], a[164:167], a[52:55], v[36:39]
    v_mfma_f32_16x16x32_bf16 v[32:35], a[152:155], a[56:59], v[32:35]
    v_mfma_f32_16x16x32_bf16 v[36:39], a[168:171], a[56:59], v[36:39]
    v_mfma_f32_16x16x32_bf16 v[32:35], a[156:159], a[60:63], v[32:35]
    v_mfma_f32_16x16x32_bf16 v[36:39], a[172:175], a[60:63], v[36:39]
    v_mfma_f32_16x16x32_bf16 v[40:43], a[144:147], a[64:67], v[72:75]
    s_nop 5
    v_exp_f32 v32, v32
    v_mfma_f32_16x16x32_bf16 v[44:47], a[160:163], a[64:67], v[72:75]
    v_mfma_f32_16x16x32_bf16 v[40:43], a[148:151], a[68:71], v[40:43]
    v_exp_f32 v33, v33
    v_mfma_f32_16x16x32_bf16 v[44:47], a[164:167], a[68:71], v[44:47]
    v_cvt_pk_bf16_f32 v48, v32, v33
    v_mfma_f32_16x16x32_bf16 v[40:43], a[152:155], a[72:75], v[40:43]
    v_exp_f32 v34, v34
    v_mfma_f32_16x16x32_bf16 v[44:47], a[168:171], a[72:75], v[44:47]
    v_mfma_f32_16x16x32_bf16 v[40:43], a[156:159], a[76:79], v[40:43]
    v_exp_f32 v35, v35
    v_mfma_f32_16x16x32_bf16 v[44:47], a[172:175], a[76:79], v[44:47]
    v_cvt_pk_bf16_f32 v49, v34, v35
    v_exp_f32 v36, v36
    v_exp_f32 v37, v37
    s_nop 0
    v_cvt_pk_bf16_f32 v50, v36, v37
    v_exp_f32 v38, v38
    v_exp_f32 v39, v39
    s_nop 0
    v_cvt_pk_bf16_f32 v51, v38, v39
    v_mfma_f32_16x16x32_bf16 v[32:35], a[112:115], a[48:51], v[68:71]
    v_exp_f32 v40, v40
    v_mfma_f32_16x16x32_bf16 v[36:39], a[128:131], a[48:51], v[68:71]
    v_mfma_f32_16x16x32_bf16 v[32:35], a[116:119], a[52:55], v[32:35]
    v_exp_f32 v41, v41
    v_mfma_f32_16x16x32_bf16 v[36:39], a[132:135], a[52:55], v[36:39]
    v_cvt_pk_bf16_f32 v52, v40, v41
    v_mfma_f32_16x16x32_bf16 v[32:35], a[120:123], a[56:59], v[32:35]
    v_exp_f32 v42, v42
    v_mfma_f32_16x16x32_bf16 v[36:39], a[136:139], a[56:59], v[36:39]
    v_mfma_f32_16x16x32_bf16 v[32:35], a[124:127], a[60:63], v[32:35]
    v_exp_f32 v43, v43
    v_mfma_f32_16x16x32_bf16 v[36:39], a[140:143], a[60:63], v[36:39]
    v_cvt_pk_bf16_f32 v53, v42, v43
    v_mfma_f32_16x16x32_bf16 v[160:163], a[176:179], v[48:51], 0
    v_exp_f32 v44, v44
    v_mfma_f32_16x16x32_bf16 v[164:167], a[180:183], v[48:51], 0
    v_mfma_f32_16x16x32_bf16 v[168:171], a[184:187], v[48:51], 0
    v_exp_f32 v45, v45
    v_mfma_f32_16x16x32_bf16 v[172:175], a[188:191], v[48:51], 0
    v_cvt_pk_bf16_f32 v54, v44, v45
    v_mfma_f32_16x16x32_bf16 v[176:179], a[192:195], v[48:51], 0
    v_exp_f32 v46, v46
    v_mfma_f32_16x16x32_bf16 v[180:183], a[196:199], v[48:51], 0
    v_mfma_f32_16x16x32_bf16 v[184:187], a[200:203], v[48:51], 0
    v_exp_f32 v47, v47
    v_mfma_f32_16x16x32_bf16 v[188:191], a[204:207], v[48:51], 0
    v_cvt_pk_bf16_f32 v55, v46, v47
    v_mfma_f32_16x16x32_bf16 a[96:99], a[108:111], v[48:51], 0
    v_mfma_f32_16x16x32_bf16 v[40:43], a[112:115], a[64:67], v[72:75]
    v_exp_f32 v32, v32
    v_mfma_f32_16x16x32_bf16 v[44:47], a[128:131], a[64:67], v[72:75]
    v_mfma_f32_16x16x32_bf16 v[40:43], a[116:119], a[68:71], v[40:43]
    v_exp_f32 v33, v33
    v_mfma_f32_16x16x32_bf16 v[44:47], a[132:135], a[68:71], v[44:47]
    v_cvt_pk_bf16_f32 v48, v32, v33
    v_mfma_f32_16x16x32_bf16 v[40:43], a[120:123], a[72:75], v[40:43]
    v_exp_f32 v34, v34
    v_mfma_f32_16x16x32_bf16 v[44:47], a[136:139], a[72:75], v[44:47]
    v_mfma_f32_16x16x32_bf16 v[40:43], a[124:127], a[76:79], v[40:43]
    v_exp_f32 v35, v35
    v_mfma_f32_16x16x32_bf16 v[44:47], a[140:143], a[76:79], v[44:47]
    v_cvt_pk_bf16_f32 v49, v34, v35
    s_waitcnt lgkmcnt(0)
    s_barrier
    v_mfma_f32_16x16x32_bf16 v[192:195], a[176:179], v[52:55], 0
    v_exp_f32 v36, v36
    v_mfma_f32_16x16x32_bf16 v[196:199], a[180:183], v[52:55], 0
    ds_read_b128 a[144:147], v6 offset:32768
    ds_read_b128 a[160:163], v6 offset:36864
    v_mfma_f32_16x16x32_bf16 v[200:203], a[184:187], v[52:55], 0
    v_exp_f32 v37, v37
    v_mfma_f32_16x16x32_bf16 v[204:207], a[188:191], v[52:55], 0
    v_cvt_pk_bf16_f32 v50, v36, v37
    ds_read_b128 a[148:151], v7 offset:32768
    v_mfma_f32_16x16x32_bf16 v[208:211], a[192:195], v[52:55], 0
    v_exp_f32 v38, v38
    v_mfma_f32_16x16x32_bf16 v[212:215], a[196:199], v[52:55], 0
    ds_read_b128 a[164:167], v7 offset:36864
    ds_read_b128 a[152:155], v8 offset:32768
    v_mfma_f32_16x16x32_bf16 v[216:219], a[200:203], v[52:55], 0
    v_exp_f32 v39, v39
    v_mfma_f32_16x16x32_bf16 v[220:223], a[204:207], v[52:55], 0
    v_cvt_pk_bf16_f32 v51, v38, v39
    ds_read_b128 a[168:171], v8 offset:36864
    v_mfma_f32_16x16x32_bf16 a[100:103], a[108:111], v[52:55], 0
    ds_read_b128 a[156:159], v9 offset:32768
    ds_read_b128 a[172:175], v9 offset:36864
    v_mfma_f32_16x16x32_bf16 v[32:35], a[112:115], a[80:83], v[76:79]
    v_exp_f32 v40, v40
    v_mfma_f32_16x16x32_bf16 v[36:39], a[128:131], a[80:83], v[76:79]
    ds_read_b64_tr_b16 a[176:177], v10 offset:32768
    ds_read_b64_tr_b16 a[178:179], v10 offset:36864
    v_mfma_f32_16x16x32_bf16 v[32:35], a[116:119], a[84:87], v[32:35]
    v_exp_f32 v41, v41
    v_mfma_f32_16x16x32_bf16 v[36:39], a[132:135], a[84:87], v[36:39]
    v_cvt_pk_bf16_f32 v52, v40, v41
    ds_read_b64_tr_b16 a[180:181], v11 offset:32768
    v_mfma_f32_16x16x32_bf16 v[32:35], a[120:123], a[88:91], v[32:35]
    v_exp_f32 v42, v42
    v_mfma_f32_16x16x32_bf16 v[36:39], a[136:139], a[88:91], v[36:39]
    ds_read_b64_tr_b16 a[182:183], v11 offset:36864
    ds_read_b64_tr_b16 a[184:185], v12 offset:32768
    v_mfma_f32_16x16x32_bf16 v[32:35], a[124:127], a[92:95], v[32:35]
    v_exp_f32 v43, v43
    v_mfma_f32_16x16x32_bf16 v[36:39], a[140:143], a[92:95], v[36:39]
    v_cvt_pk_bf16_f32 v53, v42, v43
    ds_read_b64_tr_b16 a[186:187], v12 offset:36864
    v_mfma_f32_16x16x32_bf16 v[160:163], a[208:211], v[48:51], v[160:163]
    v_exp_f32 v44, v44
    v_mfma_f32_16x16x32_bf16 v[164:167], a[212:215], v[48:51], v[164:167]
    ds_read_b64_tr_b16 a[188:189], v13 offset:32768
    ds_read_b64_tr_b16 a[190:191], v13 offset:36864
    v_mfma_f32_16x16x32_bf16 v[168:171], a[216:219], v[48:51], v[168:171]
    v_exp_f32 v45, v45
    v_mfma_f32_16x16x32_bf16 v[172:175], a[220:223], v[48:51], v[172:175]
    v_cvt_pk_bf16_f32 v54, v44, v45
    ds_read_b64_tr_b16 a[192:193], v14 offset:32768
    v_mfma_f32_16x16x32_bf16 v[176:179], a[224:227], v[48:51], v[176:179]
    v_exp_f32 v46, v46
    v_mfma_f32_16x16x32_bf16 v[180:183], a[228:231], v[48:51], v[180:183]
    ds_read_b64_tr_b16 a[194:195], v14 offset:36864
    ds_read_b64_tr_b16 a[196:197], v15 offset:32768
    v_mfma_f32_16x16x32_bf16 v[184:187], a[232:235], v[48:51], v[184:187]
    v_exp_f32 v47, v47
    v_mfma_f32_16x16x32_bf16 v[188:191], a[236:239], v[48:51], v[188:191]
    v_cvt_pk_bf16_f32 v55, v46, v47
    ds_read_b64_tr_b16 a[198:199], v15 offset:36864
    v_mfma_f32_16x16x32_bf16 a[96:99], a[108:111], v[48:51], a[96:99]
    ds_read_b64_tr_b16 a[200:201], v16 offset:32768
    ds_read_b64_tr_b16 a[202:203], v16 offset:36864
    s_waitcnt lgkmcnt(14)
    v_mfma_f32_16x16x32_bf16 v[40:43], a[144:147], a[48:51], v[68:71]
    v_exp_f32 v32, v32
    v_mfma_f32_16x16x32_bf16 v[44:47], a[160:163], a[48:51], v[68:71]
    ds_read_b64_tr_b16 a[204:205], v17 offset:32768
    ds_read_b64_tr_b16 a[206:207], v17 offset:36864
    v_mfma_f32_16x16x32_bf16 v[40:43], a[148:151], a[52:55], v[40:43]
    v_exp_f32 v33, v33
    v_mfma_f32_16x16x32_bf16 v[44:47], a[164:167], a[52:55], v[44:47]
    v_cvt_pk_bf16_f32 v48, v32, v33
    v_mfma_f32_16x16x32_bf16 v[40:43], a[152:155], a[56:59], v[40:43]
    v_exp_f32 v34, v34
    v_mfma_f32_16x16x32_bf16 v[44:47], a[168:171], a[56:59], v[44:47]
    v_mfma_f32_16x16x32_bf16 v[40:43], a[156:159], a[60:63], v[40:43]
    v_exp_f32 v35, v35
    v_mfma_f32_16x16x32_bf16 v[44:47], a[172:175], a[60:63], v[44:47]
    v_cvt_pk_bf16_f32 v49, v34, v35
    v_mfma_f32_16x16x32_bf16 v[192:195], a[208:211], v[52:55], v[192:195]
    v_exp_f32 v36, v36
    v_mfma_f32_16x16x32_bf16 v[196:199], a[212:215], v[52:55], v[196:199]
    v_mfma_f32_16x16x32_bf16 v[200:203], a[216:219], v[52:55], v[200:203]
    v_exp_f32 v37, v37
    v_mfma_f32_16x16x32_bf16 v[204:207], a[220:223], v[52:55], v[204:207]
    v_cvt_pk_bf16_f32 v50, v36, v37
    v_mfma_f32_16x16x32_bf16 v[208:211], a[224:227], v[52:55], v[208:211]
    v_exp_f32 v38, v38
    v_mfma_f32_16x16x32_bf16 v[212:215], a[228:231], v[52:55], v[212:215]
    v_mfma_f32_16x16x32_bf16 v[216:219], a[232:235], v[52:55], v[216:219]
    v_exp_f32 v39, v39
    v_mfma_f32_16x16x32_bf16 v[220:223], a[236:239], v[52:55], v[220:223]
    v_cvt_pk_bf16_f32 v51, v38, v39
    v_mfma_f32_16x16x32_bf16 a[100:103], a[108:111], v[52:55], a[100:103]
    s_waitcnt lgkmcnt(0)
    s_barrier
    v_mfma_f32_16x16x32_bf16 v[32:35], a[144:147], a[64:67], v[72:75]
    v_exp_f32 v40, v40
    v_mfma_f32_16x16x32_bf16 v[36:39], a[160:163], a[64:67], v[72:75]
    ds_read_b128 a[112:115], v6 offset:49152
    ds_read_b128 a[128:131], v6 offset:53248
    v_mfma_f32_16x16x32_bf16 v[32:35], a[148:151], a[68:71], v[32:35]
    v_exp_f32 v41, v41
    v_mfma_f32_16x16x32_bf16 v[36:39], a[164:167], a[68:71], v[36:39]
    v_cvt_pk_bf16_f32 v52, v40, v41
    ds_read_b128 a[116:119], v7 offset:49152
    v_mfma_f32_16x16x32_bf16 v[32:35], a[152:155], a[72:75], v[32:35]
    v_exp_f32 v42, v42
    v_mfma_f32_16x16x32_bf16 v[36:39], a[168:171], a[72:75], v[36:39]
    ds_read_b128 a[132:135], v7 offset:53248
    ds_read_b128 a[120:123], v8 offset:49152
    v_mfma_f32_16x16x32_bf16 v[32:35], a[156:159], a[76:79], v[32:35]
    v_exp_f32 v43, v43
    v_mfma_f32_16x16x32_bf16 v[36:39], a[172:175], a[76:79], v[36:39]
    v_cvt_pk_bf16_f32 v53, v42, v43
    ds_read_b128 a[136:139], v8 offset:53248
    v_mfma_f32_16x16x32_bf16 v[224:227], a[208:211], v[48:51], 0
    v_exp_f32 v44, v44
    v_mfma_f32_16x16x32_bf16 v[228:231], a[212:215], v[48:51], 0
    ds_read_b128 a[124:127], v9 offset:49152
    ds_read_b128 a[140:143], v9 offset:53248
    v_mfma_f32_16x16x32_bf16 v[232:235], a[216:219], v[48:51], 0
    v_exp_f32 v45, v45
    v_mfma_f32_16x16x32_bf16 v[236:239], a[220:223], v[48:51], 0
    v_cvt_pk_bf16_f32 v54, v44, v45
    ds_read_b64_tr_b16 a[208:209], v10 offset:49152
    v_mfma_f32_16x16x32_bf16 v[240:243], a[224:227], v[48:51], 0
    v_exp_f32 v46, v46
    v_mfma_f32_16x16x32_bf16 v[244:247], a[228:231], v[48:51], 0
    ds_read_b64_tr_b16 a[210:211], v10 offset:53248
    ds_read_b64_tr_b16 a[212:213], v11 offset:49152
    v_mfma_f32_16x16x32_bf16 v[248:251], a[232:235], v[48:51], 0
    v_exp_f32 v47, v47
    v_mfma_f32_16x16x32_bf16 v[252:255], a[236:239], v[48:51], 0
    v_cvt_pk_bf16_f32 v55, v46, v47
    ds_read_b64_tr_b16 a[214:215], v11 offset:53248
    v_mfma_f32_16x16x32_bf16 a[104:107], a[108:111], v[48:51], 0
    ds_read_b64_tr_b16 a[216:217], v12 offset:49152
    ds_read_b64_tr_b16 a[218:219], v12 offset:53248
    s_waitcnt lgkmcnt(6)
    v_mfma_f32_16x16x32_bf16 v[40:43], a[112:115], a[48:51], v[68:71]
    v_exp_f32 v32, v32
    v_mfma_f32_16x16x32_bf16 v[44:47], a[128:131], a[48:51], v[68:71]
    ds_read_b64_tr_b16 a[220:221], v13 offset:49152
    ds_read_b64_tr_b16 a[222:223], v13 offset:53248
    v_mfma_f32_16x16x32_bf16 v[40:43], a[116:119], a[52:55], v[40:43]
    v_exp_f32 v33, v33
    v_mfma_f32_16x16x32_bf16 v[44:47], a[132:135], a[52:55], v[44:47]
    v_cvt_pk_bf16_f32 v48, v32, v33
    ds_read_b64_tr_b16 a[224:225], v14 offset:49152
    v_mfma_f32_16x16x32_bf16 v[40:43], a[120:123], a[56:59], v[40:43]
    v_exp_f32 v34, v34
    v_mfma_f32_16x16x32_bf16 v[44:47], a[136:139], a[56:59], v[44:47]
    ds_read_b64_tr_b16 a[226:227], v14 offset:53248
    ds_read_b64_tr_b16 a[228:229], v15 offset:49152
    v_mfma_f32_16x16x32_bf16 v[40:43], a[124:127], a[60:63], v[40:43]
    v_exp_f32 v35, v35
    v_mfma_f32_16x16x32_bf16 v[44:47], a[140:143], a[60:63], v[44:47]
    v_cvt_pk_bf16_f32 v49, v34, v35
    ds_read_b64_tr_b16 a[230:231], v15 offset:53248
    v_mfma_f32_16x16x32_bf16 v[160:163], a[176:179], v[52:55], v[160:163]
    v_exp_f32 v36, v36
    v_mfma_f32_16x16x32_bf16 v[164:167], a[180:183], v[52:55], v[164:167]
    ds_read_b64_tr_b16 a[232:233], v16 offset:49152
    ds_read_b64_tr_b16 a[234:235], v16 offset:53248
    v_mfma_f32_16x16x32_bf16 v[168:171], a[184:187], v[52:55], v[168:171]
    v_exp_f32 v37, v37
    v_mfma_f32_16x16x32_bf16 v[172:175], a[188:191], v[52:55], v[172:175]
    v_cvt_pk_bf16_f32 v50, v36, v37
    ds_read_b64_tr_b16 a[236:237], v17 offset:49152
    v_mfma_f32_16x16x32_bf16 v[176:179], a[192:195], v[52:55], v[176:179]
    v_exp_f32 v38, v38
    v_mfma_f32_16x16x32_bf16 v[180:183], a[196:199], v[52:55], v[180:183]
    ds_read_b64_tr_b16 a[238:239], v17 offset:53248
    v_mfma_f32_16x16x32_bf16 v[184:187], a[200:203], v[52:55], v[184:187]
    v_exp_f32 v39, v39
    v_mfma_f32_16x16x32_bf16 v[188:191], a[204:207], v[52:55], v[188:191]
    v_cvt_pk_bf16_f32 v51, v38, v39
    v_mfma_f32_16x16x32_bf16 a[96:99], a[108:111], v[52:55], a[96:99]
    v_mfma_f32_16x16x32_bf16 v[32:35], a[112:115], a[64:67], v[72:75]
    v_exp_f32 v40, v40
    v_mfma_f32_16x16x32_bf16 v[36:39], a[128:131], a[64:67], v[72:75]
    v_mfma_f32_16x16x32_bf16 v[32:35], a[116:119], a[68:71], v[32:35]
    v_exp_f32 v41, v41
    v_mfma_f32_16x16x32_bf16 v[36:39], a[132:135], a[68:71], v[36:39]
    v_cvt_pk_bf16_f32 v52, v40, v41
    v_mfma_f32_16x16x32_bf16 v[32:35], a[120:123], a[72:75], v[32:35]
    v_exp_f32 v42, v42
    v_mfma_f32_16x16x32_bf16 v[36:39], a[136:139], a[72:75], v[36:39]
    v_mfma_f32_16x16x32_bf16 v[32:35], a[124:127], a[76:79], v[32:35]
    v_exp_f32 v43, v43
    v_mfma_f32_16x16x32_bf16 v[36:39], a[140:143], a[76:79], v[36:39]
    v_cvt_pk_bf16_f32 v53, v42, v43
    s_waitcnt lgkmcnt(0)
    s_barrier
    v_mfma_f32_16x16x32_bf16 v[192:195], a[176:179], v[48:51], v[192:195]
    v_exp_f32 v44, v44
    v_mfma_f32_16x16x32_bf16 v[196:199], a[180:183], v[48:51], v[196:199]
    ds_read_b128 a[144:147], v6
    ds_read_b128 a[160:163], v6 offset:4096
    v_mfma_f32_16x16x32_bf16 v[200:203], a[184:187], v[48:51], v[200:203]
    v_exp_f32 v45, v45
    v_mfma_f32_16x16x32_bf16 v[204:207], a[188:191], v[48:51], v[204:207]
    v_cvt_pk_bf16_f32 v54, v44, v45
    ds_read_b128 a[148:151], v7
    v_mfma_f32_16x16x32_bf16 v[208:211], a[192:195], v[48:51], v[208:211]
    v_exp_f32 v46, v46
    v_mfma_f32_16x16x32_bf16 v[212:215], a[196:199], v[48:51], v[212:215]
    ds_read_b128 a[164:167], v7 offset:4096
    ds_read_b128 a[152:155], v8
    v_mfma_f32_16x16x32_bf16 v[216:219], a[200:203], v[48:51], v[216:219]
    v_exp_f32 v47, v47
    v_mfma_f32_16x16x32_bf16 v[220:223], a[204:207], v[48:51], v[220:223]
    v_cvt_pk_bf16_f32 v55, v46, v47
    ds_read_b128 a[168:171], v8 offset:4096
    v_mfma_f32_16x16x32_bf16 a[100:103], a[108:111], v[48:51], a[100:103]
    ds_read_b128 a[156:159], v9
    ds_read_b128 a[172:175], v9 offset:4096
    v_mfma_f32_16x16x32_bf16 v[40:43], a[112:115], a[80:83], v[76:79]
    v_exp_f32 v32, v32
    v_mfma_f32_16x16x32_bf16 v[44:47], a[128:131], a[80:83], v[76:79]
    ds_read_b64_tr_b16 a[176:177], v10
    ds_read_b64_tr_b16 a[178:179], v10 offset:4096
    v_mfma_f32_16x16x32_bf16 v[40:43], a[116:119], a[84:87], v[40:43]
    v_exp_f32 v33, v33
    v_mfma_f32_16x16x32_bf16 v[44:47], a[132:135], a[84:87], v[44:47]
    v_cvt_pk_bf16_f32 v48, v32, v33
    ds_read_b64_tr_b16 a[180:181], v11
    v_mfma_f32_16x16x32_bf16 v[40:43], a[120:123], a[88:91], v[40:43]
    v_exp_f32 v34, v34
    v_mfma_f32_16x16x32_bf16 v[44:47], a[136:139], a[88:91], v[44:47]
    ds_read_b64_tr_b16 a[182:183], v11 offset:4096
    ds_read_b64_tr_b16 a[184:185], v12
    v_mfma_f32_16x16x32_bf16 v[40:43], a[124:127], a[92:95], v[40:43]
    v_exp_f32 v35, v35
    v_mfma_f32_16x16x32_bf16 v[44:47], a[140:143], a[92:95], v[44:47]
    v_cvt_pk_bf16_f32 v49, v34, v35
    ds_read_b64_tr_b16 a[186:187], v12 offset:4096
    v_mfma_f32_16x16x32_bf16 v[160:163], a[208:211], v[52:55], v[160:163]
    v_exp_f32 v36, v36
    v_mfma_f32_16x16x32_bf16 v[164:167], a[212:215], v[52:55], v[164:167]
    ds_read_b64_tr_b16 a[188:189], v13
    ds_read_b64_tr_b16 a[190:191], v13 offset:4096
    v_mfma_f32_16x16x32_bf16 v[168:171], a[216:219], v[52:55], v[168:171]
    v_exp_f32 v37, v37
    v_mfma_f32_16x16x32_bf16 v[172:175], a[220:223], v[52:55], v[172:175]
    v_cvt_pk_bf16_f32 v50, v36, v37
    ds_read_b64_tr_b16 a[192:193], v14
    v_mfma_f32_16x16x32_bf16 v[176:179], a[224:227], v[52:55], v[176:179]
    v_exp_f32 v38, v38
    v_mfma_f32_16x16x32_bf16 v[180:183], a[228:231], v[52:55], v[180:183]
    ds_read_b64_tr_b16 a[194:195], v14 offset:4096
    ds_read_b64_tr_b16 a[196:197], v15
    v_mfma_f32_16x16x32_bf16 v[184:187], a[232:235], v[52:55], v[184:187]
    v_exp_f32 v39, v39
    v_mfma_f32_16x16x32_bf16 v[188:191], a[236:239], v[52:55], v[188:191]
    v_cvt_pk_bf16_f32 v51, v38, v39
    ds_read_b64_tr_b16 a[198:199], v15 offset:4096
    v_mfma_f32_16x16x32_bf16 a[96:99], a[108:111], v[52:55], a[96:99]
    ds_read_b64_tr_b16 a[200:201], v16
    ds_read_b64_tr_b16 a[202:203], v16 offset:4096
    s_waitcnt lgkmcnt(14)
    v_mfma_f32_16x16x32_bf16 v[32:35], a[144:147], a[48:51], v[68:71]
    v_exp_f32 v40, v40
    v_mfma_f32_16x16x32_bf16 v[36:39], a[160:163], a[48:51], v[68:71]
    ds_read_b64_tr_b16 a[204:205], v17
    ds_read_b64_tr_b16 a[206:207], v17 offset:4096
    v_mfma_f32_16x16x32_bf16 v[32:35], a[148:151], a[52:55], v[32:35]
    v_exp_f32 v41, v41
    v_mfma_f32_16x16x32_bf16 v[36:39], a[164:167], a[52:55], v[36:39]
    v_cvt_pk_bf16_f32 v52, v40, v41
    v_mfma_f32_16x16x32_bf16 v[32:35], a[152:155], a[56:59], v[32:35]
    v_exp_f32 v42, v42
    v_mfma_f32_16x16x32_bf16 v[36:39], a[168:171], a[56:59], v[36:39]
    v_mfma_f32_16x16x32_bf16 v[32:35], a[156:159], a[60:63], v[32:35]
    v_exp_f32 v43, v43
    v_mfma_f32_16x16x32_bf16 v[36:39], a[172:175], a[60:63], v[36:39]
    v_cvt_pk_bf16_f32 v53, v42, v43
    v_mfma_f32_16x16x32_bf16 v[192:195], a[208:211], v[48:51], v[192:195]
    v_exp_f32 v44, v44
    v_mfma_f32_16x16x32_bf16 v[196:199], a[212:215], v[48:51], v[196:199]
    v_mfma_f32_16x16x32_bf16 v[200:203], a[216:219], v[48:51], v[200:203]
    v_exp_f32 v45, v45
    v_mfma_f32_16x16x32_bf16 v[204:207], a[220:223], v[48:51], v[204:207]
    v_cvt_pk_bf16_f32 v54, v44, v45
    v_mfma_f32_16x16x32_bf16 v[208:211], a[224:227], v[48:51], v[208:211]
    v_exp_f32 v46, v46
    v_mfma_f32_16x16x32_bf16 v[212:215], a[228:231], v[48:51], v[212:215]
    v_mfma_f32_16x16x32_bf16 v[216:219], a[232:235], v[48:51], v[216:219]
    v_exp_f32 v47, v47
    v_mfma_f32_16x16x32_bf16 v[220:223], a[236:239], v[48:51], v[220:223]
    v_cvt_pk_bf16_f32 v55, v46, v47
    v_mfma_f32_16x16x32_bf16 a[100:103], a[108:111], v[48:51], a[100:103]
    s_mov_b32 s54, 6
L_loop_C11:
    s_waitcnt vmcnt(0)
    s_waitcnt lgkmcnt(0)
    s_barrier
    s_cmp_lg_u32 s54, 5
    s_cbranch_scc1 1f
    v_mov_b32 v4, 163776
    ds_read_b128 v[80:83], v4
    s_waitcnt lgkmcnt(0)
    v_or_b32 v80, v80, v81
    v_or3_b32 v80, v80, v82, v83
    s_nop 0
    v_readfirstlane_b32 s39, v80
    s_nop 0
    s_andn2_b32 s67, s39, s55
    s_or_b32 s39, s67, s68
    s_cmp_lg_u32 s39, 0
    s_cbranch_scc1 1f
    s_lshl_b32 s39, s43, 3
    v_mov_b32 v110, s81
    v_not_b32 v111, s81
    v_mov_b32 v4, s39
    s_mov_b64 exec, 1
    buffer_store_dwordx2 v[110:111], v4, s[20:23], s84 offen offset:0 sc1
    s_mov_b64 exec, -1
1:
    v_mfma_f32_16x16x32_bf16 v[40:43], a[144:147], a[64:67], v[72:75]
    v_exp_f32 v32, v32
    v_mfma_f32_16x16x32_bf16 v[44:47], a[160:163], a[64:67], v[72:75]
    ds_read_b128 a[112:115], v6 offset:16384
    ds_read_b128 a[128:131], v6 offset:20480
    v_mfma_f32_16x16x32_bf16 v[40:43], a[148:151], a[68:71], v[40:43]
    v_exp_f32 v33, v33
    v_mfma_f32_16x16x32_bf16 v[44:47], a[164:167], a[68:71], v[44:47]
    v_cvt_pk_bf16_f32 v48, v32, v33
    ds_read_b128 a[116:119], v7 offset:16384
    v_mfma_f32_16x16x32_bf16 v[40:43], a[152:155], a[72:75], v[40:43]
    v_exp_f32 v34, v34
    v_mfma_f32_16x16x32_bf16 v[44:47], a[168:171], a[72:75], v[44:47]
    ds_read_b128 a[132:135], v7 offset:20480
    ds_read_b128 a[120:123], v8 offset:16384
    v_mfma_f32_16x16x32_bf16 v[40:43], a[156:159], a[76:79], v[40:43]
    v_exp_f32 v35, v35
    v_mfma_f32_16x16x32_bf16 v[44:47], a[172:175], a[76:79], v[44:47]
    v_cvt_pk_bf16_f32 v49, v34, v35
    ds_read_b128 a[136:139], v8 offset:20480
    v_mfma_f32_16x16x32_bf16 v[224:227], a[208:211], v[52:55], v[224:227]
    v_exp_f32 v36, v36
    v_mfma_f32_16x16x32_bf16 v[228:231], a[212:215], v[52:55], v[228:231]
    ds_read_b128 a[124:127], v9 offset:16384
    ds_read_b128 a[140:143], v9 offset:20480
    v_mfma_f32_16x16x32_bf16 v[232:235], a[216:219], v[52:55], v[232:235]
    v_exp_f32 v37, v37
    v_mfma_f32_16x16x32_bf16 v[236:239], a[220:223], v[52:55], v[236:239]
    v_cvt_pk_bf16_f32 v50, v36, v37
    ds_read_b64_tr_b16 a[208:209], v10 offset:16384
    v_mfma_f32_16x16x32_bf16 v[240:243], a[224:227], v[52:55], v[240:243]
    v_exp_f32 v38, v38
    v_mfma_f32_16x16x32_bf16 v[244:247], a[228:231], v[52:55], v[244:247]
    ds_read_b64_tr_b16 a[210:211], v10 offset:20480
    ds_read_b64_tr_b16 a[212:213], v11 offset:16384
    v_mfma_f32_16x16x32_bf16 v[248:251], a[232:235], v[52:55], v[248:251]
    v_exp_f32 v39, v39
    v_mfma_f32_16x16x32_bf16 v[252:255], a[236:239], v[52:55], v[252:255]
    v_cvt_pk_bf16_f32 v51, v38, v39
    ds_read_b64_tr_b16 a[214:215], v11 offset:20480
    v_mfma_f32_16x16x32_bf16 a[104:107], a[108:111], v[52:55], a[104:107]
    ds_read_b64_tr_b16 a[216:217], v12 offset:16384
    ds_read_b64_tr_b16 a[218:219], v12 offset:20480
    s_waitcnt lgkmcnt(6)
    v_mfma_f32_16x16x32_bf16 v[32:35], a[112:115], a[48:51], v[68:71]
    v_exp_f32 v40, v40
    v_mfma_f32_16x16x32_bf16 v[36:39], a[128:131], a[48:51], v[68:71]
    ds_read_b64_tr_b16 a[220:221], v13 offset:16384
    ds_read_b64_tr_b16 a[222:223], v13 offset:20480
    v_mfma_f32_16x16x32_bf16 v[32:35], a[116:119], a[52:55], v[32:35]
    v_exp_f32 v41, v41
    v_mfma_f32_16x16x32_bf16 v[36:39], a[132:135], a[52:55], v[36:39]
    v_cvt_pk_bf16_f32 v52, v40, v41
    ds_read_b64_tr_b16 a[224:225], v14 offset:16384
    v_mfma_f32_16x16x32_bf16 v[32:35], a[120:123], a[56:59], v[32:35]
    v_exp_f32 v42, v42
    v_mfma_f32_16x16x32_bf16 v[36:39], a[136:139], a[56:59], v[36:39]
    ds_read_b64_tr_b16 a[226:227], v14 offset:20480
    ds_read_b64_tr_b16 a[228:229], v15 offset:16384
    v_mfma_f32_16x16x32_bf16 v[32:35], a[124:127], a[60:63], v[32:35]
    v_exp_f32 v43, v43
    v_mfma_f32_16x16x32_bf16 v[36:39], a[140:143], a[60:63], v[36:39]
    v_cvt_pk_bf16_f32 v53, v42, v43
    ds_read_b64_tr_b16 a[230:231], v15 offset:20480
    v_mfma_f32_16x16x32_bf16 v[160:163], a[176:179], v[48:51], v[160:163]
    v_exp_f32 v44, v44
    v_mfma_f32_16x16x32_bf16 v[164:167], a[180:183], v[48:51], v[164:167]
    ds_read_b64_tr_b16 a[232:233], v16 offset:16384
    ds_read_b64_tr_b16 a[234:235], v16 offset:20480
    v_mfma_f32_16x16x32_bf16 v[168:171], a[184:187], v[48:51], v[168:171]
    v_exp_f32 v45, v45
    v_mfma_f32_16x16x32_bf16 v[172:175], a[188:191], v[48:51], v[172:175]
    v_cvt_pk_bf16_f32 v54, v44, v45
    ds_read_b64_tr_b16 a[236:237], v17 offset:16384
    v_mfma_f32_16x16x32_bf16 v[176:179], a[192:195], v[48:51], v[176:179]
    v_exp_f32 v46, v46
    v_mfma_f32_16x16x32_bf16 v[180:183], a[196:199], v[48:51], v[180:183]
    ds_read_b64_tr_b16 a[238:239], v17 offset:20480
    v_mfma_f32_16x16x32_bf16 v[184:187], a[200:203], v[48:51], v[184:187]
    v_exp_f32 v47, v47
    v_mfma_f32_16x16x32_bf16 v[188:191], a[204:207], v[48:51], v[188:191]
    v_cvt_pk_bf16_f32 v55, v46, v47
    v_mfma_f32_16x16x32_bf16 a[96:99], a[108:111], v[48:51], a[96:99]
    v_mfma_f32_16x16x32_bf16 v[40:43], a[112:115], a[64:67], v[72:75]
    v_exp_f32 v32, v32
    v_mfma_f32_16x16x32_bf16 v[44:47], a[128:131], a[64:67], v[72:75]
    v_mfma_f32_16x16x32_bf16 v[40:43], a[116:119], a[68:71], v[40:43]
    v_exp_f32 v33, v33
    v_mfma_f32_16x16x32_bf16 v[44:47], a[132:135], a[68:71], v[44:47]
    v_cvt_pk_bf16_f32 v48, v32, v33
    v_mfma_f32_16x16x32_bf16 v[40:43], a[120:123], a[72:75], v[40:43]
    v_exp_f32 v34, v34
    v_mfma_f32_16x16x32_bf16 v[44:47], a[136:139], a[72:75], v[44:47]
    v_mfma_f32_16x16x32_bf16 v[40:43], a[124:127], a[76:79], v[40:43]
    v_exp_f32 v35, v35
    v_mfma_f32_16x16x32_bf16 v[44:47], a[140:143], a[76:79], v[44:47]
    v_cvt_pk_bf16_f32 v49, v34, v35
    s_waitcnt lgkmcnt(0)
    s_barrier
    v_mfma_f32_16x16x32_bf16 v[192:195], a[176:179], v[52:55], v[192:195]
    v_exp_f32 v36, v36
    v_mfma_f32_16x16x32_bf16 v[196:199], a[180:183], v[52:55], v[196:199]
    ds_read_b128 a[144:147], v6 offset:32768
    ds_read_b128 a[160:163], v6 offset:36864
    v_mfma_f32_16x16x32_bf16 v[200:203], a[184:187], v[52:55], v[200:203]
    v_exp_f32 v37, v37
    v_mfma_f32_16x16x32_bf16 v[204:207], a[188:191], v[52:55], v[204:207]
    v_cvt_pk_bf16_f32 v50, v36, v37
    ds_read_b128 a[148:151], v7 offset:32768
    v_mfma_f32_16x16x32_bf16 v[208:211], a[192:195], v[52:55], v[208:211]
    v_exp_f32 v38, v38
    v_mfma_f32_16x16x32_bf16 v[212:215], a[196:199], v[52:55], v[212:215]
    ds_read_b128 a[164:167], v7 offset:36864
    ds_read_b128 a[152:155], v8 offset:32768
    v_mfma_f32_16x16x32_bf16 v[216:219], a[200:203], v[52:55], v[216:219]
    v_exp_f32 v39, v39
    v_mfma_f32_16x16x32_bf16 v[220:223], a[204:207], v[52:55], v[220:223]
    v_cvt_pk_bf16_f32 v51, v38, v39
    ds_read_b128 a[168:171], v8 offset:36864
    v_mfma_f32_16x16x32_bf16 a[100:103], a[108:111], v[52:55], a[100:103]
    ds_read_b128 a[156:159], v9 offset:32768
    ds_read_b128 a[172:175], v9 offset:36864
    v_mfma_f32_16x16x32_bf16 v[32:35], a[112:115], a[80:83], v[76:79]
    v_exp_f32 v40, v40
    v_mfma_f32_16x16x32_bf16 v[36:39], a[128:131], a[80:83], v[76:79]
    ds_read_b64_tr_b16 a[176:177], v10 offset:32768
    ds_read_b64_tr_b16 a[178:179], v10 offset:36864
    v_mfma_f32_16x16x32_bf16 v[32:35], a[116:119], a[84:87], v[32:35]
    v_exp_f32 v41, v41
    v_mfma_f32_16x16x32_bf16 v[36:39], a[132:135], a[84:87], v[36:39]
    v_cvt_pk_bf16_f32 v52, v40, v41
    ds_read_b64_tr_b16 a[180:181], v11 offset:32768
    v_mfma_f32_16x16x32_bf16 v[32:35], a[120:123], a[88:91], v[32:35]
    v_exp_f32 v42, v42
    v_mfma_f32_16x16x32_bf16 v[36:39], a[136:139], a[88:91], v[36:39]
    ds_read_b64_tr_b16 a[182:183], v11 offset:36864
    ds_read_b64_tr_b16 a[184:185], v12 offset:32768
    v_mfma_f32_16x16x32_bf16 v[32:35], a[124:127], a[92:95], v[32:35]
    v_exp_f32 v43, v43
    v_mfma_f32_16x16x32_bf16 v[36:39], a[140:143], a[92:95], v[36:39]
    v_cvt_pk_bf16_f32 v53, v42, v43
    ds_read_b64_tr_b16 a[186:187], v12 offset:36864
    v_mfma_f32_16x16x32_bf16 v[160:163], a[208:211], v[48:51], v[160:163]
    v_exp_f32 v44, v44
    v_mfma_f32_16x16x32_bf16 v[164:167], a[212:215], v[48:51], v[164:167]
    ds_read_b64_tr_b16 a[188:189], v13 offset:32768
    ds_read_b64_tr_b16 a[190:191], v13 offset:36864
    v_mfma_f32_16x16x32_bf16 v[168:171], a[216:219], v[48:51], v[168:171]
    v_exp_f32 v45, v45
    v_mfma_f32_16x16x32_bf16 v[172:175], a[220:223], v[48:51], v[172:175]
    v_cvt_pk_bf16_f32 v54, v44, v45
    ds_read_b64_tr_b16 a[192:193], v14 offset:32768
    v_mfma_f32_16x16x32_bf16 v[176:179], a[224:227], v[48:51], v[176:179]
    v_exp_f32 v46, v46
    v_mfma_f32_16x16x32_bf16 v[180:183], a[228:231], v[48:51], v[180:183]
    ds_read_b64_tr_b16 a[194:195], v14 offset:36864
    ds_read_b64_tr_b16 a[196:197], v15 offset:32768
    v_mfma_f32_16x16x32_bf16 v[184:187], a[232:235], v[48:51], v[184:187]
    v_exp_f32 v47, v47
    v_mfma_f32_16x16x32_bf16 v[188:191], a[236:239], v[48:51], v[188:191]
    v_cvt_pk_bf16_f32 v55, v46, v47
    ds_read_b64_tr_b16 a[198:199], v15 offset:36864
    v_mfma_f32_16x16x32_bf16 a[96:99], a[108:111], v[48:51], a[96:99]
    ds_read_b64_tr_b16 a[200:201], v16 offset:32768
    ds_read_b64_tr_b16 a[202:203], v16 offset:36864
    s_waitcnt lgkmcnt(14)
    v_mfma_f32_16x16x32_bf16 v[40:43], a[144:147], a[48:51], v[68:71]
    v_exp_f32 v32, v32
    v_mfma_f32_16x16x32_bf16 v[44:47], a[160:163], a[48:51], v[68:71]
    ds_read_b64_tr_b16 a[204:205], v17 offset:32768
    ds_read_b64_tr_b16 a[206:207], v17 offset:36864
    v_mfma_f32_16x16x32_bf16 v[40:43], a[148:151], a[52:55], v[40:43]
    v_exp_f32 v33, v33
    v_mfma_f32_16x16x32_bf16 v[44:47], a[164:167], a[52:55], v[44:47]
    v_cvt_pk_bf16_f32 v48, v32, v33
    v_mfma_f32_16x16x32_bf16 v[40:43], a[152:155], a[56:59], v[40:43]
    v_exp_f32 v34, v34
    v_mfma_f32_16x16x32_bf16 v[44:47], a[168:171], a[56:59], v[44:47]
    v_mfma_f32_16x16x32_bf16 v[40:43], a[156:159], a[60:63], v[40:43]
    v_exp_f32 v35, v35
    v_mfma_f32_16x16x32_bf16 v[44:47], a[172:175], a[60:63], v[44:47]
    v_cvt_pk_bf16_f32 v49, v34, v35
    v_mfma_f32_16x16x32_bf16 v[192:195], a[208:211], v[52:55], v[192:195]
    v_exp_f32 v36, v36
    v_mfma_f32_16x16x32_bf16 v[196:199], a[212:215], v[52:55], v[196:199]
    v_mfma_f32_16x16x32_bf16 v[200:203], a[216:219], v[52:55], v[200:203]
    v_exp_f32 v37, v37
    v_mfma_f32_16x16x32_bf16 v[204:207], a[220:223], v[52:55], v[204:207]
    v_cvt_pk_bf16_f32 v50, v36, v37
    v_mfma_f32_16x16x32_bf16 v[208:211], a[224:227], v[52:55], v[208:211]
    v_exp_f32 v38, v38
    v_mfma_f32_16x16x32_bf16 v[212:215], a[228:231], v[52:55], v[212:215]
    v_mfma_f32_16x16x32_bf16 v[216:219], a[232:235], v[52:55], v[216:219]
    v_exp_f32 v39, v39
    v_mfma_f32_16x16x32_bf16 v[220:223], a[236:239], v[52:55], v[220:223]
    v_cvt_pk_bf16_f32 v51, v38, v39
    v_mfma_f32_16x16x32_bf16 a[100:103], a[108:111], v[52:55], a[100:103]
    s_waitcnt lgkmcnt(0)
    s_barrier
    v_mfma_f32_16x16x32_bf16 v[32:35], a[144:147], a[64:67], v[72:75]
    v_exp_f32 v40, v40
    v_mfma_f32_16x16x32_bf16 v[36:39], a[160:163], a[64:67], v[72:75]
    ds_read_b128 a[112:115], v6 offset:49152
    ds_read_b128 a[128:131], v6 offset:53248
    v_mfma_f32_16x16x32_bf16 v[32:35], a[148:151], a[68:71], v[32:35]
    v_exp_f32 v41, v41
    v_mfma_f32_16x16x32_bf16 v[36:39], a[164:167], a[68:71], v[36:39]
    v_cvt_pk_bf16_f32 v52, v40, v41
    ds_read_b128 a[116:119], v7 offset:49152
    v_mfma_f32_16x16x32_bf16 v[32:35], a[152:155], a[72:75], v[32:35]
    v_exp_f32 v42, v42
    v_mfma_f32_16x16x32_bf16 v[36:39], a[168:171], a[72:75], v[36:39]
    ds_read_b128 a[132:135], v7 offset:53248
    ds_read_b128 a[120:123], v8 offset:49152
    v_mfma_f32_16x16x32_bf16 v[32:35], a[156:159], a[76:79], v[32:35]
    v_exp_f32 v43, v43
    v_mfma_f32_16x16x32_bf16 v[36:39], a[172:175], a[76:79], v[36:39]
    v_cvt_pk_bf16_f32 v53, v42, v43
    ds_read_b128 a[136:139], v8 offset:53248
    v_mfma_f32_16x16x32_bf16 v[224:227], a[208:211], v[48:51], v[224:227]
    v_exp_f32 v44, v44
    v_mfma_f32_16x16x32_bf16 v[228:231], a[212:215], v[48:51], v[228:231]
    ds_read_b128 a[124:127], v9 offset:49152
    ds_read_b128 a[140:143], v9 offset:53248
    v_mfma_f32_16x16x32_bf16 v[232:235], a[216:219], v[48:51], v[232:235]
    v_exp_f32 v45, v45
    v_mfma_f32_16x16x32_bf16 v[236:239], a[220:223], v[48:51], v[236:239]
    v_cvt_pk_bf16_f32 v54, v44, v45
    ds_read_b64_tr_b16 a[208:209], v10 offset:49152
    v_mfma_f32_16x16x32_bf16 v[240:243], a[224:227], v[48:51], v[240:243]
    v_exp_f32 v46, v46
    v_mfma_f32_16x16x32_bf16 v[244:247], a[228:231], v[48:51], v[244:247]
    ds_read_b64_tr_b16 a[210:211], v10 offset:53248
    ds_read_b64_tr_b16 a[212:213], v11 offset:49152
    v_mfma_f32_16x16x32_bf16 v[248:251], a[232:235], v[48:51], v[248:251]
    v_exp_f32 v47, v47
    v_mfma_f32_16x16x32_bf16 v[252:255], a[236:239], v[48:51], v[252:255]
    v_cvt_pk_bf16_f32 v55, v46, v47
    ds_read_b64_tr_b16 a[214:215], v11 offset:53248
    v_mfma_f32_16x16x32_bf16 a[104:107], a[108:111], v[48:51], a[104:107]
    ds_read_b64_tr_b16 a[216:217], v12 offset:49152
    ds_read_b64_tr_b16 a[218:219], v12 offset:53248
    s_waitcnt lgkmcnt(6)
    v_mfma_f32_16x16x32_bf16 v[40:43], a[112:115], a[48:51], v[68:71]
    v_exp_f32 v32, v32
    v_mfma_f32_16x16x32_bf16 v[44:47], a[128:131], a[48:51], v[68:71]
    ds_read_b64_tr_b16 a[220:221], v13 offset:49152
    ds_read_b64_tr_b16 a[222:223], v13 offset:53248
    v_mfma_f32_16x16x32_bf16 v[40:43], a[116:119], a[52:55], v[40:43]
    v_exp_f32 v33, v33
    v_mfma_f32_16x16x32_bf16 v[44:47], a[132:135], a[52:55], v[44:47]
    v_cvt_pk_bf16_f32 v48, v32, v33
    ds_read_b64_tr_b16 a[224:225], v14 offset:49152
    v_mfma_f32_16x16x32_bf16 v[40:43], a[120:123], a[56:59], v[40:43]
    v_exp_f32 v34, v34
    v_mfma_f32_16x16x32_bf16 v[44:47], a[136:139], a[56:59], v[44:47]
    ds_read_b64_tr_b16 a[226:227], v14 offset:53248
    ds_read_b64_tr_b16 a[228:229], v15 offset:49152
    v_mfma_f32_16x16x32_bf16 v[40:43], a[124:127], a[60:63], v[40:43]
    v_exp_f32 v35, v35
    v_mfma_f32_16x16x32_bf16 v[44:47], a[140:143], a[60:63], v[44:47]
    v_cvt_pk_bf16_f32 v49, v34, v35
    ds_read_b64_tr_b16 a[230:231], v15 offset:53248
    v_mfma_f32_16x16x32_bf16 v[160:163], a[176:179], v[52:55], v[160:163]
    v_exp_f32 v36, v36
    v_mfma_f32_16x16x32_bf16 v[164:167], a[180:183], v[52:55], v[164:167]
    ds_read_b64_tr_b16 a[232:233], v16 offset:49152
    ds_read_b64_tr_b16 a[234:235], v16 offset:53248
    v_mfma_f32_16x16x32_bf16 v[168:171], a[184:187], v[52:55], v[168:171]
    v_exp_f32 v37, v37
    v_mfma_f32_16x16x32_bf16 v[172:175], a[188:191], v[52:55], v[172:175]
    v_cvt_pk_bf16_f32 v50, v36, v37
    ds_read_b64_tr_b16 a[236:237], v17 offset:49152
    v_mfma_f32_16x16x32_bf16 v[176:179], a[192:195], v[52:55], v[176:179]
    v_exp_f32 v38, v38
    v_mfma_f32_16x16x32_bf16 v[180:183], a[196:199], v[52:55], v[180:183]
    ds_read_b64_tr_b16 a[238:239], v17 offset:53248
    v_mfma_f32_16x16x32_bf16 v[184:187], a[200:203], v[52:55], v[184:187]
    v_exp_f32 v39, v39
    v_mfma_f32_16x16x32_bf16 v[188:191], a[204:207], v[52:55], v[188:191]
    v_cvt_pk_bf16_f32 v51, v38, v39
    v_mfma_f32_16x16x32_bf16 a[96:99], a[108:111], v[52:55], a[96:99]
    v_mfma_f32_16x16x32_bf16 v[32:35], a[112:115], a[64:67], v[72:75]
    v_exp_f32 v40, v40
    v_mfma_f32_16x16x32_bf16 v[36:39], a[128:131], a[64:67], v[72:75]
    v_mfma_f32_16x16x32_bf16 v[32:35], a[116:119], a[68:71], v[32:35]
    v_exp_f32 v41, v41
    v_mfma_f32_16x16x32_bf16 v[36:39], a[132:135], a[68:71], v[36:39]
    v_cvt_pk_bf16_f32 v52, v40, v41
    v_mfma_f32_16x16x32_bf16 v[32:35], a[120:123], a[72:75], v[32:35]
    v_exp_f32 v42, v42
    v_mfma_f32_16x16x32_bf16 v[36:39], a[136:139], a[72:75], v[36:39]
    v_mfma_f32_16x16x32_bf16 v[32:35], a[124:127], a[76:79], v[32:35]
    v_exp_f32 v43, v43
    v_mfma_f32_16x16x32_bf16 v[36:39], a[140:143], a[76:79], v[36:39]
    v_cvt_pk_bf16_f32 v53, v42, v43
    s_waitcnt lgkmcnt(0)
    s_barrier
    v_mfma_f32_16x16x32_bf16 v[192:195], a[176:179], v[48:51], v[192:195]
    v_exp_f32 v44, v44
    v_mfma_f32_16x16x32_bf16 v[196:199], a[180:183], v[48:51], v[196:199]
    ds_read_b128 a[144:147], v6
    ds_read_b128 a[160:163], v6 offset:4096
    v_mfma_f32_16x16x32_bf16 v[200:203], a[184:187], v[48:51], v[200:203]
    v_exp_f32 v45, v45
    v_mfma_f32_16x16x32_bf16 v[204:207], a[188:191], v[48:51], v[204:207]
    v_cvt_pk_bf16_f32 v54, v44, v45
    ds_read_b128 a[148:151], v7
    v_mfma_f32_16x16x32_bf16 v[208:211], a[192:195], v[48:51], v[208:211]
    v_exp_f32 v46, v46
    v_mfma_f32_16x16x32_bf16 v[212:215], a[196:199], v[48:51], v[212:215]
    ds_read_b128 a[164:167], v7 offset:4096
    ds_read_b128 a[152:155], v8
    v_mfma_f32_16x16x32_bf16 v[216:219], a[200:203], v[48:51], v[216:219]
    v_exp_f32 v47, v47
    v_mfma_f32_16x16x32_bf16 v[220:223], a[204:207], v[48:51], v[220:223]
    v_cvt_pk_bf16_f32 v55, v46, v47
    ds_read_b128 a[168:171], v8 offset:4096
    v_mfma_f32_16x16x32_bf16 a[100:103], a[108:111], v[48:51], a[100:103]
    ds_read_b128 a[156:159], v9
    ds_read_b128 a[172:175], v9 offset:4096
    v_mfma_f32_16x16x32_bf16 v[40:43], a[112:115], a[80:83], v[76:79]
    v_exp_f32 v32, v32
    v_mfma_f32_16x16x32_bf16 v[44:47], a[128:131], a[80:83], v[76:79]
    ds_read_b64_tr_b16 a[176:177], v10
    ds_read_b64_tr_b16 a[178:179], v10 offset:4096
    v_mfma_f32_16x16x32_bf16 v[40:43], a[116:119], a[84:87], v[40:43]
    v_exp_f32 v33, v33
    v_mfma_f32_16x16x32_bf16 v[44:47], a[132:135], a[84:87], v[44:47]
    v_cvt_pk_bf16_f32 v48, v32, v33
    ds_read_b64_tr_b16 a[180:181], v11
    v_mfma_f32_16x16x32_bf16 v[40:43], a[120:123], a[88:91], v[40:43]
    v_exp_f32 v34, v34
    v_mfma_f32_16x16x32_bf16 v[44:47], a[136:139], a[88:91], v[44:47]
    ds_read_b64_tr_b16 a[182:183], v11 offset:4096
    ds_read_b64_tr_b16 a[184:185], v12
    v_mfma_f32_16x16x32_bf16 v[40:43], a[124:127], a[92:95], v[40:43]
    v_exp_f32 v35, v35
    v_mfma_f32_16x16x32_bf16 v[44:47], a[140:143], a[92:95], v[44:47]
    v_cvt_pk_bf16_f32 v49, v34, v35
    ds_read_b64_tr_b16 a[186:187], v12 offset:4096
    v_mfma_f32_16x16x32_bf16 v[160:163], a[208:211], v[52:55], v[160:163]
    v_exp_f32 v36, v36
    v_mfma_f32_16x16x32_bf16 v[164:167], a[212:215], v[52:55], v[164:167]
    ds_read_b64_tr_b16 a[188:189], v13
    ds_read_b64_tr_b16 a[190:191], v13 offset:4096
    v_mfma_f32_16x16x32_bf16 v[168:171], a[216:219], v[52:55], v[168:171]
    v_exp_f32 v37, v37
    v_mfma_f32_16x16x32_bf16 v[172:175], a[220:223], v[52:55], v[172:175]
    v_cvt_pk_bf16_f32 v50, v36, v37
    ds_read_b64_tr_b16 a[192:193], v14
    v_mfma_f32_16x16x32_bf16 v[176:179], a[224:227], v[52:55], v[176:179]
    v_exp_f32 v38, v38
    v_mfma_f32_16x16x32_bf16 v[180:183], a[228:231], v[52:55], v[180:183]
    ds_read_b64_tr_b16 a[194:195], v14 offset:4096
    ds_read_b64_tr_b16 a[196:197], v15
    v_mfma_f32_16x16x32_bf16 v[184:187], a[232:235], v[52:55], v[184:187]
    v_exp_f32 v39, v39
    v_mfma_f32_16x16x32_bf16 v[188:191], a[236:239], v[52:55], v[188:191]
    v_cvt_pk_bf16_f32 v51, v38, v39
    ds_read_b64_tr_b16 a[198:199], v15 offset:4096
    v_mfma_f32_16x16x32_bf16 a[96:99], a[108:111], v[52:55], a[96:99]
    ds_read_b64_tr_b16 a[200:201], v16
    ds_read_b64_tr_b16 a[202:203], v16 offset:4096
    s_waitcnt lgkmcnt(14)
    v_mfma_f32_16x16x32_bf16 v[32:35], a[144:147], a[48:51], v[68:71]
    v_exp_f32 v40, v40
    v_mfma_f32_16x16x32_bf16 v[36:39], a[160:163], a[48:51], v[68:71]
    ds_read_b64_tr_b16 a[204:205], v17
    ds_read_b64_tr_b16 a[206:207], v17 offset:4096
    v_mfma_f32_16x16x32_bf16 v[32:35], a[148:151], a[52:55], v[32:35]
    v_exp_f32 v41, v41
    v_mfma_f32_16x16x32_bf16 v[36:39], a[164:167], a[52:55], v[36:39]
    v_cvt_pk_bf16_f32 v52, v40, v41
    v_mfma_f32_16x16x32_bf16 v[32:35], a[152:155], a[56:59], v[32:35]
    v_exp_f32 v42, v42
    v_mfma_f32_16x16x32_bf16 v[36:39], a[168:171], a[56:59], v[36:39]
    v_mfma_f32_16x16x32_bf16 v[32:35], a[156:159], a[60:63], v[32:35]
    v_exp_f32 v43, v43
    v_mfma_f32_16x16x32_bf16 v[36:39], a[172:175], a[60:63], v[36:39]
    v_cvt_pk_bf16_f32 v53, v42, v43
    v_mfma_f32_16x16x32_bf16 v[192:195], a[208:211], v[48:51], v[192:195]
    v_exp_f32 v44, v44
    v_mfma_f32_16x16x32_bf16 v[196:199], a[212:215], v[48:51], v[196:199]
    v_mfma_f32_16x16x32_bf16 v[200:203], a[216:219], v[48:51], v[200:203]
    v_exp_f32 v45, v45
    v_mfma_f32_16x16x32_bf16 v[204:207], a[220:223], v[48:51], v[204:207]
    v_cvt_pk_bf16_f32 v54, v44, v45
    v_mfma_f32_16x16x32_bf16 v[208:211], a[224:227], v[48:51], v[208:211]
    v_exp_f32 v46, v46
    v_mfma_f32_16x16x32_bf16 v[212:215], a[228:231], v[48:51], v[212:215]
    v_mfma_f32_16x16x32_bf16 v[216:219], a[232:235], v[48:51], v[216:219]
    v_exp_f32 v47, v47
    v_mfma_f32_16x16x32_bf16 v[220:223], a[236:239], v[48:51], v[220:223]
    v_cvt_pk_bf16_f32 v55, v46, v47
    v_mfma_f32_16x16x32_bf16 a[100:103], a[108:111], v[48:51], a[100:103]
    s_sub_u32 s54, s54, 1
    s_cmp_lg_u32 s54, 0
    s_cbranch_scc1 L_loop_C11
    s_waitcnt lgkmcnt(0)
    s_barrier
    v_and_b32 v5, 3, v1
    v_lshlrev_b32 v5, 3, v5
    buffer_load_dwordx2 v[108:109], v5, s[20:23], s84 offen sc1
    v_mfma_f32_16x16x32_bf16 v[40:43], a[144:147], a[64:67], v[72:75]
    v_exp_f32 v32, v32
    v_mfma_f32_16x16x32_bf16 v[44:47], a[160:163], a[64:67], v[72:75]
    ds_read_b128 a[112:115], v6 offset:16384
    ds_read_b128 a[128:131], v6 offset:20480
    v_mfma_f32_16x16x32_bf16 v[40:43], a[148:151], a[68:71], v[40:43]
    v_exp_f32 v33, v33
    v_mfma_f32_16x16x32_bf16 v[44:47], a[164:167], a[68:71], v[44:47]
    v_cvt_pk_bf16_f32 v48, v32, v33
    ds_read_b128 a[116:119], v7 offset:16384
    v_mfma_f32_16x16x32_bf16 v[40:43], a[152:155], a[72:75], v[40:43]
    v_exp_f32 v34, v34
    v_mfma_f32_16x16x32_bf16 v[44:47], a[168:171], a[72:75], v[44:47]
    ds_read_b128 a[132:135], v7 offset:20480
    ds_read_b128 a[120:123], v8 offset:16384
    v_mfma_f32_16x16x32_bf16 v[40:43], a[156:159], a[76:79], v[40:43]
    v_exp_f32 v35, v35
    v_mfma_f32_16x16x32_bf16 v[44:47], a[172:175], a[76:79], v[44:47]
    v_cvt_pk_bf16_f32 v49, v34, v35
    ds_read_b128 a[136:139], v8 offset:20480
    v_mfma_f32_16x16x32_bf16 v[224:227], a[208:211], v[52:55], v[224:227]
    v_exp_f32 v36, v36
    v_mfma_f32_16x16x32_bf16 v[228:231], a[212:215], v[52:55], v[228:231]
    ds_read_b128 a[124:127], v9 offset:16384
    ds_read_b128 a[140:143], v9 offset:20480
    v_mfma_f32_16x16x32_bf16 v[232:235], a[216:219], v[52:55], v[232:235]
    v_exp_f32 v37, v37
    v_mfma_f32_16x16x32_bf16 v[236:239], a[220:223], v[52:55], v[236:239]
    v_cvt_pk_bf16_f32 v50, v36, v37
    ds_read_b64_tr_b16 a[208:209], v10 offset:16384
    v_mfma_f32_16x16x32_bf16 v[240:243], a[224:227], v[52:55], v[240:243]
    v_exp_f32 v38, v38
    v_mfma_f32_16x16x32_bf16 v[244:247], a[228:231], v[52:55], v[244:247]
    ds_read_b64_tr_b16 a[210:211], v10 offset:20480
    ds_read_b64_tr_b16 a[212:213], v11 offset:16384
    v_mfma_f32_16x16x32_bf16 v[248:251], a[232:235], v[52:55], v[248:251]
    v_exp_f32 v39, v39
    v_mfma_f32_16x16x32_bf16 v[252:255], a[236:239], v[52:55], v[252:255]
    v_cvt_pk_bf16_f32 v51, v38, v39
    ds_read_b64_tr_b16 a[214:215], v11 offset:20480
    v_mfma_f32_16x16x32_bf16 a[104:107], a[108:111], v[52:55], a[104:107]
    ds_read_b64_tr_b16 a[216:217], v12 offset:16384
    ds_read_b64_tr_b16 a[218:219], v12 offset:20480
    s_waitcnt lgkmcnt(6)
    v_mfma_f32_16x16x32_bf16 v[32:35], a[112:115], a[48:51], v[68:71]
    v_exp_f32 v40, v40
    v_mfma_f32_16x16x32_bf16 v[36:39], a[128:131], a[48:51], v[68:71]
    ds_read_b64_tr_b16 a[220:221], v13 offset:16384
    ds_read_b64_tr_b16 a[222:223], v13 offset:20480
    v_mfma_f32_16x16x32_bf16 v[32:35], a[116:119], a[52:55], v[32:35]
    v_exp_f32 v41, v41
    v_mfma_f32_16x16x32_bf16 v[36:39], a[132:135], a[52:55], v[36:39]
    v_cvt_pk_bf16_f32 v52, v40, v41
    ds_read_b64_tr_b16 a[224:225], v14 offset:16384
    v_mfma_f32_16x16x32_bf16 v[32:35], a[120:123], a[56:59], v[32:35]
    v_exp_f32 v42, v42
    v_mfma_f32_16x16x32_bf16 v[36:39], a[136:139], a[56:59], v[36:39]
    ds_read_b64_tr_b16 a[226:227], v14 offset:20480
    ds_read_b64_tr_b16 a[228:229], v15 offset:16384
    v_mfma_f32_16x16x32_bf16 v[32:35], a[124:127], a[60:63], v[32:35]
    v_exp_f32 v43, v43
    v_mfma_f32_16x16x32_bf16 v[36:39], a[140:143], a[60:63], v[36:39]
    v_cvt_pk_bf16_f32 v53, v42, v43
    ds_read_b64_tr_b16 a[230:231], v15 offset:20480
    v_mfma_f32_16x16x32_bf16 v[160:163], a[176:179], v[48:51], v[160:163]
    v_exp_f32 v44, v44
    v_mfma_f32_16x16x32_bf16 v[164:167], a[180:183], v[48:51], v[164:167]
    ds_read_b64_tr_b16 a[232:233], v16 offset:16384
    ds_read_b64_tr_b16 a[234:235], v16 offset:20480
    v_mfma_f32_16x16x32_bf16 v[168:171], a[184:187], v[48:51], v[168:171]
    v_exp_f32 v45, v45
    v_mfma_f32_16x16x32_bf16 v[172:175], a[188:191], v[48:51], v[172:175]
    v_cvt_pk_bf16_f32 v54, v44, v45
    ds_read_b64_tr_b16 a[236:237], v17 offset:16384
    v_mfma_f32_16x16x32_bf16 v[176:179], a[192:195], v[48:51], v[176:179]
    v_exp_f32 v46, v46
    v_mfma_f32_16x16x32_bf16 v[180:183], a[196:199], v[48:51], v[180:183]
    ds_read_b64_tr_b16 a[238:239], v17 offset:20480
    v_mfma_f32_16x16x32_bf16 v[184:187], a[200:203], v[48:51], v[184:187]
    v_exp_f32 v47, v47
    v_mfma_f32_16x16x32_bf16 v[188:191], a[204:207], v[48:51], v[188:191]
    v_cvt_pk_bf16_f32 v55, v46, v47
    v_mfma_f32_16x16x32_bf16 a[96:99], a[108:111], v[48:51], a[96:99]
    v_mfma_f32_16x16x32_bf16 v[40:43], a[112:115], a[64:67], v[72:75]
    v_exp_f32 v32, v32
    v_mfma_f32_16x16x32_bf16 v[44:47], a[128:131], a[64:67], v[72:75]
    v_mfma_f32_16x16x32_bf16 v[40:43], a[116:119], a[68:71], v[40:43]
    v_exp_f32 v33, v33
    v_mfma_f32_16x16x32_bf16 v[44:47], a[132:135], a[68:71], v[44:47]
    v_cvt_pk_bf16_f32 v48, v32, v33
    v_mfma_f32_16x16x32_bf16 v[40:43], a[120:123], a[72:75], v[40:43]
    v_exp_f32 v34, v34
    v_mfma_f32_16x16x32_bf16 v[44:47], a[136:139], a[72:75], v[44:47]
    v_mfma_f32_16x16x32_bf16 v[40:43], a[124:127], a[76:79], v[40:43]
    v_exp_f32 v35, v35
    v_mfma_f32_16x16x32_bf16 v[44:47], a[140:143], a[76:79], v[44:47]
    v_cvt_pk_bf16_f32 v49, v34, v35
    s_waitcnt lgkmcnt(0)
    s_barrier
    v_mfma_f32_16x16x32_bf16 v[192:195], a[176:179], v[52:55], v[192:195]
    v_exp_f32 v36, v36
    v_mfma_f32_16x16x32_bf16 v[196:199], a[180:183], v[52:55], v[196:199]
    ds_read_b128 a[144:147], v6 offset:32768
    ds_read_b128 a[160:163], v6 offset:36864
    v_mfma_f32_16x16x32_bf16 v[200:203], a[184:187], v[52:55], v[200:203]
    v_exp_f32 v37, v37
    v_mfma_f32_16x16x32_bf16 v[204:207], a[188:191], v[52:55], v[204:207]
    v_cvt_pk_bf16_f32 v50, v36, v37
    ds_read_b128 a[148:151], v7 offset:32768
    v_mfma_f32_16x16x32_bf16 v[208:211], a[192:195], v[52:55], v[208:211]
    v_exp_f32 v38, v38
    v_mfma_f32_16x16x32_bf16 v[212:215], a[196:199], v[52:55], v[212:215]
    ds_read_b128 a[164:167], v7 offset:36864
    ds_read_b128 a[152:155], v8 offset:32768
    v_mfma_f32_16x16x32_bf16 v[216:219], a[200:203], v[52:55], v[216:219]
    v_exp_f32 v39, v39
    v_mfma_f32_16x16x32_bf16 v[220:223], a[204:207], v[52:55], v[220:223]
    v_cvt_pk_bf16_f32 v51, v38, v39
    ds_read_b128 a[168:171], v8 offset:36864
    v_mfma_f32_16x16x32_bf16 a[100:103], a[108:111], v[52:55], a[100:103]
    ds_read_b128 a[156:159], v9 offset:32768
    ds_read_b128 a[172:175], v9 offset:36864
    v_mfma_f32_16x16x32_bf16 v[32:35], a[112:115], a[80:83], v[76:79]
    v_exp_f32 v40, v40
    v_mfma_f32_16x16x32_bf16 v[36:39], a[128:131], a[80:83], v[76:79]
    ds_read_b64_tr_b16 a[176:177], v10 offset:32768
    ds_read_b64_tr_b16 a[178:179], v10 offset:36864
    v_mfma_f32_16x16x32_bf16 v[32:35], a[116:119], a[84:87], v[32:35]
    v_exp_f32 v41, v41
    v_mfma_f32_16x16x32_bf16 v[36:39], a[132:135], a[84:87], v[36:39]
    v_cvt_pk_bf16_f32 v52, v40, v41
    ds_read_b64_tr_b16 a[180:181], v11 offset:32768
    v_mfma_f32_16x16x32_bf16 v[32:35], a[120:123], a[88:91], v[32:35]
    v_exp_f32 v42, v42
    v_mfma_f32_16x16x32_bf16 v[36:39], a[136:139], a[88:91], v[36:39]
    ds_read_b64_tr_b16 a[182:183], v11 offset:36864
    ds_read_b64_tr_b16 a[184:185], v12 offset:32768
    v_mfma_f32_16x16x32_bf16 v[32:35], a[124:127], a[92:95], v[32:35]
    v_exp_f32 v43, v43
    v_mfma_f32_16x16x32_bf16 v[36:39], a[140:143], a[92:95], v[36:39]
    v_cvt_pk_bf16_f32 v53, v42, v43
    ds_read_b64_tr_b16 a[186:187], v12 offset:36864
    v_mfma_f32_16x16x32_bf16 v[160:163], a[208:211], v[48:51], v[160:163]
    v_exp_f32 v44, v44
    v_mfma_f32_16x16x32_bf16 v[164:167], a[212:215], v[48:51], v[164:167]
    ds_read_b64_tr_b16 a[188:189], v13 offset:32768
    ds_read_b64_tr_b16 a[190:191], v13 offset:36864
    v_mfma_f32_16x16x32_bf16 v[168:171], a[216:219], v[48:51], v[168:171]
    v_exp_f32 v45, v45
    v_mfma_f32_16x16x32_bf16 v[172:175], a[220:223], v[48:51], v[172:175]
    v_cvt_pk_bf16_f32 v54, v44, v45
    ds_read_b64_tr_b16 a[192:193], v14 offset:32768
    v_mfma_f32_16x16x32_bf16 v[176:179], a[224:227], v[48:51], v[176:179]
    v_exp_f32 v46, v46
    v_mfma_f32_16x16x32_bf16 v[180:183], a[228:231], v[48:51], v[180:183]
    ds_read_b64_tr_b16 a[194:195], v14 offset:36864
    ds_read_b64_tr_b16 a[196:197], v15 offset:32768
    v_mfma_f32_16x16x32_bf16 v[184:187], a[232:235], v[48:51], v[184:187]
    v_exp_f32 v47, v47
    v_mfma_f32_16x16x32_bf16 v[188:191], a[236:239], v[48:51], v[188:191]
    v_cvt_pk_bf16_f32 v55, v46, v47
    ds_read_b64_tr_b16 a[198:199], v15 offset:36864
    v_mfma_f32_16x16x32_bf16 a[96:99], a[108:111], v[48:51], a[96:99]
    ds_read_b64_tr_b16 a[200:201], v16 offset:32768
    ds_read_b64_tr_b16 a[202:203], v16 offset:36864
    s_waitcnt lgkmcnt(14)
    v_mfma_f32_16x16x32_bf16 v[40:43], a[144:147], a[48:51], v[68:71]
    v_exp_f32 v32, v32
    v_mfma_f32_16x16x32_bf16 v[44:47], a[160:163], a[48:51], v[68:71]
    ds_read_b64_tr_b16 a[204:205], v17 offset:32768
    ds_read_b64_tr_b16 a[206:207], v17 offset:36864
    v_mfma_f32_16x16x32_bf16 v[40:43], a[148:151], a[52:55], v[40:43]
    v_exp_f32 v33, v33
    v_mfma_f32_16x16x32_bf16 v[44:47], a[164:167], a[52:55], v[44:47]
    v_cvt_pk_bf16_f32 v48, v32, v33
    v_mfma_f32_16x16x32_bf16 v[40:43], a[152:155], a[56:59], v[40:43]
    v_exp_f32 v34, v34
    v_mfma_f32_16x16x32_bf16 v[44:47], a[168:171], a[56:59], v[44:47]
    v_mfma_f32_16x16x32_bf16 v[40:43], a[156:159], a[60:63], v[40:43]
    v_exp_f32 v35, v35
    v_mfma_f32_16x16x32_bf16 v[44:47], a[172:175], a[60:63], v[44:47]
    v_cvt_pk_bf16_f32 v49, v34, v35
    v_mfma_f32_16x16x32_bf16 v[192:195], a[208:211], v[52:55], v[192:195]
    v_exp_f32 v36, v36
    v_mfma_f32_16x16x32_bf16 v[196:199], a[212:215], v[52:55], v[196:199]
    v_mfma_f32_16x16x32_bf16 v[200:203], a[216:219], v[52:55], v[200:203]
    v_exp_f32 v37, v37
    v_mfma_f32_16x16x32_bf16 v[204:207], a[220:223], v[52:55], v[204:207]
    v_cvt_pk_bf16_f32 v50, v36, v37
    v_mfma_f32_16x16x32_bf16 v[208:211], a[224:227], v[52:55], v[208:211]
    v_exp_f32 v38, v38
    v_mfma_f32_16x16x32_bf16 v[212:215], a[228:231], v[52:55], v[212:215]
    v_mfma_f32_16x16x32_bf16 v[216:219], a[232:235], v[52:55], v[216:219]
    v_exp_f32 v39, v39
    v_mfma_f32_16x16x32_bf16 v[220:223], a[236:239], v[52:55], v[220:223]
    v_cvt_pk_bf16_f32 v51, v38, v39
    v_mfma_f32_16x16x32_bf16 a[100:103], a[108:111], v[52:55], a[100:103]
    s_waitcnt vmcnt(0)
    v_not_b32 v109, v109
    v_xor_b32 v108, s81, v108
    v_xor_b32 v109, s81, v109
    v_or_b32 v108, v108, v109
    v_cmp_ne_u32 vcc, 0, v108
    s_lshl_b32 s39, 1, s43
    s_xor_b32 s39, s39, 15
    s_and_b32 s39, s39, vcc_lo
    s_cmp_eq_u32 s39, 0
    s_cbranch_scc1 L_poll0x
    s_cmp_lg_u32 s67, 0
    s_cbranch_scc1 L_poll0x
    s_mov_b32 s65, 1048576
L_poll0:
    v_and_b32 v5, 3, v1
    v_lshlrev_b32 v5, 3, v5
    buffer_load_dwordx2 v[108:109], v5, s[20:23], s84 offen sc1
    s_waitcnt vmcnt(0)
    v_not_b32 v109, v109
    v_xor_b32 v108, s81, v108
    v_xor_b32 v109, s81, v109
    v_or_b32 v108, v108, v109
    v_cmp_ne_u32 vcc, 0, v108
    s_lshl_b32 s39, 1, s43
    s_xor_b32 s39, s39, 15
    s_and_b32 s39, s39, vcc_lo
    s_cmp_eq_u32 s39, 0
    s_cbranch_scc1 L_poll0x
    s_sleep 2
    s_sub_u32 s65, s65, 1
    s_cmp_lg_u32 s65, 0
    s_cbranch_scc1 L_poll0
L_poll0x:
    s_waitcnt lgkmcnt(0)
    s_barrier
    v_mfma_f32_16x16x32_bf16 v[32:35], a[144:147], a[64:67], v[72:75]
    v_exp_f32 v40, v40
    v_mfma_f32_16x16x32_bf16 v[36:39], a[160:163], a[64:67], v[72:75]
    ds_read_b128 a[112:115], v6 offset:49152
    ds_read_b128 a[128:131], v6 offset:53248
    v_mfma_f32_16x16x32_bf16 v[32:35], a[148:151], a[68:71], v[32:35]
    v_exp_f32 v41, v41
    v_mfma_f32_16x16x32_bf16 v[36:39], a[164:167], a[68:71], v[36:39]
    v_cvt_pk_bf16_f32 v52, v40, v41
    ds_read_b128 a[116:119], v7 offset:49152
    v_mfma_f32_16x16x32_bf16 v[32:35], a[152:155], a[72:75], v[32:35]
    v_exp_f32 v42, v42
    v_mfma_f32_16x16x32_bf16 v[36:39], a[168:171], a[72:75], v[36:39]
    ds_read_b128 a[132:135], v7 offset:53248
    ds_read_b128 a[120:123], v8 offset:49152
    v_mfma_f32_16x16x32_bf16 v[32:35], a[156:159], a[76:79], v[32:35]
    v_exp_f32 v43, v43
    v_mfma_f32_16x16x32_bf16 v[36:39], a[172:175], a[76:79], v[36:39]
    v_cvt_pk_bf16_f32 v53, v42, v43
    ds_read_b128 a[136:139], v8 offset:53248
    v_mfma_f32_16x16x32_bf16 v[224:227], a[208:211], v[48:51], v[224:227]
    v_exp_f32 v44, v44
    v_mfma_f32_16x16x32_bf16 v[228:231], a[212:215], v[48:51], v[228:231]
    ds_read_b128 a[124:127], v9 offset:49152
    ds_read_b128 a[140:143], v9 offset:53248
    v_mfma_f32_16x16x32_bf16 v[232:235], a[216:219], v[48:51], v[232:235]
    v_exp_f32 v45, v45
    v_mfma_f32_16x16x32_bf16 v[236:239], a[220:223], v[48:51], v[236:239]
    v_cvt_pk_bf16_f32 v54, v44, v45
    ds_read_b64_tr_b16 a[208:209], v10 offset:49152
    v_mfma_f32_16x16x32_bf16 v[240:243], a[224:227], v[48:51], v[240:243]
    v_exp_f32 v46, v46
    v_mfma_f32_16x16x32_bf16 v[244:247], a[228:231], v[48:51], v[244:247]
    ds_read_b64_tr_b16 a[210:211], v10 offset:53248
    ds_read_b64_tr_b16 a[212:213], v11 offset:49152
    v_mfma_f32_16x16x32_bf16 v[248:251], a[232:235], v[48:51], v[248:251]
    v_exp_f32 v47, v47
    v_mfma_f32_16x16x32_bf16 v[252:255], a[236:239], v[48:51], v[252:255]
    v_cvt_pk_bf16_f32 v55, v46, v47
    ds_read_b64_tr_b16 a[214:215], v11 offset:53248
    v_mfma_f32_16x16x32_bf16 a[104:107], a[108:111], v[48:51], a[104:107]
    ds_read_b64_tr_b16 a[216:217], v12 offset:49152
    ds_read_b64_tr_b16 a[218:219], v12 offset:53248
    s_waitcnt lgkmcnt(6)
    v_mfma_f32_16x16x32_bf16 v[40:43], a[112:115], a[48:51], v[68:71]
    v_exp_f32 v32, v32
    v_mfma_f32_16x16x32_bf16 v[44:47], a[128:131], a[48:51], v[68:71]
    ds_read_b64_tr_b16 a[220:221], v13 offset:49152
    ds_read_b64_tr_b16 a[222:223], v13 offset:53248
    v_mfma_f32_16x16x32_bf16 v[40:43], a[116:119], a[52:55], v[40:43]
    v_exp_f32 v33, v33
    v_mfma_f32_16x16x32_bf16 v[44:47], a[132:135], a[52:55], v[44:47]
    v_cvt_pk_bf16_f32 v48, v32, v33
    ds_read_b64_tr_b16 a[224:225], v14 offset:49152
    v_mfma_f32_16x16x32_bf16 v[40:43], a[120:123], a[56:59], v[40:43]
    v_exp_f32 v34, v34
    v_mfma_f32_16x16x32_bf16 v[44:47], a[136:139], a[56:59], v[44:47]
    ds_read_b64_tr_b16 a[226:227], v14 offset:53248
    ds_read_b64_tr_b16 a[228:229], v15 offset:49152
    v_mfma_f32_16x16x32_bf16 v[40:43], a[124:127], a[60:63], v[40:43]
    v_exp_f32 v35, v35
    v_mfma_f32_16x16x32_bf16 v[44:47], a[140:143], a[60:63], v[44:47]
    v_cvt_pk_bf16_f32 v49, v34, v35
    ds_read_b64_tr_b16 a[230:231], v15 offset:53248
    v_mfma_f32_16x16x32_bf16 v[160:163], a[176:179], v[52:55], v[160:163]
    v_exp_f32 v36, v36
    v_mfma_f32_16x16x32_bf16 v[164:167], a[180:183], v[52:55], v[164:167]
    ds_read_b64_tr_b16 a[232:233], v16 offset:49152
    ds_read_b64_tr_b16 a[234:235], v16 offset:53248
    v_mfma_f32_16x16x32_bf16 v[168:171], a[184:187], v[52:55], v[168:171]
    v_exp_f32 v37, v37
    v_mfma_f32_16x16x32_bf16 v[172:175], a[188:191], v[52:55], v[172:175]
    v_cvt_pk_bf16_f32 v50, v36, v37
    ds_read_b64_tr_b16 a[236:237], v17 offset:49152
    v_mfma_f32_16x16x32_bf16 v[176:179], a[192:195], v[52:55], v[176:179]
    v_exp_f32 v38, v38
    v_mfma_f32_16x16x32_bf16 v[180:183], a[196:199], v[52:55], v[180:183]
    ds_read_b64_tr_b16 a[238:239], v17 offset:53248
    v_mfma_f32_16x16x32_bf16 v[184:187], a[200:203], v[52:55], v[184:187]
    v_exp_f32 v39, v39
    v_mfma_f32_16x16x32_bf16 v[188:191], a[204:207], v[52:55], v[188:191]
    v_cvt_pk_bf16_f32 v51, v38, v39
    v_mfma_f32_16x16x32_bf16 a[96:99], a[108:111], v[52:55], a[96:99]
    v_mfma_f32_16x16x32_bf16 v[32:35], a[112:115], a[64:67], v[72:75]
    v_exp_f32 v40, v40
    v_mfma_f32_16x16x32_bf16 v[36:39], a[128:131], a[64:67], v[72:75]
    v_mfma_f32_16x16x32_bf16 v[32:35], a[116:119], a[68:71], v[32:35]
    v_exp_f32 v41, v41
    v_mfma_f32_16x16x32_bf16 v[36:39], a[132:135], a[68:71], v[36:39]
    v_cvt_pk_bf16_f32 v52, v40, v41
    v_mfma_f32_16x16x32_bf16 v[32:35], a[120:123], a[72:75], v[32:35]
    v_exp_f32 v42, v42
    v_mfma_f32_16x16x32_bf16 v[36:39], a[136:139], a[72:75], v[36:39]
    v_mfma_f32_16x16x32_bf16 v[32:35], a[124:127], a[76:79], v[32:35]
    v_exp_f32 v43, v43
    v_mfma_f32_16x16x32_bf16 v[36:39], a[140:143], a[76:79], v[36:39]
    v_cvt_pk_bf16_f32 v53, v42, v43
    s_waitcnt lgkmcnt(0)
    s_barrier
    v_mfma_f32_16x16x32_bf16 v[192:195], a[176:179], v[48:51], v[192:195]
    v_exp_f32 v44, v44
    v_mfma_f32_16x16x32_bf16 v[196:199], a[180:183], v[48:51], v[196:199]
    s_lshl_b32 s76, s44, 5
    s_add_u32 s76, s76, s38
    v_mfma_f32_16x16x32_bf16 v[200:203], a[184:187], v[48:51], v[200:203]
    v_exp_f32 v45, v45
    v_mfma_f32_16x16x32_bf16 v[204:207], a[188:191], v[48:51], v[204:207]
    v_cvt_pk_bf16_f32 v54, v44, v45
    s_lshl_b32 s76, s76, 15
    v_mfma_f32_16x16x32_bf16 v[208:211], a[192:195], v[48:51], v[208:211]
    v_exp_f32 v46, v46
    v_mfma_f32_16x16x32_bf16 v[212:215], a[196:199], v[48:51], v[212:215]
    v_lshlrev_b32 v5, 7, v1
    buffer_load_dword v107, v5, s[24:27], s76 offen
    v_mfma_f32_16x16x32_bf16 v[216:219], a[200:203], v[48:51], v[216:219]
    v_exp_f32 v47, v47
    v_mfma_f32_16x16x32_bf16 v[220:223], a[204:207], v[48:51], v[220:223]
    v_cvt_pk_bf16_f32 v55, v46, v47
    s_add_u32 s76, s76, 8192
    v_mfma_f32_16x16x32_bf16 a[100:103], a[108:111], v[48:51], a[100:103]
    buffer_load_dword v107, v5, s[24:27], s76 offen
    s_add_u32 s76, s76, 8192
    v_mfma_f32_16x16x32_bf16 v[40:43], a[112:115], a[80:83], v[76:79]
    v_exp_f32 v32, v32
    v_mfma_f32_16x16x32_bf16 v[44:47], a[128:131], a[80:83], v[76:79]
    buffer_load_dword v107, v5, s[24:27], s76 offen
    s_add_u32 s76, s76, 8192
    v_mfma_f32_16x16x32_bf16 v[40:43], a[116:119], a[84:87], v[40:43]
    v_exp_f32 v33, v33
    v_mfma_f32_16x16x32_bf16 v[44:47], a[132:135], a[84:87], v[44:47]
    v_cvt_pk_bf16_f32 v48, v32, v33
    buffer_load_dword v107, v5, s[24:27], s76 offen
    v_mfma_f32_16x16x32_bf16 v[40:43], a[120:123], a[88:91], v[40:43]
    v_exp_f32 v34, v34
    v_mfma_f32_16x16x32_bf16 v[44:47], a[136:139], a[88:91], v[44:47]
    s_sub_u32 s76, s58, s66
    v_lshlrev_b32 v5, 7, v1
    v_mfma_f32_16x16x32_bf16 v[40:43], a[124:127], a[92:95], v[40:43]
    v_exp_f32 v35, v35
    v_mfma_f32_16x16x32_bf16 v[44:47], a[140:143], a[92:95], v[44:47]
    v_cvt_pk_bf16_f32 v49, v34, v35
    v_mfma_f32_16x16x32_bf16 v[160:163], a[208:211], v[52:55], v[160:163]
    v_exp_f32 v36, v36
    v_mfma_f32_16x16x32_bf16 v[164:167], a[212:215], v[52:55], v[164:167]
    v_mfma_f32_16x16x32_bf16 v[168:171], a[216:219], v[52:55], v[168:171]
    v_exp_f32 v37, v37
    v_mfma_f32_16x16x32_bf16 v[172:175], a[220:223], v[52:55], v[172:175]
    v_cvt_pk_bf16_f32 v50, v36, v37
    v_mfma_f32_16x16x32_bf16 v[176:179], a[224:227], v[52:55], v[176:179]
    v_exp_f32 v38, v38
    v_mfma_f32_16x16x32_bf16 v[180:183], a[228:231], v[52:55], v[180:183]
    v_mfma_f32_16x16x32_bf16 v[184:187], a[232:235], v[52:55], v[184:187]
    v_exp_f32 v39, v39
    v_mfma_f32_16x16x32_bf16 v[188:191], a[236:239], v[52:55], v[188:191]
    v_cvt_pk_bf16_f32 v51, v38, v39
    v_mfma_f32_16x16x32_bf16 a[96:99], a[108:111], v[52:55], a[96:99]
    v_exp_f32 v40, v40
    v_exp_f32 v41, v41
    s_nop 0
    v_cvt_pk_bf16_f32 v52, v40, v41
    v_exp_f32 v42, v42
    v_exp_f32 v43, v43
    s_nop 0
    v_cvt_pk_bf16_f32 v53, v42, v43
    v_mfma_f32_16x16x32_bf16 v[192:195], a[208:211], v[48:51], v[192:195]
    v_exp_f32 v44, v44
    v_mfma_f32_16x16x32_bf16 v[196:199], a[212:215], v[48:51], v[196:199]
    v_mfma_f32_16x16x32_bf16 v[200:203], a[216:219], v[48:51], v[200:203]
    v_exp_f32 v45, v45
    v_mfma_f32_16x16x32_bf16 v[204:207], a[220:223], v[48:51], v[204:207]
    v_cvt_pk_bf16_f32 v54, v44, v45
    v_mfma_f32_16x16x32_bf16 v[208:211], a[224:227], v[48:51], v[208:211]
    v_exp_f32 v46, v46
    v_mfma_f32_16x16x32_bf16 v[212:215], a[228:231], v[48:51], v[212:215]
    v_mfma_f32_16x16x32_bf16 v[216:219], a[232:235], v[48:51], v[216:219]
    v_exp_f32 v47, v47
    v_mfma_f32_16x16x32_bf16 v[220:223], a[236:239], v[48:51], v[220:223]
    v_cvt_pk_bf16_f32 v55, v46, v47
    v_mfma_f32_16x16x32_bf16 a[100:103], a[108:111], v[48:51], a[100:103]
    s_barrier
    ds_read_b32 v144, v106 offset:8192
    ds_read_b128 v[112:115], v106
    ds_read_b128 v[116:119], v106 offset:1024
    ds_read_b128 v[120:123], v106 offset:2048
    ds_read_b128 v[124:127], v106 offset:3072
    ds_read_b128 v[128:131], v106 offset:4096
    ds_read_b128 v[132:135], v106 offset:5120
    ds_read_b128 v[136:139], v106 offset:6144
    ds_read_b128 v[140:143], v106 offset:7168
    v_mfma_f32_16x16x32_bf16 v[224:227], a[208:211], v[52:55], v[224:227]
    v_mfma_f32_16x16x32_bf16 v[228:231], a[212:215], v[52:55], v[228:231]
    v_mfma_f32_16x16x32_bf16 v[232:235], a[216:219], v[52:55], v[232:235]
    v_mfma_f32_16x16x32_bf16 v[236:239], a[220:223], v[52:55], v[236:239]
    v_mfma_f32_16x16x32_bf16 v[240:243], a[224:227], v[52:55], v[240:243]
    v_mfma_f32_16x16x32_bf16 v[244:247], a[228:231], v[52:55], v[244:247]
    v_mfma_f32_16x16x32_bf16 v[248:251], a[232:235], v[52:55], v[248:251]
    v_mfma_f32_16x16x32_bf16 v[252:255], a[236:239], v[52:55], v[252:255]
    v_mfma_f32_16x16x32_bf16 a[104:107], a[108:111], v[52:55], a[104:107]
    s_mov_b32 s39, 0x53800000
    s_mov_b64 s[70:71], 0
    v_accvgpr_read_b32 v32, a96
    v_accvgpr_read_b32 v34, a100
    s_nop 3
    v_accvgpr_read_b32 v36, a104
    s_waitcnt lgkmcnt(0)
    v_add_f32 v36, v36, v144
    v_cmp_nge_f32 s[72:73], s39, v32
    v_cmp_nle_f32 vcc, 0.5, v32
    s_or_b64 s[70:71], s[70:71], s[72:73]
    s_or_b64 s[70:71], s[70:71], vcc
    v_cmp_nge_f32 s[72:73], s39, v34
    v_cmp_nle_f32 vcc, 0.5, v34
    s_or_b64 s[70:71], s[70:71], s[72:73]
    s_or_b64 s[70:71], s[70:71], vcc
    v_cmp_nge_f32 s[72:73], s39, v36
    v_cmp_nle_f32 vcc, 0.5, v36
    s_or_b64 s[70:71], s[70:71], s[72:73]
    s_or_b64 s[70:71], s[70:71], vcc
    v_rcp_f32 v32, v32
    v_rcp_f32 v34, v34
    v_rcp_f32 v36, v36
    s_or_b32 s39, s70, s71
    v_mov_b32 v3, s39
    ds_write_b32 v104, v3 offset:16
    v_mov_b32 v33, v32
    v_mov_b32 v35, v34
    v_mov_b32 v37, v36
    v_pk_add_f32 v[224:225], v[224:225], v[112:113]
    v_pk_add_f32 v[226:227], v[226:227], v[114:115]
    v_pk_add_f32 v[228:229], v[228:229], v[116:117]
    v_pk_add_f32 v[230:231], v[230:231], v[118:119]
    v_pk_add_f32 v[232:233], v[232:233], v[120:121]
    v_pk_add_f32 v[234:235], v[234:235], v[122:123]
    v_pk_add_f32 v[236:237], v[236:237], v[124:125]
    v_pk_add_f32 v[238:239], v[238:239], v[126:127]
    v_pk_add_f32 v[240:241], v[240:241], v[128:129]
    v_pk_add_f32 v[242:243], v[242:243], v[130:131]
    v_pk_add_f32 v[244:245], v[244:245], v[132:133]
    v_pk_add_f32 v[246:247], v[246:247], v[134:135]
    v_pk_add_f32 v[248:249], v[248:249], v[136:137]
    v_pk_add_f32 v[250:251], v[250:251], v[138:139]
    v_pk_add_f32 v[252:253], v[252:253], v[140:141]
    v_pk_add_f32 v[254:255], v[254:255], v[142:143]
    ds_read_b64_tr_b16 a[184:185], v99
    ds_read_b64_tr_b16 a[186:187], v99 offset:4096
    ds_read_b64_tr_b16 a[188:189], v99 offset:8
    ds_read_b64_tr_b16 a[190:191], v99 offset:4104
    v_pk_mul_f32 v[248:249], v[248:249], v[36:37]
    v_pk_mul_f32 v[250:251], v[250:251], v[36:37]
    v_pk_mul_f32 v[252:253], v[252:253], v[36:37]
    v_pk_mul_f32 v[254:255], v[254:255], v[36:37]
    v_cvt_pk_bf16_f32 v255, v254, v255
    v_cvt_pk_bf16_f32 v254, v252, v253
    v_cvt_pk_bf16_f32 v253, v250, v251
    v_cvt_pk_bf16_f32 v252, v248, v249
    s_add_u32 s39, s78, 22528
    buffer_store_dwordx4 v[252:255], v2, s[20:23], s39 offen offset:1024 sc1
    ds_read_b64_tr_b16 a[192:193], v99 offset:8192
    ds_read_b64_tr_b16 a[194:195], v99 offset:12288
    ds_read_b64_tr_b16 a[196:197], v99 offset:8200
    ds_read_b64_tr_b16 a[198:199], v99 offset:12296
    v_pk_mul_f32 v[240:241], v[240:241], v[36:37]
    v_pk_mul_f32 v[242:243], v[242:243], v[36:37]
    v_pk_mul_f32 v[244:245], v[244:245], v[36:37]
    v_pk_mul_f32 v[246:247], v[246:247], v[36:37]
    v_cvt_pk_bf16_f32 v251, v246, v247
    v_cvt_pk_bf16_f32 v250, v244, v245
    v_cvt_pk_bf16_f32 v249, v242, v243
    v_cvt_pk_bf16_f32 v248, v240, v241
    buffer_store_dwordx4 v[248:251], v2, s[20:23], s39 offen sc1
    ds_read_b128 a[112:115], v101
    ds_read_b128 a[116:119], v101 offset:1024
    ds_read_b128 a[120:123], v101 offset:2048
    ds_read_b128 a[124:127], v101 offset:3072
    v_pk_mul_f32 v[232:233], v[232:233], v[36:37]
    v_pk_mul_f32 v[234:235], v[234:235], v[36:37]
    v_pk_mul_f32 v[236:237], v[236:237], v[36:37]
    v_pk_mul_f32 v[238:239], v[238:239], v[36:37]
    v_cvt_pk_bf16_f32 v247, v238, v239
    v_cvt_pk_bf16_f32 v246, v236, v237
    v_cvt_pk_bf16_f32 v245, v234, v235
    v_cvt_pk_bf16_f32 v244, v232, v233
    s_add_u32 s39, s78, 4096
    buffer_store_dwordx4 v[244:247], v2, s[20:23], s39 offen offset:1024 sc1
    ds_read_b128 a[128:131], v101 offset:4096
    ds_read_b128 a[132:135], v101 offset:5120
    ds_read_b128 a[136:139], v101 offset:6144
    ds_read_b128 a[140:143], v101 offset:7168
    v_pk_mul_f32 v[224:225], v[224:225], v[36:37]
    v_pk_mul_f32 v[226:227], v[226:227], v[36:37]
    v_pk_mul_f32 v[228:229], v[228:229], v[36:37]
    v_pk_mul_f32 v[230:231], v[230:231], v[36:37]
    v_cvt_pk_bf16_f32 v243, v230, v231
    v_cvt_pk_bf16_f32 v242, v228, v229
    v_cvt_pk_bf16_f32 v241, v226, v227
    v_cvt_pk_bf16_f32 v240, v224, v225
    buffer_store_dwordx4 v[240:243], v2, s[20:23], s39 offen sc1
    ds_read_b128 a[144:147], v101 offset:8192
    ds_read_b128 a[148:151], v101 offset:9216
    ds_read_b128 a[152:155], v101 offset:10240
    ds_read_b128 a[156:159], v101 offset:11264
    v_pk_mul_f32 v[216:217], v[216:217], v[34:35]
    v_pk_mul_f32 v[218:219], v[218:219], v[34:35]
    v_pk_mul_f32 v[220:221], v[220:221], v[34:35]
    v_pk_mul_f32 v[222:223], v[222:223], v[34:35]
    v_cvt_pk_bf16_f32 v239, v222, v223
    v_cvt_pk_bf16_f32 v238, v220, v221
    v_cvt_pk_bf16_f32 v237, v218, v219
    v_cvt_pk_bf16_f32 v236, v216, v217
    s_add_u32 s39, s78, 20480
    buffer_store_dwordx4 v[236:239], v2, s[20:23], s39 offen offset:1024 sc1
    ds_read_b128 a[160:163], v101 offset:12288
    ds_read_b128 a[164:167], v101 offset:13312
    ds_read_b128 a[168:171], v101 offset:14336
    ds_read_b128 a[172:175], v101 offset:15360
    v_pk_mul_f32 v[208:209], v[208:209], v[34:35]
    v_pk_mul_f32 v[210:211], v[210:211], v[34:35]
    v_pk_mul_f32 v[212:213], v[212:213], v[34:35]
    v_pk_mul_f32 v[214:215], v[214:215], v[34:35]
    v_cvt_pk_bf16_f32 v235, v214, v215
    v_cvt_pk_bf16_f32 v234, v212, v213
    v_cvt_pk_bf16_f32 v233, v210, v211
    v_cvt_pk_bf16_f32 v232, v208, v209
    buffer_store_dwordx4 v[232:235], v2, s[20:23], s39 offen sc1
    ds_read_b128 a[176:179], v101 offset:16384
    ds_read_b128 a[180:183], v101 offset:17408
    v_pk_mul_f32 v[200:201], v[200:201], v[34:35]
    v_pk_mul_f32 v[202:203], v[202:203], v[34:35]
    v_pk_mul_f32 v[204:205], v[204:205], v[34:35]
    v_pk_mul_f32 v[206:207], v[206:207], v[34:35]
    v_cvt_pk_bf16_f32 v231, v206, v207
    v_cvt_pk_bf16_f32 v230, v204, v205
    v_cvt_pk_bf16_f32 v229, v202, v203
    v_cvt_pk_bf16_f32 v228, v200, v201
    s_add_u32 s39, s78, 2048
    buffer_store_dwordx4 v[228:231], v2, s[20:23], s39 offen offset:1024 sc1
    v_pk_mul_f32 v[192:193], v[192:193], v[34:35]
    v_pk_mul_f32 v[194:195], v[194:195], v[34:35]
    v_pk_mul_f32 v[196:197], v[196:197], v[34:35]
    v_pk_mul_f32 v[198:199], v[198:199], v[34:35]
    v_cvt_pk_bf16_f32 v227, v198, v199
    v_cvt_pk_bf16_f32 v226, v196, v197
    v_cvt_pk_bf16_f32 v225, v194, v195
    v_cvt_pk_bf16_f32 v224, v192, v193
    buffer_store_dwordx4 v[224:227], v2, s[20:23], s39 offen sc1
    v_pk_mul_f32 v[184:185], v[184:185], v[32:33]
    v_pk_mul_f32 v[186:187], v[186:187], v[32:33]
    v_pk_mul_f32 v[188:189], v[188:189], v[32:33]
    v_pk_mul_f32 v[190:191], v[190:191], v[32:33]
    v_cvt_pk_bf16_f32 v223, v190, v191
    v_cvt_pk_bf16_f32 v222, v188, v189
    v_cvt_pk_bf16_f32 v221, v186, v187
    v_cvt_pk_bf16_f32 v220, v184, v185
    s_add_u32 s39, s78, 18432
    buffer_store_dwordx4 v[220:223], v2, s[20:23], s39 offen offset:1024 sc1
    v_pk_mul_f32 v[176:177], v[176:177], v[32:33]
    v_pk_mul_f32 v[178:179], v[178:179], v[32:33]
    v_pk_mul_f32 v[180:181], v[180:181], v[32:33]
    v_pk_mul_f32 v[182:183], v[182:183], v[32:33]
    v_cvt_pk_bf16_f32 v219, v182, v183
    v_cvt_pk_bf16_f32 v218, v180, v181
    v_cvt_pk_bf16_f32 v217, v178, v179
    v_cvt_pk_bf16_f32 v216, v176, v177
    buffer_store_dwordx4 v[216:219], v2, s[20:23], s39 offen sc1
    v_pk_mul_f32 v[168:169], v[168:169], v[32:33]
    v_pk_mul_f32 v[170:171], v[170:171], v[32:33]
    v_pk_mul_f32 v[172:173], v[172:173], v[32:33]
    v_pk_mul_f32 v[174:175], v[174:175], v[32:33]
    v_cvt_pk_bf16_f32 v215, v174, v175
    v_cvt_pk_bf16_f32 v214, v172, v173
    v_cvt_pk_bf16_f32 v213, v170, v171
    v_cvt_pk_bf16_f32 v212, v168, v169
    s_add_u32 s39, s78, 0
    buffer_store_dwordx4 v[212:215], v2, s[20:23], s39 offen offset:1024 sc1
    v_pk_mul_f32 v[160:161], v[160:161], v[32:33]
    v_pk_mul_f32 v[162:163], v[162:163], v[32:33]
    v_pk_mul_f32 v[164:165], v[164:165], v[32:33]
    v_pk_mul_f32 v[166:167], v[166:167], v[32:33]
    v_cvt_pk_bf16_f32 v211, v166, v167
    v_cvt_pk_bf16_f32 v210, v164, v165
    v_cvt_pk_bf16_f32 v209, v162, v163
    v_cvt_pk_bf16_f32 v208, v160, v161
    buffer_store_dwordx4 v[208:211], v2, s[20:23], s39 offen sc1
    s_waitcnt lgkmcnt(0)
    s_barrier
    v_mov_b32 v4, 163776
    ds_read_b128 v[80:83], v4
    ds_read_b128 v[84:87], v4 offset:16
    s_waitcnt lgkmcnt(0)
    v_or_b32 v80, v80, v81
    v_or3_b32 v80, v80, v82, v83
    v_or3_b32 v80, v80, v84, v85
    v_or3_b32 v80, v80, v86, v87
    s_nop 0
    v_readfirstlane_b32 s39, v80
    s_nop 0
    s_andn2_b32 s39, s39, s55
    s_cmp_eq_u32 s39, 0
    s_cbranch_scc1 L_gemm
    v_mov_b32 v4, 163776
    ds_read_b128 v[80:83], v4
    s_waitcnt lgkmcnt(0)
    v_or_b32 v80, v80, v81
    v_or3_b32 v80, v80, v82, v83
    s_nop 0
    v_readfirstlane_b32 s39, v80
    s_nop 0
    s_cmp_eq_u32 s39, 0
    s_cselect_b32 s68, 1, 0
    s_mov_b32 s55, -1
    s_waitcnt vmcnt(0) lgkmcnt(0)
    v_and_b32 v3, 15, v1
    v_lshrrev_b32 v4, 4, v1
    v_xor_b32 v5, v3, v4
    v_lshlrev_b32 v5, 4, v5
    v_lshl_add_u32 v6, v3, 8, v5
    v_xor_b32 v7, 64, v6
    v_xor_b32 v8, 128, v6
    v_xor_b32 v9, 192, v6
    v_lshlrev_b32 v96, 4, v4
    v_lshrrev_b32 v3, 2, v1
    v_and_b32 v5, 7, v3
    v_lshlrev_b32 v5, 5, v5
    v_lshl_add_u32 v5, v3, 8, v5
    v_and_b32 v3, 3, v1
    v_lshl_add_u32 v5, v3, 3, v5
    v_add_u32 v10, 8192, v5
    v_xor_b32 v11, 32, v10
    v_xor_b32 v12, 64, v10
    v_xor_b32 v13, 96, v10
    v_xor_b32 v14, 128, v10
    v_xor_b32 v15, 160, v10
    v_xor_b32 v16, 192, v10
    v_xor_b32 v17, 224, v10
    v_mov_b32 v48, 0xff800000
    v_mov_b32 v49, 0xff800000
    v_mov_b32 v50, 0xff800000
    s_mov_b32 s54, 32
    s_xor_b32 s47, s69, 0
    s_mov_b32 s49, 0
L_max_C0:
    s_barrier
    s_add_u32 s47, s47, 8192
    s_barrier
    ds_read_b128 a[144:147], v6
    ds_read_b128 a[160:163], v6 offset:4096
    ds_read_b128 a[148:151], v7
    ds_read_b128 a[164:167], v7 offset:4096
    ds_read_b128 a[152:155], v8
    ds_read_b128 a[168:171], v8 offset:4096
    ds_read_b128 a[156:159], v9
    ds_read_b128 a[172:175], v9 offset:4096
    s_waitcnt lgkmcnt(0)
    v_mfma_f32_16x16x32_bf16 v[32:35], a[144:147], a[0:3], 0
    v_mfma_f32_16x16x32_bf16 v[36:39], a[160:163], a[0:3], 0
    v_mfma_f32_16x16x32_bf16 v[32:35], a[148:151], a[4:7], v[32:35]
    v_mfma_f32_16x16x32_bf16 v[36:39], a[164:167], a[4:7], v[36:39]
    v_mfma_f32_16x16x32_bf16 v[32:35], a[152:155], a[8:11], v[32:35]
    v_mfma_f32_16x16x32_bf16 v[36:39], a[168:171], a[8:11], v[36:39]
    v_mfma_f32_16x16x32_bf16 v[32:35], a[156:159], a[12:15], v[32:35]
    v_mfma_f32_16x16x32_bf16 v[36:39], a[172:175], a[12:15], v[36:39]
    s_nop 6
    v_max3_f32 v48, v32, v33, v48
    v_max3_f32 v48, v34, v35, v48
    v_max3_f32 v48, v36, v37, v48
    v_max3_f32 v48, v38, v39, v48
    v_mfma_f32_16x16x32_bf16 v[32:35], a[144:147], a[16:19], 0
    v_mfma_f32_16x16x32_bf16 v[36:39], a[160:163], a[16:19], 0
    v_mfma_f32_16x16x32_bf16 v[32:35], a[148:151], a[20:23], v[32:35]
    v_mfma_f32_16x16x32_bf16 v[36:39], a[164:167], a[20:23], v[36:39]
    v_mfma_f32_16x16x32_bf16 v[32:35], a[152:155], a[24:27], v[32:35]
    v_mfma_f32_16x16x32_bf16 v[36:39], a[168:171], a[24:27], v[36:39]
    v_mfma_f32_16x16x32_bf16 v[32:35], a[156:159], a[28:31], v[32:35]
    v_mfma_f32_16x16x32_bf16 v[36:39], a[172:175], a[28:31], v[36:39]
    s_nop 6
    v_max3_f32 v49, v32, v33, v49
    v_max3_f32 v49, v34, v35, v49
    v_max3_f32 v49, v36, v37, v49
    v_max3_f32 v49, v38, v39, v49
    v_mfma_f32_16x16x32_bf16 v[32:35], a[144:147], a[32:35], 0
    v_mfma_f32_16x16x32_bf16 v[36:39], a[160:163], a[32:35], 0
    v_mfma_f32_16x16x32_bf16 v[32:35], a[148:151], a[36:39], v[32:35]
    v_mfma_f32_16x16x32_bf16 v[36:39], a[164:167], a[36:39], v[36:39]
    v_mfma_f32_16x16x32_bf16 v[32:35], a[152:155], a[40:43], v[32:35]
    v_mfma_f32_16x16x32_bf16 v[36:39], a[168:171], a[40:43], v[36:39]
    v_mfma_f32_16x16x32_bf16 v[32:35], a[156:159], a[44:47], v[32:35]
    v_mfma_f32_16x16x32_bf16 v[36:39], a[172:175], a[44:47], v[36:39]
    s_nop 6
    v_max3_f32 v50, v32, v33, v50
    v_max3_f32 v50, v34, v35, v50
    v_max3_f32 v50, v36, v37, v50
    v_max3_f32 v50, v38, v39, v50
    s_sub_u32 s54, s54, 1
    s_cmp_lg_u32 s54, 0
    s_cbranch_scc1 L_max_C0
    v_mov_b32 v3, v48
    s_nop 1
    v_permlane32_swap_b32 v3, v48
    v_max_f32 v48, v3, v48
    v_mov_b32 v3, v48
    s_nop 1
    v_permlane16_swap_b32 v3, v48
    v_max_f32 v48, v3, v48
    v_sub_f32 v56, 0, v48
    v_sub_f32 v57, 0, v48
    v_sub_f32 v58, 0, v48
    v_sub_f32 v59, 0, v48
    v_mov_b32 v3, v49
    s_nop 1
    v_permlane32_swap_b32 v3, v49
    v_max_f32 v49, v3, v49
    v_mov_b32 v3, v49
    s_nop 1
    v_permlane16_swap_b32 v3, v49
    v_max_f32 v49, v3, v49
    v_sub_f32 v60, 0, v49
    v_sub_f32 v61, 0, v49
    v_sub_f32 v62, 0, v49
    v_sub_f32 v63, 0, v49
    v_mov_b32 v3, v50
    s_nop 1
    v_permlane32_swap_b32 v3, v50
    v_max_f32 v50, v3, v50
    v_mov_b32 v3, v50
    s_nop 1
    v_permlane16_swap_b32 v3, v50
    v_max_f32 v50, v3, v50
    v_sub_f32 v64, 0, v50
    v_sub_f32 v65, 0, v50
    v_sub_f32 v66, 0, v50
    v_sub_f32 v67, 0, v50
    v_mov_b32 v48, 0xff800000
    v_mov_b32 v49, 0xff800000
    v_mov_b32 v50, 0xff800000
    s_mov_b32 s54, 32
    s_xor_b32 s47, s69, 262144
    s_mov_b32 s49, 0
L_max_C1:
    s_barrier
    s_add_u32 s47, s47, 8192
    s_barrier
    ds_read_b128 a[144:147], v6
    ds_read_b128 a[160:163], v6 offset:4096
    ds_read_b128 a[148:151], v7
    ds_read_b128 a[164:167], v7 offset:4096
    ds_read_b128 a[152:155], v8
    ds_read_b128 a[168:171], v8 offset:4096
    ds_read_b128 a[156:159], v9
    ds_read_b128 a[172:175], v9 offset:4096
    s_waitcnt lgkmcnt(0)
    v_mfma_f32_16x16x32_bf16 v[32:35], a[144:147], a[48:51], 0
    v_mfma_f32_16x16x32_bf16 v[36:39], a[160:163], a[48:51], 0
    v_mfma_f32_16x16x32_bf16 v[32:35], a[148:151], a[52:55], v[32:35]
    v_mfma_f32_16x16x32_bf16 v[36:39], a[164:167], a[52:55], v[36:39]
    v_mfma_f32_16x16x32_bf16 v[32:35], a[152:155], a[56:59], v[32:35]
    v_mfma_f32_16x16x32_bf16 v[36:39], a[168:171], a[56:59], v[36:39]
    v_mfma_f32_16x16x32_bf16 v[32:35], a[156:159], a[60:63], v[32:35]
    v_mfma_f32_16x16x32_bf16 v[36:39], a[172:175], a[60:63], v[36:39]
    s_nop 6
    v_max3_f32 v48, v32, v33, v48
    v_max3_f32 v48, v34, v35, v48
    v_max3_f32 v48, v36, v37, v48
    v_max3_f32 v48, v38, v39, v48
    v_mfma_f32_16x16x32_bf16 v[32:35], a[144:147], a[64:67], 0
    v_mfma_f32_16x16x32_bf16 v[36:39], a[160:163], a[64:67], 0
    v_mfma_f32_16x16x32_bf16 v[32:35], a[148:151], a[68:71], v[32:35]
    v_mfma_f32_16x16x32_bf16 v[36:39], a[164:167], a[68:71], v[36:39]
    v_mfma_f32_16x16x32_bf16 v[32:35], a[152:155], a[72:75], v[32:35]
    v_mfma_f32_16x16x32_bf16 v[36:39], a[168:171], a[72:75], v[36:39]
    v_mfma_f32_16x16x32_bf16 v[32:35], a[156:159], a[76:79], v[32:35]
    v_mfma_f32_16x16x32_bf16 v[36:39], a[172:175], a[76:79], v[36:39]
    s_nop 6
    v_max3_f32 v49, v32, v33, v49
    v_max3_f32 v49, v34, v35, v49
    v_max3_f32 v49, v36, v37, v49
    v_max3_f32 v49, v38, v39, v49
    v_mfma_f32_16x16x32_bf16 v[32:35], a[144:147], a[80:83], 0
    v_mfma_f32_16x16x32_bf16 v[36:39], a[160:163], a[80:83], 0
    v_mfma_f32_16x16x32_bf16 v[32:35], a[148:151], a[84:87], v[32:35]
    v_mfma_f32_16x16x32_bf16 v[36:39], a[164:167], a[84:87], v[36:39]
    v_mfma_f32_16x16x32_bf16 v[32:35], a[152:155], a[88:91], v[32:35]
    v_mfma_f32_16x16x32_bf16 v[36:39], a[168:171], a[88:91], v[36:39]
    v_mfma_f32_16x16x32_bf16 v[32:35], a[156:159], a[92:95], v[32:35]
    v_mfma_f32_16x16x32_bf16 v[36:39], a[172:175], a[92:95], v[36:39]
    s_nop 6
    v_max3_f32 v50, v32, v33, v50
    v_max3_f32 v50, v34, v35, v50
    v_max3_f32 v50, v36, v37, v50
    v_max3_f32 v50, v38, v39, v50
    s_sub_u32 s54, s54, 1
    s_cmp_lg_u32 s54, 0
    s_cbranch_scc1 L_max_C1
    v_mov_b32 v3, v48
    s_nop 1
    v_permlane32_swap_b32 v3, v48
    v_max_f32 v48, v3, v48
    v_mov_b32 v3, v48
    s_nop 1
    v_permlane16_swap_b32 v3, v48
    v_max_f32 v48, v3, v48
    v_sub_f32 v68, 0, v48
    v_sub_f32 v69, 0, v48
    v_sub_f32 v70, 0, v48
    v_sub_f32 v71, 0, v48
    v_mov_b32 v3, v49
    s_nop 1
    v_permlane32_swap_b32 v3, v49
    v_max_f32 v49, v3, v49
    v_mov_b32 v3, v49
    s_nop 1
    v_permlane16_swap_b32 v3, v49
    v_max_f32 v49, v3, v49
    v_sub_f32 v72, 0, v49
    v_sub_f32 v73, 0, v49
    v_sub_f32 v74, 0, v49
    v_sub_f32 v75, 0, v49
    v_mov_b32 v3, v50
    s_nop 1
    v_permlane32_swap_b32 v3, v50
    v_max_f32 v50, v3, v50
    v_mov_b32 v3, v50
    s_nop 1
    v_permlane16_swap_b32 v3, v50
    v_max_f32 v50, v3, v50
    v_sub_f32 v76, 0, v50
    v_sub_f32 v77, 0, v50
    v_sub_f32 v78, 0, v50
    v_sub_f32 v79, 0, v50
    s_barrier
    s_mul_i32 s39, s36, s89
    s_add_u32 s47, s57, s39
    s_and_b32 s47, s47, 0x3ffff
    s_add_u32 s47, s47, s69
    s_lshl_b32 s49, s36, 14
    s_add_u32 m0, s49, 0
    s_add_u32 s48, s47, 0
    buffer_load_dwordx4 v18, s[12:15], s48 offen nt lds
    buffer_load_dwordx4 v19, s[12:15], s48 offen offset:1024 nt lds
    buffer_load_dwordx4 v20, s[12:15], s48 offen offset:2048 nt lds
    buffer_load_dwordx4 v21, s[12:15], s48 offen offset:3072 nt lds
    s_add_u32 m0, s49, 4096
    s_add_u32 s48, s47, 4096
    buffer_load_dwordx4 v18, s[12:15], s48 offen nt lds
    buffer_load_dwordx4 v19, s[12:15], s48 offen offset:1024 nt lds
    buffer_load_dwordx4 v20, s[12:15], s48 offen offset:2048 nt lds
    buffer_load_dwordx4 v21, s[12:15], s48 offen offset:3072 nt lds
    s_add_u32 m0, s49, 8192
    s_add_u32 s48, s47, 0
    buffer_load_dwordx4 v22, s[16:19], s48 offen nt lds
    buffer_load_dwordx4 v23, s[16:19], s48 offen offset:1024 nt lds
    buffer_load_dwordx4 v22, s[16:19], s48 offen offset:2048 nt lds
    buffer_load_dwordx4 v23, s[16:19], s48 offen offset:3072 nt lds
    s_add_u32 m0, s49, 12288
    s_add_u32 s48, s47, 4096
    buffer_load_dwordx4 v22, s[16:19], s48 offen nt lds
    buffer_load_dwordx4 v23, s[16:19], s48 offen offset:1024 nt lds
    buffer_load_dwordx4 v22, s[16:19], s48 offen offset:2048 nt lds
    buffer_load_dwordx4 v23, s[16:19], s48 offen offset:3072 nt lds
    s_cmp_eq_u32 s36, 2
    s_cselect_b32 s4, s16, s12
    s_cselect_b32 s5, s17, s13
    s_mov_b32 s6, 0x4000000
    s_mov_b32 s7, 0x20000
    s_cselect_b32 s49, 8192, 0
    s_cselect_b64 vcc, -1, 0
    s_nop 1
    v_cndmask_b32 v28, v18, v22, vcc
    v_cndmask_b32 v29, v19, v23, vcc
    v_cndmask_b32 v30, v20, v22, vcc
    v_cndmask_b32 v31, v21, v23, vcc
    s_lshl_b32 s47, s89, 2
    s_add_u32 s47, s57, s47
    s_and_b32 s47, s47, 0x3ffff
    s_mov_b32 s46, s69
    s_waitcnt vmcnt(0)
    s_barrier
    ds_read_b128 a[144:147], v6
    ds_read_b128 a[160:163], v6 offset:4096
    ds_read_b128 a[148:151], v7
    ds_read_b128 a[164:167], v7 offset:4096
    ds_read_b128 a[152:155], v8
    ds_read_b128 a[168:171], v8 offset:4096
    ds_read_b128 a[156:159], v9
    ds_read_b128 a[172:175], v9 offset:4096
    ds_read_b64_tr_b16 a[176:177], v10
    ds_read_b64_tr_b16 a[178:179], v10 offset:4096
    ds_read_b64_tr_b16 a[180:181], v11
    ds_read_b64_tr_b16 a[182:183], v11 offset:4096
    ds_read_b64_tr_b16 a[184:185], v12
    ds_read_b64_tr_b16 a[186:187], v12 offset:4096
    ds_read_b64_tr_b16 a[188:189], v13
    ds_read_b64_tr_b16 a[190:191], v13 offset:4096
    ds_read_b64_tr_b16 a[192:193], v14
    ds_read_b64_tr_b16 a[194:195], v14 offset:4096
    ds_read_b64_tr_b16 a[196:197], v15
    ds_read_b64_tr_b16 a[198:199], v15 offset:4096
    ds_read_b64_tr_b16 a[200:201], v16
    ds_read_b64_tr_b16 a[202:203], v16 offset:4096
    ds_read_b64_tr_b16 a[204:205], v17
    ds_read_b64_tr_b16 a[206:207], v17 offset:4096
    s_waitcnt lgkmcnt(0)
    s_nop 7
    s_branch L_main_C
L_gemm:
    v_mfma_f32_16x16x32_bf16 v[112:115], a[184:187], a[112:115], 0
    ds_read_b64_tr_b16 a[72:73], v99 offset:34816
    s_add_u32 s76, s43, 2
    v_mfma_f32_16x16x32_bf16 v[116:119], a[188:191], a[112:115], 0
    ds_read_b64_tr_b16 a[74:75], v99 offset:38912
    v_mfma_f32_16x16x32_bf16 v[120:123], a[184:187], a[120:123], 0
    ds_read_b64_tr_b16 a[76:77], v99 offset:34824
    s_and_b32 s76, s76, 3
    v_mfma_f32_16x16x32_bf16 v[124:127], a[188:191], a[120:123], 0
    ds_read_b64_tr_b16 a[78:79], v99 offset:38920
    v_mfma_f32_16x16x32_bf16 v[128:131], a[184:187], a[128:131], 0
    ds_read_b64_tr_b16 a[80:81], v99 offset:43008
    s_lshl_b32 s76, s76, 2
    v_mfma_f32_16x16x32_bf16 v[132:135], a[188:191], a[128:131], 0
    ds_read_b64_tr_b16 a[82:83], v99 offset:47104
    s_add_u32 s76, s76, 0
    v_mfma_f32_16x16x32_bf16 v[136:139], a[184:187], a[136:139], 0
    ds_read_b64_tr_b16 a[84:85], v99 offset:43016
    v_mfma_f32_16x16x32_bf16 v[140:143], a[188:191], a[136:139], 0
    ds_read_b64_tr_b16 a[86:87], v99 offset:47112
    s_xor_b32 s76, s76, s3
    v_mfma_f32_16x16x32_bf16 v[144:147], a[184:187], a[144:147], 0
    ds_read_b128 a[0:3], v101 offset:34816
    v_mfma_f32_16x16x32_bf16 v[148:151], a[188:191], a[144:147], 0
    ds_read_b128 a[4:7], v101 offset:35840
    s_lshl_b32 s77, s76, 16
    v_mfma_f32_16x16x32_bf16 v[152:155], a[184:187], a[152:155], 0
    ds_read_b128 a[8:11], v101 offset:36864
    s_mul_i32 s76, s76, 18432
    v_mfma_f32_16x16x32_bf16 v[156:159], a[188:191], a[152:155], 0
    ds_read_b128 a[12:15], v101 offset:37888
    v_mfma_f32_16x16x32_bf16 v[160:163], a[184:187], a[160:163], 0
    ds_read_b128 a[16:19], v101 offset:38912
    s_add_u32 s76, s76, s80
    v_mfma_f32_16x16x32_bf16 v[164:167], a[188:191], a[160:163], 0
    ds_read_b128 a[20:23], v101 offset:39936
    v_mfma_f32_16x16x32_bf16 v[168:171], a[184:187], a[168:171], 0
    ds_read_b128 a[24:27], v101 offset:40960
    s_add_u32 m0, s61, 86016
    v_mfma_f32_16x16x32_bf16 v[172:175], a[188:191], a[168:171], 0
    ds_read_b128 a[28:31], v101 offset:41984
    buffer_load_dwordx4 v2, s[20:23], s76 offen sc1 lds
    v_mfma_f32_16x16x32_bf16 v[176:179], a[184:187], a[176:179], 0
    ds_read_b128 a[32:35], v101 offset:43008
    v_mfma_f32_16x16x32_bf16 v[180:183], a[188:191], a[176:179], 0
    ds_read_b128 a[36:39], v101 offset:44032
    buffer_load_dwordx4 v2, s[20:23], s76 offen offset:1024 sc1 lds
    v_mfma_f32_16x16x32_bf16 v[112:115], a[192:195], a[116:119], v[112:115]
    ds_read_b128 a[40:43], v101 offset:45056
    buffer_load_dwordx4 v2, s[20:23], s76 offen offset:2048 sc1 lds
    v_mfma_f32_16x16x32_bf16 v[116:119], a[196:199], a[116:119], v[116:119]
    ds_read_b128 a[44:47], v101 offset:46080
    v_mfma_f32_16x16x32_bf16 v[120:123], a[192:195], a[124:127], v[120:123]
    ds_read_b128 a[48:51], v101 offset:47104
    buffer_load_dwordx4 v2, s[20:23], s76 offen offset:3072 sc1 lds
    v_mfma_f32_16x16x32_bf16 v[124:127], a[196:199], a[124:127], v[124:127]
    ds_read_b128 a[52:55], v101 offset:48128
    v_mfma_f32_16x16x32_bf16 v[128:131], a[192:195], a[132:135], v[128:131]
    ds_read_b128 a[56:59], v101 offset:49152
    s_add_u32 m0, s61, 90112
    v_mfma_f32_16x16x32_bf16 v[132:135], a[196:199], a[132:135], v[132:135]
    ds_read_b128 a[60:63], v101 offset:50176
    s_add_u32 s76, s76, 4096
    v_mfma_f32_16x16x32_bf16 v[136:139], a[192:195], a[140:143], v[136:139]
    ds_read_b128 a[64:67], v101 offset:51200
    v_mfma_f32_16x16x32_bf16 v[140:143], a[196:199], a[140:143], v[140:143]
    ds_read_b128 a[68:71], v101 offset:52224
    buffer_load_dwordx4 v2, s[20:23], s76 offen sc1 lds
    v_mfma_f32_16x16x32_bf16 v[144:147], a[192:195], a[148:151], v[144:147]
    v_mfma_f32_16x16x32_bf16 v[148:151], a[196:199], a[148:151], v[148:151]
    s_add_u32 s77, s77, s79
    v_mfma_f32_16x16x32_bf16 v[152:155], a[192:195], a[156:159], v[152:155]
    s_add_u32 m0, s66, 69632
    v_mfma_f32_16x16x32_bf16 v[156:159], a[196:199], a[156:159], v[156:159]
    v_mfma_f32_16x16x32_bf16 v[160:163], a[192:195], a[164:167], v[160:163]
    buffer_load_dwordx4 v24, s[24:27], s77 offen lds
    v_mfma_f32_16x16x32_bf16 v[164:167], a[196:199], a[164:167], v[164:167]
    v_mfma_f32_16x16x32_bf16 v[168:171], a[192:195], a[172:175], v[168:171]
    buffer_load_dwordx4 v25, s[24:27], s77 offen offset:1024 lds
    v_mfma_f32_16x16x32_bf16 v[172:175], a[196:199], a[172:175], v[172:175]
    buffer_load_dwordx4 v26, s[24:27], s77 offen offset:2048 lds
    v_mfma_f32_16x16x32_bf16 v[176:179], a[192:195], a[180:183], v[176:179]
    v_mfma_f32_16x16x32_bf16 v[180:183], a[196:199], a[180:183], v[180:183]
    buffer_load_dwordx4 v27, s[24:27], s77 offen offset:3072 lds
    s_add_u32 s39, s36, 1
    s_and_b32 s39, s39, 2
    s_cbranch_scc0 9f
    s_waitcnt vmcnt(17)
9:
    s_waitcnt lgkmcnt(0)
    s_barrier
    v_mfma_f32_16x16x32_bf16 v[112:115], a[72:75], a[0:3], v[112:115]
    ds_read_b64_tr_b16 a[184:185], v100
    s_add_u32 s76, s43, 2
    v_mfma_f32_16x16x32_bf16 v[116:119], a[76:79], a[0:3], v[116:119]
    ds_read_b64_tr_b16 a[186:187], v100 offset:4096
    v_mfma_f32_16x16x32_bf16 v[120:123], a[72:75], a[8:11], v[120:123]
    ds_read_b64_tr_b16 a[188:189], v100 offset:8
    s_and_b32 s76, s76, 3
    v_mfma_f32_16x16x32_bf16 v[124:127], a[76:79], a[8:11], v[124:127]
    ds_read_b64_tr_b16 a[190:191], v100 offset:4104
    v_mfma_f32_16x16x32_bf16 v[128:131], a[72:75], a[16:19], v[128:131]
    ds_read_b64_tr_b16 a[192:193], v100 offset:8192
    s_lshl_b32 s76, s76, 2
    v_mfma_f32_16x16x32_bf16 v[132:135], a[76:79], a[16:19], v[132:135]
    ds_read_b64_tr_b16 a[194:195], v100 offset:12288
    s_add_u32 s76, s76, 1
    v_mfma_f32_16x16x32_bf16 v[136:139], a[72:75], a[24:27], v[136:139]
    ds_read_b64_tr_b16 a[196:197], v100 offset:8200
    v_mfma_f32_16x16x32_bf16 v[140:143], a[76:79], a[24:27], v[140:143]
    ds_read_b64_tr_b16 a[198:199], v100 offset:12296
    s_xor_b32 s76, s76, s3
    v_mfma_f32_16x16x32_bf16 v[144:147], a[72:75], a[32:35], v[144:147]
    ds_read_b128 a[112:115], v102
    v_mfma_f32_16x16x32_bf16 v[148:151], a[76:79], a[32:35], v[148:151]
    ds_read_b128 a[116:119], v102 offset:1024
    s_lshl_b32 s77, s76, 16
    v_mfma_f32_16x16x32_bf16 v[152:155], a[72:75], a[40:43], v[152:155]
    ds_read_b128 a[120:123], v102 offset:2048
    s_mul_i32 s76, s76, 18432
    v_mfma_f32_16x16x32_bf16 v[156:159], a[76:79], a[40:43], v[156:159]
    ds_read_b128 a[124:127], v102 offset:3072
    v_mfma_f32_16x16x32_bf16 v[160:163], a[72:75], a[48:51], v[160:163]
    ds_read_b128 a[128:131], v102 offset:4096
    s_add_u32 s76, s76, s80
    v_mfma_f32_16x16x32_bf16 v[164:167], a[76:79], a[48:51], v[164:167]
    ds_read_b128 a[132:135], v102 offset:5120
    v_mfma_f32_16x16x32_bf16 v[168:171], a[72:75], a[56:59], v[168:171]
    ds_read_b128 a[136:139], v102 offset:6144
    s_add_u32 m0, s61, 120832
    v_mfma_f32_16x16x32_bf16 v[172:175], a[76:79], a[56:59], v[172:175]
    ds_read_b128 a[140:143], v102 offset:7168
    buffer_load_dwordx4 v2, s[20:23], s76 offen sc1 lds
    v_mfma_f32_16x16x32_bf16 v[176:179], a[72:75], a[64:67], v[176:179]
    ds_read_b128 a[144:147], v102 offset:8192
    v_mfma_f32_16x16x32_bf16 v[180:183], a[76:79], a[64:67], v[180:183]
    ds_read_b128 a[148:151], v102 offset:9216
    buffer_load_dwordx4 v2, s[20:23], s76 offen offset:1024 sc1 lds
    v_mfma_f32_16x16x32_bf16 v[112:115], a[80:83], a[4:7], v[112:115]
    ds_read_b128 a[152:155], v102 offset:10240
    buffer_load_dwordx4 v2, s[20:23], s76 offen offset:2048 sc1 lds
    v_mfma_f32_16x16x32_bf16 v[116:119], a[84:87], a[4:7], v[116:119]
    ds_read_b128 a[156:159], v102 offset:11264
    v_mfma_f32_16x16x32_bf16 v[120:123], a[80:83], a[12:15], v[120:123]
    ds_read_b128 a[160:163], v102 offset:12288
    buffer_load_dwordx4 v2, s[20:23], s76 offen offset:3072 sc1 lds
    v_mfma_f32_16x16x32_bf16 v[124:127], a[84:87], a[12:15], v[124:127]
    ds_read_b128 a[164:167], v102 offset:13312
    v_mfma_f32_16x16x32_bf16 v[128:131], a[80:83], a[20:23], v[128:131]
    ds_read_b128 a[168:171], v102 offset:14336
    s_add_u32 m0, s61, 124928
    v_mfma_f32_16x16x32_bf16 v[132:135], a[84:87], a[20:23], v[132:135]
    ds_read_b128 a[172:175], v102 offset:15360
    s_add_u32 s76, s76, 4096
    v_mfma_f32_16x16x32_bf16 v[136:139], a[80:83], a[28:31], v[136:139]
    ds_read_b128 a[176:179], v102 offset:16384
    v_mfma_f32_16x16x32_bf16 v[140:143], a[84:87], a[28:31], v[140:143]
    ds_read_b128 a[180:183], v102 offset:17408
    buffer_load_dwordx4 v2, s[20:23], s76 offen sc1 lds
    v_mfma_f32_16x16x32_bf16 v[144:147], a[80:83], a[36:39], v[144:147]
    v_mfma_f32_16x16x32_bf16 v[148:151], a[84:87], a[36:39], v[148:151]
    s_add_u32 s77, s77, s79
    v_mfma_f32_16x16x32_bf16 v[152:155], a[80:83], a[44:47], v[152:155]
    s_add_u32 m0, s66, 104448
    v_mfma_f32_16x16x32_bf16 v[156:159], a[84:87], a[44:47], v[156:159]
    v_mfma_f32_16x16x32_bf16 v[160:163], a[80:83], a[52:55], v[160:163]
    buffer_load_dwordx4 v24, s[24:27], s77 offen lds
    v_mfma_f32_16x16x32_bf16 v[164:167], a[84:87], a[52:55], v[164:167]
    v_mfma_f32_16x16x32_bf16 v[168:171], a[80:83], a[60:63], v[168:171]
    buffer_load_dwordx4 v25, s[24:27], s77 offen offset:1024 lds
    v_mfma_f32_16x16x32_bf16 v[172:175], a[84:87], a[60:63], v[172:175]
    buffer_load_dwordx4 v26, s[24:27], s77 offen offset:2048 lds
    v_mfma_f32_16x16x32_bf16 v[176:179], a[80:83], a[68:71], v[176:179]
    v_mfma_f32_16x16x32_bf16 v[180:183], a[84:87], a[68:71], v[180:183]
    buffer_load_dwordx4 v27, s[24:27], s77 offen offset:3072 lds
    s_waitcnt lgkmcnt(0)
    s_barrier
    v_mfma_f32_16x16x32_bf16 v[112:115], a[184:187], a[112:115], v[112:115]
    ds_read_b64_tr_b16 a[72:73], v100 offset:16384
    s_add_u32 s76, s43, 3
    v_mfma_f32_16x16x32_bf16 v[116:119], a[188:191], a[112:115], v[116:119]
    ds_read_b64_tr_b16 a[74:75], v100 offset:20480
    v_mfma_f32_16x16x32_bf16 v[120:123], a[184:187], a[120:123], v[120:123]
    ds_read_b64_tr_b16 a[76:77], v100 offset:16392
    s_and_b32 s76, s76, 3
    v_mfma_f32_16x16x32_bf16 v[124:127], a[188:191], a[120:123], v[124:127]
    ds_read_b64_tr_b16 a[78:79], v100 offset:20488
    v_mfma_f32_16x16x32_bf16 v[128:131], a[184:187], a[128:131], v[128:131]
    ds_read_b64_tr_b16 a[80:81], v100 offset:24576
    s_lshl_b32 s76, s76, 2
    v_mfma_f32_16x16x32_bf16 v[132:135], a[188:191], a[128:131], v[132:135]
    ds_read_b64_tr_b16 a[82:83], v100 offset:28672
    s_add_u32 s76, s76, 0
    v_mfma_f32_16x16x32_bf16 v[136:139], a[184:187], a[136:139], v[136:139]
    ds_read_b64_tr_b16 a[84:85], v100 offset:24584
    v_mfma_f32_16x16x32_bf16 v[140:143], a[188:191], a[136:139], v[140:143]
    ds_read_b64_tr_b16 a[86:87], v100 offset:28680
    s_xor_b32 s76, s76, s3
    v_mfma_f32_16x16x32_bf16 v[144:147], a[184:187], a[144:147], v[144:147]
    ds_read_b128 a[0:3], v102 offset:18432
    v_mfma_f32_16x16x32_bf16 v[148:151], a[188:191], a[144:147], v[148:151]
    ds_read_b128 a[4:7], v102 offset:19456
    s_lshl_b32 s77, s76, 16
    v_mfma_f32_16x16x32_bf16 v[152:155], a[184:187], a[152:155], v[152:155]
    ds_read_b128 a[8:11], v102 offset:20480
    s_mul_i32 s76, s76, 18432
    v_mfma_f32_16x16x32_bf16 v[156:159], a[188:191], a[152:155], v[156:159]
    ds_read_b128 a[12:15], v102 offset:21504
    v_mfma_f32_16x16x32_bf16 v[160:163], a[184:187], a[160:163], v[160:163]
    ds_read_b128 a[16:19], v102 offset:22528
    s_add_u32 s76, s76, s80
    v_mfma_f32_16x16x32_bf16 v[164:167], a[188:191], a[160:163], v[164:167]
    ds_read_b128 a[20:23], v102 offset:23552
    v_mfma_f32_16x16x32_bf16 v[168:171], a[184:187], a[168:171], v[168:171]
    ds_read_b128 a[24:27], v102 offset:24576
    s_add_u32 m0, s61, 32768
    v_mfma_f32_16x16x32_bf16 v[172:175], a[188:191], a[168:171], v[172:175]
    ds_read_b128 a[28:31], v102 offset:25600
    buffer_load_dwordx4 v2, s[20:23], s76 offen sc1 lds
    v_mfma_f32_16x16x32_bf16 v[176:179], a[184:187], a[176:179], v[176:179]
    ds_read_b128 a[32:35], v102 offset:26624
    v_mfma_f32_16x16x32_bf16 v[180:183], a[188:191], a[176:179], v[180:183]
    ds_read_b128 a[36:39], v102 offset:27648
    buffer_load_dwordx4 v2, s[20:23], s76 offen offset:1024 sc1 lds
    v_mfma_f32_16x16x32_bf16 v[112:115], a[192:195], a[116:119], v[112:115]
    ds_read_b128 a[40:43], v102 offset:28672
    buffer_load_dwordx4 v2, s[20:23], s76 offen offset:2048 sc1 lds
    v_mfma_f32_16x16x32_bf16 v[116:119], a[196:199], a[116:119], v[116:119]
    ds_read_b128 a[44:47], v102 offset:29696
    v_mfma_f32_16x16x32_bf16 v[120:123], a[192:195], a[124:127], v[120:123]
    ds_read_b128 a[48:51], v102 offset:30720
    buffer_load_dwordx4 v2, s[20:23], s76 offen offset:3072 sc1 lds
    v_mfma_f32_16x16x32_bf16 v[124:127], a[196:199], a[124:127], v[124:127]
    ds_read_b128 a[52:55], v102 offset:31744
    v_mfma_f32_16x16x32_bf16 v[128:131], a[192:195], a[132:135], v[128:131]
    ds_read_b128 a[56:59], v102 offset:32768
    s_add_u32 m0, s61, 36864
    v_mfma_f32_16x16x32_bf16 v[132:135], a[196:199], a[132:135], v[132:135]
    ds_read_b128 a[60:63], v102 offset:33792
    s_add_u32 s76, s76, 4096
    v_mfma_f32_16x16x32_bf16 v[136:139], a[192:195], a[140:143], v[136:139]
    ds_read_b128 a[64:67], v102 offset:34816
    v_mfma_f32_16x16x32_bf16 v[140:143], a[196:199], a[140:143], v[140:143]
    ds_read_b128 a[68:71], v102 offset:35840
    buffer_load_dwordx4 v2, s[20:23], s76 offen sc1 lds
    v_mfma_f32_16x16x32_bf16 v[144:147], a[192:195], a[148:151], v[144:147]
    v_mfma_f32_16x16x32_bf16 v[148:151], a[196:199], a[148:151], v[148:151]
    s_add_u32 s77, s77, s79
    v_mfma_f32_16x16x32_bf16 v[152:155], a[192:195], a[156:159], v[152:155]
    s_add_u32 m0, s66, 0
    v_mfma_f32_16x16x32_bf16 v[156:159], a[196:199], a[156:159], v[156:159]
    v_mfma_f32_16x16x32_bf16 v[160:163], a[192:195], a[164:167], v[160:163]
    buffer_load_dwordx4 v24, s[24:27], s77 offen lds
    v_mfma_f32_16x16x32_bf16 v[164:167], a[196:199], a[164:167], v[164:167]
    v_mfma_f32_16x16x32_bf16 v[168:171], a[192:195], a[172:175], v[168:171]
    buffer_load_dwordx4 v25, s[24:27], s77 offen offset:1024 lds
    v_mfma_f32_16x16x32_bf16 v[172:175], a[196:199], a[172:175], v[172:175]
    buffer_load_dwordx4 v26, s[24:27], s77 offen offset:2048 lds
    v_mfma_f32_16x16x32_bf16 v[176:179], a[192:195], a[180:183], v[176:179]
    v_mfma_f32_16x16x32_bf16 v[180:183], a[196:199], a[180:183], v[180:183]
    buffer_load_dwordx4 v27, s[24:27], s77 offen offset:3072 lds
    s_waitcnt vmcnt(27)
    s_waitcnt vmcnt(18)
    s_waitcnt lgkmcnt(0)
    s_barrier
    s_cmp_lg_u32 s36, 3
    s_cbranch_scc1 L_sig1
    s_lshl_b32 s39, s43, 3
    v_mov_b32 v110, s81
    v_not_b32 v111, s81
    v_mov_b32 v4, s39
    s_mov_b64 exec, 1
    buffer_store_dwordx2 v[110:111], v4, s[20:23], s84 offen offset:32 sc1
    s_mov_b64 exec, -1
L_sig1:
    v_mfma_f32_16x16x32_bf16 v[112:115], a[72:75], a[0:3], v[112:115]
    ds_read_b64_tr_b16 a[184:185], v99
    s_add_u32 s76, s43, 3
    v_mfma_f32_16x16x32_bf16 v[116:119], a[76:79], a[0:3], v[116:119]
    ds_read_b64_tr_b16 a[186:187], v99 offset:4096
    v_mfma_f32_16x16x32_bf16 v[120:123], a[72:75], a[8:11], v[120:123]
    ds_read_b64_tr_b16 a[188:189], v99 offset:8
    s_and_b32 s76, s76, 3
    v_mfma_f32_16x16x32_bf16 v[124:127], a[76:79], a[8:11], v[124:127]
    ds_read_b64_tr_b16 a[190:191], v99 offset:4104
    v_mfma_f32_16x16x32_bf16 v[128:131], a[72:75], a[16:19], v[128:131]
    ds_read_b64_tr_b16 a[192:193], v99 offset:8192
    s_lshl_b32 s76, s76, 2
    v_mfma_f32_16x16x32_bf16 v[132:135], a[76:79], a[16:19], v[132:135]
    ds_read_b64_tr_b16 a[194:195], v99 offset:12288
    s_add_u32 s76, s76, 1
    v_mfma_f32_16x16x32_bf16 v[136:139], a[72:75], a[24:27], v[136:139]
    ds_read_b64_tr_b16 a[196:197], v99 offset:8200
    v_mfma_f32_16x16x32_bf16 v[140:143], a[76:79], a[24:27], v[140:143]
    ds_read_b64_tr_b16 a[198:199], v99 offset:12296
    s_xor_b32 s76, s76, s3
    v_mfma_f32_16x16x32_bf16 v[144:147], a[72:75], a[32:35], v[144:147]
    ds_read_b128 a[112:115], v101
    v_mfma_f32_16x16x32_bf16 v[148:151], a[76:79], a[32:35], v[148:151]
    ds_read_b128 a[116:119], v101 offset:1024
    s_lshl_b32 s77, s76, 16
    v_mfma_f32_16x16x32_bf16 v[152:155], a[72:75], a[40:43], v[152:155]
    ds_read_b128 a[120:123], v101 offset:2048
    s_mul_i32 s76, s76, 18432
    v_mfma_f32_16x16x32_bf16 v[156:159], a[76:79], a[40:43], v[156:159]
    ds_read_b128 a[124:127], v101 offset:3072
    v_mfma_f32_16x16x32_bf16 v[160:163], a[72:75], a[48:51], v[160:163]
    ds_read_b128 a[128:131], v101 offset:4096
    s_add_u32 s76, s76, s80
    v_mfma_f32_16x16x32_bf16 v[164:167], a[76:79], a[48:51], v[164:167]
    ds_read_b128 a[132:135], v101 offset:5120
    v_mfma_f32_16x16x32_bf16 v[168:171], a[72:75], a[56:59], v[168:171]
    ds_read_b128 a[136:139], v101 offset:6144
    s_add_u32 m0, s61, 51200
    v_mfma_f32_16x16x32_bf16 v[172:175], a[76:79], a[56:59], v[172:175]
    ds_read_b128 a[140:143], v101 offset:7168
    buffer_load_dwordx4 v2, s[20:23], s76 offen sc1 lds
    v_mfma_f32_16x16x32_bf16 v[176:179], a[72:75], a[64:67], v[176:179]
    ds_read_b128 a[144:147], v101 offset:8192
    v_mfma_f32_16x16x32_bf16 v[180:183], a[76:79], a[64:67], v[180:183]
    ds_read_b128 a[148:151], v101 offset:9216
    buffer_load_dwordx4 v2, s[20:23], s76 offen offset:1024 sc1 lds
    v_mfma_f32_16x16x32_bf16 v[112:115], a[80:83], a[4:7], v[112:115]
    ds_read_b128 a[152:155], v101 offset:10240
    buffer_load_dwordx4 v2, s[20:23], s76 offen offset:2048 sc1 lds
    v_mfma_f32_16x16x32_bf16 v[116:119], a[84:87], a[4:7], v[116:119]
    ds_read_b128 a[156:159], v101 offset:11264
    v_mfma_f32_16x16x32_bf16 v[120:123], a[80:83], a[12:15], v[120:123]
    ds_read_b128 a[160:163], v101 offset:12288
    buffer_load_dwordx4 v2, s[20:23], s76 offen offset:3072 sc1 lds
    v_mfma_f32_16x16x32_bf16 v[124:127], a[84:87], a[12:15], v[124:127]
    ds_read_b128 a[164:167], v101 offset:13312
    v_mfma_f32_16x16x32_bf16 v[128:131], a[80:83], a[20:23], v[128:131]
    ds_read_b128 a[168:171], v101 offset:14336
    s_add_u32 m0, s61, 55296
    v_mfma_f32_16x16x32_bf16 v[132:135], a[84:87], a[20:23], v[132:135]
    ds_read_b128 a[172:175], v101 offset:15360
    s_add_u32 s76, s76, 4096
    v_mfma_f32_16x16x32_bf16 v[136:139], a[80:83], a[28:31], v[136:139]
    ds_read_b128 a[176:179], v101 offset:16384
    v_mfma_f32_16x16x32_bf16 v[140:143], a[84:87], a[28:31], v[140:143]
    ds_read_b128 a[180:183], v101 offset:17408
    buffer_load_dwordx4 v2, s[20:23], s76 offen sc1 lds
    v_mfma_f32_16x16x32_bf16 v[144:147], a[80:83], a[36:39], v[144:147]
    v_mfma_f32_16x16x32_bf16 v[148:151], a[84:87], a[36:39], v[148:151]
    s_add_u32 s77, s77, s79
    v_mfma_f32_16x16x32_bf16 v[152:155], a[80:83], a[44:47], v[152:155]
    s_add_u32 m0, s66, 16384
    v_mfma_f32_16x16x32_bf16 v[156:159], a[84:87], a[44:47], v[156:159]
    v_mfma_f32_16x16x32_bf16 v[160:163], a[80:83], a[52:55], v[160:163]
    buffer_load_dwordx4 v24, s[24:27], s77 offen lds
    v_mfma_f32_16x16x32_bf16 v[164:167], a[84:87], a[52:55], v[164:167]
    v_mfma_f32_16x16x32_bf16 v[168:171], a[80:83], a[60:63], v[168:171]
    buffer_load_dwordx4 v25, s[24:27], s77 offen offset:1024 lds
    v_mfma_f32_16x16x32_bf16 v[172:175], a[84:87], a[60:63], v[172:175]
    buffer_load_dwordx4 v26, s[24:27], s77 offen offset:2048 lds
    v_mfma_f32_16x16x32_bf16 v[176:179], a[80:83], a[68:71], v[176:179]
    v_mfma_f32_16x16x32_bf16 v[180:183], a[84:87], a[68:71], v[180:183]
    buffer_load_dwordx4 v27, s[24:27], s77 offen offset:3072 lds
    s_waitcnt vmcnt(18)
    s_waitcnt lgkmcnt(0)
    s_barrier
    v_mfma_f32_16x16x32_bf16 v[112:115], a[184:187], a[112:115], v[112:115]
    ds_read_b64_tr_b16 a[72:73], v99 offset:34816
    s_add_u32 s76, s43, 0
    v_mfma_f32_16x16x32_bf16 v[116:119], a[188:191], a[112:115], v[116:119]
    ds_read_b64_tr_b16 a[74:75], v99 offset:38912
    v_mfma_f32_16x16x32_bf16 v[120:123], a[184:187], a[120:123], v[120:123]
    ds_read_b64_tr_b16 a[76:77], v99 offset:34824
    s_and_b32 s76, s76, 3
    v_mfma_f32_16x16x32_bf16 v[124:127], a[188:191], a[120:123], v[124:127]
    ds_read_b64_tr_b16 a[78:79], v99 offset:38920
    v_mfma_f32_16x16x32_bf16 v[128:131], a[184:187], a[128:131], v[128:131]
    ds_read_b64_tr_b16 a[80:81], v99 offset:43008
    s_lshl_b32 s76, s76, 2
    v_mfma_f32_16x16x32_bf16 v[132:135], a[188:191], a[128:131], v[132:135]
    ds_read_b64_tr_b16 a[82:83], v99 offset:47104
    s_add_u32 s76, s76, 2
    v_mfma_f32_16x16x32_bf16 v[136:139], a[184:187], a[136:139], v[136:139]
    ds_read_b64_tr_b16 a[84:85], v99 offset:43016
    v_mfma_f32_16x16x32_bf16 v[140:143], a[188:191], a[136:139], v[140:143]
    ds_read_b64_tr_b16 a[86:87], v99 offset:47112
    s_xor_b32 s76, s76, s3
    v_mfma_f32_16x16x32_bf16 v[144:147], a[184:187], a[144:147], v[144:147]
    ds_read_b128 a[0:3], v101 offset:34816
    v_mfma_f32_16x16x32_bf16 v[148:151], a[188:191], a[144:147], v[148:151]
    ds_read_b128 a[4:7], v101 offset:35840
    s_lshl_b32 s77, s76, 16
    v_mfma_f32_16x16x32_bf16 v[152:155], a[184:187], a[152:155], v[152:155]
    ds_read_b128 a[8:11], v101 offset:36864
    s_mul_i32 s76, s76, 18432
    v_mfma_f32_16x16x32_bf16 v[156:159], a[188:191], a[152:155], v[156:159]
    ds_read_b128 a[12:15], v101 offset:37888
    v_mfma_f32_16x16x32_bf16 v[160:163], a[184:187], a[160:163], v[160:163]
    ds_read_b128 a[16:19], v101 offset:38912
    s_add_u32 s76, s76, s80
    v_mfma_f32_16x16x32_bf16 v[164:167], a[188:191], a[160:163], v[164:167]
    ds_read_b128 a[20:23], v101 offset:39936
    v_mfma_f32_16x16x32_bf16 v[168:171], a[184:187], a[168:171], v[168:171]
    ds_read_b128 a[24:27], v101 offset:40960
    s_add_u32 m0, s61, 86016
    v_mfma_f32_16x16x32_bf16 v[172:175], a[188:191], a[168:171], v[172:175]
    ds_read_b128 a[28:31], v101 offset:41984
    buffer_load_dwordx4 v2, s[20:23], s76 offen sc1 lds
    v_mfma_f32_16x16x32_bf16 v[176:179], a[184:187], a[176:179], v[176:179]
    ds_read_b128 a[32:35], v101 offset:43008
    v_mfma_f32_16x16x32_bf16 v[180:183], a[188:191], a[176:179], v[180:183]
    ds_read_b128 a[36:39], v101 offset:44032
    buffer_load_dwordx4 v2, s[20:23], s76 offen offset:1024 sc1 lds
    v_mfma_f32_16x16x32_bf16 v[112:115], a[192:195], a[116:119], v[112:115]
    ds_read_b128 a[40:43], v101 offset:45056
    buffer_load_dwordx4 v2, s[20:23], s76 offen offset:2048 sc1 lds
    v_mfma_f32_16x16x32_bf16 v[116:119], a[196:199], a[116:119], v[116:119]
    ds_read_b128 a[44:47], v101 offset:46080
    v_mfma_f32_16x16x32_bf16 v[120:123], a[192:195], a[124:127], v[120:123]
    ds_read_b128 a[48:51], v101 offset:47104
    buffer_load_dwordx4 v2, s[20:23], s76 offen offset:3072 sc1 lds
    v_mfma_f32_16x16x32_bf16 v[124:127], a[196:199], a[124:127], v[124:127]
    ds_read_b128 a[52:55], v101 offset:48128
    v_mfma_f32_16x16x32_bf16 v[128:131], a[192:195], a[132:135], v[128:131]
    ds_read_b128 a[56:59], v101 offset:49152
    s_add_u32 m0, s61, 90112
    v_mfma_f32_16x16x32_bf16 v[132:135], a[196:199], a[132:135], v[132:135]
    ds_read_b128 a[60:63], v101 offset:50176
    s_add_u32 s76, s76, 4096
    v_mfma_f32_16x16x32_bf16 v[136:139], a[192:195], a[140:143], v[136:139]
    ds_read_b128 a[64:67], v101 offset:51200
    v_mfma_f32_16x16x32_bf16 v[140:143], a[196:199], a[140:143], v[140:143]
    ds_read_b128 a[68:71], v101 offset:52224
    buffer_load_dwordx4 v2, s[20:23], s76 offen sc1 lds
    v_mfma_f32_16x16x32_bf16 v[144:147], a[192:195], a[148:151], v[144:147]
    v_mfma_f32_16x16x32_bf16 v[148:151], a[196:199], a[148:151], v[148:151]
    s_add_u32 s77, s77, s79
    v_mfma_f32_16x16x32_bf16 v[152:155], a[192:195], a[156:159], v[152:155]
    s_add_u32 m0, s66, 69632
    v_mfma_f32_16x16x32_bf16 v[156:159], a[196:199], a[156:159], v[156:159]
    v_mfma_f32_16x16x32_bf16 v[160:163], a[192:195], a[164:167], v[160:163]
    buffer_load_dwordx4 v24, s[24:27], s77 offen lds
    v_mfma_f32_16x16x32_bf16 v[164:167], a[196:199], a[164:167], v[164:167]
    v_mfma_f32_16x16x32_bf16 v[168:171], a[192:195], a[172:175], v[168:171]
    buffer_load_dwordx4 v25, s[24:27], s77 offen offset:1024 lds
    v_mfma_f32_16x16x32_bf16 v[172:175], a[196:199], a[172:175], v[172:175]
    buffer_load_dwordx4 v26, s[24:27], s77 offen offset:2048 lds
    v_mfma_f32_16x16x32_bf16 v[176:179], a[192:195], a[180:183], v[176:179]
    v_mfma_f32_16x16x32_bf16 v[180:183], a[196:199], a[180:183], v[180:183]
    buffer_load_dwordx4 v27, s[24:27], s77 offen offset:3072 lds
    s_waitcnt vmcnt(18)
    s_waitcnt lgkmcnt(0)
    s_barrier
    v_mfma_f32_16x16x32_bf16 v[112:115], a[72:75], a[0:3], v[112:115]
    ds_read_b64_tr_b16 a[184:185], v100
    s_cmp_lg_u32 s36, 0
    s_cbranch_scc1 7f
    v_and_b32 v5, 3, v1
    v_lshlrev_b32 v5, 3, v5
    buffer_load_dwordx2 v[108:109], v5, s[20:23], s84 offen offset:32 sc1
7:
    v_mfma_f32_16x16x32_bf16 v[116:119], a[76:79], a[0:3], v[116:119]
    ds_read_b64_tr_b16 a[186:187], v100 offset:4096
    v_mfma_f32_16x16x32_bf16 v[120:123], a[72:75], a[8:11], v[120:123]
    ds_read_b64_tr_b16 a[188:189], v100 offset:8
    s_add_u32 s76, s43, 0
    v_mfma_f32_16x16x32_bf16 v[124:127], a[76:79], a[8:11], v[124:127]
    ds_read_b64_tr_b16 a[190:191], v100 offset:4104
    v_mfma_f32_16x16x32_bf16 v[128:131], a[72:75], a[16:19], v[128:131]
    ds_read_b64_tr_b16 a[192:193], v100 offset:8192
    s_and_b32 s76, s76, 3
    v_mfma_f32_16x16x32_bf16 v[132:135], a[76:79], a[16:19], v[132:135]
    ds_read_b64_tr_b16 a[194:195], v100 offset:12288
    s_lshl_b32 s76, s76, 2
    v_mfma_f32_16x16x32_bf16 v[136:139], a[72:75], a[24:27], v[136:139]
    ds_read_b64_tr_b16 a[196:197], v100 offset:8200
    v_mfma_f32_16x16x32_bf16 v[140:143], a[76:79], a[24:27], v[140:143]
    ds_read_b64_tr_b16 a[198:199], v100 offset:12296
    s_add_u32 s76, s76, 3
    v_mfma_f32_16x16x32_bf16 v[144:147], a[72:75], a[32:35], v[144:147]
    ds_read_b128 a[112:115], v102
    s_xor_b32 s76, s76, s3
    v_mfma_f32_16x16x32_bf16 v[148:151], a[76:79], a[32:35], v[148:151]
    ds_read_b128 a[116:119], v102 offset:1024
    v_mfma_f32_16x16x32_bf16 v[152:155], a[72:75], a[40:43], v[152:155]
    ds_read_b128 a[120:123], v102 offset:2048
    s_lshl_b32 s77, s76, 16
    v_mfma_f32_16x16x32_bf16 v[156:159], a[76:79], a[40:43], v[156:159]
    ds_read_b128 a[124:127], v102 offset:3072
    s_mul_i32 s76, s76, 18432
    v_mfma_f32_16x16x32_bf16 v[160:163], a[72:75], a[48:51], v[160:163]
    ds_read_b128 a[128:131], v102 offset:4096
    v_mfma_f32_16x16x32_bf16 v[164:167], a[76:79], a[48:51], v[164:167]
    ds_read_b128 a[132:135], v102 offset:5120
    s_add_u32 s76, s76, s80
    v_mfma_f32_16x16x32_bf16 v[168:171], a[72:75], a[56:59], v[168:171]
    ds_read_b128 a[136:139], v102 offset:6144
    v_mfma_f32_16x16x32_bf16 v[172:175], a[76:79], a[56:59], v[172:175]
    ds_read_b128 a[140:143], v102 offset:7168
    s_add_u32 m0, s61, 120832
    v_mfma_f32_16x16x32_bf16 v[176:179], a[72:75], a[64:67], v[176:179]
    ds_read_b128 a[144:147], v102 offset:8192
    buffer_load_dwordx4 v2, s[20:23], s76 offen sc1 lds
    v_mfma_f32_16x16x32_bf16 v[180:183], a[76:79], a[64:67], v[180:183]
    ds_read_b128 a[148:151], v102 offset:9216
    v_mfma_f32_16x16x32_bf16 v[112:115], a[80:83], a[4:7], v[112:115]
    ds_read_b128 a[152:155], v102 offset:10240
    buffer_load_dwordx4 v2, s[20:23], s76 offen offset:1024 sc1 lds
    v_mfma_f32_16x16x32_bf16 v[116:119], a[84:87], a[4:7], v[116:119]
    ds_read_b128 a[156:159], v102 offset:11264
    buffer_load_dwordx4 v2, s[20:23], s76 offen offset:2048 sc1 lds
    v_mfma_f32_16x16x32_bf16 v[120:123], a[80:83], a[12:15], v[120:123]
    ds_read_b128 a[160:163], v102 offset:12288
    v_mfma_f32_16x16x32_bf16 v[124:127], a[84:87], a[12:15], v[124:127]
    ds_read_b128 a[164:167], v102 offset:13312
    buffer_load_dwordx4 v2, s[20:23], s76 offen offset:3072 sc1 lds
    v_mfma_f32_16x16x32_bf16 v[128:131], a[80:83], a[20:23], v[128:131]
    ds_read_b128 a[168:171], v102 offset:14336
    s_add_u32 m0, s61, 124928
    v_mfma_f32_16x16x32_bf16 v[132:135], a[84:87], a[20:23], v[132:135]
    ds_read_b128 a[172:175], v102 offset:15360
    v_mfma_f32_16x16x32_bf16 v[136:139], a[80:83], a[28:31], v[136:139]
    ds_read_b128 a[176:179], v102 offset:16384
    s_add_u32 s76, s76, 4096
    v_mfma_f32_16x16x32_bf16 v[140:143], a[84:87], a[28:31], v[140:143]
    ds_read_b128 a[180:183], v102 offset:17408
    v_mfma_f32_16x16x32_bf16 v[144:147], a[80:83], a[36:39], v[144:147]
    buffer_load_dwordx4 v2, s[20:23], s76 offen sc1 lds
    v_mfma_f32_16x16x32_bf16 v[148:151], a[84:87], a[36:39], v[148:151]
    s_add_u32 s77, s77, s79
    v_mfma_f32_16x16x32_bf16 v[152:155], a[80:83], a[44:47], v[152:155]
    v_mfma_f32_16x16x32_bf16 v[156:159], a[84:87], a[44:47], v[156:159]
    s_add_u32 m0, s66, 104448
    v_mfma_f32_16x16x32_bf16 v[160:163], a[80:83], a[52:55], v[160:163]
    buffer_load_dwordx4 v24, s[24:27], s77 offen lds
    v_mfma_f32_16x16x32_bf16 v[164:167], a[84:87], a[52:55], v[164:167]
    v_mfma_f32_16x16x32_bf16 v[168:171], a[80:83], a[60:63], v[168:171]
    buffer_load_dwordx4 v25, s[24:27], s77 offen offset:1024 lds
    v_mfma_f32_16x16x32_bf16 v[172:175], a[84:87], a[60:63], v[172:175]
    buffer_load_dwordx4 v26, s[24:27], s77 offen offset:2048 lds
    v_mfma_f32_16x16x32_bf16 v[176:179], a[80:83], a[68:71], v[176:179]
    v_mfma_f32_16x16x32_bf16 v[180:183], a[84:87], a[68:71], v[180:183]
    buffer_load_dwordx4 v27, s[24:27], s77 offen offset:3072 lds
    s_cmp_lg_u32 s36, 0
    s_cbranch_scc1 L_poll1x
    s_waitcnt vmcnt(9)
    v_not_b32 v109, v109
    v_xor_b32 v108, s81, v108
    v_xor_b32 v109, s81, v109
    v_or_b32 v108, v108, v109
    v_cmp_ne_u32 vcc, 0, v108
    s_lshl_b32 s39, 1, s43
    s_xor_b32 s39, s39, 15
    s_and_b32 s39, s39, vcc_lo
    s_cmp_eq_u32 s39, 0
    s_cbranch_scc1 L_poll1x
    s_mov_b32 s65, 1048576
L_poll1:
    v_and_b32 v5, 3, v1
    v_lshlrev_b32 v5, 3, v5
    buffer_load_dwordx2 v[108:109], v5, s[20:23], s84 offen offset:32 sc1
    s_waitcnt vmcnt(0)
    v_not_b32 v109, v109
    v_xor_b32 v108, s81, v108
    v_xor_b32 v109, s81, v109
    v_or_b32 v108, v108, v109
    v_cmp_ne_u32 vcc, 0, v108
    s_lshl_b32 s39, 1, s43
    s_xor_b32 s39, s39, 15
    s_and_b32 s39, s39, vcc_lo
    s_cmp_eq_u32 s39, 0
    s_cbranch_scc1 L_poll1x
    s_sleep 2
    s_sub_u32 s65, s65, 1
    s_cmp_lg_u32 s65, 0
    s_cbranch_scc1 L_poll1
L_poll1x:
    s_waitcnt vmcnt(18)
    s_waitcnt lgkmcnt(0)
    s_barrier
    v_mfma_f32_16x16x32_bf16 v[112:115], a[184:187], a[112:115], v[112:115]
    ds_read_b64_tr_b16 a[72:73], v100 offset:16384
    s_add_u32 s76, s43, 1
    v_mfma_f32_16x16x32_bf16 v[116:119], a[188:191], a[112:115], v[116:119]
    ds_read_b64_tr_b16 a[74:75], v100 offset:20480
    v_mfma_f32_16x16x32_bf16 v[120:123], a[184:187], a[120:123], v[120:123]
    ds_read_b64_tr_b16 a[76:77], v100 offset:16392
    s_and_b32 s76, s76, 3
    v_mfma_f32_16x16x32_bf16 v[124:127], a[188:191], a[120:123], v[124:127]
    ds_read_b64_tr_b16 a[78:79], v100 offset:20488
    v_mfma_f32_16x16x32_bf16 v[128:131], a[184:187], a[128:131], v[128:131]
    ds_read_b64_tr_b16 a[80:81], v100 offset:24576
    s_lshl_b32 s76, s76, 2
    v_mfma_f32_16x16x32_bf16 v[132:135], a[188:191], a[128:131], v[132:135]
    ds_read_b64_tr_b16 a[82:83], v100 offset:28672
    s_add_u32 s76, s76, 2
    v_mfma_f32_16x16x32_bf16 v[136:139], a[184:187], a[136:139], v[136:139]
    ds_read_b64_tr_b16 a[84:85], v100 offset:24584
    v_mfma_f32_16x16x32_bf16 v[140:143], a[188:191], a[136:139], v[140:143]
    ds_read_b64_tr_b16 a[86:87], v100 offset:28680
    s_xor_b32 s76, s76, s3
    v_mfma_f32_16x16x32_bf16 v[144:147], a[184:187], a[144:147], v[144:147]
    ds_read_b128 a[0:3], v102 offset:18432
    v_mfma_f32_16x16x32_bf16 v[148:151], a[188:191], a[144:147], v[148:151]
    ds_read_b128 a[4:7], v102 offset:19456
    s_lshl_b32 s77, s76, 16
    v_mfma_f32_16x16x32_bf16 v[152:155], a[184:187], a[152:155], v[152:155]
    ds_read_b128 a[8:11], v102 offset:20480
    s_mul_i32 s76, s76, 18432
    v_mfma_f32_16x16x32_bf16 v[156:159], a[188:191], a[152:155], v[156:159]
    ds_read_b128 a[12:15], v102 offset:21504
    v_mfma_f32_16x16x32_bf16 v[160:163], a[184:187], a[160:163], v[160:163]
    ds_read_b128 a[16:19], v102 offset:22528
    s_add_u32 s76, s76, s80
    v_mfma_f32_16x16x32_bf16 v[164:167], a[188:191], a[160:163], v[164:167]
    ds_read_b128 a[20:23], v102 offset:23552
    v_mfma_f32_16x16x32_bf16 v[168:171], a[184:187], a[168:171], v[168:171]
    ds_read_b128 a[24:27], v102 offset:24576
    s_add_u32 m0, s61, 32768
    v_mfma_f32_16x16x32_bf16 v[172:175], a[188:191], a[168:171], v[172:175]
    ds_read_b128 a[28:31], v102 offset:25600
    buffer_load_dwordx4 v2, s[20:23], s76 offen sc1 lds
    v_mfma_f32_16x16x32_bf16 v[176:179], a[184:187], a[176:179], v[176:179]
    ds_read_b128 a[32:35], v102 offset:26624
    v_mfma_f32_16x16x32_bf16 v[180:183], a[188:191], a[176:179], v[180:183]
    ds_read_b128 a[36:39], v102 offset:27648
    buffer_load_dwordx4 v2, s[20:23], s76 offen offset:1024 sc1 lds
    v_mfma_f32_16x16x32_bf16 v[112:115], a[192:195], a[116:119], v[112:115]
    ds_read_b128 a[40:43], v102 offset:28672
    buffer_load_dwordx4 v2, s[20:23], s76 offen offset:2048 sc1 lds
    v_mfma_f32_16x16x32_bf16 v[116:119], a[196:199], a[116:119], v[116:119]
    ds_read_b128 a[44:47], v102 offset:29696
    v_mfma_f32_16x16x32_bf16 v[120:123], a[192:195], a[124:127], v[120:123]
    ds_read_b128 a[48:51], v102 offset:30720
    buffer_load_dwordx4 v2, s[20:23], s76 offen offset:3072 sc1 lds
    v_mfma_f32_16x16x32_bf16 v[124:127], a[196:199], a[124:127], v[124:127]
    ds_read_b128 a[52:55], v102 offset:31744
    v_mfma_f32_16x16x32_bf16 v[128:131], a[192:195], a[132:135], v[128:131]
    ds_read_b128 a[56:59], v102 offset:32768
    s_add_u32 m0, s61, 36864
    v_mfma_f32_16x16x32_bf16 v[132:135], a[196:199], a[132:135], v[132:135]
    ds_read_b128 a[60:63], v102 offset:33792
    s_add_u32 s76, s76, 4096
    v_mfma_f32_16x16x32_bf16 v[136:139], a[192:195], a[140:143], v[136:139]
    ds_read_b128 a[64:67], v102 offset:34816
    v_mfma_f32_16x16x32_bf16 v[140:143], a[196:199], a[140:143], v[140:143]
    ds_read_b128 a[68:71], v102 offset:35840
    buffer_load_dwordx4 v2, s[20:23], s76 offen sc1 lds
    v_mfma_f32_16x16x32_bf16 v[144:147], a[192:195], a[148:151], v[144:147]
    v_mfma_f32_16x16x32_bf16 v[148:151], a[196:199], a[148:151], v[148:151]
    s_add_u32 s77, s77, s79
    v_mfma_f32_16x16x32_bf16 v[152:155], a[192:195], a[156:159], v[152:155]
    s_add_u32 m0, s66, 0
    v_mfma_f32_16x16x32_bf16 v[156:159], a[196:199], a[156:159], v[156:159]
    v_mfma_f32_16x16x32_bf16 v[160:163], a[192:195], a[164:167], v[160:163]
    buffer_load_dwordx4 v24, s[24:27], s77 offen lds
    v_mfma_f32_16x16x32_bf16 v[164:167], a[196:199], a[164:167], v[164:167]
    v_mfma_f32_16x16x32_bf16 v[168:171], a[192:195], a[172:175], v[168:171]
    buffer_load_dwordx4 v25, s[24:27], s77 offen offset:1024 lds
    v_mfma_f32_16x16x32_bf16 v[172:175], a[196:199], a[172:175], v[172:175]
    buffer_load_dwordx4 v26, s[24:27], s77 offen offset:2048 lds
    v_mfma_f32_16x16x32_bf16 v[176:179], a[192:195], a[180:183], v[176:179]
    v_mfma_f32_16x16x32_bf16 v[180:183], a[196:199], a[180:183], v[180:183]
    buffer_load_dwordx4 v27, s[24:27], s77 offen offset:3072 lds
    s_waitcnt vmcnt(18)
    s_waitcnt lgkmcnt(0)
    s_barrier
    v_mfma_f32_16x16x32_bf16 v[112:115], a[72:75], a[0:3], v[112:115]
    ds_read_b64_tr_b16 a[184:185], v99
    s_add_u32 s76, s43, 2
    v_mfma_f32_16x16x32_bf16 v[116:119], a[76:79], a[0:3], v[116:119]
    ds_read_b64_tr_b16 a[186:187], v99 offset:4096
    v_mfma_f32_16x16x32_bf16 v[120:123], a[72:75], a[8:11], v[120:123]
    ds_read_b64_tr_b16 a[188:189], v99 offset:8
    s_and_b32 s76, s76, 3
    v_mfma_f32_16x16x32_bf16 v[124:127], a[76:79], a[8:11], v[124:127]
    ds_read_b64_tr_b16 a[190:191], v99 offset:4104
    v_mfma_f32_16x16x32_bf16 v[128:131], a[72:75], a[16:19], v[128:131]
    ds_read_b64_tr_b16 a[192:193], v99 offset:8192
    s_lshl_b32 s76, s76, 2
    v_mfma_f32_16x16x32_bf16 v[132:135], a[76:79], a[16:19], v[132:135]
    ds_read_b64_tr_b16 a[194:195], v99 offset:12288
    s_add_u32 s76, s76, 2
    v_mfma_f32_16x16x32_bf16 v[136:139], a[72:75], a[24:27], v[136:139]
    ds_read_b64_tr_b16 a[196:197], v99 offset:8200
    v_mfma_f32_16x16x32_bf16 v[140:143], a[76:79], a[24:27], v[140:143]
    ds_read_b64_tr_b16 a[198:199], v99 offset:12296
    s_xor_b32 s76, s76, s3
    v_mfma_f32_16x16x32_bf16 v[144:147], a[72:75], a[32:35], v[144:147]
    ds_read_b128 a[112:115], v101
    v_mfma_f32_16x16x32_bf16 v[148:151], a[76:79], a[32:35], v[148:151]
    ds_read_b128 a[116:119], v101 offset:1024
    s_lshl_b32 s77, s76, 16
    v_mfma_f32_16x16x32_bf16 v[152:155], a[72:75], a[40:43], v[152:155]
    ds_read_b128 a[120:123], v101 offset:2048
    s_mul_i32 s76, s76, 18432
    v_mfma_f32_16x16x32_bf16 v[156:159], a[76:79], a[40:43], v[156:159]
    ds_read_b128 a[124:127], v101 offset:3072
    v_mfma_f32_16x16x32_bf16 v[160:163], a[72:75], a[48:51], v[160:163]
    ds_read_b128 a[128:131], v101 offset:4096
    s_add_u32 s76, s76, s80
    v_mfma_f32_16x16x32_bf16 v[164:167], a[76:79], a[48:51], v[164:167]
    ds_read_b128 a[132:135], v101 offset:5120
    v_mfma_f32_16x16x32_bf16 v[168:171], a[72:75], a[56:59], v[168:171]
    ds_read_b128 a[136:139], v101 offset:6144
    s_add_u32 m0, s61, 51200
    v_mfma_f32_16x16x32_bf16 v[172:175], a[76:79], a[56:59], v[172:175]
    ds_read_b128 a[140:143], v101 offset:7168
    buffer_load_dwordx4 v2, s[20:23], s76 offen sc1 lds
    v_mfma_f32_16x16x32_bf16 v[176:179], a[72:75], a[64:67], v[176:179]
    ds_read_b128 a[144:147], v101 offset:8192
    v_mfma_f32_16x16x32_bf16 v[180:183], a[76:79], a[64:67], v[180:183]
    ds_read_b128 a[148:151], v101 offset:9216
    buffer_load_dwordx4 v2, s[20:23], s76 offen offset:1024 sc1 lds
    v_mfma_f32_16x16x32_bf16 v[112:115], a[80:83], a[4:7], v[112:115]
    ds_read_b128 a[152:155], v101 offset:10240
    buffer_load_dwordx4 v2, s[20:23], s76 offen offset:2048 sc1 lds
    v_mfma_f32_16x16x32_bf16 v[116:119], a[84:87], a[4:7], v[116:119]
    ds_read_b128 a[156:159], v101 offset:11264
    v_mfma_f32_16x16x32_bf16 v[120:123], a[80:83], a[12:15], v[120:123]
    ds_read_b128 a[160:163], v101 offset:12288
    buffer_load_dwordx4 v2, s[20:23], s76 offen offset:3072 sc1 lds
    v_mfma_f32_16x16x32_bf16 v[124:127], a[84:87], a[12:15], v[124:127]
    ds_read_b128 a[164:167], v101 offset:13312
    v_mfma_f32_16x16x32_bf16 v[128:131], a[80:83], a[20:23], v[128:131]
    ds_read_b128 a[168:171], v101 offset:14336
    s_add_u32 m0, s61, 55296
    v_mfma_f32_16x16x32_bf16 v[132:135], a[84:87], a[20:23], v[132:135]
    ds_read_b128 a[172:175], v101 offset:15360
    s_add_u32 s76, s76, 4096
    v_mfma_f32_16x16x32_bf16 v[136:139], a[80:83], a[28:31], v[136:139]
    ds_read_b128 a[176:179], v101 offset:16384
    v_mfma_f32_16x16x32_bf16 v[140:143], a[84:87], a[28:31], v[140:143]
    ds_read_b128 a[180:183], v101 offset:17408
    buffer_load_dwordx4 v2, s[20:23], s76 offen sc1 lds
    v_mfma_f32_16x16x32_bf16 v[144:147], a[80:83], a[36:39], v[144:147]
    v_mfma_f32_16x16x32_bf16 v[148:151], a[84:87], a[36:39], v[148:151]
    s_add_u32 s77, s77, s79
    v_mfma_f32_16x16x32_bf16 v[152:155], a[80:83], a[44:47], v[152:155]
    s_add_u32 m0, s66, 16384
    v_mfma_f32_16x16x32_bf16 v[156:159], a[84:87], a[44:47], v[156:159]
    v_mfma_f32_16x16x32_bf16 v[160:163], a[80:83], a[52:55], v[160:163]
    buffer_load_dwordx4 v24, s[24:27], s77 offen lds
    v_mfma_f32_16x16x32_bf16 v[164:167], a[84:87], a[52:55], v[164:167]
    v_mfma_f32_16x16x32_bf16 v[168:171], a[80:83], a[60:63], v[168:171]
    buffer_load_dwordx4 v25, s[24:27], s77 offen offset:1024 lds
    v_mfma_f32_16x16x32_bf16 v[172:175], a[84:87], a[60:63], v[172:175]
    buffer_load_dwordx4 v26, s[24:27], s77 offen offset:2048 lds
    v_mfma_f32_16x16x32_bf16 v[176:179], a[80:83], a[68:71], v[176:179]
    v_mfma_f32_16x16x32_bf16 v[180:183], a[84:87], a[68:71], v[180:183]
    buffer_load_dwordx4 v27, s[24:27], s77 offen offset:3072 lds
    s_waitcnt vmcnt(18)
    s_waitcnt lgkmcnt(0)
    s_barrier
    v_mfma_f32_16x16x32_bf16 v[112:115], a[184:187], a[112:115], v[112:115]
    ds_read_b64_tr_b16 a[72:73], v99 offset:34816
    s_add_u32 s76, s43, 3
    v_mfma_f32_16x16x32_bf16 v[116:119], a[188:191], a[112:115], v[116:119]
    ds_read_b64_tr_b16 a[74:75], v99 offset:38912
    v_mfma_f32_16x16x32_bf16 v[120:123], a[184:187], a[120:123], v[120:123]
    ds_read_b64_tr_b16 a[76:77], v99 offset:34824
    s_and_b32 s76, s76, 3
    v_mfma_f32_16x16x32_bf16 v[124:127], a[188:191], a[120:123], v[124:127]
    ds_read_b64_tr_b16 a[78:79], v99 offset:38920
    v_mfma_f32_16x16x32_bf16 v[128:131], a[184:187], a[128:131], v[128:131]
    ds_read_b64_tr_b16 a[80:81], v99 offset:43008
    s_lshl_b32 s76, s76, 2
    v_mfma_f32_16x16x32_bf16 v[132:135], a[188:191], a[128:131], v[132:135]
    ds_read_b64_tr_b16 a[82:83], v99 offset:47104
    s_add_u32 s76, s76, 2
    v_mfma_f32_16x16x32_bf16 v[136:139], a[184:187], a[136:139], v[136:139]
    ds_read_b64_tr_b16 a[84:85], v99 offset:43016
    v_mfma_f32_16x16x32_bf16 v[140:143], a[188:191], a[136:139], v[140:143]
    ds_read_b64_tr_b16 a[86:87], v99 offset:47112
    s_xor_b32 s76, s76, s3
    v_mfma_f32_16x16x32_bf16 v[144:147], a[184:187], a[144:147], v[144:147]
    ds_read_b128 a[0:3], v101 offset:34816
    v_mfma_f32_16x16x32_bf16 v[148:151], a[188:191], a[144:147], v[148:151]
    ds_read_b128 a[4:7], v101 offset:35840
    s_lshl_b32 s77, s76, 16
    v_mfma_f32_16x16x32_bf16 v[152:155], a[184:187], a[152:155], v[152:155]
    ds_read_b128 a[8:11], v101 offset:36864
    s_mul_i32 s76, s76, 18432
    v_mfma_f32_16x16x32_bf16 v[156:159], a[188:191], a[152:155], v[156:159]
    ds_read_b128 a[12:15], v101 offset:37888
    v_mfma_f32_16x16x32_bf16 v[160:163], a[184:187], a[160:163], v[160:163]
    ds_read_b128 a[16:19], v101 offset:38912
    s_add_u32 s76, s76, s80
    v_mfma_f32_16x16x32_bf16 v[164:167], a[188:191], a[160:163], v[164:167]
    ds_read_b128 a[20:23], v101 offset:39936
    v_mfma_f32_16x16x32_bf16 v[168:171], a[184:187], a[168:171], v[168:171]
    ds_read_b128 a[24:27], v101 offset:40960
    s_add_u32 m0, s61, 86016
    v_mfma_f32_16x16x32_bf16 v[172:175], a[188:191], a[168:171], v[172:175]
    ds_read_b128 a[28:31], v101 offset:41984
    buffer_load_dwordx4 v2, s[20:23], s76 offen sc1 lds
    v_mfma_f32_16x16x32_bf16 v[176:179], a[184:187], a[176:179], v[176:179]
    ds_read_b128 a[32:35], v101 offset:43008
    v_mfma_f32_16x16x32_bf16 v[180:183], a[188:191], a[176:179], v[180:183]
    ds_read_b128 a[36:39], v101 offset:44032
    buffer_load_dwordx4 v2, s[20:23], s76 offen offset:1024 sc1 lds
    v_mfma_f32_16x16x32_bf16 v[112:115], a[192:195], a[116:119], v[112:115]
    ds_read_b128 a[40:43], v101 offset:45056
    buffer_load_dwordx4 v2, s[20:23], s76 offen offset:2048 sc1 lds
    v_mfma_f32_16x16x32_bf16 v[116:119], a[196:199], a[116:119], v[116:119]
    ds_read_b128 a[44:47], v101 offset:46080
    v_mfma_f32_16x16x32_bf16 v[120:123], a[192:195], a[124:127], v[120:123]
    ds_read_b128 a[48:51], v101 offset:47104
    buffer_load_dwordx4 v2, s[20:23], s76 offen offset:3072 sc1 lds
    v_mfma_f32_16x16x32_bf16 v[124:127], a[196:199], a[124:127], v[124:127]
    ds_read_b128 a[52:55], v101 offset:48128
    v_mfma_f32_16x16x32_bf16 v[128:131], a[192:195], a[132:135], v[128:131]
    ds_read_b128 a[56:59], v101 offset:49152
    s_add_u32 m0, s61, 90112
    v_mfma_f32_16x16x32_bf16 v[132:135], a[196:199], a[132:135], v[132:135]
    ds_read_b128 a[60:63], v101 offset:50176
    s_add_u32 s76, s76, 4096
    v_mfma_f32_16x16x32_bf16 v[136:139], a[192:195], a[140:143], v[136:139]
    ds_read_b128 a[64:67], v101 offset:51200
    v_mfma_f32_16x16x32_bf16 v[140:143], a[196:199], a[140:143], v[140:143]
    ds_read_b128 a[68:71], v101 offset:52224
    buffer_load_dwordx4 v2, s[20:23], s76 offen sc1 lds
    v_mfma_f32_16x16x32_bf16 v[144:147], a[192:195], a[148:151], v[144:147]
    v_mfma_f32_16x16x32_bf16 v[148:151], a[196:199], a[148:151], v[148:151]
    s_add_u32 s77, s77, s79
    v_mfma_f32_16x16x32_bf16 v[152:155], a[192:195], a[156:159], v[152:155]
    s_add_u32 m0, s66, 69632
    v_mfma_f32_16x16x32_bf16 v[156:159], a[196:199], a[156:159], v[156:159]
    v_mfma_f32_16x16x32_bf16 v[160:163], a[192:195], a[164:167], v[160:163]
    buffer_load_dwordx4 v24, s[24:27], s77 offen lds
    v_mfma_f32_16x16x32_bf16 v[164:167], a[196:199], a[164:167], v[164:167]
    v_mfma_f32_16x16x32_bf16 v[168:171], a[192:195], a[172:175], v[168:171]
    buffer_load_dwordx4 v25, s[24:27], s77 offen offset:1024 lds
    v_mfma_f32_16x16x32_bf16 v[172:175], a[196:199], a[172:175], v[172:175]
    buffer_load_dwordx4 v26, s[24:27], s77 offen offset:2048 lds
    v_mfma_f32_16x16x32_bf16 v[176:179], a[192:195], a[180:183], v[176:179]
    v_mfma_f32_16x16x32_bf16 v[180:183], a[196:199], a[180:183], v[180:183]
    buffer_load_dwordx4 v27, s[24:27], s77 offen offset:3072 lds
    s_waitcnt vmcnt(18)
    s_waitcnt lgkmcnt(0)
    s_barrier
    v_mfma_f32_16x16x32_bf16 v[112:115], a[72:75], a[0:3], v[112:115]
    ds_read_b64_tr_b16 a[184:185], v100
    s_add_u32 s76, s43, 1
    v_mfma_f32_16x16x32_bf16 v[116:119], a[76:79], a[0:3], v[116:119]
    ds_read_b64_tr_b16 a[186:187], v100 offset:4096
    v_mfma_f32_16x16x32_bf16 v[120:123], a[72:75], a[8:11], v[120:123]
    ds_read_b64_tr_b16 a[188:189], v100 offset:8
    s_and_b32 s76, s76, 3
    v_mfma_f32_16x16x32_bf16 v[124:127], a[76:79], a[8:11], v[124:127]
    ds_read_b64_tr_b16 a[190:191], v100 offset:4104
    v_mfma_f32_16x16x32_bf16 v[128:131], a[72:75], a[16:19], v[128:131]
    ds_read_b64_tr_b16 a[192:193], v100 offset:8192
    s_lshl_b32 s76, s76, 2
    v_mfma_f32_16x16x32_bf16 v[132:135], a[76:79], a[16:19], v[132:135]
    ds_read_b64_tr_b16 a[194:195], v100 offset:12288
    s_add_u32 s76, s76, 3
    v_mfma_f32_16x16x32_bf16 v[136:139], a[72:75], a[24:27], v[136:139]
    ds_read_b64_tr_b16 a[196:197], v100 offset:8200
    v_mfma_f32_16x16x32_bf16 v[140:143], a[76:79], a[24:27], v[140:143]
    ds_read_b64_tr_b16 a[198:199], v100 offset:12296
    s_xor_b32 s76, s76, s3
    v_mfma_f32_16x16x32_bf16 v[144:147], a[72:75], a[32:35], v[144:147]
    ds_read_b128 a[112:115], v102
    v_mfma_f32_16x16x32_bf16 v[148:151], a[76:79], a[32:35], v[148:151]
    ds_read_b128 a[116:119], v102 offset:1024
    s_lshl_b32 s77, s76, 16
    v_mfma_f32_16x16x32_bf16 v[152:155], a[72:75], a[40:43], v[152:155]
    ds_read_b128 a[120:123], v102 offset:2048
    s_mul_i32 s76, s76, 18432
    v_mfma_f32_16x16x32_bf16 v[156:159], a[76:79], a[40:43], v[156:159]
    ds_read_b128 a[124:127], v102 offset:3072
    v_mfma_f32_16x16x32_bf16 v[160:163], a[72:75], a[48:51], v[160:163]
    ds_read_b128 a[128:131], v102 offset:4096
    s_add_u32 s76, s76, s80
    v_mfma_f32_16x16x32_bf16 v[164:167], a[76:79], a[48:51], v[164:167]
    ds_read_b128 a[132:135], v102 offset:5120
    v_mfma_f32_16x16x32_bf16 v[168:171], a[72:75], a[56:59], v[168:171]
    ds_read_b128 a[136:139], v102 offset:6144
    s_add_u32 m0, s61, 120832
    v_mfma_f32_16x16x32_bf16 v[172:175], a[76:79], a[56:59], v[172:175]
    ds_read_b128 a[140:143], v102 offset:7168
    buffer_load_dwordx4 v2, s[20:23], s76 offen sc1 lds
    v_mfma_f32_16x16x32_bf16 v[176:179], a[72:75], a[64:67], v[176:179]
    ds_read_b128 a[144:147], v102 offset:8192
    v_mfma_f32_16x16x32_bf16 v[180:183], a[76:79], a[64:67], v[180:183]
    ds_read_b128 a[148:151], v102 offset:9216
    buffer_load_dwordx4 v2, s[20:23], s76 offen offset:1024 sc1 lds
    v_mfma_f32_16x16x32_bf16 v[112:115], a[80:83], a[4:7], v[112:115]
    ds_read_b128 a[152:155], v102 offset:10240
    buffer_load_dwordx4 v2, s[20:23], s76 offen offset:2048 sc1 lds
    v_mfma_f32_16x16x32_bf16 v[116:119], a[84:87], a[4:7], v[116:119]
    ds_read_b128 a[156:159], v102 offset:11264
    v_mfma_f32_16x16x32_bf16 v[120:123], a[80:83], a[12:15], v[120:123]
    ds_read_b128 a[160:163], v102 offset:12288
    buffer_load_dwordx4 v2, s[20:23], s76 offen offset:3072 sc1 lds
    v_mfma_f32_16x16x32_bf16 v[124:127], a[84:87], a[12:15], v[124:127]
    ds_read_b128 a[164:167], v102 offset:13312
    v_mfma_f32_16x16x32_bf16 v[128:131], a[80:83], a[20:23], v[128:131]
    ds_read_b128 a[168:171], v102 offset:14336
    s_add_u32 m0, s61, 124928
    v_mfma_f32_16x16x32_bf16 v[132:135], a[84:87], a[20:23], v[132:135]
    ds_read_b128 a[172:175], v102 offset:15360
    s_add_u32 s76, s76, 4096
    v_mfma_f32_16x16x32_bf16 v[136:139], a[80:83], a[28:31], v[136:139]
    ds_read_b128 a[176:179], v102 offset:16384
    v_mfma_f32_16x16x32_bf16 v[140:143], a[84:87], a[28:31], v[140:143]
    ds_read_b128 a[180:183], v102 offset:17408
    buffer_load_dwordx4 v2, s[20:23], s76 offen sc1 lds
    v_mfma_f32_16x16x32_bf16 v[144:147], a[80:83], a[36:39], v[144:147]
    v_mfma_f32_16x16x32_bf16 v[148:151], a[84:87], a[36:39], v[148:151]
    s_add_u32 s77, s77, s79
    v_mfma_f32_16x16x32_bf16 v[152:155], a[80:83], a[44:47], v[152:155]
    s_add_u32 m0, s66, 104448
    v_mfma_f32_16x16x32_bf16 v[156:159], a[84:87], a[44:47], v[156:159]
    v_mfma_f32_16x16x32_bf16 v[160:163], a[80:83], a[52:55], v[160:163]
    buffer_load_dwordx4 v24, s[24:27], s77 offen lds
    v_mfma_f32_16x16x32_bf16 v[164:167], a[84:87], a[52:55], v[164:167]
    v_mfma_f32_16x16x32_bf16 v[168:171], a[80:83], a[60:63], v[168:171]
    buffer_load_dwordx4 v25, s[24:27], s77 offen offset:1024 lds
    v_mfma_f32_16x16x32_bf16 v[172:175], a[84:87], a[60:63], v[172:175]
    buffer_load_dwordx4 v26, s[24:27], s77 offen offset:2048 lds
    v_mfma_f32_16x16x32_bf16 v[176:179], a[80:83], a[68:71], v[176:179]
    v_mfma_f32_16x16x32_bf16 v[180:183], a[84:87], a[68:71], v[180:183]
    buffer_load_dwordx4 v27, s[24:27], s77 offen offset:3072 lds
    s_waitcnt vmcnt(18)
    s_waitcnt lgkmcnt(0)
    s_barrier
    v_mfma_f32_16x16x32_bf16 v[112:115], a[184:187], a[112:115], v[112:115]
    ds_read_b64_tr_b16 a[72:73], v100 offset:16384
    s_add_u32 s76, s43, 2
    v_mfma_f32_16x16x32_bf16 v[116:119], a[188:191], a[112:115], v[116:119]
    ds_read_b64_tr_b16 a[74:75], v100 offset:20480
    v_mfma_f32_16x16x32_bf16 v[120:123], a[184:187], a[120:123], v[120:123]
    ds_read_b64_tr_b16 a[76:77], v100 offset:16392
    s_and_b32 s76, s76, 3
    v_mfma_f32_16x16x32_bf16 v[124:127], a[188:191], a[120:123], v[124:127]
    ds_read_b64_tr_b16 a[78:79], v100 offset:20488
    v_mfma_f32_16x16x32_bf16 v[128:131], a[184:187], a[128:131], v[128:131]
    ds_read_b64_tr_b16 a[80:81], v100 offset:24576
    s_lshl_b32 s76, s76, 2
    v_mfma_f32_16x16x32_bf16 v[132:135], a[188:191], a[128:131], v[132:135]
    ds_read_b64_tr_b16 a[82:83], v100 offset:28672
    s_add_u32 s76, s76, 3
    v_mfma_f32_16x16x32_bf16 v[136:139], a[184:187], a[136:139], v[136:139]
    ds_read_b64_tr_b16 a[84:85], v100 offset:24584
    v_mfma_f32_16x16x32_bf16 v[140:143], a[188:191], a[136:139], v[140:143]
    ds_read_b64_tr_b16 a[86:87], v100 offset:28680
    s_xor_b32 s76, s76, s3
    v_mfma_f32_16x16x32_bf16 v[144:147], a[184:187], a[144:147], v[144:147]
    ds_read_b128 a[0:3], v102 offset:18432
    v_mfma_f32_16x16x32_bf16 v[148:151], a[188:191], a[144:147], v[148:151]
    ds_read_b128 a[4:7], v102 offset:19456
    s_lshl_b32 s77, s76, 16
    v_mfma_f32_16x16x32_bf16 v[152:155], a[184:187], a[152:155], v[152:155]
    ds_read_b128 a[8:11], v102 offset:20480
    s_mul_i32 s76, s76, 18432
    v_mfma_f32_16x16x32_bf16 v[156:159], a[188:191], a[152:155], v[156:159]
    ds_read_b128 a[12:15], v102 offset:21504
    v_mfma_f32_16x16x32_bf16 v[160:163], a[184:187], a[160:163], v[160:163]
    ds_read_b128 a[16:19], v102 offset:22528
    s_add_u32 s76, s76, s80
    v_mfma_f32_16x16x32_bf16 v[164:167], a[188:191], a[160:163], v[164:167]
    ds_read_b128 a[20:23], v102 offset:23552
    v_mfma_f32_16x16x32_bf16 v[168:171], a[184:187], a[168:171], v[168:171]
    ds_read_b128 a[24:27], v102 offset:24576
    s_add_u32 m0, s61, 32768
    v_mfma_f32_16x16x32_bf16 v[172:175], a[188:191], a[168:171], v[172:175]
    ds_read_b128 a[28:31], v102 offset:25600
    buffer_load_dwordx4 v2, s[20:23], s76 offen sc1 lds
    v_mfma_f32_16x16x32_bf16 v[176:179], a[184:187], a[176:179], v[176:179]
    ds_read_b128 a[32:35], v102 offset:26624
    v_mfma_f32_16x16x32_bf16 v[180:183], a[188:191], a[176:179], v[180:183]
    ds_read_b128 a[36:39], v102 offset:27648
    buffer_load_dwordx4 v2, s[20:23], s76 offen offset:1024 sc1 lds
    v_mfma_f32_16x16x32_bf16 v[112:115], a[192:195], a[116:119], v[112:115]
    ds_read_b128 a[40:43], v102 offset:28672
    buffer_load_dwordx4 v2, s[20:23], s76 offen offset:2048 sc1 lds
    v_mfma_f32_16x16x32_bf16 v[116:119], a[196:199], a[116:119], v[116:119]
    ds_read_b128 a[44:47], v102 offset:29696
    v_mfma_f32_16x16x32_bf16 v[120:123], a[192:195], a[124:127], v[120:123]
    ds_read_b128 a[48:51], v102 offset:30720
    buffer_load_dwordx4 v2, s[20:23], s76 offen offset:3072 sc1 lds
    v_mfma_f32_16x16x32_bf16 v[124:127], a[196:199], a[124:127], v[124:127]
    ds_read_b128 a[52:55], v102 offset:31744
    v_mfma_f32_16x16x32_bf16 v[128:131], a[192:195], a[132:135], v[128:131]
    ds_read_b128 a[56:59], v102 offset:32768
    s_add_u32 m0, s61, 36864
    v_mfma_f32_16x16x32_bf16 v[132:135], a[196:199], a[132:135], v[132:135]
    ds_read_b128 a[60:63], v102 offset:33792
    s_add_u32 s76, s76, 4096
    v_mfma_f32_16x16x32_bf16 v[136:139], a[192:195], a[140:143], v[136:139]
    ds_read_b128 a[64:67], v102 offset:34816
    v_mfma_f32_16x16x32_bf16 v[140:143], a[196:199], a[140:143], v[140:143]
    ds_read_b128 a[68:71], v102 offset:35840
    buffer_load_dwordx4 v2, s[20:23], s76 offen sc1 lds
    v_mfma_f32_16x16x32_bf16 v[144:147], a[192:195], a[148:151], v[144:147]
    v_mfma_f32_16x16x32_bf16 v[148:151], a[196:199], a[148:151], v[148:151]
    s_add_u32 s77, s77, s79
    v_mfma_f32_16x16x32_bf16 v[152:155], a[192:195], a[156:159], v[152:155]
    s_add_u32 m0, s66, 0
    v_mfma_f32_16x16x32_bf16 v[156:159], a[196:199], a[156:159], v[156:159]
    v_mfma_f32_16x16x32_bf16 v[160:163], a[192:195], a[164:167], v[160:163]
    buffer_load_dwordx4 v24, s[24:27], s77 offen lds
    v_mfma_f32_16x16x32_bf16 v[164:167], a[196:199], a[164:167], v[164:167]
    v_mfma_f32_16x16x32_bf16 v[168:171], a[192:195], a[172:175], v[168:171]
    buffer_load_dwordx4 v25, s[24:27], s77 offen offset:1024 lds
    v_mfma_f32_16x16x32_bf16 v[172:175], a[196:199], a[172:175], v[172:175]
    buffer_load_dwordx4 v26, s[24:27], s77 offen offset:2048 lds
    v_mfma_f32_16x16x32_bf16 v[176:179], a[192:195], a[180:183], v[176:179]
    v_mfma_f32_16x16x32_bf16 v[180:183], a[196:199], a[180:183], v[180:183]
    buffer_load_dwordx4 v27, s[24:27], s77 offen offset:3072 lds
    s_waitcnt vmcnt(18)
    s_waitcnt lgkmcnt(0)
    s_barrier
    v_mfma_f32_16x16x32_bf16 v[112:115], a[72:75], a[0:3], v[112:115]
    ds_read_b64_tr_b16 a[184:185], v99
    s_add_u32 s76, s43, 3
    v_mfma_f32_16x16x32_bf16 v[116:119], a[76:79], a[0:3], v[116:119]
    ds_read_b64_tr_b16 a[186:187], v99 offset:4096
    v_mfma_f32_16x16x32_bf16 v[120:123], a[72:75], a[8:11], v[120:123]
    ds_read_b64_tr_b16 a[188:189], v99 offset:8
    s_and_b32 s76, s76, 3
    v_mfma_f32_16x16x32_bf16 v[124:127], a[76:79], a[8:11], v[124:127]
    ds_read_b64_tr_b16 a[190:191], v99 offset:4104
    v_mfma_f32_16x16x32_bf16 v[128:131], a[72:75], a[16:19], v[128:131]
    ds_read_b64_tr_b16 a[192:193], v99 offset:8192
    s_lshl_b32 s76, s76, 2
    v_mfma_f32_16x16x32_bf16 v[132:135], a[76:79], a[16:19], v[132:135]
    ds_read_b64_tr_b16 a[194:195], v99 offset:12288
    s_add_u32 s76, s76, 3
    v_mfma_f32_16x16x32_bf16 v[136:139], a[72:75], a[24:27], v[136:139]
    ds_read_b64_tr_b16 a[196:197], v99 offset:8200
    v_mfma_f32_16x16x32_bf16 v[140:143], a[76:79], a[24:27], v[140:143]
    ds_read_b64_tr_b16 a[198:199], v99 offset:12296
    s_xor_b32 s76, s76, s3
    v_mfma_f32_16x16x32_bf16 v[144:147], a[72:75], a[32:35], v[144:147]
    ds_read_b128 a[112:115], v101
    v_mfma_f32_16x16x32_bf16 v[148:151], a[76:79], a[32:35], v[148:151]
    ds_read_b128 a[116:119], v101 offset:1024
    s_lshl_b32 s77, s76, 16
    v_mfma_f32_16x16x32_bf16 v[152:155], a[72:75], a[40:43], v[152:155]
    ds_read_b128 a[120:123], v101 offset:2048
    s_mul_i32 s76, s76, 18432
    v_mfma_f32_16x16x32_bf16 v[156:159], a[76:79], a[40:43], v[156:159]
    ds_read_b128 a[124:127], v101 offset:3072
    v_mfma_f32_16x16x32_bf16 v[160:163], a[72:75], a[48:51], v[160:163]
    ds_read_b128 a[128:131], v101 offset:4096
    s_add_u32 s76, s76, s80
    v_mfma_f32_16x16x32_bf16 v[164:167], a[76:79], a[48:51], v[164:167]
    ds_read_b128 a[132:135], v101 offset:5120
    v_mfma_f32_16x16x32_bf16 v[168:171], a[72:75], a[56:59], v[168:171]
    ds_read_b128 a[136:139], v101 offset:6144
    s_add_u32 m0, s61, 51200
    v_mfma_f32_16x16x32_bf16 v[172:175], a[76:79], a[56:59], v[172:175]
    ds_read_b128 a[140:143], v101 offset:7168
    buffer_load_dwordx4 v2, s[20:23], s76 offen sc1 lds
    v_mfma_f32_16x16x32_bf16 v[176:179], a[72:75], a[64:67], v[176:179]
    ds_read_b128 a[144:147], v101 offset:8192
    v_mfma_f32_16x16x32_bf16 v[180:183], a[76:79], a[64:67], v[180:183]
    ds_read_b128 a[148:151], v101 offset:9216
    buffer_load_dwordx4 v2, s[20:23], s76 offen offset:1024 sc1 lds
    v_mfma_f32_16x16x32_bf16 v[112:115], a[80:83], a[4:7], v[112:115]
    ds_read_b128 a[152:155], v101 offset:10240
    buffer_load_dwordx4 v2, s[20:23], s76 offen offset:2048 sc1 lds
    v_mfma_f32_16x16x32_bf16 v[116:119], a[84:87], a[4:7], v[116:119]
    ds_read_b128 a[156:159], v101 offset:11264
    v_mfma_f32_16x16x32_bf16 v[120:123], a[80:83], a[12:15], v[120:123]
    ds_read_b128 a[160:163], v101 offset:12288
    buffer_load_dwordx4 v2, s[20:23], s76 offen offset:3072 sc1 lds
    v_mfma_f32_16x16x32_bf16 v[124:127], a[84:87], a[12:15], v[124:127]
    ds_read_b128 a[164:167], v101 offset:13312
    v_mfma_f32_16x16x32_bf16 v[128:131], a[80:83], a[20:23], v[128:131]
    ds_read_b128 a[168:171], v101 offset:14336
    s_add_u32 m0, s61, 55296
    v_mfma_f32_16x16x32_bf16 v[132:135], a[84:87], a[20:23], v[132:135]
    ds_read_b128 a[172:175], v101 offset:15360
    s_add_u32 s76, s76, 4096
    v_mfma_f32_16x16x32_bf16 v[136:139], a[80:83], a[28:31], v[136:139]
    ds_read_b128 a[176:179], v101 offset:16384
    v_mfma_f32_16x16x32_bf16 v[140:143], a[84:87], a[28:31], v[140:143]
    ds_read_b128 a[180:183], v101 offset:17408
    buffer_load_dwordx4 v2, s[20:23], s76 offen sc1 lds
    v_mfma_f32_16x16x32_bf16 v[144:147], a[80:83], a[36:39], v[144:147]
    v_mfma_f32_16x16x32_bf16 v[148:151], a[84:87], a[36:39], v[148:151]
    s_add_u32 s77, s77, s79
    v_mfma_f32_16x16x32_bf16 v[152:155], a[80:83], a[44:47], v[152:155]
    s_add_u32 m0, s66, 16384
    v_mfma_f32_16x16x32_bf16 v[156:159], a[84:87], a[44:47], v[156:159]
    v_mfma_f32_16x16x32_bf16 v[160:163], a[80:83], a[52:55], v[160:163]
    buffer_load_dwordx4 v24, s[24:27], s77 offen lds
    v_mfma_f32_16x16x32_bf16 v[164:167], a[84:87], a[52:55], v[164:167]
    v_mfma_f32_16x16x32_bf16 v[168:171], a[80:83], a[60:63], v[168:171]
    buffer_load_dwordx4 v25, s[24:27], s77 offen offset:1024 lds
    v_mfma_f32_16x16x32_bf16 v[172:175], a[84:87], a[60:63], v[172:175]
    buffer_load_dwordx4 v26, s[24:27], s77 offen offset:2048 lds
    v_mfma_f32_16x16x32_bf16 v[176:179], a[80:83], a[68:71], v[176:179]
    v_mfma_f32_16x16x32_bf16 v[180:183], a[84:87], a[68:71], v[180:183]
    buffer_load_dwordx4 v27, s[24:27], s77 offen offset:3072 lds
    s_waitcnt vmcnt(18)
    s_waitcnt lgkmcnt(0)
    s_barrier
    v_mfma_f32_16x16x32_bf16 v[112:115], a[184:187], a[112:115], v[112:115]
    ds_read_b64_tr_b16 a[72:73], v99 offset:34816
    v_mfma_f32_16x16x32_bf16 v[116:119], a[188:191], a[112:115], v[116:119]
    ds_read_b64_tr_b16 a[74:75], v99 offset:38912
    v_mfma_f32_16x16x32_bf16 v[120:123], a[184:187], a[120:123], v[120:123]
    ds_read_b64_tr_b16 a[76:77], v99 offset:34824
    v_mfma_f32_16x16x32_bf16 v[124:127], a[188:191], a[120:123], v[124:127]
    ds_read_b64_tr_b16 a[78:79], v99 offset:38920
    v_mfma_f32_16x16x32_bf16 v[128:131], a[184:187], a[128:131], v[128:131]
    ds_read_b64_tr_b16 a[80:81], v99 offset:43008
    v_mfma_f32_16x16x32_bf16 v[132:135], a[188:191], a[128:131], v[132:135]
    ds_read_b64_tr_b16 a[82:83], v99 offset:47104
    v_mfma_f32_16x16x32_bf16 v[136:139], a[184:187], a[136:139], v[136:139]
    ds_read_b64_tr_b16 a[84:85], v99 offset:43016
    v_mfma_f32_16x16x32_bf16 v[140:143], a[188:191], a[136:139], v[140:143]
    ds_read_b64_tr_b16 a[86:87], v99 offset:47112
    v_mfma_f32_16x16x32_bf16 v[144:147], a[184:187], a[144:147], v[144:147]
    ds_read_b128 a[0:3], v101 offset:34816
    v_mfma_f32_16x16x32_bf16 v[148:151], a[188:191], a[144:147], v[148:151]
    ds_read_b128 a[4:7], v101 offset:35840
    v_mfma_f32_16x16x32_bf16 v[152:155], a[184:187], a[152:155], v[152:155]
    ds_read_b128 a[8:11], v101 offset:36864
    v_mfma_f32_16x16x32_bf16 v[156:159], a[188:191], a[152:155], v[156:159]
    ds_read_b128 a[12:15], v101 offset:37888
    v_mfma_f32_16x16x32_bf16 v[160:163], a[184:187], a[160:163], v[160:163]
    ds_read_b128 a[16:19], v101 offset:38912
    v_mfma_f32_16x16x32_bf16 v[164:167], a[188:191], a[160:163], v[164:167]
    ds_read_b128 a[20:23], v101 offset:39936
    v_mfma_f32_16x16x32_bf16 v[168:171], a[184:187], a[168:171], v[168:171]
    ds_read_b128 a[24:27], v101 offset:40960
    v_mfma_f32_16x16x32_bf16 v[172:175], a[188:191], a[168:171], v[172:175]
    ds_read_b128 a[28:31], v101 offset:41984
    v_mfma_f32_16x16x32_bf16 v[176:179], a[184:187], a[176:179], v[176:179]
    ds_read_b128 a[32:35], v101 offset:43008
    v_mfma_f32_16x16x32_bf16 v[180:183], a[188:191], a[176:179], v[180:183]
    ds_read_b128 a[36:39], v101 offset:44032
    v_mfma_f32_16x16x32_bf16 v[112:115], a[192:195], a[116:119], v[112:115]
    ds_read_b128 a[40:43], v101 offset:45056
    v_mfma_f32_16x16x32_bf16 v[116:119], a[196:199], a[116:119], v[116:119]
    ds_read_b128 a[44:47], v101 offset:46080
    v_mfma_f32_16x16x32_bf16 v[120:123], a[192:195], a[124:127], v[120:123]
    ds_read_b128 a[48:51], v101 offset:47104
    v_mfma_f32_16x16x32_bf16 v[124:127], a[196:199], a[124:127], v[124:127]
    ds_read_b128 a[52:55], v101 offset:48128
    v_mfma_f32_16x16x32_bf16 v[128:131], a[192:195], a[132:135], v[128:131]
    ds_read_b128 a[56:59], v101 offset:49152
    v_mfma_f32_16x16x32_bf16 v[132:135], a[196:199], a[132:135], v[132:135]
    ds_read_b128 a[60:63], v101 offset:50176
    v_mfma_f32_16x16x32_bf16 v[136:139], a[192:195], a[140:143], v[136:139]
    ds_read_b128 a[64:67], v101 offset:51200
    v_mfma_f32_16x16x32_bf16 v[140:143], a[196:199], a[140:143], v[140:143]
    ds_read_b128 a[68:71], v101 offset:52224
    v_mfma_f32_16x16x32_bf16 v[144:147], a[192:195], a[148:151], v[144:147]
    v_mfma_f32_16x16x32_bf16 v[148:151], a[196:199], a[148:151], v[148:151]
    v_mfma_f32_16x16x32_bf16 v[152:155], a[192:195], a[156:159], v[152:155]
    v_mfma_f32_16x16x32_bf16 v[156:159], a[196:199], a[156:159], v[156:159]
    v_mfma_f32_16x16x32_bf16 v[160:163], a[192:195], a[164:167], v[160:163]
    v_mfma_f32_16x16x32_bf16 v[164:167], a[196:199], a[164:167], v[164:167]
    v_mfma_f32_16x16x32_bf16 v[168:171], a[192:195], a[172:175], v[168:171]
    v_mfma_f32_16x16x32_bf16 v[172:175], a[196:199], a[172:175], v[172:175]
    v_mfma_f32_16x16x32_bf16 v[176:179], a[192:195], a[180:183], v[176:179]
    v_mfma_f32_16x16x32_bf16 v[180:183], a[196:199], a[180:183], v[180:183]
    s_waitcnt vmcnt(9)
    s_waitcnt lgkmcnt(0)
    s_barrier
    v_mfma_f32_16x16x32_bf16 v[112:115], a[72:75], a[0:3], v[112:115]
    ds_read_b64_tr_b16 a[184:185], v100
    v_mfma_f32_16x16x32_bf16 v[116:119], a[76:79], a[0:3], v[116:119]
    ds_read_b64_tr_b16 a[186:187], v100 offset:4096
    v_mfma_f32_16x16x32_bf16 v[120:123], a[72:75], a[8:11], v[120:123]
    ds_read_b64_tr_b16 a[188:189], v100 offset:8
    v_mfma_f32_16x16x32_bf16 v[124:127], a[76:79], a[8:11], v[124:127]
    ds_read_b64_tr_b16 a[190:191], v100 offset:4104
    v_mfma_f32_16x16x32_bf16 v[128:131], a[72:75], a[16:19], v[128:131]
    ds_read_b64_tr_b16 a[192:193], v100 offset:8192
    v_mfma_f32_16x16x32_bf16 v[132:135], a[76:79], a[16:19], v[132:135]
    ds_read_b64_tr_b16 a[194:195], v100 offset:12288
    v_mfma_f32_16x16x32_bf16 v[136:139], a[72:75], a[24:27], v[136:139]
    ds_read_b64_tr_b16 a[196:197], v100 offset:8200
    v_mfma_f32_16x16x32_bf16 v[140:143], a[76:79], a[24:27], v[140:143]
    ds_read_b64_tr_b16 a[198:199], v100 offset:12296
    v_mfma_f32_16x16x32_bf16 v[144:147], a[72:75], a[32:35], v[144:147]
    ds_read_b128 a[112:115], v102
    v_mfma_f32_16x16x32_bf16 v[148:151], a[76:79], a[32:35], v[148:151]
    ds_read_b128 a[116:119], v102 offset:1024
    v_mfma_f32_16x16x32_bf16 v[152:155], a[72:75], a[40:43], v[152:155]
    ds_read_b128 a[120:123], v102 offset:2048
    v_mfma_f32_16x16x32_bf16 v[156:159], a[76:79], a[40:43], v[156:159]
    ds_read_b128 a[124:127], v102 offset:3072
    v_mfma_f32_16x16x32_bf16 v[160:163], a[72:75], a[48:51], v[160:163]
    ds_read_b128 a[128:131], v102 offset:4096
    v_mfma_f32_16x16x32_bf16 v[164:167], a[76:79], a[48:51], v[164:167]
    ds_read_b128 a[132:135], v102 offset:5120
    v_mfma_f32_16x16x32_bf16 v[168:171], a[72:75], a[56:59], v[168:171]
    ds_read_b128 a[136:139], v102 offset:6144
    v_mfma_f32_16x16x32_bf16 v[172:175], a[76:79], a[56:59], v[172:175]
    ds_read_b128 a[140:143], v102 offset:7168
    v_mfma_f32_16x16x32_bf16 v[176:179], a[72:75], a[64:67], v[176:179]
    ds_read_b128 a[144:147], v102 offset:8192
    v_mfma_f32_16x16x32_bf16 v[180:183], a[76:79], a[64:67], v[180:183]
    ds_read_b128 a[148:151], v102 offset:9216
    v_mfma_f32_16x16x32_bf16 v[112:115], a[80:83], a[4:7], v[112:115]
    ds_read_b128 a[152:155], v102 offset:10240
    v_mfma_f32_16x16x32_bf16 v[116:119], a[84:87], a[4:7], v[116:119]
    ds_read_b128 a[156:159], v102 offset:11264
    v_mfma_f32_16x16x32_bf16 v[120:123], a[80:83], a[12:15], v[120:123]
    ds_read_b128 a[160:163], v102 offset:12288
    v_mfma_f32_16x16x32_bf16 v[124:127], a[84:87], a[12:15], v[124:127]
    ds_read_b128 a[164:167], v102 offset:13312
    v_mfma_f32_16x16x32_bf16 v[128:131], a[80:83], a[20:23], v[128:131]
    ds_read_b128 a[168:171], v102 offset:14336
    v_mfma_f32_16x16x32_bf16 v[132:135], a[84:87], a[20:23], v[132:135]
    ds_read_b128 a[172:175], v102 offset:15360
    v_mfma_f32_16x16x32_bf16 v[136:139], a[80:83], a[28:31], v[136:139]
    ds_read_b128 a[176:179], v102 offset:16384
    v_mfma_f32_16x16x32_bf16 v[140:143], a[84:87], a[28:31], v[140:143]
    ds_read_b128 a[180:183], v102 offset:17408
    v_mfma_f32_16x16x32_bf16 v[144:147], a[80:83], a[36:39], v[144:147]
    v_mfma_f32_16x16x32_bf16 v[148:151], a[84:87], a[36:39], v[148:151]
    v_mfma_f32_16x16x32_bf16 v[152:155], a[80:83], a[44:47], v[152:155]
    v_mfma_f32_16x16x32_bf16 v[156:159], a[84:87], a[44:47], v[156:159]
    v_mfma_f32_16x16x32_bf16 v[160:163], a[80:83], a[52:55], v[160:163]
    v_mfma_f32_16x16x32_bf16 v[164:167], a[84:87], a[52:55], v[164:167]
    v_mfma_f32_16x16x32_bf16 v[168:171], a[80:83], a[60:63], v[168:171]
    v_mfma_f32_16x16x32_bf16 v[172:175], a[84:87], a[60:63], v[172:175]
    v_mfma_f32_16x16x32_bf16 v[176:179], a[80:83], a[68:71], v[176:179]
    v_mfma_f32_16x16x32_bf16 v[180:183], a[84:87], a[68:71], v[180:183]
    s_waitcnt vmcnt(0)
    s_waitcnt lgkmcnt(0)
    s_barrier
    v_mfma_f32_16x16x32_bf16 v[112:115], a[184:187], a[112:115], v[112:115]
    ds_read_b64_tr_b16 a[72:73], v100 offset:16384
    v_mfma_f32_16x16x32_bf16 v[116:119], a[188:191], a[112:115], v[116:119]
    ds_read_b64_tr_b16 a[74:75], v100 offset:20480
    v_mfma_f32_16x16x32_bf16 v[120:123], a[184:187], a[120:123], v[120:123]
    ds_read_b64_tr_b16 a[76:77], v100 offset:16392
    v_mfma_f32_16x16x32_bf16 v[124:127], a[188:191], a[120:123], v[124:127]
    ds_read_b64_tr_b16 a[78:79], v100 offset:20488
    v_mfma_f32_16x16x32_bf16 v[128:131], a[184:187], a[128:131], v[128:131]
    ds_read_b64_tr_b16 a[80:81], v100 offset:24576
    v_mfma_f32_16x16x32_bf16 v[132:135], a[188:191], a[128:131], v[132:135]
    ds_read_b64_tr_b16 a[82:83], v100 offset:28672
    v_mfma_f32_16x16x32_bf16 v[136:139], a[184:187], a[136:139], v[136:139]
    ds_read_b64_tr_b16 a[84:85], v100 offset:24584
    v_mfma_f32_16x16x32_bf16 v[140:143], a[188:191], a[136:139], v[140:143]
    ds_read_b64_tr_b16 a[86:87], v100 offset:28680
    v_mfma_f32_16x16x32_bf16 v[144:147], a[184:187], a[144:147], v[144:147]
    ds_read_b128 a[0:3], v102 offset:18432
    v_mfma_f32_16x16x32_bf16 v[148:151], a[188:191], a[144:147], v[148:151]
    ds_read_b128 a[4:7], v102 offset:19456
    v_mfma_f32_16x16x32_bf16 v[152:155], a[184:187], a[152:155], v[152:155]
    ds_read_b128 a[8:11], v102 offset:20480
    v_mfma_f32_16x16x32_bf16 v[156:159], a[188:191], a[152:155], v[156:159]
    ds_read_b128 a[12:15], v102 offset:21504
    v_mfma_f32_16x16x32_bf16 v[160:163], a[184:187], a[160:163], v[160:163]
    ds_read_b128 a[16:19], v102 offset:22528
    v_mfma_f32_16x16x32_bf16 v[164:167], a[188:191], a[160:163], v[164:167]
    ds_read_b128 a[20:23], v102 offset:23552
    v_mfma_f32_16x16x32_bf16 v[168:171], a[184:187], a[168:171], v[168:171]
    ds_read_b128 a[24:27], v102 offset:24576
    v_mfma_f32_16x16x32_bf16 v[172:175], a[188:191], a[168:171], v[172:175]
    ds_read_b128 a[28:31], v102 offset:25600
    v_mfma_f32_16x16x32_bf16 v[176:179], a[184:187], a[176:179], v[176:179]
    ds_read_b128 a[32:35], v102 offset:26624
    v_mfma_f32_16x16x32_bf16 v[180:183], a[188:191], a[176:179], v[180:183]
    ds_read_b128 a[36:39], v102 offset:27648
    v_mfma_f32_16x16x32_bf16 v[112:115], a[192:195], a[116:119], v[112:115]
    ds_read_b128 a[40:43], v102 offset:28672
    v_mfma_f32_16x16x32_bf16 v[116:119], a[196:199], a[116:119], v[116:119]
    ds_read_b128 a[44:47], v102 offset:29696
    v_mfma_f32_16x16x32_bf16 v[120:123], a[192:195], a[124:127], v[120:123]
    ds_read_b128 a[48:51], v102 offset:30720
    v_mfma_f32_16x16x32_bf16 v[124:127], a[196:199], a[124:127], v[124:127]
    ds_read_b128 a[52:55], v102 offset:31744
    v_mfma_f32_16x16x32_bf16 v[128:131], a[192:195], a[132:135], v[128:131]
    ds_read_b128 a[56:59], v102 offset:32768
    v_mfma_f32_16x16x32_bf16 v[132:135], a[196:199], a[132:135], v[132:135]
    ds_read_b128 a[60:63], v102 offset:33792
    v_mfma_f32_16x16x32_bf16 v[136:139], a[192:195], a[140:143], v[136:139]
    ds_read_b128 a[64:67], v102 offset:34816
    v_mfma_f32_16x16x32_bf16 v[140:143], a[196:199], a[140:143], v[140:143]
    ds_read_b128 a[68:71], v102 offset:35840
    v_mfma_f32_16x16x32_bf16 v[144:147], a[192:195], a[148:151], v[144:147]
    v_mfma_f32_16x16x32_bf16 v[148:151], a[196:199], a[148:151], v[148:151]
    v_mfma_f32_16x16x32_bf16 v[152:155], a[192:195], a[156:159], v[152:155]
    v_mfma_f32_16x16x32_bf16 v[156:159], a[196:199], a[156:159], v[156:159]
    v_mfma_f32_16x16x32_bf16 v[160:163], a[192:195], a[164:167], v[160:163]
    v_mfma_f32_16x16x32_bf16 v[164:167], a[196:199], a[164:167], v[164:167]
    v_mfma_f32_16x16x32_bf16 v[168:171], a[192:195], a[172:175], v[168:171]
    v_mfma_f32_16x16x32_bf16 v[172:175], a[196:199], a[172:175], v[172:175]
    v_mfma_f32_16x16x32_bf16 v[176:179], a[192:195], a[180:183], v[176:179]
    v_mfma_f32_16x16x32_bf16 v[180:183], a[196:199], a[180:183], v[180:183]
    s_waitcnt lgkmcnt(0)
    s_barrier
    v_mfma_f32_16x16x32_bf16 v[112:115], a[72:75], a[0:3], v[112:115]
    v_mfma_f32_16x16x32_bf16 v[116:119], a[76:79], a[0:3], v[116:119]
    v_mfma_f32_16x16x32_bf16 v[120:123], a[72:75], a[8:11], v[120:123]
    v_mfma_f32_16x16x32_bf16 v[124:127], a[76:79], a[8:11], v[124:127]
    v_mfma_f32_16x16x32_bf16 v[128:131], a[72:75], a[16:19], v[128:131]
    v_mfma_f32_16x16x32_bf16 v[132:135], a[76:79], a[16:19], v[132:135]
    v_mfma_f32_16x16x32_bf16 v[136:139], a[72:75], a[24:27], v[136:139]
    v_mfma_f32_16x16x32_bf16 v[140:143], a[76:79], a[24:27], v[140:143]
    v_mfma_f32_16x16x32_bf16 v[144:147], a[72:75], a[32:35], v[144:147]
    v_mfma_f32_16x16x32_bf16 v[148:151], a[76:79], a[32:35], v[148:151]
    v_mfma_f32_16x16x32_bf16 v[152:155], a[72:75], a[40:43], v[152:155]
    v_mfma_f32_16x16x32_bf16 v[156:159], a[76:79], a[40:43], v[156:159]
    v_mfma_f32_16x16x32_bf16 v[160:163], a[72:75], a[48:51], v[160:163]
    v_mfma_f32_16x16x32_bf16 v[164:167], a[76:79], a[48:51], v[164:167]
    v_mfma_f32_16x16x32_bf16 v[168:171], a[72:75], a[56:59], v[168:171]
    v_mfma_f32_16x16x32_bf16 v[172:175], a[76:79], a[56:59], v[172:175]
    v_mfma_f32_16x16x32_bf16 v[176:179], a[72:75], a[64:67], v[176:179]
    v_mfma_f32_16x16x32_bf16 v[180:183], a[76:79], a[64:67], v[180:183]
    v_mfma_f32_16x16x32_bf16 v[112:115], a[80:83], a[4:7], v[112:115]
    v_mfma_f32_16x16x32_bf16 v[116:119], a[84:87], a[4:7], v[116:119]
    v_mfma_f32_16x16x32_bf16 v[120:123], a[80:83], a[12:15], v[120:123]
    v_mfma_f32_16x16x32_bf16 v[124:127], a[84:87], a[12:15], v[124:127]
    v_mfma_f32_16x16x32_bf16 v[128:131], a[80:83], a[20:23], v[128:131]
    v_mfma_f32_16x16x32_bf16 v[132:135], a[84:87], a[20:23], v[132:135]
    v_mfma_f32_16x16x32_bf16 v[136:139], a[80:83], a[28:31], v[136:139]
    v_mfma_f32_16x16x32_bf16 v[140:143], a[84:87], a[28:31], v[140:143]
    v_mfma_f32_16x16x32_bf16 v[144:147], a[80:83], a[36:39], v[144:147]
    v_mfma_f32_16x16x32_bf16 v[148:151], a[84:87], a[36:39], v[148:151]
    v_mfma_f32_16x16x32_bf16 v[152:155], a[80:83], a[44:47], v[152:155]
    v_mfma_f32_16x16x32_bf16 v[156:159], a[84:87], a[44:47], v[156:159]
    v_mfma_f32_16x16x32_bf16 v[160:163], a[80:83], a[52:55], v[160:163]
    v_mfma_f32_16x16x32_bf16 v[164:167], a[84:87], a[52:55], v[164:167]
    v_mfma_f32_16x16x32_bf16 v[168:171], a[80:83], a[60:63], v[168:171]
    v_mfma_f32_16x16x32_bf16 v[172:175], a[84:87], a[60:63], v[172:175]
    v_mfma_f32_16x16x32_bf16 v[176:179], a[80:83], a[68:71], v[176:179]
    v_mfma_f32_16x16x32_bf16 v[180:183], a[84:87], a[68:71], v[180:183]
    s_mul_i32 s76, s42, 294912
    s_lshl_b32 s39, s45, 10
    s_add_u32 s76, s76, s39
    s_lshl_b32 s39, s43, 8
    s_add_u32 s76, s76, s39
    s_lshl_b32 s39, s36, 6
    s_add_u32 s76, s76, s39
    s_mov_b32 s40, 0xffff0000
    s_cmp_eq_u32 s44, 1
    s_cbranch_scc1 L_fin1
    s_cmp_eq_u32 s44, 2
    s_cbranch_scc1 L_fin2
    s_cmp_eq_u32 s44, 3
    s_cbranch_scc1 L_fin3
    v_and_b32 v5, 3, v1
    v_lshlrev_b32 v5, 3, v5
    buffer_load_dwordx2 v[108:109], v5, s[20:23], s85 offen sc1
    v_cvt_pk_bf16_f32 v120, v120, v121
    v_cvt_pk_bf16_f32 v121, v122, v123
    v_cvt_pk_bf16_f32 v122, v124, v125
    v_cvt_pk_bf16_f32 v123, v126, v127
    s_add_u32 s41, s62, 1024
    buffer_store_dwordx4 v[120:123], v2, s[20:23], s41 offen sc1
    v_cvt_pk_bf16_f32 v128, v128, v129
    v_cvt_pk_bf16_f32 v129, v130, v131
    v_cvt_pk_bf16_f32 v130, v132, v133
    v_cvt_pk_bf16_f32 v131, v134, v135
    s_add_u32 s41, s62, 2048
    buffer_store_dwordx4 v[128:131], v2, s[20:23], s41 offen sc1
    v_cvt_pk_bf16_f32 v136, v136, v137
    v_cvt_pk_bf16_f32 v137, v138, v139
    v_cvt_pk_bf16_f32 v138, v140, v141
    v_cvt_pk_bf16_f32 v139, v142, v143
    s_add_u32 s41, s62, 3072
    buffer_store_dwordx4 v[136:139], v2, s[20:23], s41 offen sc1
    v_cvt_pk_bf16_f32 v152, v152, v153
    v_cvt_pk_bf16_f32 v153, v154, v155
    v_cvt_pk_bf16_f32 v154, v156, v157
    v_cvt_pk_bf16_f32 v155, v158, v159
    s_add_u32 s41, s62, 5120
    buffer_store_dwordx4 v[152:155], v2, s[20:23], s41 offen sc1
    v_cvt_pk_bf16_f32 v160, v160, v161
    v_cvt_pk_bf16_f32 v161, v162, v163
    v_cvt_pk_bf16_f32 v162, v164, v165
    v_cvt_pk_bf16_f32 v163, v166, v167
    s_add_u32 s41, s62, 6144
    buffer_store_dwordx4 v[160:163], v2, s[20:23], s41 offen sc1
    v_cvt_pk_bf16_f32 v168, v168, v169
    v_cvt_pk_bf16_f32 v169, v170, v171
    v_cvt_pk_bf16_f32 v170, v172, v173
    v_cvt_pk_bf16_f32 v171, v174, v175
    s_add_u32 s41, s62, 7168
    buffer_store_dwordx4 v[168:171], v2, s[20:23], s41 offen sc1
    s_waitcnt vmcnt(0)
    s_lshl_b32 s39, s44, 3
    v_mov_b32 v110, s81
    v_not_b32 v111, s81
    v_mov_b32 v4, s39
    s_mov_b64 exec, 1
    buffer_store_dwordx2 v[110:111], v4, s[20:23], s85 offen offset:0 sc1
    s_mov_b64 exec, -1
    v_not_b32 v109, v109
    v_xor_b32 v108, s81, v108
    v_xor_b32 v109, s81, v109
    v_or_b32 v108, v108, v109
    v_cmp_ne_u32 vcc, 0, v108
    s_lshl_b32 s39, 1, s44
    s_xor_b32 s39, s39, 15
    s_and_b32 s39, s39, vcc_lo
    s_cmp_eq_u32 s39, 0
    s_cbranch_scc1 L_poll20x
    s_mov_b32 s65, 1048576
L_poll20:
    v_and_b32 v5, 3, v1
    v_lshlrev_b32 v5, 3, v5
    buffer_load_dwordx2 v[108:109], v5, s[20:23], s85 offen sc1
    s_waitcnt vmcnt(0)
    v_not_b32 v109, v109
    v_xor_b32 v108, s81, v108
    v_xor_b32 v109, s81, v109
    v_or_b32 v108, v108, v109
    v_cmp_ne_u32 vcc, 0, v108
    s_lshl_b32 s39, 1, s44
    s_xor_b32 s39, s39, 15
    s_and_b32 s39, s39, vcc_lo
    s_cmp_eq_u32 s39, 0
    s_cbranch_scc1 L_poll20x
    s_sleep 2
    s_sub_u32 s65, s65, 1
    s_cmp_lg_u32 s65, 0
    s_cbranch_scc1 L_poll20
L_poll20x:
    s_add_u32 s41, s62, 36864
    buffer_load_dwordx4 v[184:187], v2, s[20:23], s41 offen sc1
    s_add_u32 s41, s62, 73728
    buffer_load_dwordx4 v[196:199], v2, s[20:23], s41 offen sc1
    s_add_u32 s41, s62, 110592
    buffer_load_dwordx4 v[208:211], v2, s[20:23], s41 offen sc1
    s_add_u32 s41, s62, 40960
    buffer_load_dwordx4 v[188:191], v2, s[20:23], s41 offen sc1
    s_add_u32 s41, s62, 77824
    buffer_load_dwordx4 v[200:203], v2, s[20:23], s41 offen sc1
    s_add_u32 s41, s62, 114688
    buffer_load_dwordx4 v[212:215], v2, s[20:23], s41 offen sc1
    s_add_u32 s41, s62, 45056
    buffer_load_dwordx4 v[192:195], v2, s[20:23], s41 offen sc1
    s_add_u32 s41, s62, 81920
    buffer_load_dwordx4 v[204:207], v2, s[20:23], s41 offen sc1
    s_add_u32 s41, s62, 118784
    buffer_load_dwordx4 v[216:219], v2, s[20:23], s41 offen sc1
    s_waitcnt vmcnt(8)
    v_lshlrev_b32 v3, 16, v184
    v_and_b32 v4, s40, v184
    v_add_f32 v112, v112, v3
    v_add_f32 v113, v113, v4
    v_lshlrev_b32 v3, 16, v185
    v_and_b32 v4, s40, v185
    v_add_f32 v114, v114, v3
    v_add_f32 v115, v115, v4
    v_lshlrev_b32 v3, 16, v186
    v_and_b32 v4, s40, v186
    v_add_f32 v116, v116, v3
    v_add_f32 v117, v117, v4
    v_lshlrev_b32 v3, 16, v187
    v_and_b32 v4, s40, v187
    v_add_f32 v118, v118, v3
    v_add_f32 v119, v119, v4
    s_waitcnt vmcnt(7)
    v_lshlrev_b32 v3, 16, v196
    v_and_b32 v4, s40, v196
    v_add_f32 v112, v112, v3
    v_add_f32 v113, v113, v4
    v_lshlrev_b32 v3, 16, v197
    v_and_b32 v4, s40, v197
    v_add_f32 v114, v114, v3
    v_add_f32 v115, v115, v4
    v_lshlrev_b32 v3, 16, v198
    v_and_b32 v4, s40, v198
    v_add_f32 v116, v116, v3
    v_add_f32 v117, v117, v4
    v_lshlrev_b32 v3, 16, v199
    v_and_b32 v4, s40, v199
    v_add_f32 v118, v118, v3
    v_add_f32 v119, v119, v4
    s_waitcnt vmcnt(6)
    v_lshlrev_b32 v3, 16, v208
    v_and_b32 v4, s40, v208
    v_add_f32 v112, v112, v3
    v_add_f32 v113, v113, v4
    v_lshlrev_b32 v3, 16, v209
    v_and_b32 v4, s40, v209
    v_add_f32 v114, v114, v3
    v_add_f32 v115, v115, v4
    v_lshlrev_b32 v3, 16, v210
    v_and_b32 v4, s40, v210
    v_add_f32 v116, v116, v3
    v_add_f32 v117, v117, v4
    v_lshlrev_b32 v3, 16, v211
    v_and_b32 v4, s40, v211
    v_add_f32 v118, v118, v3
    v_add_f32 v119, v119, v4
    v_cvt_pk_bf16_f32 v112, v112, v113
    v_cvt_pk_bf16_f32 v113, v114, v115
    v_cvt_pk_bf16_f32 v114, v116, v117
    v_cvt_pk_bf16_f32 v115, v118, v119
    s_add_u32 s41, s76, 0
    buffer_store_dwordx4 v[112:115], v103, s[28:31], s41 offen sc1
    s_waitcnt vmcnt(6)
    v_lshlrev_b32 v3, 16, v188
    v_and_b32 v4, s40, v188
    v_add_f32 v144, v144, v3
    v_add_f32 v145, v145, v4
    v_lshlrev_b32 v3, 16, v189
    v_and_b32 v4, s40, v189
    v_add_f32 v146, v146, v3
    v_add_f32 v147, v147, v4
    v_lshlrev_b32 v3, 16, v190
    v_and_b32 v4, s40, v190
    v_add_f32 v148, v148, v3
    v_add_f32 v149, v149, v4
    v_lshlrev_b32 v3, 16, v191
    v_and_b32 v4, s40, v191
    v_add_f32 v150, v150, v3
    v_add_f32 v151, v151, v4
    s_waitcnt vmcnt(5)
    v_lshlrev_b32 v3, 16, v200
    v_and_b32 v4, s40, v200
    v_add_f32 v144, v144, v3
    v_add_f32 v145, v145, v4
    v_lshlrev_b32 v3, 16, v201
    v_and_b32 v4, s40, v201
    v_add_f32 v146, v146, v3
    v_add_f32 v147, v147, v4
    v_lshlrev_b32 v3, 16, v202
    v_and_b32 v4, s40, v202
    v_add_f32 v148, v148, v3
    v_add_f32 v149, v149, v4
    v_lshlrev_b32 v3, 16, v203
    v_and_b32 v4, s40, v203
    v_add_f32 v150, v150, v3
    v_add_f32 v151, v151, v4
    s_waitcnt vmcnt(4)
    v_lshlrev_b32 v3, 16, v212
    v_and_b32 v4, s40, v212
    v_add_f32 v144, v144, v3
    v_add_f32 v145, v145, v4
    v_lshlrev_b32 v3, 16, v213
    v_and_b32 v4, s40, v213
    v_add_f32 v146, v146, v3
    v_add_f32 v147, v147, v4
    v_lshlrev_b32 v3, 16, v214
    v_and_b32 v4, s40, v214
    v_add_f32 v148, v148, v3
    v_add_f32 v149, v149, v4
    v_lshlrev_b32 v3, 16, v215
    v_and_b32 v4, s40, v215
    v_add_f32 v150, v150, v3
    v_add_f32 v151, v151, v4
    v_cvt_pk_bf16_f32 v144, v144, v145
    v_cvt_pk_bf16_f32 v145, v146, v147
    v_cvt_pk_bf16_f32 v146, v148, v149
    v_cvt_pk_bf16_f32 v147, v150, v151
    s_add_u32 s41, s76, 131072
    buffer_store_dwordx4 v[144:147], v103, s[28:31], s41 offen sc1
    s_waitcnt vmcnt(4)
    v_lshlrev_b32 v3, 16, v192
    v_and_b32 v4, s40, v192
    v_add_f32 v176, v176, v3
    v_add_f32 v177, v177, v4
    v_lshlrev_b32 v3, 16, v193
    v_and_b32 v4, s40, v193
    v_add_f32 v178, v178, v3
    v_add_f32 v179, v179, v4
    v_lshlrev_b32 v3, 16, v194
    v_and_b32 v4, s40, v194
    v_add_f32 v180, v180, v3
    v_add_f32 v181, v181, v4
    v_lshlrev_b32 v3, 16, v195
    v_and_b32 v4, s40, v195
    v_add_f32 v182, v182, v3
    v_add_f32 v183, v183, v4
    s_waitcnt vmcnt(3)
    v_lshlrev_b32 v3, 16, v204
    v_and_b32 v4, s40, v204
    v_add_f32 v176, v176, v3
    v_add_f32 v177, v177, v4
    v_lshlrev_b32 v3, 16, v205
    v_and_b32 v4, s40, v205
    v_add_f32 v178, v178, v3
    v_add_f32 v179, v179, v4
    v_lshlrev_b32 v3, 16, v206
    v_and_b32 v4, s40, v206
    v_add_f32 v180, v180, v3
    v_add_f32 v181, v181, v4
    v_lshlrev_b32 v3, 16, v207
    v_and_b32 v4, s40, v207
    v_add_f32 v182, v182, v3
    v_add_f32 v183, v183, v4
    s_waitcnt vmcnt(2)
    v_lshlrev_b32 v3, 16, v216
    v_and_b32 v4, s40, v216
    v_add_f32 v176, v176, v3
    v_add_f32 v177, v177, v4
    v_lshlrev_b32 v3, 16, v217
    v_and_b32 v4, s40, v217
    v_add_f32 v178, v178, v3
    v_add_f32 v179, v179, v4
    v_lshlrev_b32 v3, 16, v218
    v_and_b32 v4, s40, v218
    v_add_f32 v180, v180, v3
    v_add_f32 v181, v181, v4
    v_lshlrev_b32 v3, 16, v219
    v_and_b32 v4, s40, v219
    v_add_f32 v182, v182, v3
    v_add_f32 v183, v183, v4
    v_cvt_pk_bf16_f32 v176, v176, v177
    v_cvt_pk_bf16_f32 v177, v178, v179
    v_cvt_pk_bf16_f32 v178, v180, v181
    v_cvt_pk_bf16_f32 v179, v182, v183
    s_add_u32 s41, s76, 262144
    buffer_store_dwordx4 v[176:179], v103, s[28:31], s41 offen sc1
    s_endpgm
L_fin1:
    v_and_b32 v5, 3, v1
    v_lshlrev_b32 v5, 3, v5
    buffer_load_dwordx2 v[108:109], v5, s[20:23], s85 offen sc1
    v_cvt_pk_bf16_f32 v112, v112, v113
    v_cvt_pk_bf16_f32 v113, v114, v115
    v_cvt_pk_bf16_f32 v114, v116, v117
    v_cvt_pk_bf16_f32 v115, v118, v119
    s_add_u32 s41, s62, 36864
    buffer_store_dwordx4 v[112:115], v2, s[20:23], s41 offen sc1
    v_cvt_pk_bf16_f32 v128, v128, v129
    v_cvt_pk_bf16_f32 v129, v130, v131
    v_cvt_pk_bf16_f32 v130, v132, v133
    v_cvt_pk_bf16_f32 v131, v134, v135
    s_add_u32 s41, s62, 38912
    buffer_store_dwordx4 v[128:131], v2, s[20:23], s41 offen sc1
    v_cvt_pk_bf16_f32 v136, v136, v137
    v_cvt_pk_bf16_f32 v137, v138, v139
    v_cvt_pk_bf16_f32 v138, v140, v141
    v_cvt_pk_bf16_f32 v139, v142, v143
    s_add_u32 s41, s62, 39936
    buffer_store_dwordx4 v[136:139], v2, s[20:23], s41 offen sc1
    v_cvt_pk_bf16_f32 v144, v144, v145
    v_cvt_pk_bf16_f32 v145, v146, v147
    v_cvt_pk_bf16_f32 v146, v148, v149
    v_cvt_pk_bf16_f32 v147, v150, v151
    s_add_u32 s41, s62, 40960
    buffer_store_dwordx4 v[144:147], v2, s[20:23], s41 offen sc1
    v_cvt_pk_bf16_f32 v160, v160, v161
    v_cvt_pk_bf16_f32 v161, v162, v163
    v_cvt_pk_bf16_f32 v162, v164, v165
    v_cvt_pk_bf16_f32 v163, v166, v167
    s_add_u32 s41, s62, 43008
    buffer_store_dwordx4 v[160:163], v2, s[20:23], s41 offen sc1
    v_cvt_pk_bf16_f32 v168, v168, v169
    v_cvt_pk_bf16_f32 v169, v170, v171
    v_cvt_pk_bf16_f32 v170, v172, v173
    v_cvt_pk_bf16_f32 v171, v174, v175
    s_add_u32 s41, s62, 44032
    buffer_store_dwordx4 v[168:171], v2, s[20:23], s41 offen sc1
    v_cvt_pk_bf16_f32 v176, v176, v177
    v_cvt_pk_bf16_f32 v177, v178, v179
    v_cvt_pk_bf16_f32 v178, v180, v181
    v_cvt_pk_bf16_f32 v179, v182, v183
    s_add_u32 s41, s62, 45056
    buffer_store_dwordx4 v[176:179], v2, s[20:23], s41 offen sc1
    s_waitcnt vmcnt(0)
    s_lshl_b32 s39, s44, 3
    v_mov_b32 v110, s81
    v_not_b32 v111, s81
    v_mov_b32 v4, s39
    s_mov_b64 exec, 1
    buffer_store_dwordx2 v[110:111], v4, s[20:23], s85 offen offset:0 sc1
    s_mov_b64 exec, -1
    v_not_b32 v109, v109
    v_xor_b32 v108, s81, v108
    v_xor_b32 v109, s81, v109
    v_or_b32 v108, v108, v109
    v_cmp_ne_u32 vcc, 0, v108
    s_lshl_b32 s39, 1, s44
    s_xor_b32 s39, s39, 15
    s_and_b32 s39, s39, vcc_lo
    s_cmp_eq_u32 s39, 0
    s_cbranch_scc1 L_poll21x
    s_mov_b32 s65, 1048576
L_poll21:
    v_and_b32 v5, 3, v1
    v_lshlrev_b32 v5, 3, v5
    buffer_load_dwordx2 v[108:109], v5, s[20:23], s85 offen sc1
    s_waitcnt vmcnt(0)
    v_not_b32 v109, v109
    v_xor_b32 v108, s81, v108
    v_xor_b32 v109, s81, v109
    v_or_b32 v108, v108, v109
    v_cmp_ne_u32 vcc, 0, v108
    s_lshl_b32 s39, 1, s44
    s_xor_b32 s39, s39, 15
    s_and_b32 s39, s39, vcc_lo
    s_cmp_eq_u32 s39, 0
    s_cbranch_scc1 L_poll21x
    s_sleep 2
    s_sub_u32 s65, s65, 1
    s_cmp_lg_u32 s65, 0
    s_cbranch_scc1 L_poll21
L_poll21x:
    s_add_u32 s41, s62, 1024
    buffer_load_dwordx4 v[184:187], v2, s[20:23], s41 offen sc1
    s_add_u32 s41, s62, 74752
    buffer_load_dwordx4 v[196:199], v2, s[20:23], s41 offen sc1
    s_add_u32 s41, s62, 111616
    buffer_load_dwordx4 v[208:211], v2, s[20:23], s41 offen sc1
    s_add_u32 s41, s62, 5120
    buffer_load_dwordx4 v[188:191], v2, s[20:23], s41 offen sc1
    s_add_u32 s41, s62, 78848
    buffer_load_dwordx4 v[200:203], v2, s[20:23], s41 offen sc1
    s_add_u32 s41, s62, 115712
    buffer_load_dwordx4 v[212:215], v2, s[20:23], s41 offen sc1
    s_waitcnt vmcnt(5)
    v_lshlrev_b32 v3, 16, v184
    v_and_b32 v4, s40, v184
    v_add_f32 v120, v120, v3
    v_add_f32 v121, v121, v4
    v_lshlrev_b32 v3, 16, v185
    v_and_b32 v4, s40, v185
    v_add_f32 v122, v122, v3
    v_add_f32 v123, v123, v4
    v_lshlrev_b32 v3, 16, v186
    v_and_b32 v4, s40, v186
    v_add_f32 v124, v124, v3
    v_add_f32 v125, v125, v4
    v_lshlrev_b32 v3, 16, v187
    v_and_b32 v4, s40, v187
    v_add_f32 v126, v126, v3
    v_add_f32 v127, v127, v4
    s_waitcnt vmcnt(4)
    v_lshlrev_b32 v3, 16, v196
    v_and_b32 v4, s40, v196
    v_add_f32 v120, v120, v3
    v_add_f32 v121, v121, v4
    v_lshlrev_b32 v3, 16, v197
    v_and_b32 v4, s40, v197
    v_add_f32 v122, v122, v3
    v_add_f32 v123, v123, v4
    v_lshlrev_b32 v3, 16, v198
    v_and_b32 v4, s40, v198
    v_add_f32 v124, v124, v3
    v_add_f32 v125, v125, v4
    v_lshlrev_b32 v3, 16, v199
    v_and_b32 v4, s40, v199
    v_add_f32 v126, v126, v3
    v_add_f32 v127, v127, v4
    s_waitcnt vmcnt(3)
    v_lshlrev_b32 v3, 16, v208
    v_and_b32 v4, s40, v208
    v_add_f32 v120, v120, v3
    v_add_f32 v121, v121, v4
    v_lshlrev_b32 v3, 16, v209
    v_and_b32 v4, s40, v209
    v_add_f32 v122, v122, v3
    v_add_f32 v123, v123, v4
    v_lshlrev_b32 v3, 16, v210
    v_and_b32 v4, s40, v210
    v_add_f32 v124, v124, v3
    v_add_f32 v125, v125, v4
    v_lshlrev_b32 v3, 16, v211
    v_and_b32 v4, s40, v211
    v_add_f32 v126, v126, v3
    v_add_f32 v127, v127, v4
    v_cvt_pk_bf16_f32 v120, v120, v121
    v_cvt_pk_bf16_f32 v121, v122, v123
    v_cvt_pk_bf16_f32 v122, v124, v125
    v_cvt_pk_bf16_f32 v123, v126, v127
    s_add_u32 s41, s76, 32768
    buffer_store_dwordx4 v[120:123], v103, s[28:31], s41 offen sc1
    s_waitcnt vmcnt(3)
    v_lshlrev_b32 v3, 16, v188
    v_and_b32 v4, s40, v188
    v_add_f32 v152, v152, v3
    v_add_f32 v153, v153, v4
    v_lshlrev_b32 v3, 16, v189
    v_and_b32 v4, s40, v189
    v_add_f32 v154, v154, v3
    v_add_f32 v155, v155, v4
    v_lshlrev_b32 v3, 16, v190
    v_and_b32 v4, s40, v190
    v_add_f32 v156, v156, v3
    v_add_f32 v157, v157, v4
    v_lshlrev_b32 v3, 16, v191
    v_and_b32 v4, s40, v191
    v_add_f32 v158, v158, v3
    v_add_f32 v159, v159, v4
    s_waitcnt vmcnt(2)
    v_lshlrev_b32 v3, 16, v200
    v_and_b32 v4, s40, v200
    v_add_f32 v152, v152, v3
    v_add_f32 v153, v153, v4
    v_lshlrev_b32 v3, 16, v201
    v_and_b32 v4, s40, v201
    v_add_f32 v154, v154, v3
    v_add_f32 v155, v155, v4
    v_lshlrev_b32 v3, 16, v202
    v_and_b32 v4, s40, v202
    v_add_f32 v156, v156, v3
    v_add_f32 v157, v157, v4
    v_lshlrev_b32 v3, 16, v203
    v_and_b32 v4, s40, v203
    v_add_f32 v158, v158, v3
    v_add_f32 v159, v159, v4
    s_waitcnt vmcnt(1)
    v_lshlrev_b32 v3, 16, v212
    v_and_b32 v4, s40, v212
    v_add_f32 v152, v152, v3
    v_add_f32 v153, v153, v4
    v_lshlrev_b32 v3, 16, v213
    v_and_b32 v4, s40, v213
    v_add_f32 v154, v154, v3
    v_add_f32 v155, v155, v4
    v_lshlrev_b32 v3, 16, v214
    v_and_b32 v4, s40, v214
    v_add_f32 v156, v156, v3
    v_add_f32 v157, v157, v4
    v_lshlrev_b32 v3, 16, v215
    v_and_b32 v4, s40, v215
    v_add_f32 v158, v158, v3
    v_add_f32 v159, v159, v4
    v_cvt_pk_bf16_f32 v152, v152, v153
    v_cvt_pk_bf16_f32 v153, v154, v155
    v_cvt_pk_bf16_f32 v154, v156, v157
    v_cvt_pk_bf16_f32 v155, v158, v159
    s_add_u32 s41, s76, 163840
    buffer_store_dwordx4 v[152:155], v103, s[28:31], s41 offen sc1
    s_endpgm
L_fin2:
    v_and_b32 v5, 3, v1
    v_lshlrev_b32 v5, 3, v5
    buffer_load_dwordx2 v[108:109], v5, s[20:23], s85 offen sc1
    v_cvt_pk_bf16_f32 v112, v112, v113
    v_cvt_pk_bf16_f32 v113, v114, v115
    v_cvt_pk_bf16_f32 v114, v116, v117
    v_cvt_pk_bf16_f32 v115, v118, v119
    s_add_u32 s41, s62, 73728
    buffer_store_dwordx4 v[112:115], v2, s[20:23], s41 offen sc1
    v_cvt_pk_bf16_f32 v120, v120, v121
    v_cvt_pk_bf16_f32 v121, v122, v123
    v_cvt_pk_bf16_f32 v122, v124, v125
    v_cvt_pk_bf16_f32 v123, v126, v127
    s_add_u32 s41, s62, 74752
    buffer_store_dwordx4 v[120:123], v2, s[20:23], s41 offen sc1
    v_cvt_pk_bf16_f32 v136, v136, v137
    v_cvt_pk_bf16_f32 v137, v138, v139
    v_cvt_pk_bf16_f32 v138, v140, v141
    v_cvt_pk_bf16_f32 v139, v142, v143
    s_add_u32 s41, s62, 76800
    buffer_store_dwordx4 v[136:139], v2, s[20:23], s41 offen sc1
    v_cvt_pk_bf16_f32 v144, v144, v145
    v_cvt_pk_bf16_f32 v145, v146, v147
    v_cvt_pk_bf16_f32 v146, v148, v149
    v_cvt_pk_bf16_f32 v147, v150, v151
    s_add_u32 s41, s62, 77824
    buffer_store_dwordx4 v[144:147], v2, s[20:23], s41 offen sc1
    v_cvt_pk_bf16_f32 v152, v152, v153
    v_cvt_pk_bf16_f32 v153, v154, v155
    v_cvt_pk_bf16_f32 v154, v156, v157
    v_cvt_pk_bf16_f32 v155, v158, v159
    s_add_u32 s41, s62, 78848
    buffer_store_dwordx4 v[152:155], v2, s[20:23], s41 offen sc1
    v_cvt_pk_bf16_f32 v168, v168, v169
    v_cvt_pk_bf16_f32 v169, v170, v171
    v_cvt_pk_bf16_f32 v170, v172, v173
    v_cvt_pk_bf16_f32 v171, v174, v175
    s_add_u32 s41, s62, 80896
    buffer_store_dwordx4 v[168:171], v2, s[20:23], s41 offen sc1
    v_cvt_pk_bf16_f32 v176, v176, v177
    v_cvt_pk_bf16_f32 v177, v178, v179
    v_cvt_pk_bf16_f32 v178, v180, v181
    v_cvt_pk_bf16_f32 v179, v182, v183
    s_add_u32 s41, s62, 81920
    buffer_store_dwordx4 v[176:179], v2, s[20:23], s41 offen sc1
    s_waitcnt vmcnt(0)
    s_lshl_b32 s39, s44, 3
    v_mov_b32 v110, s81
    v_not_b32 v111, s81
    v_mov_b32 v4, s39
    s_mov_b64 exec, 1
    buffer_store_dwordx2 v[110:111], v4, s[20:23], s85 offen offset:0 sc1
    s_mov_b64 exec, -1
    v_not_b32 v109, v109
    v_xor_b32 v108, s81, v108
    v_xor_b32 v109, s81, v109
    v_or_b32 v108, v108, v109
    v_cmp_ne_u32 vcc, 0, v108
    s_lshl_b32 s39, 1, s44
    s_xor_b32 s39, s39, 15
    s_and_b32 s39, s39, vcc_lo
    s_cmp_eq_u32 s39, 0
    s_cbranch_scc1 L_poll22x
    s_mov_b32 s65, 1048576
L_poll22:
    v_and_b32 v5, 3, v1
    v_lshlrev_b32 v5, 3, v5
    buffer_load_dwordx2 v[108:109], v5, s[20:23], s85 offen sc1
    s_waitcnt vmcnt(0)
    v_not_b32 v109, v109
    v_xor_b32 v108, s81, v108
    v_xor_b32 v109, s81, v109
    v_or_b32 v108, v108, v109
    v_cmp_ne_u32 vcc, 0, v108
    s_lshl_b32 s39, 1, s44
    s_xor_b32 s39, s39, 15
    s_and_b32 s39, s39, vcc_lo
    s_cmp_eq_u32 s39, 0
    s_cbranch_scc1 L_poll22x
    s_sleep 2
    s_sub_u32 s65, s65, 1
    s_cmp_lg_u32 s65, 0
    s_cbranch_scc1 L_poll22
L_poll22x:
    s_add_u32 s41, s62, 2048
    buffer_load_dwordx4 v[184:187], v2, s[20:23], s41 offen sc1
    s_add_u32 s41, s62, 38912
    buffer_load_dwordx4 v[196:199], v2, s[20:23], s41 offen sc1
    s_add_u32 s41, s62, 112640
    buffer_load_dwordx4 v[208:211], v2, s[20:23], s41 offen sc1
    s_add_u32 s41, s62, 6144
    buffer_load_dwordx4 v[188:191], v2, s[20:23], s41 offen sc1
    s_add_u32 s41, s62, 43008
    buffer_load_dwordx4 v[200:203], v2, s[20:23], s41 offen sc1
    s_add_u32 s41, s62, 116736
    buffer_load_dwordx4 v[212:215], v2, s[20:23], s41 offen sc1
    s_waitcnt vmcnt(5)
    v_lshlrev_b32 v3, 16, v184
    v_and_b32 v4, s40, v184
    v_add_f32 v128, v128, v3
    v_add_f32 v129, v129, v4
    v_lshlrev_b32 v3, 16, v185
    v_and_b32 v4, s40, v185
    v_add_f32 v130, v130, v3
    v_add_f32 v131, v131, v4
    v_lshlrev_b32 v3, 16, v186
    v_and_b32 v4, s40, v186
    v_add_f32 v132, v132, v3
    v_add_f32 v133, v133, v4
    v_lshlrev_b32 v3, 16, v187
    v_and_b32 v4, s40, v187
    v_add_f32 v134, v134, v3
    v_add_f32 v135, v135, v4
    s_waitcnt vmcnt(4)
    v_lshlrev_b32 v3, 16, v196
    v_and_b32 v4, s40, v196
    v_add_f32 v128, v128, v3
    v_add_f32 v129, v129, v4
    v_lshlrev_b32 v3, 16, v197
    v_and_b32 v4, s40, v197
    v_add_f32 v130, v130, v3
    v_add_f32 v131, v131, v4
    v_lshlrev_b32 v3, 16, v198
    v_and_b32 v4, s40, v198
    v_add_f32 v132, v132, v3
    v_add_f32 v133, v133, v4
    v_lshlrev_b32 v3, 16, v199
    v_and_b32 v4, s40, v199
    v_add_f32 v134, v134, v3
    v_add_f32 v135, v135, v4
    s_waitcnt vmcnt(3)
    v_lshlrev_b32 v3, 16, v208
    v_and_b32 v4, s40, v208
    v_add_f32 v128, v128, v3
    v_add_f32 v129, v129, v4
    v_lshlrev_b32 v3, 16, v209
    v_and_b32 v4, s40, v209
    v_add_f32 v130, v130, v3
    v_add_f32 v131, v131, v4
    v_lshlrev_b32 v3, 16, v210
    v_and_b32 v4, s40, v210
    v_add_f32 v132, v132, v3
    v_add_f32 v133, v133, v4
    v_lshlrev_b32 v3, 16, v211
    v_and_b32 v4, s40, v211
    v_add_f32 v134, v134, v3
    v_add_f32 v135, v135, v4
    v_cvt_pk_bf16_f32 v128, v128, v129
    v_cvt_pk_bf16_f32 v129, v130, v131
    v_cvt_pk_bf16_f32 v130, v132, v133
    v_cvt_pk_bf16_f32 v131, v134, v135
    s_add_u32 s41, s76, 65536
    buffer_store_dwordx4 v[128:131], v103, s[28:31], s41 offen sc1
    s_waitcnt vmcnt(3)
    v_lshlrev_b32 v3, 16, v188
    v_and_b32 v4, s40, v188
    v_add_f32 v160, v160, v3
    v_add_f32 v161, v161, v4
    v_lshlrev_b32 v3, 16, v189
    v_and_b32 v4, s40, v189
    v_add_f32 v162, v162, v3
    v_add_f32 v163, v163, v4
    v_lshlrev_b32 v3, 16, v190
    v_and_b32 v4, s40, v190
    v_add_f32 v164, v164, v3
    v_add_f32 v165, v165, v4
    v_lshlrev_b32 v3, 16, v191
    v_and_b32 v4, s40, v191
    v_add_f32 v166, v166, v3
    v_add_f32 v167, v167, v4
    s_waitcnt vmcnt(2)
    v_lshlrev_b32 v3, 16, v200
    v_and_b32 v4, s40, v200
    v_add_f32 v160, v160, v3
    v_add_f32 v161, v161, v4
    v_lshlrev_b32 v3, 16, v201
    v_and_b32 v4, s40, v201
    v_add_f32 v162, v162, v3
    v_add_f32 v163, v163, v4
    v_lshlrev_b32 v3, 16, v202
    v_and_b32 v4, s40, v202
    v_add_f32 v164, v164, v3
    v_add_f32 v165, v165, v4
    v_lshlrev_b32 v3, 16, v203
    v_and_b32 v4, s40, v203
    v_add_f32 v166, v166, v3
    v_add_f32 v167, v167, v4
    s_waitcnt vmcnt(1)
    v_lshlrev_b32 v3, 16, v212
    v_and_b32 v4, s40, v212
    v_add_f32 v160, v160, v3
    v_add_f32 v161, v161, v4
    v_lshlrev_b32 v3, 16, v213
    v_and_b32 v4, s40, v213
    v_add_f32 v162, v162, v3
    v_add_f32 v163, v163, v4
    v_lshlrev_b32 v3, 16, v214
    v_and_b32 v4, s40, v214
    v_add_f32 v164, v164, v3
    v_add_f32 v165, v165, v4
    v_lshlrev_b32 v3, 16, v215
    v_and_b32 v4, s40, v215
    v_add_f32 v166, v166, v3
    v_add_f32 v167, v167, v4
    v_cvt_pk_bf16_f32 v160, v160, v161
    v_cvt_pk_bf16_f32 v161, v162, v163
    v_cvt_pk_bf16_f32 v162, v164, v165
    v_cvt_pk_bf16_f32 v163, v166, v167
    s_add_u32 s41, s76, 196608
    buffer_store_dwordx4 v[160:163], v103, s[28:31], s41 offen sc1
    s_endpgm
L_fin3:
    v_and_b32 v5, 3, v1
    v_lshlrev_b32 v5, 3, v5
    buffer_load_dwordx2 v[108:109], v5, s[20:23], s85 offen sc1
    v_cvt_pk_bf16_f32 v112, v112, v113
    v_cvt_pk_bf16_f32 v113, v114, v115
    v_cvt_pk_bf16_f32 v114, v116, v117
    v_cvt_pk_bf16_f32 v115, v118, v119
    s_add_u32 s41, s62, 110592
    buffer_store_dwordx4 v[112:115], v2, s[20:23], s41 offen sc1
    v_cvt_pk_bf16_f32 v120, v120, v121
    v_cvt_pk_bf16_f32 v121, v122, v123
    v_cvt_pk_bf16_f32 v122, v124, v125
    v_cvt_pk_bf16_f32 v123, v126, v127
    s_add_u32 s41, s62, 111616
    buffer_store_dwordx4 v[120:123], v2, s[20:23], s41 offen sc1
    v_cvt_pk_bf16_f32 v128, v128, v129
    v_cvt_pk_bf16_f32 v129, v130, v131
    v_cvt_pk_bf16_f32 v130, v132, v133
    v_cvt_pk_bf16_f32 v131, v134, v135
    s_add_u32 s41, s62, 112640
    buffer_store_dwordx4 v[128:131], v2, s[20:23], s41 offen sc1
    v_cvt_pk_bf16_f32 v144, v144, v145
    v_cvt_pk_bf16_f32 v145, v146, v147
    v_cvt_pk_bf16_f32 v146, v148, v149
    v_cvt_pk_bf16_f32 v147, v150, v151
    s_add_u32 s41, s62, 114688
    buffer_store_dwordx4 v[144:147], v2, s[20:23], s41 offen sc1
    v_cvt_pk_bf16_f32 v152, v152, v153
    v_cvt_pk_bf16_f32 v153, v154, v155
    v_cvt_pk_bf16_f32 v154, v156, v157
    v_cvt_pk_bf16_f32 v155, v158, v159
    s_add_u32 s41, s62, 115712
    buffer_store_dwordx4 v[152:155], v2, s[20:23], s41 offen sc1
    v_cvt_pk_bf16_f32 v160, v160, v161
    v_cvt_pk_bf16_f32 v161, v162, v163
    v_cvt_pk_bf16_f32 v162, v164, v165
    v_cvt_pk_bf16_f32 v163, v166, v167
    s_add_u32 s41, s62, 116736
    buffer_store_dwordx4 v[160:163], v2, s[20:23], s41 offen sc1
    v_cvt_pk_bf16_f32 v176, v176, v177
    v_cvt_pk_bf16_f32 v177, v178, v179
    v_cvt_pk_bf16_f32 v178, v180, v181
    v_cvt_pk_bf16_f32 v179, v182, v183
    s_add_u32 s41, s62, 118784
    buffer_store_dwordx4 v[176:179], v2, s[20:23], s41 offen sc1
    s_waitcnt vmcnt(0)
    s_lshl_b32 s39, s44, 3
    v_mov_b32 v110, s81
    v_not_b32 v111, s81
    v_mov_b32 v4, s39
    s_mov_b64 exec, 1
    buffer_store_dwordx2 v[110:111], v4, s[20:23], s85 offen offset:0 sc1
    s_mov_b64 exec, -1
    v_not_b32 v109, v109
    v_xor_b32 v108, s81, v108
    v_xor_b32 v109, s81, v109
    v_or_b32 v108, v108, v109
    v_cmp_ne_u32 vcc, 0, v108
    s_lshl_b32 s39, 1, s44
    s_xor_b32 s39, s39, 15
    s_and_b32 s39, s39, vcc_lo
    s_cmp_eq_u32 s39, 0
    s_cbranch_scc1 L_poll23x
    s_mov_b32 s65, 1048576
L_poll23:
    v_and_b32 v5, 3, v1
    v_lshlrev_b32 v5, 3, v5
    buffer_load_dwordx2 v[108:109], v5, s[20:23], s85 offen sc1
    s_waitcnt vmcnt(0)
    v_not_b32 v109, v109
    v_xor_b32 v108, s81, v108
    v_xor_b32 v109, s81, v109
    v_or_b32 v108, v108, v109
    v_cmp_ne_u32 vcc, 0, v108
    s_lshl_b32 s39, 1, s44
    s_xor_b32 s39, s39, 15
    s_and_b32 s39, s39, vcc_lo
    s_cmp_eq_u32 s39, 0
    s_cbranch_scc1 L_poll23x
    s_sleep 2
    s_sub_u32 s65, s65, 1
    s_cmp_lg_u32 s65, 0
    s_cbranch_scc1 L_poll23
L_poll23x:
    s_add_u32 s41, s62, 3072
    buffer_load_dwordx4 v[184:187], v2, s[20:23], s41 offen sc1
    s_add_u32 s41, s62, 39936
    buffer_load_dwordx4 v[196:199], v2, s[20:23], s41 offen sc1
    s_add_u32 s41, s62, 76800
    buffer_load_dwordx4 v[208:211], v2, s[20:23], s41 offen sc1
    s_add_u32 s41, s62, 7168
    buffer_load_dwordx4 v[188:191], v2, s[20:23], s41 offen sc1
    s_add_u32 s41, s62, 44032
    buffer_load_dwordx4 v[200:203], v2, s[20:23], s41 offen sc1
    s_add_u32 s41, s62, 80896
    buffer_load_dwordx4 v[212:215], v2, s[20:23], s41 offen sc1
    s_waitcnt vmcnt(5)
    v_lshlrev_b32 v3, 16, v184
    v_and_b32 v4, s40, v184
    v_add_f32 v136, v136, v3
    v_add_f32 v137, v137, v4
    v_lshlrev_b32 v3, 16, v185
    v_and_b32 v4, s40, v185
    v_add_f32 v138, v138, v3
    v_add_f32 v139, v139, v4
    v_lshlrev_b32 v3, 16, v186
    v_and_b32 v4, s40, v186
    v_add_f32 v140, v140, v3
    v_add_f32 v141, v141, v4
    v_lshlrev_b32 v3, 16, v187
    v_and_b32 v4, s40, v187
    v_add_f32 v142, v142, v3
    v_add_f32 v143, v143, v4
    s_waitcnt vmcnt(4)
    v_lshlrev_b32 v3, 16, v196
    v_and_b32 v4, s40, v196
    v_add_f32 v136, v136, v3
    v_add_f32 v137, v137, v4
    v_lshlrev_b32 v3, 16, v197
    v_and_b32 v4, s40, v197
    v_add_f32 v138, v138, v3
    v_add_f32 v139, v139, v4
    v_lshlrev_b32 v3, 16, v198
    v_and_b32 v4, s40, v198
    v_add_f32 v140, v140, v3
    v_add_f32 v141, v141, v4
    v_lshlrev_b32 v3, 16, v199
    v_and_b32 v4, s40, v199
    v_add_f32 v142, v142, v3
    v_add_f32 v143, v143, v4
    s_waitcnt vmcnt(3)
    v_lshlrev_b32 v3, 16, v208
    v_and_b32 v4, s40, v208
    v_add_f32 v136, v136, v3
    v_add_f32 v137, v137, v4
    v_lshlrev_b32 v3, 16, v209
    v_and_b32 v4, s40, v209
    v_add_f32 v138, v138, v3
    v_add_f32 v139, v139, v4
    v_lshlrev_b32 v3, 16, v210
    v_and_b32 v4, s40, v210
    v_add_f32 v140, v140, v3
    v_add_f32 v141, v141, v4
    v_lshlrev_b32 v3, 16, v211
    v_and_b32 v4, s40, v211
    v_add_f32 v142, v142, v3
    v_add_f32 v143, v143, v4
    v_cvt_pk_bf16_f32 v136, v136, v137
    v_cvt_pk_bf16_f32 v137, v138, v139
    v_cvt_pk_bf16_f32 v138, v140, v141
    v_cvt_pk_bf16_f32 v139, v142, v143
    s_add_u32 s41, s76, 98304
    buffer_store_dwordx4 v[136:139], v103, s[28:31], s41 offen sc1
    s_waitcnt vmcnt(3)
    v_lshlrev_b32 v3, 16, v188
    v_and_b32 v4, s40, v188
    v_add_f32 v168, v168, v3
    v_add_f32 v169, v169, v4
    v_lshlrev_b32 v3, 16, v189
    v_and_b32 v4, s40, v189
    v_add_f32 v170, v170, v3
    v_add_f32 v171, v171, v4
    v_lshlrev_b32 v3, 16, v190
    v_and_b32 v4, s40, v190
    v_add_f32 v172, v172, v3
    v_add_f32 v173, v173, v4
    v_lshlrev_b32 v3, 16, v191
    v_and_b32 v4, s40, v191
    v_add_f32 v174, v174, v3
    v_add_f32 v175, v175, v4
    s_waitcnt vmcnt(2)
    v_lshlrev_b32 v3, 16, v200
    v_and_b32 v4, s40, v200
    v_add_f32 v168, v168, v3
    v_add_f32 v169, v169, v4
    v_lshlrev_b32 v3, 16, v201
    v_and_b32 v4, s40, v201
    v_add_f32 v170, v170, v3
    v_add_f32 v171, v171, v4
    v_lshlrev_b32 v3, 16, v202
    v_and_b32 v4, s40, v202
    v_add_f32 v172, v172, v3
    v_add_f32 v173, v173, v4
    v_lshlrev_b32 v3, 16, v203
    v_and_b32 v4, s40, v203
    v_add_f32 v174, v174, v3
    v_add_f32 v175, v175, v4
    s_waitcnt vmcnt(1)
    v_lshlrev_b32 v3, 16, v212
    v_and_b32 v4, s40, v212
    v_add_f32 v168, v168, v3
    v_add_f32 v169, v169, v4
    v_lshlrev_b32 v3, 16, v213
    v_and_b32 v4, s40, v213
    v_add_f32 v170, v170, v3
    v_add_f32 v171, v171, v4
    v_lshlrev_b32 v3, 16, v214
    v_and_b32 v4, s40, v214
    v_add_f32 v172, v172, v3
    v_add_f32 v173, v173, v4
    v_lshlrev_b32 v3, 16, v215
    v_and_b32 v4, s40, v215
    v_add_f32 v174, v174, v3
    v_add_f32 v175, v175, v4
    v_cvt_pk_bf16_f32 v168, v168, v169
    v_cvt_pk_bf16_f32 v169, v170, v171
    v_cvt_pk_bf16_f32 v170, v172, v173
    v_cvt_pk_bf16_f32 v171, v174, v175
    s_add_u32 s41, s76, 229376
    buffer_store_dwordx4 v[168:171], v103, s[28:31], s41 offen sc1
    s_endpgm
L_done:
    s_endpgm
L_end:
.section .rodata,"a"
.p2align 6
.amdhsa_kernel concat_heads__mha_block_cached__gqa_block_cached__near_ridge_kernel
  .amdhsa_next_free_vgpr 512
  .amdhsa_next_free_sgpr 102
  .amdhsa_accum_offset 256
  .amdhsa_group_segment_fixed_size 0
  .amdhsa_kernarg_size 104
  .amdhsa_user_sgpr_count 2
  .amdhsa_user_sgpr_kernarg_segment_ptr 1
  .amdhsa_system_sgpr_workgroup_id_x 1
.end_amdhsa_kernel
```
